```python
import torch

def _softmax(x, axis=-1):
    return torch.softmax(x, dim=axis)

def _gelu(x):
    return torch.nn.functional.gelu(x, approximate='tanh')

def _silu(x):
    return torch.nn.functional.silu(x)

def _sigmoid(x):
    return torch.sigmoid(x)

def _layernorm(x, axis=-1, eps=1e-05):
    m = x.mean(dim=axis, keepdim=True)
    v = x.var(dim=axis, keepdim=True, unbiased=False)
    return (x - m) / torch.sqrt(v + eps)

def _scatter_add(tgt, idx, src, axis=0):
    return tgt.clone().index_add_(axis, idx, src)

def _segment_sum(src, seg, n):
    out = torch.zeros((n,) + src.shape[1:], dtype=src.dtype)
    return out.index_add_(0, seg, src)

def _pad(x, pw):
    flat = tuple((v for pair in reversed(pw) for v in pair))
    return torch.nn.functional.pad(x, flat)
kernel_name = 'adaLN_cond__sliding_block_cached__swiglu_ffn__prompt'

def setup_inputs():

    _w = lambda a: (lambda t: t.to(torch.bfloat16) if t.is_floating_point() else t)(torch.as_tensor(a))

    def _A_setup():
        B, Sq, D = (1, 2048, 640)
        Hq, Hkv, Sk, Dh = (32, 32, 2048, 128)
        assert Hq % Hkv == 0, (Hq, Hkv)
        return {'x': _w((lambda *s: torch.randn(*s, dtype=torch.bfloat16) * 0.05)(B, Sq, D)), 'k_cache': _w((lambda *s: torch.randn(*s, dtype=torch.bfloat16) * 3.2)(B, Hkv, Sk, Dh)), 'v_cache': _w((lambda *s: torch.randn(*s, dtype=torch.bfloat16) * 0.4)(B, Hkv, Sk, Dh)), 'wq': _w((lambda *s: torch.randn(*s, dtype=torch.bfloat16) * 3.2)(D, Hq * Dh) * D ** (-0.5)), 'wo': _w((lambda *s: torch.randn(*s, dtype=torch.bfloat16) * 0.4)(Hq * Dh, D) * (Hq * Dh) ** (-0.5))}
    _A_in = _A_setup()

    def _B_setup():
        B, S, D, F = (1, 2048, 640, 1728)
        return {'x': _w((lambda *s: torch.randn(*s, dtype=torch.bfloat16) * 0.05)(B, S, D)), 'w_gate': _w((lambda *s: torch.randn(*s, dtype=torch.bfloat16) * 0.05)(D, F)), 'w_up': _w((lambda *s: torch.randn(*s, dtype=torch.bfloat16) * 0.05)(D, F)), 'w_down': _w((lambda *s: torch.randn(*s, dtype=torch.bfloat16) * 0.05)(F, D))}
    _B_in = _B_setup()
    return {'A_x': _A_in['x'], 'A_k_cache': _A_in['k_cache'], 'A_v_cache': _A_in['v_cache'], 'A_wq': _A_in['wq'], 'A_wo': _A_in['wo'], 'B_x': _B_in['x'], 'B_w_gate': _B_in['w_gate'], 'B_w_up': _B_in['w_up'], 'B_w_down': _B_in['w_down'], 'c': _w((lambda *s: torch.randn(*s, dtype=torch.bfloat16) * 0.1)(1, 640) * 8.0), 'w_mod': _w((lambda *s: torch.randn(*s, dtype=torch.bfloat16) * 0.1)(640, 6 * 640) * 640 ** (-0.5) * 8.0)}

def reference(A_x, A_k_cache, A_v_cache, A_wq, A_wo, B_x, B_w_gate, B_w_up, B_w_down, c, w_mod):

    def _A_ref(x, k_cache, v_cache, wq, wo):
        B, Sq, D = x.shape
        Hq, Dh = (32, 128)
        Hkv, Sk = (k_cache.shape[1], k_cache.shape[2])
        W = min(4096, max(256, Sk // 4))
        rep = Hq // Hkv
        q = (lambda x, *d: x.permute(*d))((x @ wq).reshape(B, Sq, Hq, Dh), 0, 2, 1, 3)
        k = (lambda x, n, axis: torch.repeat_interleave(x, n, dim=axis))(k_cache[:, :, Sk - W:, :], rep, axis=1)
        v = (lambda x, n, axis: torch.repeat_interleave(x, n, dim=axis))(v_cache[:, :, Sk - W:, :], rep, axis=1)
        scores = torch.einsum('bhqd,bhkd->bhqk', q, k) * Dh ** (-0.5)
        p = _softmax(scores, axis=-1)
        o = torch.einsum('bhqk,bhkd->bhqd', p, v)
        return (lambda x, *d: x.permute(*d))(o, 0, 2, 1, 3).reshape(B, Sq, Hq * Dh) @ wo

    def _B_ref(x, w_gate, w_up, w_down):
        g = _silu(x @ w_gate)
        u = x @ w_up
        return g * u @ w_down
    x = A_x
    mod = (_silu(c) @ w_mod).reshape(c.shape[0], 6, 1, -1)
    sa, ca, ga, sb, cb, gb = (mod[:, 0].clone(), mod[:, 1].clone(), mod[:, 2].clone(), mod[:, 3].clone(), mod[:, 4].clone(), mod[:, 5].clone())
    h = _layernorm(x, axis=-1) * (1 + ca) + sa
    x = x + ga * _A_ref(h, A_k_cache, A_v_cache, A_wq, A_wo)
    h = _layernorm(x, axis=-1) * (1 + cb) + sb
    x = x + gb * _B_ref(h, B_w_gate, B_w_up, B_w_down)
    return x
```

```asm
; @launch grid=(256,1,1) block=(512,1,1) lds=163840
.amdgcn_target "amdgcn-amd-amdhsa--gfx950"
.text
.globl adaLN_cond__sliding_block_cached__swiglu_ffn__prompt_kernel
.p2align 8
.type adaLN_cond__sliding_block_cached__swiglu_ffn__prompt_kernel,@function
adaLN_cond__sliding_block_cached__swiglu_ffn__prompt_kernel:
    s_cmp_ge_u32 s2, 256
    s_cbranch_scc1 L_done
    s_load_dwordx4 s[4:7], s[0:1], 8
    s_load_dwordx2 s[8:9], s[0:1], 24
    s_load_dwordx4 s[56:59], s[0:1], 96
    s_load_dwordx4 s[60:63], s[0:1], 72
    s_load_dwordx2 s[64:65], s[0:1], 0
    s_load_dwordx2 s[84:85], s[0:1], 32
    s_load_dwordx2 s[86:87], s[0:1], 64
    s_load_dwordx4 s[88:91], s[0:1], 72
    v_and_b32 v1, 63, v0
    v_lshrrev_b32 v198, 6, v0
    s_nop 0
    v_readfirstlane_b32 s93, v198
    s_nop 0
    s_cmp_ge_u32 s93, 2
    s_cbranch_scc1 L_adaLN_cond__sliding_block_cached__swiglu_ffn__prompt_kernel_1
    v_and_b32 v52, 3, v1
    v_lshrrev_b32 v53, 2, v1
    s_lshl_b32 s3, s2, 1
    s_add_u32 s3, s3, s93
    s_lshl_b32 s3, s3, 2
    v_add_u32 v54, s3, v52
    v_mul_u32_u24 v55, 1280, v54
    v_lshl_add_u32 v55, v53, 4, v55
    s_waitcnt lgkmcnt(0)
    s_mov_b32 s68, s64
    s_mov_b32 s69, s65
    s_mov_b32 s70, 0x280000
    s_mov_b32 s71, 0x20000
    buffer_load_dwordx4 v[60:63], v55, s[68:71], 0 offen offset:0
    buffer_load_dwordx4 v[64:67], v55, s[68:71], 0 offen offset:256
    buffer_load_dwordx4 v[68:71], v55, s[68:71], 0 offen offset:512
    buffer_load_dwordx4 v[72:75], v55, s[68:71], 0 offen offset:768
    buffer_load_dwordx4 v[76:79], v55, s[68:71], 0 offen offset:1024
    s_add_u32 s72, s58, 0x100000
    s_addc_u32 s73, s59, 0
    s_mov_b32 s74, 0x280000
    s_mov_b32 s75, 0x20000
    v_lshrrev_b32 v56, 4, v54
    v_mul_u32_u24 v56, 20, v56
    v_lshrrev_b32 v57, 2, v53
    v_add_lshl_u32 v56, v56, v57, 10
    v_and_b32 v57, 3, v53
    v_lshl_add_u32 v56, v57, 8, v56
    v_and_b32 v57, 15, v54
    v_lshl_add_u32 v56, v57, 4, v56
    s_branch L_adaLN_cond__sliding_block_cached__swiglu_ffn__prompt_kernel_2
L_adaLN_cond__sliding_block_cached__swiglu_ffn__prompt_kernel_1:
    s_lshr_b32 s66, s2, 2
    s_and_b32 s3, s2, 3
    s_mul_i32 s3, s3, 160
    v_subrev_u32 v52, 128, v0
    v_and_b32 v53, 7, v52
    v_lshrrev_b32 v54, 3, v52
    v_add_u32 v56, s3, v54
    v_mul_u32_u24 v55, 7680, v56
    v_lshl_add_u32 v55, v53, 4, v55
    s_lshl_b32 s67, s66, 7
    v_add_u32 v55, s67, v55
    v_lshlrev_b32 v56, 1, v56
    s_waitcnt lgkmcnt(0)
    s_mov_b32 s72, s62
    s_mov_b32 s73, s63
    s_mov_b32 s74, 0x4b0000
    s_mov_b32 s75, 0x20000
    s_cmp_lt_u32 s2, 80
    s_cselect_b32 s74, s74, 0
    s_mov_b32 s68, s60
    s_mov_b32 s69, s61
    s_mov_b32 s70, 0x500
    s_mov_b32 s71, 0x20000
    s_mov_b32 s67, 0x0
    buffer_load_dwordx4 v[60:63], v55, s[72:75], s67 offen
    s_mov_b32 s67, 0x5a000
    buffer_load_dwordx4 v[64:67], v55, s[72:75], s67 offen
    s_mov_b32 s67, 0xb4000
    buffer_load_dwordx4 v[68:71], v55, s[72:75], s67 offen
    s_mov_b32 s67, 0x10e000
    buffer_load_dwordx4 v[72:75], v55, s[72:75], s67 offen
    buffer_load_ushort v88, v56, s[68:71], 0 offen offset:0
    buffer_load_ushort v89, v56, s[68:71], 0 offen offset:96
    buffer_load_ushort v90, v56, s[68:71], 0 offen offset:192
    buffer_load_ushort v91, v56, s[68:71], 0 offen offset:288
L_adaLN_cond__sliding_block_cached__swiglu_ffn__prompt_kernel_2:
    s_add_u32 s76, s58, 0xc0000
    s_addc_u32 s77, s59, 0
    s_mov_b32 s79, 0x20000
    s_cmp_lt_u32 s2, 80
    s_cselect_b32 s78, 0x5000, 0
    s_mov_b32 s94, s58
    s_mov_b32 s95, s59
    s_mov_b32 s96, s56
    s_mov_b32 s97, s57
    s_mov_b32 s58, 256
    s_mov_b32 s59, 0x20000
    s_mov_b32 s98, 0
    s_or_b32 s3, s2, s93
    s_cmp_lg_u32 s3, 0
    s_cbranch_scc1 L_adaLN_cond__sliding_block_cached__swiglu_ffn__prompt_kernel_3
    s_memrealtime s[100:101]
    v_mov_b32 v199, 0
    s_waitcnt lgkmcnt(0)
    s_or_b32 s3, s100, 1
    v_mov_b32 v198, s3
    s_mov_b64 exec, 1
    buffer_store_dword v198, v199, s[56:59], 0 offen sc1
    s_mov_b64 exec, -1
L_adaLN_cond__sliding_block_cached__swiglu_ffn__prompt_kernel_3:
    s_and_b32 s40, s2, 7
    s_lshr_b32 s41, s2, 3
    s_and_b32 s42, s41, 3
    s_lshl_b32 s37, s40, 2
    s_add_u32 s37, s37, s42
    s_lshr_b32 s38, s41, 2
    v_and_b32 v196, 15, v1
    v_lshrrev_b32 v197, 4, v1
    v_lshlrev_b32 v8, 4, v1
    s_lshl_b32 s39, s93, 11
    s_lshl_b32 s40, s38, 3
    s_add_u32 s40, s40, s93
    s_mul_i32 s53, s40, 40960
    s_lshl_b32 s41, s93, 3
    v_add_u32 v199, s41, v197
    v_add_u32 v198, 0, v197
    v_lshlrev_b32 v198, 1, v198
    v_xor_b32 v198, v196, v198
    v_lshlrev_b32 v198, 4, v198
    v_lshl_add_u32 v6, v199, 8, v198
    v_add_u32 v198, 4, v197
    v_lshlrev_b32 v198, 1, v198
    v_xor_b32 v198, v196, v198
    v_lshlrev_b32 v198, 4, v198
    v_lshl_add_u32 v7, v199, 8, v198
    v_add_u32 v198, 0, v199
    v_and_b32 v198, 15, v198
    v_xor_b32 v198, v196, v198
    v_lshlrev_b32 v198, 4, v198
    v_lshl_add_u32 v4, v199, 8, v198
    v_add_u32 v198, 4, v199
    v_and_b32 v198, 15, v198
    v_xor_b32 v198, v196, v198
    v_lshlrev_b32 v198, 4, v198
    v_lshl_add_u32 v5, v199, 8, v198
    s_and_b32 s41, s93, 1
    s_lshl_b32 s41, s41, 2
    v_add_u32 v198, s41, v197
    v_lshlrev_b32 v198, 1, v198
    v_xor_b32 v198, v196, v198
    v_lshlrev_b32 v198, 4, v198
    v_lshl_add_u32 v2, v199, 13, v198
    s_add_u32 s24, s94, 0x100000
    s_addc_u32 s25, s95, 0
    s_mov_b32 s26, 0x280000
    s_mov_b32 s27, 0x20000
    s_add_u32 s28, s94, 0xc0000
    s_addc_u32 s29, s95, 0
    s_mov_b32 s30, 0x5000
    s_mov_b32 s31, 0x20000
    s_mov_b32 s12, s8
    s_mov_b32 s13, s9
    s_mov_b32 s14, 0x500000
    s_mov_b32 s15, 0x20000
    s_lshl_b32 s51, s37, 8
    s_mov_b32 s16, s4
    s_mov_b32 s17, s5
    s_mov_b32 s18, 0x1000000
    s_mov_b32 s19, 0x20000
    s_mov_b32 s20, s6
    s_mov_b32 s21, s7
    s_mov_b32 s22, 0x1000000
    s_mov_b32 s23, 0x20000
    s_add_u32 s32, s94, 0x1400000
    s_addc_u32 s33, s95, 0
    s_mov_b32 s34, 0x1000000
    s_mov_b32 s35, 0x20000
    s_lshl_b32 s50, s37, 19
    s_add_u32 s50, s50, 0x60000
    s_mov_b32 s48, 0x3e0293ee
    s_mov_b32 s49, 0x5f800000
    v_bfe_u32 v198, v1, 2, 2
    v_lshl_add_u32 v200, v197, 2, v198
    v_and_b32 v201, 7, v200
    v_lshlrev_b32 v201, 5, v201
    v_lshl_add_u32 v201, v200, 8, v201
    v_and_b32 v199, 3, v1
    v_lshl_add_u32 v3, v199, 3, v201
    v_add_u32 v3, 65536, v3
    v_lshl_add_u32 v200, v197, 3, v198
    v_and_b32 v201, 1, v197
    v_lshl_add_u32 v201, v201, 2, v198
    v_lshlrev_b32 v201, 5, v201
    v_lshl_add_u32 v201, v200, 8, v201
    v_lshl_add_u32 v16, v199, 3, v201
    v_xor_b32 v17, 32, v16
    v_xor_b32 v18, 64, v16
    v_xor_b32 v19, 96, v16
    v_xor_b32 v20, 128, v16
    v_xor_b32 v21, 160, v16
    v_xor_b32 v22, 192, v16
    v_xor_b32 v23, 224, v16
    v_lshrrev_b32 v198, 1, v197
    v_xor_b32 v198, v196, v198
    v_lshlrev_b32 v198, 4, v198
    v_lshl_add_u32 v198, v196, 8, v198
    v_and_b32 v199, 1, v197
    v_lshl_add_u32 v24, v199, 3, v198
    v_xor_b32 v25, 32, v24
    v_xor_b32 v26, 64, v24
    v_xor_b32 v27, 96, v24
    v_xor_b32 v28, 128, v24
    v_xor_b32 v29, 160, v24
    v_xor_b32 v30, 192, v24
    v_xor_b32 v31, 224, v24
    v_lshlrev_b32 v9, 5, v197
    v_add_u32 v9, 0x24000, v9
    s_lshl_b32 s40, s38, 2
    s_lshr_b32 s41, s93, 1
    s_add_u32 s40, s40, s41
    s_lshl_b32 s54, s40, 19
    s_and_b32 s41, s93, 1
    s_lshl_b32 s41, s41, 11
    s_add_u32 s54, s54, s41
    s_lshl_b32 s41, s37, 14
    s_add_u32 s54, s54, s41
    s_cmp_ge_u32 s93, 2
    s_cbranch_scc1 L_adaLN_cond__sliding_block_cached__swiglu_ffn__prompt_kernel_4
    s_waitcnt vmcnt(4)
    v_lshlrev_b32 v80, 16, v60
    v_and_b32 v81, 0xffff0000, v60
    v_lshlrev_b32 v82, 16, v61
    v_and_b32 v83, 0xffff0000, v61
    v_lshlrev_b32 v84, 16, v62
    v_and_b32 v85, 0xffff0000, v62
    v_lshlrev_b32 v86, 16, v63
    v_and_b32 v87, 0xffff0000, v63
    s_waitcnt vmcnt(3)
    v_lshlrev_b32 v88, 16, v64
    v_and_b32 v89, 0xffff0000, v64
    v_lshlrev_b32 v90, 16, v65
    v_and_b32 v91, 0xffff0000, v65
    v_lshlrev_b32 v92, 16, v66
    v_and_b32 v93, 0xffff0000, v66
    v_lshlrev_b32 v94, 16, v67
    v_and_b32 v95, 0xffff0000, v67
    s_waitcnt vmcnt(2)
    v_lshlrev_b32 v96, 16, v68
    v_and_b32 v97, 0xffff0000, v68
    v_lshlrev_b32 v98, 16, v69
    v_and_b32 v99, 0xffff0000, v69
    v_lshlrev_b32 v100, 16, v70
    v_and_b32 v101, 0xffff0000, v70
    v_lshlrev_b32 v102, 16, v71
    v_and_b32 v103, 0xffff0000, v71
    s_waitcnt vmcnt(1)
    v_lshlrev_b32 v104, 16, v72
    v_and_b32 v105, 0xffff0000, v72
    v_lshlrev_b32 v106, 16, v73
    v_and_b32 v107, 0xffff0000, v73
    v_lshlrev_b32 v108, 16, v74
    v_and_b32 v109, 0xffff0000, v74
    v_lshlrev_b32 v110, 16, v75
    v_and_b32 v111, 0xffff0000, v75
    s_waitcnt vmcnt(0)
    v_lshlrev_b32 v112, 16, v76
    v_and_b32 v113, 0xffff0000, v76
    v_lshlrev_b32 v114, 16, v77
    v_and_b32 v115, 0xffff0000, v77
    v_lshlrev_b32 v116, 16, v78
    v_and_b32 v117, 0xffff0000, v78
    v_lshlrev_b32 v118, 16, v79
    v_and_b32 v119, 0xffff0000, v79
    v_pk_add_f32 v[58:59], v[80:81], v[82:83]
    v_pk_add_f32 v[58:59], v[58:59], v[84:85]
    v_pk_add_f32 v[58:59], v[58:59], v[86:87]
    v_pk_add_f32 v[58:59], v[58:59], v[88:89]
    v_pk_add_f32 v[58:59], v[58:59], v[90:91]
    v_pk_add_f32 v[58:59], v[58:59], v[92:93]
    v_pk_add_f32 v[58:59], v[58:59], v[94:95]
    v_pk_add_f32 v[58:59], v[58:59], v[96:97]
    v_pk_add_f32 v[58:59], v[58:59], v[98:99]
    v_pk_add_f32 v[58:59], v[58:59], v[100:101]
    v_pk_add_f32 v[58:59], v[58:59], v[102:103]
    v_pk_add_f32 v[58:59], v[58:59], v[104:105]
    v_pk_add_f32 v[58:59], v[58:59], v[106:107]
    v_pk_add_f32 v[58:59], v[58:59], v[108:109]
    v_pk_add_f32 v[58:59], v[58:59], v[110:111]
    v_pk_add_f32 v[58:59], v[58:59], v[112:113]
    v_pk_add_f32 v[58:59], v[58:59], v[114:115]
    v_pk_add_f32 v[58:59], v[58:59], v[116:117]
    v_pk_add_f32 v[58:59], v[58:59], v[118:119]
    v_add_f32 v58, v58, v59
    s_nop 1
    v_add_f32_dpp v58, v58, v58 row_ror:4 row_mask:0xf bank_mask:0xf
    s_nop 1
    v_add_f32_dpp v58, v58, v58 row_ror:8 row_mask:0xf bank_mask:0xf
    v_mov_b32 v59, v58
    s_nop 1
    v_permlane16_swap_b32 v58, v59
    v_add_f32 v58, v58, v59
    v_mov_b32 v59, v58
    s_nop 1
    v_permlane32_swap_b32 v58, v59
    v_add_f32 v58, v58, v59
    v_mul_f32 v58, 0xbacccccd, v58
    v_mov_b32 v59, v58
    s_add_u32 s68, s94, 0xd0000
    s_addc_u32 s69, s95, 0
    s_mov_b32 s70, 0x2000
    s_mov_b32 s71, 0x20000
    v_lshlrev_b32 v57, 2, v54
    s_mov_b64 exec, 15
    buffer_store_dword v58, v57, s[68:71], 0 offen sc1
    s_mov_b64 exec, -1
    v_pk_add_f32 v[80:81], v[80:81], v[58:59]
    v_pk_add_f32 v[82:83], v[82:83], v[58:59]
    v_pk_add_f32 v[84:85], v[84:85], v[58:59]
    v_pk_add_f32 v[86:87], v[86:87], v[58:59]
    v_pk_add_f32 v[88:89], v[88:89], v[58:59]
    v_pk_add_f32 v[90:91], v[90:91], v[58:59]
    v_pk_add_f32 v[92:93], v[92:93], v[58:59]
    v_pk_add_f32 v[94:95], v[94:95], v[58:59]
    v_pk_add_f32 v[96:97], v[96:97], v[58:59]
    v_pk_add_f32 v[98:99], v[98:99], v[58:59]
    v_pk_add_f32 v[100:101], v[100:101], v[58:59]
    v_pk_add_f32 v[102:103], v[102:103], v[58:59]
    v_pk_add_f32 v[104:105], v[104:105], v[58:59]
    v_pk_add_f32 v[106:107], v[106:107], v[58:59]
    v_pk_add_f32 v[108:109], v[108:109], v[58:59]
    v_pk_add_f32 v[110:111], v[110:111], v[58:59]
    v_pk_add_f32 v[112:113], v[112:113], v[58:59]
    v_pk_add_f32 v[114:115], v[114:115], v[58:59]
    v_pk_add_f32 v[116:117], v[116:117], v[58:59]
    v_pk_add_f32 v[118:119], v[118:119], v[58:59]
    v_pk_mul_f32 v[58:59], v[80:81], v[80:81]
    v_pk_fma_f32 v[58:59], v[82:83], v[82:83], v[58:59]
    v_pk_fma_f32 v[58:59], v[84:85], v[84:85], v[58:59]
    v_pk_fma_f32 v[58:59], v[86:87], v[86:87], v[58:59]
    v_pk_fma_f32 v[58:59], v[88:89], v[88:89], v[58:59]
    v_pk_fma_f32 v[58:59], v[90:91], v[90:91], v[58:59]
    v_pk_fma_f32 v[58:59], v[92:93], v[92:93], v[58:59]
    v_pk_fma_f32 v[58:59], v[94:95], v[94:95], v[58:59]
    v_pk_fma_f32 v[58:59], v[96:97], v[96:97], v[58:59]
    v_pk_fma_f32 v[58:59], v[98:99], v[98:99], v[58:59]
    v_pk_fma_f32 v[58:59], v[100:101], v[100:101], v[58:59]
    v_pk_fma_f32 v[58:59], v[102:103], v[102:103], v[58:59]
    v_pk_fma_f32 v[58:59], v[104:105], v[104:105], v[58:59]
    v_pk_fma_f32 v[58:59], v[106:107], v[106:107], v[58:59]
    v_pk_fma_f32 v[58:59], v[108:109], v[108:109], v[58:59]
    v_pk_fma_f32 v[58:59], v[110:111], v[110:111], v[58:59]
    v_pk_fma_f32 v[58:59], v[112:113], v[112:113], v[58:59]
    v_pk_fma_f32 v[58:59], v[114:115], v[114:115], v[58:59]
    v_pk_fma_f32 v[58:59], v[116:117], v[116:117], v[58:59]
    v_pk_fma_f32 v[58:59], v[118:119], v[118:119], v[58:59]
    v_add_f32 v58, v58, v59
    s_nop 1
    v_add_f32_dpp v58, v58, v58 row_ror:4 row_mask:0xf bank_mask:0xf
    s_nop 1
    v_add_f32_dpp v58, v58, v58 row_ror:8 row_mask:0xf bank_mask:0xf
    v_mov_b32 v59, v58
    s_nop 1
    v_permlane16_swap_b32 v58, v59
    v_add_f32 v58, v58, v59
    v_mov_b32 v59, v58
    s_nop 1
    v_permlane32_swap_b32 v58, v59
    v_add_f32 v58, v58, v59
    v_mov_b32 v59, 0x3727c5ac
    v_fmac_f32 v59, 0x3acccccd, v58
    v_rsq_f32 v59, v59
    s_nop 0
    v_mov_b32 v58, v59
    v_pk_mul_f32 v[80:81], v[80:81], v[58:59]
    v_pk_mul_f32 v[82:83], v[82:83], v[58:59]
    v_pk_mul_f32 v[84:85], v[84:85], v[58:59]
    v_pk_mul_f32 v[86:87], v[86:87], v[58:59]
    v_cvt_pk_f16_f32 v60, v80, v81
    v_cvt_pk_f16_f32 v61, v82, v83
    v_cvt_pk_f16_f32 v62, v84, v85
    v_cvt_pk_f16_f32 v63, v86, v87
    s_movk_i32 s3, 0
    buffer_store_dwordx4 v[60:63], v56, s[72:75], s3 offen sc1
    v_pk_mul_f32 v[88:89], v[88:89], v[58:59]
    v_pk_mul_f32 v[90:91], v[90:91], v[58:59]
    v_pk_mul_f32 v[92:93], v[92:93], v[58:59]
    v_pk_mul_f32 v[94:95], v[94:95], v[58:59]
    v_cvt_pk_f16_f32 v64, v88, v89
    v_cvt_pk_f16_f32 v65, v90, v91
    v_cvt_pk_f16_f32 v66, v92, v93
    v_cvt_pk_f16_f32 v67, v94, v95
    s_movk_i32 s3, 4096
    buffer_store_dwordx4 v[64:67], v56, s[72:75], s3 offen sc1
    v_pk_mul_f32 v[96:97], v[96:97], v[58:59]
    v_pk_mul_f32 v[98:99], v[98:99], v[58:59]
    v_pk_mul_f32 v[100:101], v[100:101], v[58:59]
    v_pk_mul_f32 v[102:103], v[102:103], v[58:59]
    v_cvt_pk_f16_f32 v68, v96, v97
    v_cvt_pk_f16_f32 v69, v98, v99
    v_cvt_pk_f16_f32 v70, v100, v101
    v_cvt_pk_f16_f32 v71, v102, v103
    s_movk_i32 s3, 8192
    buffer_store_dwordx4 v[68:71], v56, s[72:75], s3 offen sc1
    v_pk_mul_f32 v[104:105], v[104:105], v[58:59]
    v_pk_mul_f32 v[106:107], v[106:107], v[58:59]
    v_pk_mul_f32 v[108:109], v[108:109], v[58:59]
    v_pk_mul_f32 v[110:111], v[110:111], v[58:59]
    v_cvt_pk_f16_f32 v72, v104, v105
    v_cvt_pk_f16_f32 v73, v106, v107
    v_cvt_pk_f16_f32 v74, v108, v109
    v_cvt_pk_f16_f32 v75, v110, v111
    s_movk_i32 s3, 12288
    buffer_store_dwordx4 v[72:75], v56, s[72:75], s3 offen sc1
    v_pk_mul_f32 v[112:113], v[112:113], v[58:59]
    v_pk_mul_f32 v[114:115], v[114:115], v[58:59]
    v_pk_mul_f32 v[116:117], v[116:117], v[58:59]
    v_pk_mul_f32 v[118:119], v[118:119], v[58:59]
    v_cvt_pk_f16_f32 v76, v112, v113
    v_cvt_pk_f16_f32 v77, v114, v115
    v_cvt_pk_f16_f32 v78, v116, v117
    v_cvt_pk_f16_f32 v79, v118, v119
    s_movk_i32 s3, 16384
    buffer_store_dwordx4 v[76:79], v56, s[72:75], s3 offen sc1
    s_branch L_adaLN_cond__sliding_block_cached__swiglu_ffn__prompt_kernel_5
L_adaLN_cond__sliding_block_cached__swiglu_ffn__prompt_kernel_4:
    s_mov_b32 s67, 0xbfb8aa3b
    s_waitcnt vmcnt(3)
    v_lshlrev_b32 v88, 16, v88
    s_waitcnt vmcnt(2)
    v_lshlrev_b32 v89, 16, v89
    s_waitcnt vmcnt(1)
    v_lshlrev_b32 v90, 16, v90
    s_waitcnt vmcnt(0)
    v_lshlrev_b32 v91, 16, v91
    v_mul_f32 v96, s67, v88
    v_mul_f32 v97, s67, v89
    v_mul_f32 v98, s67, v90
    v_mul_f32 v99, s67, v91
    v_exp_f32 v96, v96
    v_exp_f32 v97, v97
    v_exp_f32 v98, v98
    v_exp_f32 v99, v99
    v_add_f32 v96, 1.0, v96
    v_add_f32 v97, 1.0, v97
    v_add_f32 v98, 1.0, v98
    v_add_f32 v99, 1.0, v99
    v_rcp_f32 v96, v96
    v_rcp_f32 v97, v97
    v_rcp_f32 v98, v98
    v_rcp_f32 v99, v99
    v_mul_f32 v88, v88, v96
    v_mul_f32 v89, v89, v97
    v_mul_f32 v90, v90, v98
    v_mul_f32 v91, v91, v99
    v_cvt_pk_bf16_f32 v88, v88, v88
    v_cvt_pk_bf16_f32 v89, v89, v89
    v_cvt_pk_bf16_f32 v90, v90, v90
    v_cvt_pk_bf16_f32 v91, v91, v91
    v_lshlrev_b32 v88, 16, v88
    v_lshlrev_b32 v89, 16, v89
    v_lshlrev_b32 v90, 16, v90
    v_lshlrev_b32 v91, 16, v91
    s_cmp_ge_u32 s2, 4
    s_cbranch_scc1 L_adaLN_cond__sliding_block_cached__swiglu_ffn__prompt_kernel_6
    s_add_u32 s68, s94, 0xd4000
    s_addc_u32 s69, s95, 0
    s_mov_b32 s70, 0x500
    s_mov_b32 s71, 0x20000
    v_cmp_eq_u32 vcc, 0, v53
    s_nop 0
    s_and_saveexec_b64 s[100:101], vcc
    buffer_store_short_d16_hi v88, v56, s[68:71], 0 offen offset:0 sc1
    buffer_store_short_d16_hi v89, v56, s[68:71], 0 offen offset:96 sc1
    buffer_store_short_d16_hi v90, v56, s[68:71], 0 offen offset:192 sc1
    v_cmp_gt_u32 vcc, 16, v54
    s_nop 0
    s_and_b64 exec, exec, vcc
    buffer_store_short_d16_hi v91, v56, s[68:71], 0 offen offset:288 sc1
    s_mov_b64 exec, -1
    s_waitcnt vmcnt(0)
L_adaLN_cond__sliding_block_cached__swiglu_ffn__prompt_kernel_6:
    v_cmp_gt_u32 vcc, 16, v54
    s_nop 1
    v_cndmask_b32 v91, 0, v91, vcc
    v_lshlrev_b32 v112, 16, v60
    v_and_b32 v113, 0xffff0000, v60
    v_lshlrev_b32 v114, 16, v61
    v_and_b32 v115, 0xffff0000, v61
    v_lshlrev_b32 v116, 16, v62
    v_and_b32 v117, 0xffff0000, v62
    v_lshlrev_b32 v118, 16, v63
    v_and_b32 v119, 0xffff0000, v63
    v_mul_f32 v104, v88, v112
    v_mul_f32 v105, v88, v113
    v_mul_f32 v106, v88, v114
    v_mul_f32 v107, v88, v115
    v_mul_f32 v108, v88, v116
    v_mul_f32 v109, v88, v117
    v_mul_f32 v110, v88, v118
    v_mul_f32 v111, v88, v119
    v_lshlrev_b32 v112, 16, v64
    v_and_b32 v113, 0xffff0000, v64
    v_lshlrev_b32 v114, 16, v65
    v_and_b32 v115, 0xffff0000, v65
    v_lshlrev_b32 v116, 16, v66
    v_and_b32 v117, 0xffff0000, v66
    v_lshlrev_b32 v118, 16, v67
    v_and_b32 v119, 0xffff0000, v67
    v_fmac_f32 v104, v89, v112
    v_fmac_f32 v105, v89, v113
    v_fmac_f32 v106, v89, v114
    v_fmac_f32 v107, v89, v115
    v_fmac_f32 v108, v89, v116
    v_fmac_f32 v109, v89, v117
    v_fmac_f32 v110, v89, v118
    v_fmac_f32 v111, v89, v119
    v_lshlrev_b32 v112, 16, v68
    v_and_b32 v113, 0xffff0000, v68
    v_lshlrev_b32 v114, 16, v69
    v_and_b32 v115, 0xffff0000, v69
    v_lshlrev_b32 v116, 16, v70
    v_and_b32 v117, 0xffff0000, v70
    v_lshlrev_b32 v118, 16, v71
    v_and_b32 v119, 0xffff0000, v71
    v_fmac_f32 v104, v90, v112
    v_fmac_f32 v105, v90, v113
    v_fmac_f32 v106, v90, v114
    v_fmac_f32 v107, v90, v115
    v_fmac_f32 v108, v90, v116
    v_fmac_f32 v109, v90, v117
    v_fmac_f32 v110, v90, v118
    v_fmac_f32 v111, v90, v119
    v_lshlrev_b32 v112, 16, v72
    v_and_b32 v113, 0xffff0000, v72
    v_lshlrev_b32 v114, 16, v73
    v_and_b32 v115, 0xffff0000, v73
    v_lshlrev_b32 v116, 16, v74
    v_and_b32 v117, 0xffff0000, v74
    v_lshlrev_b32 v118, 16, v75
    v_and_b32 v119, 0xffff0000, v75
    v_fmac_f32 v104, v91, v112
    v_fmac_f32 v105, v91, v113
    v_fmac_f32 v106, v91, v114
    v_fmac_f32 v107, v91, v115
    v_fmac_f32 v108, v91, v116
    v_fmac_f32 v109, v91, v117
    v_fmac_f32 v110, v91, v118
    v_fmac_f32 v111, v91, v119
    v_add_f32_dpp v104, v104, v104 row_ror:8 row_mask:0xf bank_mask:0xf
    v_add_f32_dpp v105, v105, v105 row_ror:8 row_mask:0xf bank_mask:0xf
    v_add_f32_dpp v106, v106, v106 row_ror:8 row_mask:0xf bank_mask:0xf
    v_add_f32_dpp v107, v107, v107 row_ror:8 row_mask:0xf bank_mask:0xf
    v_add_f32_dpp v108, v108, v108 row_ror:8 row_mask:0xf bank_mask:0xf
    v_add_f32_dpp v109, v109, v109 row_ror:8 row_mask:0xf bank_mask:0xf
    v_add_f32_dpp v110, v110, v110 row_ror:8 row_mask:0xf bank_mask:0xf
    v_add_f32_dpp v111, v111, v111 row_ror:8 row_mask:0xf bank_mask:0xf
    v_mov_b32 v112, v104
    v_mov_b32 v113, v105
    v_mov_b32 v114, v106
    v_mov_b32 v115, v107
    v_mov_b32 v116, v108
    v_mov_b32 v117, v109
    v_mov_b32 v118, v110
    v_mov_b32 v119, v111
    v_permlane16_swap_b32 v104, v112
    v_permlane16_swap_b32 v105, v113
    v_permlane16_swap_b32 v106, v114
    v_permlane16_swap_b32 v107, v115
    v_permlane16_swap_b32 v108, v116
    v_permlane16_swap_b32 v109, v117
    v_permlane16_swap_b32 v110, v118
    v_permlane16_swap_b32 v111, v119
    v_add_f32 v104, v104, v112
    v_add_f32 v105, v105, v113
    v_add_f32 v106, v106, v114
    v_add_f32 v107, v107, v115
    v_add_f32 v108, v108, v116
    v_add_f32 v109, v109, v117
    v_add_f32 v110, v110, v118
    v_add_f32 v111, v111, v119
    v_mov_b32 v112, v104
    v_mov_b32 v113, v105
    v_mov_b32 v114, v106
    v_mov_b32 v115, v107
    v_mov_b32 v116, v108
    v_mov_b32 v117, v109
    v_mov_b32 v118, v110
    v_mov_b32 v119, v111
    v_permlane32_swap_b32 v104, v112
    v_permlane32_swap_b32 v105, v113
    v_permlane32_swap_b32 v106, v114
    v_permlane32_swap_b32 v107, v115
    v_permlane32_swap_b32 v108, v116
    v_permlane32_swap_b32 v109, v117
    v_permlane32_swap_b32 v110, v118
    v_permlane32_swap_b32 v111, v119
    v_add_f32 v104, v104, v112
    v_add_f32 v105, v105, v113
    v_add_f32 v106, v106, v114
    v_add_f32 v107, v107, v115
    v_add_f32 v108, v108, v116
    v_add_f32 v109, v109, v117
    v_add_f32 v110, v110, v118
    v_add_f32 v111, v111, v119
    s_sub_u32 s3, s93, 2
    s_lshl_b32 s3, s3, 8
    s_add_u32 s3, s3, 0x25a00
    v_lshlrev_b32 v57, 5, v53
    v_add_u32 v57, s3, v57
    ds_write_b128 v57, v[104:107]
    ds_write_b128 v57, v[108:111] offset:16
    s_waitcnt lgkmcnt(0)
L_adaLN_cond__sliding_block_cached__swiglu_ffn__prompt_kernel_5:
    v_mov_b32 v200, 0
    buffer_load_dword v33, v200, s[56:59], 0 offen sc1
    s_barrier
    s_cmp_eq_u32 s93, 2
    s_cbranch_scc1 L_adaLN_cond__sliding_block_cached__swiglu_ffn__prompt_kernel_7
    s_cmp_ge_u32 s93, 2
    s_cbranch_scc1 L_adaLN_cond__sliding_block_cached__swiglu_ffn__prompt_kernel_9
    s_waitcnt vmcnt(0)
    v_cmp_eq_u32 vcc, 0, v33
    s_cbranch_vccnz L_adaLN_cond__sliding_block_cached__swiglu_ffn__prompt_kernel_11
L_adaLN_cond__sliding_block_cached__swiglu_ffn__prompt_kernel_10:
    v_readfirstlane_b32 s98, v33
    s_lshr_b32 s44, s2, 5
    s_and_b32 s46, s2, 31
    s_lshl_b32 s46, s46, 1
    s_add_u32 s46, s46, s93
    s_lshl_b32 s45, s44, 6
    s_add_u32 s45, s45, s46
    s_lshl_b32 s45, s45, 7
    s_add_u32 s45, s45, 0x0
    s_add_u32 s4, s94, 0x380000
    s_addc_u32 s5, s95, 0
    s_mov_b32 s6, 0x80000
    s_mov_b32 s7, 0x20000
    s_mov_b64 exec, 1
    v_mov_b32 v198, s98
    v_mov_b32 v199, 0
    buffer_store_dword v198, v199, s[4:7], s45 offen sc1
    s_mov_b64 exec, -1
    s_cmp_eq_u32 s93, 0
    s_cbranch_scc1 L_adaLN_cond__sliding_block_cached__swiglu_ffn__prompt_kernel_8
L_adaLN_cond__sliding_block_cached__swiglu_ffn__prompt_kernel_9:
    s_add_u32 s43, s51, 0x0
    s_add_u32 m0, s39, 0x0
    s_nop 0
    buffer_load_dwordx4 v2, s[12:15], s43 offen lds
    s_add_u32 s43, s51, 0x7c00
    s_add_u32 m0, s39, 0x0
    s_nop 0
    buffer_load_dwordx4 v2, s[12:15], s43 offen offset:1024 lds
    s_add_u32 s43, s51, 0x80000
    s_add_u32 m0, s39, 0x4000
    s_nop 0
    buffer_load_dwordx4 v2, s[12:15], s43 offen lds
    s_add_u32 s43, s51, 0x87c00
    s_add_u32 m0, s39, 0x4000
    s_nop 0
    buffer_load_dwordx4 v2, s[12:15], s43 offen offset:1024 lds
    s_add_u32 s43, s51, 0x100000
    s_add_u32 m0, s39, 0x8000
    s_nop 0
    buffer_load_dwordx4 v2, s[12:15], s43 offen lds
    s_add_u32 s43, s51, 0x107c00
    s_add_u32 m0, s39, 0x8000
    s_nop 0
    buffer_load_dwordx4 v2, s[12:15], s43 offen offset:1024 lds
    s_and_b32 s3, s93, 5
    s_cmp_lg_u32 s3, 4
    s_cbranch_scc1 L_adaLN_cond__sliding_block_cached__swiglu_ffn__prompt_kernel_8
    v_subrev_u32 v201, 0x40000, v2
    s_add_u32 s43, s51, 0x0
    s_add_u32 m0, s39, 0xffffe000
    s_nop 0
    buffer_load_dwordx4 v201, s[12:15], s43 offen lds
    s_add_u32 s43, s51, 0x7c00
    s_add_u32 m0, s39, 0xffffe000
    s_nop 0
    buffer_load_dwordx4 v201, s[12:15], s43 offen offset:1024 lds
    s_add_u32 s43, s51, 0x80000
    s_add_u32 m0, s39, 0x2000
    s_nop 0
    buffer_load_dwordx4 v201, s[12:15], s43 offen lds
    s_add_u32 s43, s51, 0x87c00
    s_add_u32 m0, s39, 0x2000
    s_nop 0
    buffer_load_dwordx4 v201, s[12:15], s43 offen offset:1024 lds
    s_add_u32 s43, s51, 0x100000
    s_add_u32 m0, s39, 0x6000
    s_nop 0
    buffer_load_dwordx4 v201, s[12:15], s43 offen lds
    s_add_u32 s43, s51, 0x107c00
    s_add_u32 m0, s39, 0x6000
    s_nop 0
    buffer_load_dwordx4 v201, s[12:15], s43 offen offset:1024 lds
    s_branch L_adaLN_cond__sliding_block_cached__swiglu_ffn__prompt_kernel_8
L_adaLN_cond__sliding_block_cached__swiglu_ffn__prompt_kernel_7:
    v_lshlrev_b32 v56, 2, v1
    v_add_u32 v57, 0x25a00, v56
    ds_read_b32 v112, v57 offset:0
    ds_read_b32 v113, v57 offset:256
    ds_read_b32 v114, v57 offset:512
    ds_read_b32 v115, v57 offset:768
    ds_read_b32 v116, v57 offset:1024
    ds_read_b32 v117, v57 offset:1280
    s_waitcnt lgkmcnt(4)
    v_add_f32 v112, v112, v113
    s_waitcnt lgkmcnt(2)
    v_add_f32 v114, v114, v115
    s_waitcnt lgkmcnt(0)
    v_add_f32 v116, v116, v117
    v_add_f32 v112, v112, v114
    v_add_f32 v112, v112, v116
    s_and_b32 s3, s2, 3
    s_mul_i32 s3, s3, 5120
    s_lshl_b32 s67, s66, 8
    s_add_u32 s3, s3, s67
    buffer_store_dword v112, v56, s[76:79], s3 offen sc1
    s_waitcnt vmcnt(1)
    v_cmp_eq_u32 vcc, 0, v33
    s_cbranch_vccnz L_adaLN_cond__sliding_block_cached__swiglu_ffn__prompt_kernel_15
L_adaLN_cond__sliding_block_cached__swiglu_ffn__prompt_kernel_14:
    v_readfirstlane_b32 s98, v33
    s_waitcnt vmcnt(0)
    s_mov_b32 s44, 0
    s_lshl_b32 s45, s44, 6
    s_add_u32 s45, s45, s2
    s_lshl_b32 s45, s45, 7
    s_add_u32 s45, s45, 0x10000
    s_cmp_lt_u32 s2, 80
    s_cselect_b32 s45, s45, 0x7fff0000
    s_add_u32 s4, s94, 0x380000
    s_addc_u32 s5, s95, 0
    s_mov_b32 s6, 0x80000
    s_mov_b32 s7, 0x20000
    s_mov_b64 exec, 1
    v_mov_b32 v198, s98
    v_mov_b32 v199, 0
    buffer_store_dword v198, v199, s[4:7], s45 offen sc1
    s_mov_b64 exec, -1
L_adaLN_cond__sliding_block_cached__swiglu_ffn__prompt_kernel_8:
    s_cmp_lg_u32 s93, 0
    s_cbranch_scc1 L_adaLN_cond__sliding_block_cached__swiglu_ffn__prompt_kernel_18
    v_lshlrev_b32 v200, 7, v1
    s_lshl_b32 s45, s38, 13
    v_add_u32 v196, s45, v200
    v_add_u32 v200, 0x10000, v200
    v_and_b32 v201, 15, v1
    v_lshlrev_b32 v201, 7, v201
    v_add_u32 v201, 0x12000, v201
    s_add_u32 s4, s94, 0x380000
    s_addc_u32 s5, s95, 0
    s_mov_b32 s6, 0x80000
    s_mov_b32 s7, 0x20000
    s_mov_b32 s3, 60000
L_adaLN_cond__sliding_block_cached__swiglu_ffn__prompt_kernel_20:
    buffer_load_dword v198, v200, s[4:7], 0 offen sc1
    buffer_load_dword v199, v201, s[4:7], 0 offen sc1
    buffer_load_dword v197, v196, s[4:7], 0 offen sc1
    s_waitcnt vmcnt(2)
    v_cmp_ne_u32 vcc, s98, v198
    s_nop 0
    s_mov_b64 s[100:101], vcc
    s_waitcnt vmcnt(1)
    v_cmp_ne_u32 vcc, s98, v199
    s_nop 0
    s_or_b64 s[100:101], s[100:101], vcc
    s_waitcnt vmcnt(0)
    v_cmp_ne_u32 vcc, s98, v197
    s_nop 0
    s_or_b64 s[100:101], s[100:101], vcc
    s_mov_b64 vcc, s[100:101]
    s_cbranch_vccz L_adaLN_cond__sliding_block_cached__swiglu_ffn__prompt_kernel_19
    s_sleep 1
    s_sub_u32 s3, s3, 1
    s_cmp_lg_u32 s3, 0
    s_cbranch_scc1 L_adaLN_cond__sliding_block_cached__swiglu_ffn__prompt_kernel_20
L_adaLN_cond__sliding_block_cached__swiglu_ffn__prompt_kernel_19:
L_adaLN_cond__sliding_block_cached__swiglu_ffn__prompt_kernel_18:
    s_barrier
    s_cmp_ge_u32 s93, 5
    s_cbranch_scc1 L_adaLN_cond__sliding_block_cached__swiglu_ffn__prompt_kernel_21
    v_lshlrev_b32 v198, 4, v0
    s_movk_i32 s3, 0
    buffer_load_dwordx4 v[204:207], v198, s[28:31], s3 offen sc1
    s_movk_i32 s3, 5120
    buffer_load_dwordx4 v[208:211], v198, s[28:31], s3 offen sc1
    s_movk_i32 s3, 10240
    buffer_load_dwordx4 v[212:215], v198, s[28:31], s3 offen sc1
    s_movk_i32 s3, 15360
    buffer_load_dwordx4 v[216:219], v198, s[28:31], s3 offen sc1
L_adaLN_cond__sliding_block_cached__swiglu_ffn__prompt_kernel_21:
    s_load_dwordx4 s[28:31], s[0:1], 48
    s_add_u32 s52, s53, 0x0
    buffer_load_dwordx4 v[52:55], v8, s[24:27], s52 offen sc1
    s_add_u32 s52, s53, 0x5000
    buffer_load_dwordx4 v[56:59], v8, s[24:27], s52 offen sc1
    s_add_u32 s52, s53, 0x400
    buffer_load_dwordx4 v[60:63], v8, s[24:27], s52 offen sc1
    s_add_u32 s52, s53, 0x5400
    buffer_load_dwordx4 v[64:67], v8, s[24:27], s52 offen sc1
    s_waitcnt lgkmcnt(0)
    s_cmp_ge_u32 s93, 5
    s_cbranch_scc1 L_adaLN_cond__sliding_block_cached__swiglu_ffn__prompt_kernel_22
    v_cmp_lt_u32 vcc, 159, v0
    v_subrev_u32 v199, 160, v0
    s_nop 0
    v_cndmask_b32 v199, v0, v199, vcc
    v_cndmask_b32 v200, 0, 1.0, vcc
    v_cndmask_b32 v201, 16, 0, vcc
    v_lshrrev_b32 v198, 1, v199
    v_lshl_add_u32 v201, v198, 5, v201
    v_and_b32 v198, 1, v199
    v_lshl_add_u32 v201, v198, 3, v201
    v_add_u32 v201, 0x24000, v201
    s_waitcnt vmcnt(6)
    v_pk_add_f32 v[204:205], v[204:205], v[208:209]
    s_waitcnt vmcnt(4)
    v_pk_add_f32 v[212:213], v[212:213], v[216:217]
    v_pk_add_f32 v[204:205], v[204:205], v[212:213]
    v_pk_add_f32 v[206:207], v[206:207], v[210:211]
    v_pk_add_f32 v[214:215], v[214:215], v[218:219]
    v_pk_add_f32 v[206:207], v[206:207], v[214:215]
    v_cvt_pk_bf16_f32 v208, v204, v205
    v_lshlrev_b32 v204, 16, v208
    v_and_b32 v205, 0xffff0000, v208
    v_cvt_pk_bf16_f32 v210, v206, v207
    v_lshlrev_b32 v206, 16, v210
    v_and_b32 v207, 0xffff0000, v210
    v_add_f32 v204, v204, v200
    v_add_f32 v205, v205, v200
    v_add_f32 v206, v206, v200
    v_add_f32 v207, v207, v200
    v_cvt_pk_bf16_f32 v208, v204, v205
    v_lshlrev_b32 v204, 16, v208
    v_and_b32 v205, 0xffff0000, v208
    v_cvt_pk_bf16_f32 v210, v206, v207
    v_lshlrev_b32 v206, 16, v210
    v_and_b32 v207, 0xffff0000, v210
    v_cvt_pk_f16_f32 v208, v204, v205
    v_cvt_pk_f16_f32 v209, v206, v207
    ds_write_b64 v201, v[208:209]
    s_waitcnt lgkmcnt(0)
L_adaLN_cond__sliding_block_cached__swiglu_ffn__prompt_kernel_22:
    s_waitcnt vmcnt(8)
    s_barrier
    ds_read_b128 v[228:231], v9 offset:0
    ds_read_b128 v[232:235], v9 offset:16
    ds_read_b64_tr_b16 v[196:197], v16 offset:0
    ds_read_b64_tr_b16 v[198:199], v16 offset:1024
    ds_read_b64_tr_b16 v[200:201], v17 offset:0
    ds_read_b64_tr_b16 v[202:203], v17 offset:1024
    ds_read_b64_tr_b16 v[204:205], v18 offset:0
    ds_read_b64_tr_b16 v[206:207], v18 offset:1024
    ds_read_b64_tr_b16 v[208:209], v19 offset:0
    ds_read_b64_tr_b16 v[210:211], v19 offset:1024
    ds_read_b64_tr_b16 v[212:213], v20 offset:0
    ds_read_b64_tr_b16 v[214:215], v20 offset:1024
    ds_read_b64_tr_b16 v[216:217], v21 offset:0
    ds_read_b64_tr_b16 v[218:219], v21 offset:1024
    s_add_u32 s52, s53, 0x800
    buffer_load_dwordx4 v[68:71], v8, s[24:27], s52 offen sc1
    s_add_u32 s52, s53, 0x5800
    buffer_load_dwordx4 v[72:75], v8, s[24:27], s52 offen sc1
    s_add_u32 s52, s53, 0xc00
    buffer_load_dwordx4 v[76:79], v8, s[24:27], s52 offen sc1
    s_add_u32 s52, s53, 0x5c00
    buffer_load_dwordx4 v[80:83], v8, s[24:27], s52 offen sc1
    s_waitcnt vmcnt(7) lgkmcnt(12)
    v_fma_mix_f32 v244, v52, v228, v232 op_sel:[0,0,0] op_sel_hi:[1,1,1]
    v_fma_mix_f32 v245, v52, v228, v232 op_sel:[1,1,1] op_sel_hi:[1,1,1]
    v_fma_mix_f32 v246, v53, v229, v233 op_sel:[0,0,0] op_sel_hi:[1,1,1]
    v_fma_mix_f32 v247, v53, v229, v233 op_sel:[1,1,1] op_sel_hi:[1,1,1]
    v_fma_mix_f32 v248, v54, v230, v234 op_sel:[0,0,0] op_sel_hi:[1,1,1]
    v_fma_mix_f32 v249, v54, v230, v234 op_sel:[1,1,1] op_sel_hi:[1,1,1]
    v_fma_mix_f32 v250, v55, v231, v235 op_sel:[0,0,0] op_sel_hi:[1,1,1]
    v_fma_mix_f32 v251, v55, v231, v235 op_sel:[1,1,1] op_sel_hi:[1,1,1]
    v_cvt_pk_bf16_f32 v116, v244, v245
    v_cvt_pk_bf16_f32 v117, v246, v247
    v_cvt_pk_bf16_f32 v118, v248, v249
    v_cvt_pk_bf16_f32 v119, v250, v251
    s_waitcnt vmcnt(6)
    v_fma_mix_f32 v244, v56, v228, v232 op_sel:[0,0,0] op_sel_hi:[1,1,1]
    v_fma_mix_f32 v245, v56, v228, v232 op_sel:[1,1,1] op_sel_hi:[1,1,1]
    v_fma_mix_f32 v246, v57, v229, v233 op_sel:[0,0,0] op_sel_hi:[1,1,1]
    v_fma_mix_f32 v247, v57, v229, v233 op_sel:[1,1,1] op_sel_hi:[1,1,1]
    v_fma_mix_f32 v248, v58, v230, v234 op_sel:[0,0,0] op_sel_hi:[1,1,1]
    v_fma_mix_f32 v249, v58, v230, v234 op_sel:[1,1,1] op_sel_hi:[1,1,1]
    v_fma_mix_f32 v250, v59, v231, v235 op_sel:[0,0,0] op_sel_hi:[1,1,1]
    v_fma_mix_f32 v251, v59, v231, v235 op_sel:[1,1,1] op_sel_hi:[1,1,1]
    v_cvt_pk_bf16_f32 v120, v244, v245
    v_cvt_pk_bf16_f32 v121, v246, v247
    v_cvt_pk_bf16_f32 v122, v248, v249
    v_cvt_pk_bf16_f32 v123, v250, v251
    ds_read_b128 v[236:239], v9 offset:128
    ds_read_b128 v[240:243], v9 offset:144
    s_waitcnt lgkmcnt(12)
    v_mfma_f32_16x16x32_bf16 v[132:135], v[196:199], v[116:119], 0
    ds_read_b64_tr_b16 v[220:221], v22 offset:0
    ds_read_b64_tr_b16 v[222:223], v22 offset:1024
    s_add_u32 s52, s53, 0x1000
    buffer_load_dwordx4 v[84:87], v8, s[24:27], s52 offen sc1
    v_mfma_f32_16x16x32_bf16 v[136:139], v[196:199], v[120:123], 0
    s_add_u32 s52, s53, 0x6000
    buffer_load_dwordx4 v[88:91], v8, s[24:27], s52 offen sc1
    s_waitcnt lgkmcnt(12)
    v_mfma_f32_16x16x32_bf16 v[140:143], v[200:203], v[116:119], 0
    ds_read_b64_tr_b16 v[224:225], v23 offset:0
    ds_read_b64_tr_b16 v[226:227], v23 offset:1024
    s_add_u32 s52, s53, 0x1400
    buffer_load_dwordx4 v[92:95], v8, s[24:27], s52 offen sc1
    s_waitcnt vmcnt(8) lgkmcnt(4)
    v_fma_mix_f32 v244, v60, v236, v240 op_sel:[0,0,0] op_sel_hi:[1,1,1]
    v_fma_mix_f32 v245, v60, v236, v240 op_sel:[1,1,1] op_sel_hi:[1,1,1]
    s_add_u32 s43, s51, 0x180000
    s_add_u32 m0, s39, 0xc000
    s_nop 0
    buffer_load_dwordx4 v2, s[12:15], s43 offen lds
    v_mfma_f32_16x16x32_bf16 v[144:147], v[200:203], v[120:123], 0
    s_add_u32 s52, s53, 0x6400
    buffer_load_dwordx4 v[96:99], v8, s[24:27], s52 offen sc1
    v_fma_mix_f32 v246, v61, v237, v241 op_sel:[0,0,0] op_sel_hi:[1,1,1]
    v_fma_mix_f32 v247, v61, v237, v241 op_sel:[1,1,1] op_sel_hi:[1,1,1]
    v_mfma_f32_16x16x32_bf16 v[148:151], v[204:207], v[116:119], 0
    ds_read_b64_tr_b16 v[196:197], v16 offset:8192
    ds_read_b64_tr_b16 v[198:199], v16 offset:9216
    v_fma_mix_f32 v248, v62, v238, v242 op_sel:[0,0,0] op_sel_hi:[1,1,1]
    v_fma_mix_f32 v249, v62, v238, v242 op_sel:[1,1,1] op_sel_hi:[1,1,1]
    v_mfma_f32_16x16x32_bf16 v[152:155], v[204:207], v[120:123], 0
    v_fma_mix_f32 v250, v63, v239, v243 op_sel:[0,0,0] op_sel_hi:[1,1,1]
    v_fma_mix_f32 v251, v63, v239, v243 op_sel:[1,1,1] op_sel_hi:[1,1,1]
    v_mfma_f32_16x16x32_bf16 v[156:159], v[208:211], v[116:119], 0
    ds_read_b64_tr_b16 v[200:201], v17 offset:8192
    ds_read_b64_tr_b16 v[202:203], v17 offset:9216
    v_cvt_pk_bf16_f32 v124, v244, v245
    v_cvt_pk_bf16_f32 v125, v246, v247
    s_add_u32 s52, s53, 0x1800
    buffer_load_dwordx4 v[100:103], v8, s[24:27], s52 offen sc1
    v_mfma_f32_16x16x32_bf16 v[160:163], v[208:211], v[120:123], 0
    v_cvt_pk_bf16_f32 v126, v248, v249
    v_cvt_pk_bf16_f32 v127, v250, v251
    v_mfma_f32_16x16x32_bf16 v[164:167], v[212:215], v[116:119], 0
    ds_read_b64_tr_b16 v[204:205], v18 offset:8192
    ds_read_b64_tr_b16 v[206:207], v18 offset:9216
    s_waitcnt vmcnt(10)
    v_fma_mix_f32 v244, v64, v236, v240 op_sel:[0,0,0] op_sel_hi:[1,1,1]
    ds_read_b128 v[228:231], v9 offset:256
    ds_read_b128 v[232:235], v9 offset:272
    v_mfma_f32_16x16x32_bf16 v[168:171], v[212:215], v[120:123], 0
    v_fma_mix_f32 v245, v64, v236, v240 op_sel:[1,1,1] op_sel_hi:[1,1,1]
    v_fma_mix_f32 v246, v65, v237, v241 op_sel:[0,0,0] op_sel_hi:[1,1,1]
    v_mfma_f32_16x16x32_bf16 v[172:175], v[216:219], v[116:119], 0
    ds_read_b64_tr_b16 v[208:209], v19 offset:8192
    ds_read_b64_tr_b16 v[210:211], v19 offset:9216
    v_fma_mix_f32 v247, v65, v237, v241 op_sel:[1,1,1] op_sel_hi:[1,1,1]
    v_fma_mix_f32 v248, v66, v238, v242 op_sel:[0,0,0] op_sel_hi:[1,1,1]
    v_mfma_f32_16x16x32_bf16 v[176:179], v[216:219], v[120:123], 0
    v_fma_mix_f32 v249, v66, v238, v242 op_sel:[1,1,1] op_sel_hi:[1,1,1]
    v_fma_mix_f32 v250, v67, v239, v243 op_sel:[0,0,0] op_sel_hi:[1,1,1]
    s_waitcnt lgkmcnt(12)
    v_mfma_f32_16x16x32_bf16 v[180:183], v[220:223], v[116:119], 0
    ds_read_b64_tr_b16 v[212:213], v20 offset:8192
    ds_read_b64_tr_b16 v[214:215], v20 offset:9216
    v_fma_mix_f32 v251, v67, v239, v243 op_sel:[1,1,1] op_sel_hi:[1,1,1]
    v_cvt_pk_bf16_f32 v128, v244, v245
    s_add_u32 s52, s53, 0x6800
    buffer_load_dwordx4 v[104:107], v8, s[24:27], s52 offen sc1
    v_mfma_f32_16x16x32_bf16 v[184:187], v[220:223], v[120:123], 0
    v_cvt_pk_bf16_f32 v129, v246, v247
    v_cvt_pk_bf16_f32 v130, v248, v249
    s_waitcnt lgkmcnt(12)
    v_mfma_f32_16x16x32_bf16 v[188:191], v[224:227], v[116:119], 0
    ds_read_b64_tr_b16 v[216:217], v21 offset:8192
    ds_read_b64_tr_b16 v[218:219], v21 offset:9216
    v_cvt_pk_bf16_f32 v131, v250, v251
    v_mfma_f32_16x16x32_bf16 v[192:195], v[224:227], v[120:123], 0
    s_waitcnt lgkmcnt(12)
    v_mfma_f32_16x16x32_bf16 v[132:135], v[196:199], v[124:127], v[132:135]
    ds_read_b64_tr_b16 v[220:221], v22 offset:8192
    ds_read_b64_tr_b16 v[222:223], v22 offset:9216
    v_mfma_f32_16x16x32_bf16 v[136:139], v[196:199], v[128:131], v[136:139]
    s_waitcnt lgkmcnt(12)
    v_mfma_f32_16x16x32_bf16 v[140:143], v[200:203], v[124:127], v[140:143]
    ds_read_b64_tr_b16 v[224:225], v23 offset:8192
    ds_read_b64_tr_b16 v[226:227], v23 offset:9216
    s_waitcnt vmcnt(10) lgkmcnt(10)
    v_fma_mix_f32 v244, v68, v228, v232 op_sel:[0,0,0] op_sel_hi:[1,1,1]
    v_fma_mix_f32 v245, v68, v228, v232 op_sel:[1,1,1] op_sel_hi:[1,1,1]
    s_add_u32 s43, s51, 0x187c00
    s_add_u32 m0, s39, 0xc000
    s_nop 0
    buffer_load_dwordx4 v2, s[12:15], s43 offen offset:1024 lds
    v_mfma_f32_16x16x32_bf16 v[144:147], v[200:203], v[128:131], v[144:147]
    v_fma_mix_f32 v246, v69, v229, v233 op_sel:[0,0,0] op_sel_hi:[1,1,1]
    v_fma_mix_f32 v247, v69, v229, v233 op_sel:[1,1,1] op_sel_hi:[1,1,1]
    v_mfma_f32_16x16x32_bf16 v[148:151], v[204:207], v[124:127], v[148:151]
    s_barrier
    ds_read_b64_tr_b16 v[196:197], v16 offset:16384
    ds_read_b64_tr_b16 v[198:199], v16 offset:17408
    v_fma_mix_f32 v248, v70, v230, v234 op_sel:[0,0,0] op_sel_hi:[1,1,1]
    v_fma_mix_f32 v249, v70, v230, v234 op_sel:[1,1,1] op_sel_hi:[1,1,1]
    v_mfma_f32_16x16x32_bf16 v[152:155], v[204:207], v[128:131], v[152:155]
    v_fma_mix_f32 v250, v71, v231, v235 op_sel:[0,0,0] op_sel_hi:[1,1,1]
    v_fma_mix_f32 v251, v71, v231, v235 op_sel:[1,1,1] op_sel_hi:[1,1,1]
    s_waitcnt lgkmcnt(10)
    v_mfma_f32_16x16x32_bf16 v[156:159], v[208:211], v[124:127], v[156:159]
    ds_read_b64_tr_b16 v[200:201], v17 offset:16384
    ds_read_b64_tr_b16 v[202:203], v17 offset:17408
    v_cvt_pk_bf16_f32 v116, v244, v245
    v_cvt_pk_bf16_f32 v117, v246, v247
    s_add_u32 s52, s53, 0x1c00
    buffer_load_dwordx4 v[52:55], v8, s[24:27], s52 offen sc1
    v_mfma_f32_16x16x32_bf16 v[160:163], v[208:211], v[128:131], v[160:163]
    v_cvt_pk_bf16_f32 v118, v248, v249
    v_cvt_pk_bf16_f32 v119, v250, v251
    s_waitcnt lgkmcnt(10)
    v_mfma_f32_16x16x32_bf16 v[164:167], v[212:215], v[124:127], v[164:167]
    ds_read_b64_tr_b16 v[204:205], v18 offset:16384
    ds_read_b64_tr_b16 v[206:207], v18 offset:17408
    s_waitcnt vmcnt(11)
    v_fma_mix_f32 v244, v72, v228, v232 op_sel:[0,0,0] op_sel_hi:[1,1,1]
    ds_read_b128 v[236:239], v9 offset:384
    ds_read_b128 v[240:243], v9 offset:400
    v_mfma_f32_16x16x32_bf16 v[168:171], v[212:215], v[128:131], v[168:171]
    v_fma_mix_f32 v245, v72, v228, v232 op_sel:[1,1,1] op_sel_hi:[1,1,1]
    v_fma_mix_f32 v246, v73, v229, v233 op_sel:[0,0,0] op_sel_hi:[1,1,1]
    s_waitcnt lgkmcnt(12)
    v_mfma_f32_16x16x32_bf16 v[172:175], v[216:219], v[124:127], v[172:175]
    ds_read_b64_tr_b16 v[208:209], v19 offset:16384
    ds_read_b64_tr_b16 v[210:211], v19 offset:17408
    v_fma_mix_f32 v247, v73, v229, v233 op_sel:[1,1,1] op_sel_hi:[1,1,1]
    v_fma_mix_f32 v248, v74, v230, v234 op_sel:[0,0,0] op_sel_hi:[1,1,1]
    v_mfma_f32_16x16x32_bf16 v[176:179], v[216:219], v[128:131], v[176:179]
    v_fma_mix_f32 v249, v74, v230, v234 op_sel:[1,1,1] op_sel_hi:[1,1,1]
    v_fma_mix_f32 v250, v75, v231, v235 op_sel:[0,0,0] op_sel_hi:[1,1,1]
    s_waitcnt lgkmcnt(12)
    v_mfma_f32_16x16x32_bf16 v[180:183], v[220:223], v[124:127], v[180:183]
    ds_read_b64_tr_b16 v[212:213], v20 offset:16384
    ds_read_b64_tr_b16 v[214:215], v20 offset:17408
    v_fma_mix_f32 v251, v75, v231, v235 op_sel:[1,1,1] op_sel_hi:[1,1,1]
    v_cvt_pk_bf16_f32 v120, v244, v245
    s_add_u32 s52, s53, 0x6c00
    buffer_load_dwordx4 v[56:59], v8, s[24:27], s52 offen sc1
    v_mfma_f32_16x16x32_bf16 v[184:187], v[220:223], v[128:131], v[184:187]
    v_cvt_pk_bf16_f32 v121, v246, v247
    v_cvt_pk_bf16_f32 v122, v248, v249
    s_waitcnt lgkmcnt(12)
    v_mfma_f32_16x16x32_bf16 v[188:191], v[224:227], v[124:127], v[188:191]
    ds_read_b64_tr_b16 v[216:217], v21 offset:16384
    ds_read_b64_tr_b16 v[218:219], v21 offset:17408
    v_cvt_pk_bf16_f32 v123, v250, v251
    v_mfma_f32_16x16x32_bf16 v[192:195], v[224:227], v[128:131], v[192:195]
    s_waitcnt lgkmcnt(12)
    v_mfma_f32_16x16x32_bf16 v[132:135], v[196:199], v[116:119], v[132:135]
    ds_read_b64_tr_b16 v[220:221], v22 offset:16384
    ds_read_b64_tr_b16 v[222:223], v22 offset:17408
    v_mfma_f32_16x16x32_bf16 v[136:139], v[196:199], v[120:123], v[136:139]
    s_waitcnt lgkmcnt(12)
    v_mfma_f32_16x16x32_bf16 v[140:143], v[200:203], v[116:119], v[140:143]
    ds_read_b64_tr_b16 v[224:225], v23 offset:16384
    ds_read_b64_tr_b16 v[226:227], v23 offset:17408
    s_waitcnt vmcnt(11) lgkmcnt(10)
    v_fma_mix_f32 v244, v76, v236, v240 op_sel:[0,0,0] op_sel_hi:[1,1,1]
    v_fma_mix_f32 v245, v76, v236, v240 op_sel:[1,1,1] op_sel_hi:[1,1,1]
    s_add_u32 s43, s51, 0x200000
    s_add_u32 m0, s39, 0x10000
    s_nop 0
    buffer_load_dwordx4 v2, s[12:15], s43 offen lds
    v_mfma_f32_16x16x32_bf16 v[144:147], v[200:203], v[120:123], v[144:147]
    v_fma_mix_f32 v246, v77, v237, v241 op_sel:[0,0,0] op_sel_hi:[1,1,1]
    v_fma_mix_f32 v247, v77, v237, v241 op_sel:[1,1,1] op_sel_hi:[1,1,1]
    v_mfma_f32_16x16x32_bf16 v[148:151], v[204:207], v[116:119], v[148:151]
    ds_read_b64_tr_b16 v[196:197], v16 offset:24576
    ds_read_b64_tr_b16 v[198:199], v16 offset:25600
    v_fma_mix_f32 v248, v78, v238, v242 op_sel:[0,0,0] op_sel_hi:[1,1,1]
    v_fma_mix_f32 v249, v78, v238, v242 op_sel:[1,1,1] op_sel_hi:[1,1,1]
    v_mfma_f32_16x16x32_bf16 v[152:155], v[204:207], v[120:123], v[152:155]
    v_fma_mix_f32 v250, v79, v239, v243 op_sel:[0,0,0] op_sel_hi:[1,1,1]
    v_fma_mix_f32 v251, v79, v239, v243 op_sel:[1,1,1] op_sel_hi:[1,1,1]
    s_waitcnt lgkmcnt(10)
    v_mfma_f32_16x16x32_bf16 v[156:159], v[208:211], v[116:119], v[156:159]
    ds_read_b64_tr_b16 v[200:201], v17 offset:24576
    ds_read_b64_tr_b16 v[202:203], v17 offset:25600
    v_cvt_pk_bf16_f32 v124, v244, v245
    v_cvt_pk_bf16_f32 v125, v246, v247
    s_add_u32 s52, s53, 0x2000
    buffer_load_dwordx4 v[60:63], v8, s[24:27], s52 offen sc1
    v_mfma_f32_16x16x32_bf16 v[160:163], v[208:211], v[120:123], v[160:163]
    v_cvt_pk_bf16_f32 v126, v248, v249
    v_cvt_pk_bf16_f32 v127, v250, v251
    s_waitcnt lgkmcnt(10)
    v_mfma_f32_16x16x32_bf16 v[164:167], v[212:215], v[116:119], v[164:167]
    ds_read_b64_tr_b16 v[204:205], v18 offset:24576
    ds_read_b64_tr_b16 v[206:207], v18 offset:25600
    s_waitcnt vmcnt(12)
    v_fma_mix_f32 v244, v80, v236, v240 op_sel:[0,0,0] op_sel_hi:[1,1,1]
    ds_read_b128 v[228:231], v9 offset:512
    ds_read_b128 v[232:235], v9 offset:528
    v_mfma_f32_16x16x32_bf16 v[168:171], v[212:215], v[120:123], v[168:171]
    v_fma_mix_f32 v245, v80, v236, v240 op_sel:[1,1,1] op_sel_hi:[1,1,1]
    v_fma_mix_f32 v246, v81, v237, v241 op_sel:[0,0,0] op_sel_hi:[1,1,1]
    s_waitcnt lgkmcnt(12)
    v_mfma_f32_16x16x32_bf16 v[172:175], v[216:219], v[116:119], v[172:175]
    ds_read_b64_tr_b16 v[208:209], v19 offset:24576
    ds_read_b64_tr_b16 v[210:211], v19 offset:25600
    v_fma_mix_f32 v247, v81, v237, v241 op_sel:[1,1,1] op_sel_hi:[1,1,1]
    v_fma_mix_f32 v248, v82, v238, v242 op_sel:[0,0,0] op_sel_hi:[1,1,1]
    v_mfma_f32_16x16x32_bf16 v[176:179], v[216:219], v[120:123], v[176:179]
    v_fma_mix_f32 v249, v82, v238, v242 op_sel:[1,1,1] op_sel_hi:[1,1,1]
    v_fma_mix_f32 v250, v83, v239, v243 op_sel:[0,0,0] op_sel_hi:[1,1,1]
    s_waitcnt lgkmcnt(12)
    v_mfma_f32_16x16x32_bf16 v[180:183], v[220:223], v[116:119], v[180:183]
    ds_read_b64_tr_b16 v[212:213], v20 offset:24576
    ds_read_b64_tr_b16 v[214:215], v20 offset:25600
    v_fma_mix_f32 v251, v83, v239, v243 op_sel:[1,1,1] op_sel_hi:[1,1,1]
    v_cvt_pk_bf16_f32 v128, v244, v245
    s_add_u32 s52, s53, 0x7000
    buffer_load_dwordx4 v[64:67], v8, s[24:27], s52 offen sc1
    v_mfma_f32_16x16x32_bf16 v[184:187], v[220:223], v[120:123], v[184:187]
    v_cvt_pk_bf16_f32 v129, v246, v247
    v_cvt_pk_bf16_f32 v130, v248, v249
    s_waitcnt lgkmcnt(12)
    v_mfma_f32_16x16x32_bf16 v[188:191], v[224:227], v[116:119], v[188:191]
    ds_read_b64_tr_b16 v[216:217], v21 offset:24576
    ds_read_b64_tr_b16 v[218:219], v21 offset:25600
    v_cvt_pk_bf16_f32 v131, v250, v251
    v_mfma_f32_16x16x32_bf16 v[192:195], v[224:227], v[120:123], v[192:195]
    s_waitcnt lgkmcnt(12)
    v_mfma_f32_16x16x32_bf16 v[132:135], v[196:199], v[124:127], v[132:135]
    ds_read_b64_tr_b16 v[220:221], v22 offset:24576
    ds_read_b64_tr_b16 v[222:223], v22 offset:25600
    v_mfma_f32_16x16x32_bf16 v[136:139], v[196:199], v[128:131], v[136:139]
    s_waitcnt lgkmcnt(12)
    v_mfma_f32_16x16x32_bf16 v[140:143], v[200:203], v[124:127], v[140:143]
    ds_read_b64_tr_b16 v[224:225], v23 offset:24576
    ds_read_b64_tr_b16 v[226:227], v23 offset:25600
    s_waitcnt vmcnt(12) lgkmcnt(10)
    v_fma_mix_f32 v244, v84, v228, v232 op_sel:[0,0,0] op_sel_hi:[1,1,1]
    v_fma_mix_f32 v245, v84, v228, v232 op_sel:[1,1,1] op_sel_hi:[1,1,1]
    s_add_u32 s43, s51, 0x207c00
    s_add_u32 m0, s39, 0x10000
    s_nop 0
    buffer_load_dwordx4 v2, s[12:15], s43 offen offset:1024 lds
    v_mfma_f32_16x16x32_bf16 v[144:147], v[200:203], v[128:131], v[144:147]
    v_fma_mix_f32 v246, v85, v229, v233 op_sel:[0,0,0] op_sel_hi:[1,1,1]
    v_fma_mix_f32 v247, v85, v229, v233 op_sel:[1,1,1] op_sel_hi:[1,1,1]
    v_mfma_f32_16x16x32_bf16 v[148:151], v[204:207], v[124:127], v[148:151]
    s_waitcnt vmcnt(6)
    s_barrier
    ds_read_b64_tr_b16 v[196:197], v16 offset:32768
    ds_read_b64_tr_b16 v[198:199], v16 offset:33792
    v_fma_mix_f32 v248, v86, v230, v234 op_sel:[0,0,0] op_sel_hi:[1,1,1]
    v_fma_mix_f32 v249, v86, v230, v234 op_sel:[1,1,1] op_sel_hi:[1,1,1]
    v_mfma_f32_16x16x32_bf16 v[152:155], v[204:207], v[128:131], v[152:155]
    v_fma_mix_f32 v250, v87, v231, v235 op_sel:[0,0,0] op_sel_hi:[1,1,1]
    v_fma_mix_f32 v251, v87, v231, v235 op_sel:[1,1,1] op_sel_hi:[1,1,1]
    s_waitcnt lgkmcnt(10)
    v_mfma_f32_16x16x32_bf16 v[156:159], v[208:211], v[124:127], v[156:159]
    ds_read_b64_tr_b16 v[200:201], v17 offset:32768
    ds_read_b64_tr_b16 v[202:203], v17 offset:33792
    v_cvt_pk_bf16_f32 v116, v244, v245
    v_cvt_pk_bf16_f32 v117, v246, v247
    s_add_u32 s52, s53, 0x2400
    buffer_load_dwordx4 v[68:71], v8, s[24:27], s52 offen sc1
    v_mfma_f32_16x16x32_bf16 v[160:163], v[208:211], v[128:131], v[160:163]
    v_cvt_pk_bf16_f32 v118, v248, v249
    v_cvt_pk_bf16_f32 v119, v250, v251
    s_waitcnt lgkmcnt(10)
    v_mfma_f32_16x16x32_bf16 v[164:167], v[212:215], v[124:127], v[164:167]
    ds_read_b64_tr_b16 v[204:205], v18 offset:32768
    ds_read_b64_tr_b16 v[206:207], v18 offset:33792
    v_fma_mix_f32 v244, v88, v228, v232 op_sel:[0,0,0] op_sel_hi:[1,1,1]
    ds_read_b128 v[236:239], v9 offset:640
    ds_read_b128 v[240:243], v9 offset:656
    v_mfma_f32_16x16x32_bf16 v[168:171], v[212:215], v[128:131], v[168:171]
    v_fma_mix_f32 v245, v88, v228, v232 op_sel:[1,1,1] op_sel_hi:[1,1,1]
    v_fma_mix_f32 v246, v89, v229, v233 op_sel:[0,0,0] op_sel_hi:[1,1,1]
    s_waitcnt lgkmcnt(12)
    v_mfma_f32_16x16x32_bf16 v[172:175], v[216:219], v[124:127], v[172:175]
    ds_read_b64_tr_b16 v[208:209], v19 offset:32768
    ds_read_b64_tr_b16 v[210:211], v19 offset:33792
    v_fma_mix_f32 v247, v89, v229, v233 op_sel:[1,1,1] op_sel_hi:[1,1,1]
    v_fma_mix_f32 v248, v90, v230, v234 op_sel:[0,0,0] op_sel_hi:[1,1,1]
    v_mfma_f32_16x16x32_bf16 v[176:179], v[216:219], v[128:131], v[176:179]
    v_fma_mix_f32 v249, v90, v230, v234 op_sel:[1,1,1] op_sel_hi:[1,1,1]
    v_fma_mix_f32 v250, v91, v231, v235 op_sel:[0,0,0] op_sel_hi:[1,1,1]
    s_waitcnt lgkmcnt(12)
    v_mfma_f32_16x16x32_bf16 v[180:183], v[220:223], v[124:127], v[180:183]
    ds_read_b64_tr_b16 v[212:213], v20 offset:32768
    ds_read_b64_tr_b16 v[214:215], v20 offset:33792
    v_fma_mix_f32 v251, v91, v231, v235 op_sel:[1,1,1] op_sel_hi:[1,1,1]
    v_cvt_pk_bf16_f32 v120, v244, v245
    s_add_u32 s52, s53, 0x7400
    buffer_load_dwordx4 v[72:75], v8, s[24:27], s52 offen sc1
    v_mfma_f32_16x16x32_bf16 v[184:187], v[220:223], v[128:131], v[184:187]
    v_cvt_pk_bf16_f32 v121, v246, v247
    v_cvt_pk_bf16_f32 v122, v248, v249
    s_waitcnt lgkmcnt(12)
    v_mfma_f32_16x16x32_bf16 v[188:191], v[224:227], v[124:127], v[188:191]
    ds_read_b64_tr_b16 v[216:217], v21 offset:32768
    ds_read_b64_tr_b16 v[218:219], v21 offset:33792
    v_cvt_pk_bf16_f32 v123, v250, v251
    v_mfma_f32_16x16x32_bf16 v[192:195], v[224:227], v[128:131], v[192:195]
    s_waitcnt lgkmcnt(12)
    v_mfma_f32_16x16x32_bf16 v[132:135], v[196:199], v[116:119], v[132:135]
    ds_read_b64_tr_b16 v[220:221], v22 offset:32768
    ds_read_b64_tr_b16 v[222:223], v22 offset:33792
    v_mfma_f32_16x16x32_bf16 v[136:139], v[196:199], v[120:123], v[136:139]
    s_waitcnt lgkmcnt(12)
    v_mfma_f32_16x16x32_bf16 v[140:143], v[200:203], v[116:119], v[140:143]
    ds_read_b64_tr_b16 v[224:225], v23 offset:32768
    ds_read_b64_tr_b16 v[226:227], v23 offset:33792
    s_waitcnt lgkmcnt(10)
    v_fma_mix_f32 v244, v92, v236, v240 op_sel:[0,0,0] op_sel_hi:[1,1,1]
    v_fma_mix_f32 v245, v92, v236, v240 op_sel:[1,1,1] op_sel_hi:[1,1,1]
    s_add_u32 s43, s51, 0x280000
    s_add_u32 m0, s39, 0x14000
    s_nop 0
    buffer_load_dwordx4 v2, s[12:15], s43 offen lds
    v_mfma_f32_16x16x32_bf16 v[144:147], v[200:203], v[120:123], v[144:147]
    v_fma_mix_f32 v246, v93, v237, v241 op_sel:[0,0,0] op_sel_hi:[1,1,1]
    v_fma_mix_f32 v247, v93, v237, v241 op_sel:[1,1,1] op_sel_hi:[1,1,1]
    v_mfma_f32_16x16x32_bf16 v[148:151], v[204:207], v[116:119], v[148:151]
    ds_read_b64_tr_b16 v[196:197], v16 offset:40960
    ds_read_b64_tr_b16 v[198:199], v16 offset:41984
    v_fma_mix_f32 v248, v94, v238, v242 op_sel:[0,0,0] op_sel_hi:[1,1,1]
    v_fma_mix_f32 v249, v94, v238, v242 op_sel:[1,1,1] op_sel_hi:[1,1,1]
    v_mfma_f32_16x16x32_bf16 v[152:155], v[204:207], v[120:123], v[152:155]
    v_fma_mix_f32 v250, v95, v239, v243 op_sel:[0,0,0] op_sel_hi:[1,1,1]
    v_fma_mix_f32 v251, v95, v239, v243 op_sel:[1,1,1] op_sel_hi:[1,1,1]
    s_waitcnt lgkmcnt(10)
    v_mfma_f32_16x16x32_bf16 v[156:159], v[208:211], v[116:119], v[156:159]
    ds_read_b64_tr_b16 v[200:201], v17 offset:40960
    ds_read_b64_tr_b16 v[202:203], v17 offset:41984
    v_cvt_pk_bf16_f32 v124, v244, v245
    v_cvt_pk_bf16_f32 v125, v246, v247
    s_add_u32 s52, s53, 0x2800
    buffer_load_dwordx4 v[76:79], v8, s[24:27], s52 offen sc1
    v_mfma_f32_16x16x32_bf16 v[160:163], v[208:211], v[120:123], v[160:163]
    v_cvt_pk_bf16_f32 v126, v248, v249
    v_cvt_pk_bf16_f32 v127, v250, v251
    s_waitcnt lgkmcnt(10)
    v_mfma_f32_16x16x32_bf16 v[164:167], v[212:215], v[116:119], v[164:167]
    ds_read_b64_tr_b16 v[204:205], v18 offset:40960
    ds_read_b64_tr_b16 v[206:207], v18 offset:41984
    v_fma_mix_f32 v244, v96, v236, v240 op_sel:[0,0,0] op_sel_hi:[1,1,1]
    ds_read_b128 v[228:231], v9 offset:768
    ds_read_b128 v[232:235], v9 offset:784
    v_mfma_f32_16x16x32_bf16 v[168:171], v[212:215], v[120:123], v[168:171]
    v_fma_mix_f32 v245, v96, v236, v240 op_sel:[1,1,1] op_sel_hi:[1,1,1]
    v_fma_mix_f32 v246, v97, v237, v241 op_sel:[0,0,0] op_sel_hi:[1,1,1]
    s_waitcnt lgkmcnt(12)
    v_mfma_f32_16x16x32_bf16 v[172:175], v[216:219], v[116:119], v[172:175]
    ds_read_b64_tr_b16 v[208:209], v19 offset:40960
    ds_read_b64_tr_b16 v[210:211], v19 offset:41984
    v_fma_mix_f32 v247, v97, v237, v241 op_sel:[1,1,1] op_sel_hi:[1,1,1]
    v_fma_mix_f32 v248, v98, v238, v242 op_sel:[0,0,0] op_sel_hi:[1,1,1]
    v_mfma_f32_16x16x32_bf16 v[176:179], v[216:219], v[120:123], v[176:179]
    v_fma_mix_f32 v249, v98, v238, v242 op_sel:[1,1,1] op_sel_hi:[1,1,1]
    v_fma_mix_f32 v250, v99, v239, v243 op_sel:[0,0,0] op_sel_hi:[1,1,1]
    s_waitcnt lgkmcnt(12)
    v_mfma_f32_16x16x32_bf16 v[180:183], v[220:223], v[116:119], v[180:183]
    ds_read_b64_tr_b16 v[212:213], v20 offset:40960
    ds_read_b64_tr_b16 v[214:215], v20 offset:41984
    v_fma_mix_f32 v251, v99, v239, v243 op_sel:[1,1,1] op_sel_hi:[1,1,1]
    v_cvt_pk_bf16_f32 v128, v244, v245
    s_add_u32 s52, s53, 0x7800
    buffer_load_dwordx4 v[80:83], v8, s[24:27], s52 offen sc1
    v_mfma_f32_16x16x32_bf16 v[184:187], v[220:223], v[120:123], v[184:187]
    v_cvt_pk_bf16_f32 v129, v246, v247
    v_cvt_pk_bf16_f32 v130, v248, v249
    s_waitcnt lgkmcnt(12)
    v_mfma_f32_16x16x32_bf16 v[188:191], v[224:227], v[116:119], v[188:191]
    ds_read_b64_tr_b16 v[216:217], v21 offset:40960
    ds_read_b64_tr_b16 v[218:219], v21 offset:41984
    v_cvt_pk_bf16_f32 v131, v250, v251
    v_mfma_f32_16x16x32_bf16 v[192:195], v[224:227], v[120:123], v[192:195]
    s_waitcnt lgkmcnt(12)
    v_mfma_f32_16x16x32_bf16 v[132:135], v[196:199], v[124:127], v[132:135]
    ds_read_b64_tr_b16 v[220:221], v22 offset:40960
    ds_read_b64_tr_b16 v[222:223], v22 offset:41984
    v_mfma_f32_16x16x32_bf16 v[136:139], v[196:199], v[128:131], v[136:139]
    s_waitcnt lgkmcnt(12)
    v_mfma_f32_16x16x32_bf16 v[140:143], v[200:203], v[124:127], v[140:143]
    ds_read_b64_tr_b16 v[224:225], v23 offset:40960
    ds_read_b64_tr_b16 v[226:227], v23 offset:41984
    s_waitcnt lgkmcnt(10)
    v_fma_mix_f32 v244, v100, v228, v232 op_sel:[0,0,0] op_sel_hi:[1,1,1]
    v_fma_mix_f32 v245, v100, v228, v232 op_sel:[1,1,1] op_sel_hi:[1,1,1]
    s_add_u32 s43, s51, 0x287c00
    s_add_u32 m0, s39, 0x14000
    s_nop 0
    buffer_load_dwordx4 v2, s[12:15], s43 offen offset:1024 lds
    v_mfma_f32_16x16x32_bf16 v[144:147], v[200:203], v[128:131], v[144:147]
    v_fma_mix_f32 v246, v101, v229, v233 op_sel:[0,0,0] op_sel_hi:[1,1,1]
    v_fma_mix_f32 v247, v101, v229, v233 op_sel:[1,1,1] op_sel_hi:[1,1,1]
    v_mfma_f32_16x16x32_bf16 v[148:151], v[204:207], v[124:127], v[148:151]
    ds_read_b64_tr_b16 v[196:197], v16 offset:49152
    ds_read_b64_tr_b16 v[198:199], v16 offset:50176
    v_fma_mix_f32 v248, v102, v230, v234 op_sel:[0,0,0] op_sel_hi:[1,1,1]
    v_fma_mix_f32 v249, v102, v230, v234 op_sel:[1,1,1] op_sel_hi:[1,1,1]
    v_mfma_f32_16x16x32_bf16 v[152:155], v[204:207], v[128:131], v[152:155]
    v_fma_mix_f32 v250, v103, v231, v235 op_sel:[0,0,0] op_sel_hi:[1,1,1]
    v_fma_mix_f32 v251, v103, v231, v235 op_sel:[1,1,1] op_sel_hi:[1,1,1]
    s_waitcnt lgkmcnt(10)
    v_mfma_f32_16x16x32_bf16 v[156:159], v[208:211], v[124:127], v[156:159]
    ds_read_b64_tr_b16 v[200:201], v17 offset:49152
    ds_read_b64_tr_b16 v[202:203], v17 offset:50176
    v_cvt_pk_bf16_f32 v116, v244, v245
    v_cvt_pk_bf16_f32 v117, v246, v247
    s_add_u32 s52, s53, 0x2c00
    buffer_load_dwordx4 v[84:87], v8, s[24:27], s52 offen sc1
    v_mfma_f32_16x16x32_bf16 v[160:163], v[208:211], v[128:131], v[160:163]
    v_cvt_pk_bf16_f32 v118, v248, v249
    v_cvt_pk_bf16_f32 v119, v250, v251
    s_waitcnt lgkmcnt(10)
    v_mfma_f32_16x16x32_bf16 v[164:167], v[212:215], v[124:127], v[164:167]
    ds_read_b64_tr_b16 v[204:205], v18 offset:49152
    ds_read_b64_tr_b16 v[206:207], v18 offset:50176
    v_fma_mix_f32 v244, v104, v228, v232 op_sel:[0,0,0] op_sel_hi:[1,1,1]
    ds_read_b128 v[236:239], v9 offset:896
    ds_read_b128 v[240:243], v9 offset:912
    v_mfma_f32_16x16x32_bf16 v[168:171], v[212:215], v[128:131], v[168:171]
    v_fma_mix_f32 v245, v104, v228, v232 op_sel:[1,1,1] op_sel_hi:[1,1,1]
    v_fma_mix_f32 v246, v105, v229, v233 op_sel:[0,0,0] op_sel_hi:[1,1,1]
    s_waitcnt lgkmcnt(12)
    v_mfma_f32_16x16x32_bf16 v[172:175], v[216:219], v[124:127], v[172:175]
    ds_read_b64_tr_b16 v[208:209], v19 offset:49152
    ds_read_b64_tr_b16 v[210:211], v19 offset:50176
    v_fma_mix_f32 v247, v105, v229, v233 op_sel:[1,1,1] op_sel_hi:[1,1,1]
    v_fma_mix_f32 v248, v106, v230, v234 op_sel:[0,0,0] op_sel_hi:[1,1,1]
    v_mfma_f32_16x16x32_bf16 v[176:179], v[216:219], v[128:131], v[176:179]
    v_fma_mix_f32 v249, v106, v230, v234 op_sel:[1,1,1] op_sel_hi:[1,1,1]
    v_fma_mix_f32 v250, v107, v231, v235 op_sel:[0,0,0] op_sel_hi:[1,1,1]
    s_waitcnt lgkmcnt(12)
    v_mfma_f32_16x16x32_bf16 v[180:183], v[220:223], v[124:127], v[180:183]
    ds_read_b64_tr_b16 v[212:213], v20 offset:49152
    ds_read_b64_tr_b16 v[214:215], v20 offset:50176
    v_fma_mix_f32 v251, v107, v231, v235 op_sel:[1,1,1] op_sel_hi:[1,1,1]
    v_cvt_pk_bf16_f32 v120, v244, v245
    s_add_u32 s52, s53, 0x7c00
    buffer_load_dwordx4 v[88:91], v8, s[24:27], s52 offen sc1
    v_mfma_f32_16x16x32_bf16 v[184:187], v[220:223], v[128:131], v[184:187]
    v_cvt_pk_bf16_f32 v121, v246, v247
    v_cvt_pk_bf16_f32 v122, v248, v249
    s_waitcnt lgkmcnt(12)
    v_mfma_f32_16x16x32_bf16 v[188:191], v[224:227], v[124:127], v[188:191]
    ds_read_b64_tr_b16 v[216:217], v21 offset:49152
    ds_read_b64_tr_b16 v[218:219], v21 offset:50176
    v_cvt_pk_bf16_f32 v123, v250, v251
    v_mfma_f32_16x16x32_bf16 v[192:195], v[224:227], v[128:131], v[192:195]
    s_waitcnt lgkmcnt(12)
    v_mfma_f32_16x16x32_bf16 v[132:135], v[196:199], v[116:119], v[132:135]
    ds_read_b64_tr_b16 v[220:221], v22 offset:49152
    ds_read_b64_tr_b16 v[222:223], v22 offset:50176
    v_mfma_f32_16x16x32_bf16 v[136:139], v[196:199], v[120:123], v[136:139]
    s_waitcnt lgkmcnt(12)
    v_mfma_f32_16x16x32_bf16 v[140:143], v[200:203], v[116:119], v[140:143]
    ds_read_b64_tr_b16 v[224:225], v23 offset:49152
    ds_read_b64_tr_b16 v[226:227], v23 offset:50176
    s_waitcnt vmcnt(13) lgkmcnt(10)
    v_fma_mix_f32 v244, v52, v236, v240 op_sel:[0,0,0] op_sel_hi:[1,1,1]
    v_fma_mix_f32 v245, v52, v236, v240 op_sel:[1,1,1] op_sel_hi:[1,1,1]
    s_add_u32 s43, s51, 0x300000
    s_add_u32 m0, s39, 0x18000
    s_nop 0
    buffer_load_dwordx4 v2, s[12:15], s43 offen lds
    v_mfma_f32_16x16x32_bf16 v[144:147], v[200:203], v[120:123], v[144:147]
    v_fma_mix_f32 v246, v53, v237, v241 op_sel:[0,0,0] op_sel_hi:[1,1,1]
    v_fma_mix_f32 v247, v53, v237, v241 op_sel:[1,1,1] op_sel_hi:[1,1,1]
    v_mfma_f32_16x16x32_bf16 v[148:151], v[204:207], v[116:119], v[148:151]
    ds_read_b64_tr_b16 v[196:197], v16 offset:57344
    ds_read_b64_tr_b16 v[198:199], v16 offset:58368
    v_fma_mix_f32 v248, v54, v238, v242 op_sel:[0,0,0] op_sel_hi:[1,1,1]
    v_fma_mix_f32 v249, v54, v238, v242 op_sel:[1,1,1] op_sel_hi:[1,1,1]
    v_mfma_f32_16x16x32_bf16 v[152:155], v[204:207], v[120:123], v[152:155]
    v_fma_mix_f32 v250, v55, v239, v243 op_sel:[0,0,0] op_sel_hi:[1,1,1]
    v_fma_mix_f32 v251, v55, v239, v243 op_sel:[1,1,1] op_sel_hi:[1,1,1]
    s_waitcnt lgkmcnt(10)
    v_mfma_f32_16x16x32_bf16 v[156:159], v[208:211], v[116:119], v[156:159]
    ds_read_b64_tr_b16 v[200:201], v17 offset:57344
    ds_read_b64_tr_b16 v[202:203], v17 offset:58368
    v_cvt_pk_bf16_f32 v124, v244, v245
    v_cvt_pk_bf16_f32 v125, v246, v247
    s_add_u32 s52, s53, 0x3000
    buffer_load_dwordx4 v[92:95], v8, s[24:27], s52 offen sc1
    v_mfma_f32_16x16x32_bf16 v[160:163], v[208:211], v[120:123], v[160:163]
    v_cvt_pk_bf16_f32 v126, v248, v249
    v_cvt_pk_bf16_f32 v127, v250, v251
    s_waitcnt lgkmcnt(10)
    v_mfma_f32_16x16x32_bf16 v[164:167], v[212:215], v[116:119], v[164:167]
    ds_read_b64_tr_b16 v[204:205], v18 offset:57344
    ds_read_b64_tr_b16 v[206:207], v18 offset:58368
    s_waitcnt vmcnt(14)
    v_fma_mix_f32 v244, v56, v236, v240 op_sel:[0,0,0] op_sel_hi:[1,1,1]
    ds_read_b128 v[228:231], v9 offset:1024
    ds_read_b128 v[232:235], v9 offset:1040
    v_mfma_f32_16x16x32_bf16 v[168:171], v[212:215], v[120:123], v[168:171]
    v_fma_mix_f32 v245, v56, v236, v240 op_sel:[1,1,1] op_sel_hi:[1,1,1]
    v_fma_mix_f32 v246, v57, v237, v241 op_sel:[0,0,0] op_sel_hi:[1,1,1]
    s_waitcnt lgkmcnt(12)
    v_mfma_f32_16x16x32_bf16 v[172:175], v[216:219], v[116:119], v[172:175]
    ds_read_b64_tr_b16 v[208:209], v19 offset:57344
    ds_read_b64_tr_b16 v[210:211], v19 offset:58368
    v_fma_mix_f32 v247, v57, v237, v241 op_sel:[1,1,1] op_sel_hi:[1,1,1]
    v_fma_mix_f32 v248, v58, v238, v242 op_sel:[0,0,0] op_sel_hi:[1,1,1]
    v_mfma_f32_16x16x32_bf16 v[176:179], v[216:219], v[120:123], v[176:179]
    v_fma_mix_f32 v249, v58, v238, v242 op_sel:[1,1,1] op_sel_hi:[1,1,1]
    v_fma_mix_f32 v250, v59, v239, v243 op_sel:[0,0,0] op_sel_hi:[1,1,1]
    s_waitcnt lgkmcnt(12)
    v_mfma_f32_16x16x32_bf16 v[180:183], v[220:223], v[116:119], v[180:183]
    ds_read_b64_tr_b16 v[212:213], v20 offset:57344
    ds_read_b64_tr_b16 v[214:215], v20 offset:58368
    v_fma_mix_f32 v251, v59, v239, v243 op_sel:[1,1,1] op_sel_hi:[1,1,1]
    v_cvt_pk_bf16_f32 v128, v244, v245
    s_add_u32 s52, s53, 0x8000
    buffer_load_dwordx4 v[96:99], v8, s[24:27], s52 offen sc1
    v_mfma_f32_16x16x32_bf16 v[184:187], v[220:223], v[120:123], v[184:187]
    v_cvt_pk_bf16_f32 v129, v246, v247
    v_cvt_pk_bf16_f32 v130, v248, v249
    s_waitcnt lgkmcnt(12)
    v_mfma_f32_16x16x32_bf16 v[188:191], v[224:227], v[116:119], v[188:191]
    ds_read_b64_tr_b16 v[216:217], v21 offset:57344
    ds_read_b64_tr_b16 v[218:219], v21 offset:58368
    v_cvt_pk_bf16_f32 v131, v250, v251
    v_mfma_f32_16x16x32_bf16 v[192:195], v[224:227], v[120:123], v[192:195]
    s_waitcnt lgkmcnt(12)
    v_mfma_f32_16x16x32_bf16 v[132:135], v[196:199], v[124:127], v[132:135]
    ds_read_b64_tr_b16 v[220:221], v22 offset:57344
    ds_read_b64_tr_b16 v[222:223], v22 offset:58368
    v_mfma_f32_16x16x32_bf16 v[136:139], v[196:199], v[128:131], v[136:139]
    s_waitcnt lgkmcnt(12)
    v_mfma_f32_16x16x32_bf16 v[140:143], v[200:203], v[124:127], v[140:143]
    ds_read_b64_tr_b16 v[224:225], v23 offset:57344
    ds_read_b64_tr_b16 v[226:227], v23 offset:58368
    s_waitcnt vmcnt(13) lgkmcnt(10)
    v_fma_mix_f32 v244, v60, v228, v232 op_sel:[0,0,0] op_sel_hi:[1,1,1]
    v_fma_mix_f32 v245, v60, v228, v232 op_sel:[1,1,1] op_sel_hi:[1,1,1]
    s_add_u32 s43, s51, 0x307c00
    s_add_u32 m0, s39, 0x18000
    s_nop 0
    buffer_load_dwordx4 v2, s[12:15], s43 offen offset:1024 lds
    v_mfma_f32_16x16x32_bf16 v[144:147], v[200:203], v[128:131], v[144:147]
    v_fma_mix_f32 v246, v61, v229, v233 op_sel:[0,0,0] op_sel_hi:[1,1,1]
    v_fma_mix_f32 v247, v61, v229, v233 op_sel:[1,1,1] op_sel_hi:[1,1,1]
    v_mfma_f32_16x16x32_bf16 v[148:151], v[204:207], v[124:127], v[148:151]
    s_waitcnt vmcnt(6)
    s_barrier
    v_add_u32 v16, 0x10000, v16
    v_add_u32 v17, 0x10000, v17
    v_add_u32 v18, 0x10000, v18
    v_add_u32 v19, 0x10000, v19
    v_add_u32 v20, 0x10000, v20
    v_add_u32 v21, 0x10000, v21
    v_add_u32 v22, 0x10000, v22
    v_add_u32 v23, 0x10000, v23
    ds_read_b64_tr_b16 v[196:197], v16 offset:0
    ds_read_b64_tr_b16 v[198:199], v16 offset:1024
    v_fma_mix_f32 v248, v62, v230, v234 op_sel:[0,0,0] op_sel_hi:[1,1,1]
    v_fma_mix_f32 v249, v62, v230, v234 op_sel:[1,1,1] op_sel_hi:[1,1,1]
    v_mfma_f32_16x16x32_bf16 v[152:155], v[204:207], v[128:131], v[152:155]
    v_fma_mix_f32 v250, v63, v231, v235 op_sel:[0,0,0] op_sel_hi:[1,1,1]
    v_fma_mix_f32 v251, v63, v231, v235 op_sel:[1,1,1] op_sel_hi:[1,1,1]
    s_waitcnt lgkmcnt(10)
    v_mfma_f32_16x16x32_bf16 v[156:159], v[208:211], v[124:127], v[156:159]
    ds_read_b64_tr_b16 v[200:201], v17 offset:0
    ds_read_b64_tr_b16 v[202:203], v17 offset:1024
    v_cvt_pk_bf16_f32 v116, v244, v245
    v_cvt_pk_bf16_f32 v117, v246, v247
    s_add_u32 s52, s53, 0x3400
    buffer_load_dwordx4 v[100:103], v8, s[24:27], s52 offen sc1
    v_mfma_f32_16x16x32_bf16 v[160:163], v[208:211], v[128:131], v[160:163]
    v_cvt_pk_bf16_f32 v118, v248, v249
    v_cvt_pk_bf16_f32 v119, v250, v251
    s_waitcnt lgkmcnt(10)
    v_mfma_f32_16x16x32_bf16 v[164:167], v[212:215], v[124:127], v[164:167]
    ds_read_b64_tr_b16 v[204:205], v18 offset:0
    ds_read_b64_tr_b16 v[206:207], v18 offset:1024
    v_fma_mix_f32 v244, v64, v228, v232 op_sel:[0,0,0] op_sel_hi:[1,1,1]
    ds_read_b128 v[236:239], v9 offset:1152
    ds_read_b128 v[240:243], v9 offset:1168
    v_mfma_f32_16x16x32_bf16 v[168:171], v[212:215], v[128:131], v[168:171]
    v_fma_mix_f32 v245, v64, v228, v232 op_sel:[1,1,1] op_sel_hi:[1,1,1]
    v_fma_mix_f32 v246, v65, v229, v233 op_sel:[0,0,0] op_sel_hi:[1,1,1]
    s_waitcnt lgkmcnt(12)
    v_mfma_f32_16x16x32_bf16 v[172:175], v[216:219], v[124:127], v[172:175]
    ds_read_b64_tr_b16 v[208:209], v19 offset:0
    ds_read_b64_tr_b16 v[210:211], v19 offset:1024
    v_fma_mix_f32 v247, v65, v229, v233 op_sel:[1,1,1] op_sel_hi:[1,1,1]
    v_fma_mix_f32 v248, v66, v230, v234 op_sel:[0,0,0] op_sel_hi:[1,1,1]
    v_mfma_f32_16x16x32_bf16 v[176:179], v[216:219], v[128:131], v[176:179]
    v_fma_mix_f32 v249, v66, v230, v234 op_sel:[1,1,1] op_sel_hi:[1,1,1]
    v_fma_mix_f32 v250, v67, v231, v235 op_sel:[0,0,0] op_sel_hi:[1,1,1]
    s_waitcnt lgkmcnt(12)
    v_mfma_f32_16x16x32_bf16 v[180:183], v[220:223], v[124:127], v[180:183]
    ds_read_b64_tr_b16 v[212:213], v20 offset:0
    ds_read_b64_tr_b16 v[214:215], v20 offset:1024
    v_fma_mix_f32 v251, v67, v231, v235 op_sel:[1,1,1] op_sel_hi:[1,1,1]
    v_cvt_pk_bf16_f32 v120, v244, v245
    s_add_u32 s52, s53, 0x8400
    buffer_load_dwordx4 v[104:107], v8, s[24:27], s52 offen sc1
    v_mfma_f32_16x16x32_bf16 v[184:187], v[220:223], v[128:131], v[184:187]
    v_cvt_pk_bf16_f32 v121, v246, v247
    v_cvt_pk_bf16_f32 v122, v248, v249
    s_waitcnt lgkmcnt(12)
    v_mfma_f32_16x16x32_bf16 v[188:191], v[224:227], v[124:127], v[188:191]
    ds_read_b64_tr_b16 v[216:217], v21 offset:0
    ds_read_b64_tr_b16 v[218:219], v21 offset:1024
    v_cvt_pk_bf16_f32 v123, v250, v251
    v_mfma_f32_16x16x32_bf16 v[192:195], v[224:227], v[128:131], v[192:195]
    s_waitcnt lgkmcnt(12)
    v_mfma_f32_16x16x32_bf16 v[132:135], v[196:199], v[116:119], v[132:135]
    ds_read_b64_tr_b16 v[220:221], v22 offset:0
    ds_read_b64_tr_b16 v[222:223], v22 offset:1024
    v_mfma_f32_16x16x32_bf16 v[136:139], v[196:199], v[120:123], v[136:139]
    s_waitcnt lgkmcnt(12)
    v_mfma_f32_16x16x32_bf16 v[140:143], v[200:203], v[116:119], v[140:143]
    ds_read_b64_tr_b16 v[224:225], v23 offset:0
    ds_read_b64_tr_b16 v[226:227], v23 offset:1024
    s_waitcnt lgkmcnt(10)
    v_fma_mix_f32 v244, v68, v236, v240 op_sel:[0,0,0] op_sel_hi:[1,1,1]
    v_fma_mix_f32 v245, v68, v236, v240 op_sel:[1,1,1] op_sel_hi:[1,1,1]
    s_add_u32 s43, s51, 0x380000
    s_add_u32 m0, s39, 0x1c000
    s_nop 0
    buffer_load_dwordx4 v2, s[12:15], s43 offen lds
    v_mfma_f32_16x16x32_bf16 v[144:147], v[200:203], v[120:123], v[144:147]
    v_fma_mix_f32 v246, v69, v237, v241 op_sel:[0,0,0] op_sel_hi:[1,1,1]
    v_fma_mix_f32 v247, v69, v237, v241 op_sel:[1,1,1] op_sel_hi:[1,1,1]
    v_mfma_f32_16x16x32_bf16 v[148:151], v[204:207], v[116:119], v[148:151]
    ds_read_b64_tr_b16 v[196:197], v16 offset:8192
    ds_read_b64_tr_b16 v[198:199], v16 offset:9216
    v_fma_mix_f32 v248, v70, v238, v242 op_sel:[0,0,0] op_sel_hi:[1,1,1]
    v_fma_mix_f32 v249, v70, v238, v242 op_sel:[1,1,1] op_sel_hi:[1,1,1]
    v_mfma_f32_16x16x32_bf16 v[152:155], v[204:207], v[120:123], v[152:155]
    v_fma_mix_f32 v250, v71, v239, v243 op_sel:[0,0,0] op_sel_hi:[1,1,1]
    v_fma_mix_f32 v251, v71, v239, v243 op_sel:[1,1,1] op_sel_hi:[1,1,1]
    s_waitcnt lgkmcnt(10)
    v_mfma_f32_16x16x32_bf16 v[156:159], v[208:211], v[116:119], v[156:159]
    ds_read_b64_tr_b16 v[200:201], v17 offset:8192
    ds_read_b64_tr_b16 v[202:203], v17 offset:9216
    v_cvt_pk_bf16_f32 v124, v244, v245
    v_cvt_pk_bf16_f32 v125, v246, v247
    s_add_u32 s52, s53, 0x3800
    buffer_load_dwordx4 v[52:55], v8, s[24:27], s52 offen sc1
    v_mfma_f32_16x16x32_bf16 v[160:163], v[208:211], v[120:123], v[160:163]
    v_cvt_pk_bf16_f32 v126, v248, v249
    v_cvt_pk_bf16_f32 v127, v250, v251
    s_waitcnt lgkmcnt(10)
    v_mfma_f32_16x16x32_bf16 v[164:167], v[212:215], v[116:119], v[164:167]
    ds_read_b64_tr_b16 v[204:205], v18 offset:8192
    ds_read_b64_tr_b16 v[206:207], v18 offset:9216
    v_fma_mix_f32 v244, v72, v236, v240 op_sel:[0,0,0] op_sel_hi:[1,1,1]
    ds_read_b128 v[228:231], v9 offset:1280
    ds_read_b128 v[232:235], v9 offset:1296
    v_mfma_f32_16x16x32_bf16 v[168:171], v[212:215], v[120:123], v[168:171]
    v_fma_mix_f32 v245, v72, v236, v240 op_sel:[1,1,1] op_sel_hi:[1,1,1]
    v_fma_mix_f32 v246, v73, v237, v241 op_sel:[0,0,0] op_sel_hi:[1,1,1]
    s_waitcnt lgkmcnt(12)
    v_mfma_f32_16x16x32_bf16 v[172:175], v[216:219], v[116:119], v[172:175]
    ds_read_b64_tr_b16 v[208:209], v19 offset:8192
    ds_read_b64_tr_b16 v[210:211], v19 offset:9216
    v_fma_mix_f32 v247, v73, v237, v241 op_sel:[1,1,1] op_sel_hi:[1,1,1]
    v_fma_mix_f32 v248, v74, v238, v242 op_sel:[0,0,0] op_sel_hi:[1,1,1]
    v_mfma_f32_16x16x32_bf16 v[176:179], v[216:219], v[120:123], v[176:179]
    v_fma_mix_f32 v249, v74, v238, v242 op_sel:[1,1,1] op_sel_hi:[1,1,1]
    v_fma_mix_f32 v250, v75, v239, v243 op_sel:[0,0,0] op_sel_hi:[1,1,1]
    s_waitcnt lgkmcnt(12)
    v_mfma_f32_16x16x32_bf16 v[180:183], v[220:223], v[116:119], v[180:183]
    ds_read_b64_tr_b16 v[212:213], v20 offset:8192
    ds_read_b64_tr_b16 v[214:215], v20 offset:9216
    v_fma_mix_f32 v251, v75, v239, v243 op_sel:[1,1,1] op_sel_hi:[1,1,1]
    v_cvt_pk_bf16_f32 v128, v244, v245
    s_add_u32 s52, s53, 0x8800
    buffer_load_dwordx4 v[56:59], v8, s[24:27], s52 offen sc1
    v_mfma_f32_16x16x32_bf16 v[184:187], v[220:223], v[120:123], v[184:187]
    v_cvt_pk_bf16_f32 v129, v246, v247
    v_cvt_pk_bf16_f32 v130, v248, v249
    s_waitcnt lgkmcnt(12)
    v_mfma_f32_16x16x32_bf16 v[188:191], v[224:227], v[116:119], v[188:191]
    ds_read_b64_tr_b16 v[216:217], v21 offset:8192
    ds_read_b64_tr_b16 v[218:219], v21 offset:9216
    v_cvt_pk_bf16_f32 v131, v250, v251
    v_mfma_f32_16x16x32_bf16 v[192:195], v[224:227], v[120:123], v[192:195]
    s_waitcnt lgkmcnt(12)
    v_mfma_f32_16x16x32_bf16 v[132:135], v[196:199], v[124:127], v[132:135]
    ds_read_b64_tr_b16 v[220:221], v22 offset:8192
    ds_read_b64_tr_b16 v[222:223], v22 offset:9216
    v_mfma_f32_16x16x32_bf16 v[136:139], v[196:199], v[128:131], v[136:139]
    s_waitcnt lgkmcnt(12)
    v_mfma_f32_16x16x32_bf16 v[140:143], v[200:203], v[124:127], v[140:143]
    ds_read_b64_tr_b16 v[224:225], v23 offset:8192
    ds_read_b64_tr_b16 v[226:227], v23 offset:9216
    s_waitcnt lgkmcnt(10)
    v_fma_mix_f32 v244, v76, v228, v232 op_sel:[0,0,0] op_sel_hi:[1,1,1]
    v_fma_mix_f32 v245, v76, v228, v232 op_sel:[1,1,1] op_sel_hi:[1,1,1]
    s_add_u32 s43, s51, 0x387c00
    s_add_u32 m0, s39, 0x1c000
    s_nop 0
    buffer_load_dwordx4 v2, s[12:15], s43 offen offset:1024 lds
    v_mfma_f32_16x16x32_bf16 v[144:147], v[200:203], v[128:131], v[144:147]
    v_fma_mix_f32 v246, v77, v229, v233 op_sel:[0,0,0] op_sel_hi:[1,1,1]
    v_fma_mix_f32 v247, v77, v229, v233 op_sel:[1,1,1] op_sel_hi:[1,1,1]
    v_mfma_f32_16x16x32_bf16 v[148:151], v[204:207], v[124:127], v[148:151]
    ds_read_b64_tr_b16 v[196:197], v16 offset:16384
    ds_read_b64_tr_b16 v[198:199], v16 offset:17408
    v_fma_mix_f32 v248, v78, v230, v234 op_sel:[0,0,0] op_sel_hi:[1,1,1]
    v_fma_mix_f32 v249, v78, v230, v234 op_sel:[1,1,1] op_sel_hi:[1,1,1]
    v_mfma_f32_16x16x32_bf16 v[152:155], v[204:207], v[128:131], v[152:155]
    v_fma_mix_f32 v250, v79, v231, v235 op_sel:[0,0,0] op_sel_hi:[1,1,1]
    v_fma_mix_f32 v251, v79, v231, v235 op_sel:[1,1,1] op_sel_hi:[1,1,1]
    s_waitcnt lgkmcnt(10)
    v_mfma_f32_16x16x32_bf16 v[156:159], v[208:211], v[124:127], v[156:159]
    ds_read_b64_tr_b16 v[200:201], v17 offset:16384
    ds_read_b64_tr_b16 v[202:203], v17 offset:17408
    v_cvt_pk_bf16_f32 v116, v244, v245
    v_cvt_pk_bf16_f32 v117, v246, v247
    s_add_u32 s52, s53, 0x3c00
    buffer_load_dwordx4 v[60:63], v8, s[24:27], s52 offen sc1
    v_mfma_f32_16x16x32_bf16 v[160:163], v[208:211], v[128:131], v[160:163]
    v_cvt_pk_bf16_f32 v118, v248, v249
    v_cvt_pk_bf16_f32 v119, v250, v251
    s_waitcnt lgkmcnt(10)
    v_mfma_f32_16x16x32_bf16 v[164:167], v[212:215], v[124:127], v[164:167]
    ds_read_b64_tr_b16 v[204:205], v18 offset:16384
    ds_read_b64_tr_b16 v[206:207], v18 offset:17408
    v_fma_mix_f32 v244, v80, v228, v232 op_sel:[0,0,0] op_sel_hi:[1,1,1]
    ds_read_b128 v[236:239], v9 offset:1408
    ds_read_b128 v[240:243], v9 offset:1424
    v_mfma_f32_16x16x32_bf16 v[168:171], v[212:215], v[128:131], v[168:171]
    v_fma_mix_f32 v245, v80, v228, v232 op_sel:[1,1,1] op_sel_hi:[1,1,1]
    v_fma_mix_f32 v246, v81, v229, v233 op_sel:[0,0,0] op_sel_hi:[1,1,1]
    s_waitcnt lgkmcnt(12)
    v_mfma_f32_16x16x32_bf16 v[172:175], v[216:219], v[124:127], v[172:175]
    ds_read_b64_tr_b16 v[208:209], v19 offset:16384
    ds_read_b64_tr_b16 v[210:211], v19 offset:17408
    v_fma_mix_f32 v247, v81, v229, v233 op_sel:[1,1,1] op_sel_hi:[1,1,1]
    v_fma_mix_f32 v248, v82, v230, v234 op_sel:[0,0,0] op_sel_hi:[1,1,1]
    v_mfma_f32_16x16x32_bf16 v[176:179], v[216:219], v[128:131], v[176:179]
    v_fma_mix_f32 v249, v82, v230, v234 op_sel:[1,1,1] op_sel_hi:[1,1,1]
    v_fma_mix_f32 v250, v83, v231, v235 op_sel:[0,0,0] op_sel_hi:[1,1,1]
    s_waitcnt lgkmcnt(12)
    v_mfma_f32_16x16x32_bf16 v[180:183], v[220:223], v[124:127], v[180:183]
    ds_read_b64_tr_b16 v[212:213], v20 offset:16384
    ds_read_b64_tr_b16 v[214:215], v20 offset:17408
    v_fma_mix_f32 v251, v83, v231, v235 op_sel:[1,1,1] op_sel_hi:[1,1,1]
    v_cvt_pk_bf16_f32 v120, v244, v245
    s_add_u32 s52, s53, 0x8c00
    buffer_load_dwordx4 v[64:67], v8, s[24:27], s52 offen sc1
    v_mfma_f32_16x16x32_bf16 v[184:187], v[220:223], v[128:131], v[184:187]
    v_cvt_pk_bf16_f32 v121, v246, v247
    v_cvt_pk_bf16_f32 v122, v248, v249
    s_waitcnt lgkmcnt(12)
    v_mfma_f32_16x16x32_bf16 v[188:191], v[224:227], v[124:127], v[188:191]
    ds_read_b64_tr_b16 v[216:217], v21 offset:16384
    ds_read_b64_tr_b16 v[218:219], v21 offset:17408
    v_cvt_pk_bf16_f32 v123, v250, v251
    v_mfma_f32_16x16x32_bf16 v[192:195], v[224:227], v[128:131], v[192:195]
    s_waitcnt lgkmcnt(12)
    v_mfma_f32_16x16x32_bf16 v[132:135], v[196:199], v[116:119], v[132:135]
    ds_read_b64_tr_b16 v[220:221], v22 offset:16384
    ds_read_b64_tr_b16 v[222:223], v22 offset:17408
    v_mfma_f32_16x16x32_bf16 v[136:139], v[196:199], v[120:123], v[136:139]
    s_waitcnt lgkmcnt(12)
    v_mfma_f32_16x16x32_bf16 v[140:143], v[200:203], v[116:119], v[140:143]
    ds_read_b64_tr_b16 v[224:225], v23 offset:16384
    ds_read_b64_tr_b16 v[226:227], v23 offset:17408
    s_waitcnt vmcnt(13) lgkmcnt(10)
    v_fma_mix_f32 v244, v84, v236, v240 op_sel:[0,0,0] op_sel_hi:[1,1,1]
    v_fma_mix_f32 v245, v84, v236, v240 op_sel:[1,1,1] op_sel_hi:[1,1,1]
    s_add_u32 s43, s51, 0x400000
    s_add_u32 m0, s39, 0x20000
    s_nop 0
    buffer_load_dwordx4 v2, s[12:15], s43 offen lds
    v_mfma_f32_16x16x32_bf16 v[144:147], v[200:203], v[120:123], v[144:147]
    v_fma_mix_f32 v246, v85, v237, v241 op_sel:[0,0,0] op_sel_hi:[1,1,1]
    v_fma_mix_f32 v247, v85, v237, v241 op_sel:[1,1,1] op_sel_hi:[1,1,1]
    v_mfma_f32_16x16x32_bf16 v[148:151], v[204:207], v[116:119], v[148:151]
    ds_read_b64_tr_b16 v[196:197], v16 offset:24576
    ds_read_b64_tr_b16 v[198:199], v16 offset:25600
    v_fma_mix_f32 v248, v86, v238, v242 op_sel:[0,0,0] op_sel_hi:[1,1,1]
    v_fma_mix_f32 v249, v86, v238, v242 op_sel:[1,1,1] op_sel_hi:[1,1,1]
    v_mfma_f32_16x16x32_bf16 v[152:155], v[204:207], v[120:123], v[152:155]
    v_fma_mix_f32 v250, v87, v239, v243 op_sel:[0,0,0] op_sel_hi:[1,1,1]
    v_fma_mix_f32 v251, v87, v239, v243 op_sel:[1,1,1] op_sel_hi:[1,1,1]
    s_waitcnt lgkmcnt(10)
    v_mfma_f32_16x16x32_bf16 v[156:159], v[208:211], v[116:119], v[156:159]
    ds_read_b64_tr_b16 v[200:201], v17 offset:24576
    ds_read_b64_tr_b16 v[202:203], v17 offset:25600
    v_cvt_pk_bf16_f32 v124, v244, v245
    v_cvt_pk_bf16_f32 v125, v246, v247
    s_add_u32 s52, s53, 0x4000
    buffer_load_dwordx4 v[68:71], v8, s[24:27], s52 offen sc1
    v_mfma_f32_16x16x32_bf16 v[160:163], v[208:211], v[120:123], v[160:163]
    v_cvt_pk_bf16_f32 v126, v248, v249
    v_cvt_pk_bf16_f32 v127, v250, v251
    s_waitcnt lgkmcnt(10)
    v_mfma_f32_16x16x32_bf16 v[164:167], v[212:215], v[116:119], v[164:167]
    ds_read_b64_tr_b16 v[204:205], v18 offset:24576
    ds_read_b64_tr_b16 v[206:207], v18 offset:25600
    s_waitcnt vmcnt(14)
    v_fma_mix_f32 v244, v88, v236, v240 op_sel:[0,0,0] op_sel_hi:[1,1,1]
    ds_read_b128 v[228:231], v9 offset:1536
    ds_read_b128 v[232:235], v9 offset:1552
    v_mfma_f32_16x16x32_bf16 v[168:171], v[212:215], v[120:123], v[168:171]
    v_fma_mix_f32 v245, v88, v236, v240 op_sel:[1,1,1] op_sel_hi:[1,1,1]
    v_fma_mix_f32 v246, v89, v237, v241 op_sel:[0,0,0] op_sel_hi:[1,1,1]
    s_waitcnt lgkmcnt(12)
    v_mfma_f32_16x16x32_bf16 v[172:175], v[216:219], v[116:119], v[172:175]
    ds_read_b64_tr_b16 v[208:209], v19 offset:24576
    ds_read_b64_tr_b16 v[210:211], v19 offset:25600
    v_fma_mix_f32 v247, v89, v237, v241 op_sel:[1,1,1] op_sel_hi:[1,1,1]
    v_fma_mix_f32 v248, v90, v238, v242 op_sel:[0,0,0] op_sel_hi:[1,1,1]
    v_mfma_f32_16x16x32_bf16 v[176:179], v[216:219], v[120:123], v[176:179]
    v_fma_mix_f32 v249, v90, v238, v242 op_sel:[1,1,1] op_sel_hi:[1,1,1]
    v_fma_mix_f32 v250, v91, v239, v243 op_sel:[0,0,0] op_sel_hi:[1,1,1]
    s_waitcnt lgkmcnt(12)
    v_mfma_f32_16x16x32_bf16 v[180:183], v[220:223], v[116:119], v[180:183]
    ds_read_b64_tr_b16 v[212:213], v20 offset:24576
    ds_read_b64_tr_b16 v[214:215], v20 offset:25600
    v_fma_mix_f32 v251, v91, v239, v243 op_sel:[1,1,1] op_sel_hi:[1,1,1]
    v_cvt_pk_bf16_f32 v128, v244, v245
    s_add_u32 s52, s53, 0x9000
    buffer_load_dwordx4 v[72:75], v8, s[24:27], s52 offen sc1
    v_mfma_f32_16x16x32_bf16 v[184:187], v[220:223], v[120:123], v[184:187]
    v_cvt_pk_bf16_f32 v129, v246, v247
    v_cvt_pk_bf16_f32 v130, v248, v249
    s_waitcnt lgkmcnt(12)
    v_mfma_f32_16x16x32_bf16 v[188:191], v[224:227], v[116:119], v[188:191]
    ds_read_b64_tr_b16 v[216:217], v21 offset:24576
    ds_read_b64_tr_b16 v[218:219], v21 offset:25600
    v_cvt_pk_bf16_f32 v131, v250, v251
    v_mfma_f32_16x16x32_bf16 v[192:195], v[224:227], v[120:123], v[192:195]
    s_waitcnt lgkmcnt(12)
    v_mfma_f32_16x16x32_bf16 v[132:135], v[196:199], v[124:127], v[132:135]
    ds_read_b64_tr_b16 v[220:221], v22 offset:24576
    ds_read_b64_tr_b16 v[222:223], v22 offset:25600
    v_mfma_f32_16x16x32_bf16 v[136:139], v[196:199], v[128:131], v[136:139]
    s_waitcnt lgkmcnt(12)
    v_mfma_f32_16x16x32_bf16 v[140:143], v[200:203], v[124:127], v[140:143]
    ds_read_b64_tr_b16 v[224:225], v23 offset:24576
    ds_read_b64_tr_b16 v[226:227], v23 offset:25600
    s_waitcnt vmcnt(13) lgkmcnt(10)
    v_fma_mix_f32 v244, v92, v228, v232 op_sel:[0,0,0] op_sel_hi:[1,1,1]
    v_fma_mix_f32 v245, v92, v228, v232 op_sel:[1,1,1] op_sel_hi:[1,1,1]
    s_add_u32 s43, s51, 0x407c00
    s_add_u32 m0, s39, 0x20000
    s_nop 0
    buffer_load_dwordx4 v2, s[12:15], s43 offen offset:1024 lds
    v_mfma_f32_16x16x32_bf16 v[144:147], v[200:203], v[128:131], v[144:147]
    v_fma_mix_f32 v246, v93, v229, v233 op_sel:[0,0,0] op_sel_hi:[1,1,1]
    v_fma_mix_f32 v247, v93, v229, v233 op_sel:[1,1,1] op_sel_hi:[1,1,1]
    v_mfma_f32_16x16x32_bf16 v[148:151], v[204:207], v[124:127], v[148:151]
    s_waitcnt vmcnt(6)
    s_barrier
    ds_read_b64_tr_b16 v[196:197], v16 offset:32768
    ds_read_b64_tr_b16 v[198:199], v16 offset:33792
    v_fma_mix_f32 v248, v94, v230, v234 op_sel:[0,0,0] op_sel_hi:[1,1,1]
    v_fma_mix_f32 v249, v94, v230, v234 op_sel:[1,1,1] op_sel_hi:[1,1,1]
    v_mfma_f32_16x16x32_bf16 v[152:155], v[204:207], v[128:131], v[152:155]
    v_fma_mix_f32 v250, v95, v231, v235 op_sel:[0,0,0] op_sel_hi:[1,1,1]
    v_fma_mix_f32 v251, v95, v231, v235 op_sel:[1,1,1] op_sel_hi:[1,1,1]
    s_waitcnt lgkmcnt(10)
    v_mfma_f32_16x16x32_bf16 v[156:159], v[208:211], v[124:127], v[156:159]
    ds_read_b64_tr_b16 v[200:201], v17 offset:32768
    ds_read_b64_tr_b16 v[202:203], v17 offset:33792
    v_cvt_pk_bf16_f32 v116, v244, v245
    v_cvt_pk_bf16_f32 v117, v246, v247
    s_add_u32 s52, s53, 0x4400
    buffer_load_dwordx4 v[76:79], v8, s[24:27], s52 offen sc1
    v_mfma_f32_16x16x32_bf16 v[160:163], v[208:211], v[128:131], v[160:163]
    v_cvt_pk_bf16_f32 v118, v248, v249
    v_cvt_pk_bf16_f32 v119, v250, v251
    s_waitcnt lgkmcnt(10)
    v_mfma_f32_16x16x32_bf16 v[164:167], v[212:215], v[124:127], v[164:167]
    ds_read_b64_tr_b16 v[204:205], v18 offset:32768
    ds_read_b64_tr_b16 v[206:207], v18 offset:33792
    v_fma_mix_f32 v244, v96, v228, v232 op_sel:[0,0,0] op_sel_hi:[1,1,1]
    ds_read_b128 v[236:239], v9 offset:1664
    ds_read_b128 v[240:243], v9 offset:1680
    v_mfma_f32_16x16x32_bf16 v[168:171], v[212:215], v[128:131], v[168:171]
    v_fma_mix_f32 v245, v96, v228, v232 op_sel:[1,1,1] op_sel_hi:[1,1,1]
    v_fma_mix_f32 v246, v97, v229, v233 op_sel:[0,0,0] op_sel_hi:[1,1,1]
    s_waitcnt lgkmcnt(12)
    v_mfma_f32_16x16x32_bf16 v[172:175], v[216:219], v[124:127], v[172:175]
    ds_read_b64_tr_b16 v[208:209], v19 offset:32768
    ds_read_b64_tr_b16 v[210:211], v19 offset:33792
    v_fma_mix_f32 v247, v97, v229, v233 op_sel:[1,1,1] op_sel_hi:[1,1,1]
    v_fma_mix_f32 v248, v98, v230, v234 op_sel:[0,0,0] op_sel_hi:[1,1,1]
    v_mfma_f32_16x16x32_bf16 v[176:179], v[216:219], v[128:131], v[176:179]
    v_fma_mix_f32 v249, v98, v230, v234 op_sel:[1,1,1] op_sel_hi:[1,1,1]
    v_fma_mix_f32 v250, v99, v231, v235 op_sel:[0,0,0] op_sel_hi:[1,1,1]
    s_waitcnt lgkmcnt(12)
    v_mfma_f32_16x16x32_bf16 v[180:183], v[220:223], v[124:127], v[180:183]
    ds_read_b64_tr_b16 v[212:213], v20 offset:32768
    ds_read_b64_tr_b16 v[214:215], v20 offset:33792
    v_fma_mix_f32 v251, v99, v231, v235 op_sel:[1,1,1] op_sel_hi:[1,1,1]
    v_cvt_pk_bf16_f32 v120, v244, v245
    s_add_u32 s52, s53, 0x9400
    buffer_load_dwordx4 v[80:83], v8, s[24:27], s52 offen sc1
    v_mfma_f32_16x16x32_bf16 v[184:187], v[220:223], v[128:131], v[184:187]
    v_cvt_pk_bf16_f32 v121, v246, v247
    v_cvt_pk_bf16_f32 v122, v248, v249
    s_waitcnt lgkmcnt(12)
    v_mfma_f32_16x16x32_bf16 v[188:191], v[224:227], v[124:127], v[188:191]
    ds_read_b64_tr_b16 v[216:217], v21 offset:32768
    ds_read_b64_tr_b16 v[218:219], v21 offset:33792
    v_cvt_pk_bf16_f32 v123, v250, v251
    v_mfma_f32_16x16x32_bf16 v[192:195], v[224:227], v[128:131], v[192:195]
    s_waitcnt lgkmcnt(12)
    v_mfma_f32_16x16x32_bf16 v[132:135], v[196:199], v[116:119], v[132:135]
    ds_read_b64_tr_b16 v[220:221], v22 offset:32768
    ds_read_b64_tr_b16 v[222:223], v22 offset:33792
    v_mfma_f32_16x16x32_bf16 v[136:139], v[196:199], v[120:123], v[136:139]
    s_waitcnt lgkmcnt(12)
    v_mfma_f32_16x16x32_bf16 v[140:143], v[200:203], v[116:119], v[140:143]
    ds_read_b64_tr_b16 v[224:225], v23 offset:32768
    ds_read_b64_tr_b16 v[226:227], v23 offset:33792
    s_waitcnt lgkmcnt(10)
    v_fma_mix_f32 v244, v100, v236, v240 op_sel:[0,0,0] op_sel_hi:[1,1,1]
    v_fma_mix_f32 v245, v100, v236, v240 op_sel:[1,1,1] op_sel_hi:[1,1,1]
    s_add_u32 s43, s51, 0x480000
    s_add_u32 m0, s39, 0x0
    s_nop 0
    buffer_load_dwordx4 v2, s[12:15], s43 offen lds
    v_mfma_f32_16x16x32_bf16 v[144:147], v[200:203], v[120:123], v[144:147]
    v_fma_mix_f32 v246, v101, v237, v241 op_sel:[0,0,0] op_sel_hi:[1,1,1]
    v_fma_mix_f32 v247, v101, v237, v241 op_sel:[1,1,1] op_sel_hi:[1,1,1]
    v_mfma_f32_16x16x32_bf16 v[148:151], v[204:207], v[116:119], v[148:151]
    ds_read_b64_tr_b16 v[196:197], v16 offset:40960
    ds_read_b64_tr_b16 v[198:199], v16 offset:41984
    v_fma_mix_f32 v248, v102, v238, v242 op_sel:[0,0,0] op_sel_hi:[1,1,1]
    v_fma_mix_f32 v249, v102, v238, v242 op_sel:[1,1,1] op_sel_hi:[1,1,1]
    v_mfma_f32_16x16x32_bf16 v[152:155], v[204:207], v[120:123], v[152:155]
    v_fma_mix_f32 v250, v103, v239, v243 op_sel:[0,0,0] op_sel_hi:[1,1,1]
    v_fma_mix_f32 v251, v103, v239, v243 op_sel:[1,1,1] op_sel_hi:[1,1,1]
    s_waitcnt lgkmcnt(10)
    v_mfma_f32_16x16x32_bf16 v[156:159], v[208:211], v[116:119], v[156:159]
    ds_read_b64_tr_b16 v[200:201], v17 offset:40960
    ds_read_b64_tr_b16 v[202:203], v17 offset:41984
    v_cvt_pk_bf16_f32 v124, v244, v245
    v_cvt_pk_bf16_f32 v125, v246, v247
    s_add_u32 s52, s53, 0x4800
    buffer_load_dwordx4 v[84:87], v8, s[24:27], s52 offen sc1
    v_mfma_f32_16x16x32_bf16 v[160:163], v[208:211], v[120:123], v[160:163]
    v_cvt_pk_bf16_f32 v126, v248, v249
    v_cvt_pk_bf16_f32 v127, v250, v251
    s_waitcnt lgkmcnt(10)
    v_mfma_f32_16x16x32_bf16 v[164:167], v[212:215], v[116:119], v[164:167]
    ds_read_b64_tr_b16 v[204:205], v18 offset:40960
    ds_read_b64_tr_b16 v[206:207], v18 offset:41984
    v_fma_mix_f32 v244, v104, v236, v240 op_sel:[0,0,0] op_sel_hi:[1,1,1]
    ds_read_b128 v[228:231], v9 offset:1792
    ds_read_b128 v[232:235], v9 offset:1808
    v_mfma_f32_16x16x32_bf16 v[168:171], v[212:215], v[120:123], v[168:171]
    v_fma_mix_f32 v245, v104, v236, v240 op_sel:[1,1,1] op_sel_hi:[1,1,1]
    v_fma_mix_f32 v246, v105, v237, v241 op_sel:[0,0,0] op_sel_hi:[1,1,1]
    s_waitcnt lgkmcnt(12)
    v_mfma_f32_16x16x32_bf16 v[172:175], v[216:219], v[116:119], v[172:175]
    ds_read_b64_tr_b16 v[208:209], v19 offset:40960
    ds_read_b64_tr_b16 v[210:211], v19 offset:41984
    v_fma_mix_f32 v247, v105, v237, v241 op_sel:[1,1,1] op_sel_hi:[1,1,1]
    v_fma_mix_f32 v248, v106, v238, v242 op_sel:[0,0,0] op_sel_hi:[1,1,1]
    v_mfma_f32_16x16x32_bf16 v[176:179], v[216:219], v[120:123], v[176:179]
    v_fma_mix_f32 v249, v106, v238, v242 op_sel:[1,1,1] op_sel_hi:[1,1,1]
    v_fma_mix_f32 v250, v107, v239, v243 op_sel:[0,0,0] op_sel_hi:[1,1,1]
    s_waitcnt lgkmcnt(12)
    v_mfma_f32_16x16x32_bf16 v[180:183], v[220:223], v[116:119], v[180:183]
    ds_read_b64_tr_b16 v[212:213], v20 offset:40960
    ds_read_b64_tr_b16 v[214:215], v20 offset:41984
    v_fma_mix_f32 v251, v107, v239, v243 op_sel:[1,1,1] op_sel_hi:[1,1,1]
    v_cvt_pk_bf16_f32 v128, v244, v245
    s_add_u32 s52, s53, 0x9800
    buffer_load_dwordx4 v[88:91], v8, s[24:27], s52 offen sc1
    v_mfma_f32_16x16x32_bf16 v[184:187], v[220:223], v[120:123], v[184:187]
    v_cvt_pk_bf16_f32 v129, v246, v247
    v_cvt_pk_bf16_f32 v130, v248, v249
    s_waitcnt lgkmcnt(12)
    v_mfma_f32_16x16x32_bf16 v[188:191], v[224:227], v[116:119], v[188:191]
    ds_read_b64_tr_b16 v[216:217], v21 offset:40960
    ds_read_b64_tr_b16 v[218:219], v21 offset:41984
    v_cvt_pk_bf16_f32 v131, v250, v251
    v_mfma_f32_16x16x32_bf16 v[192:195], v[224:227], v[120:123], v[192:195]
    s_waitcnt lgkmcnt(12)
    v_mfma_f32_16x16x32_bf16 v[132:135], v[196:199], v[124:127], v[132:135]
    ds_read_b64_tr_b16 v[220:221], v22 offset:40960
    ds_read_b64_tr_b16 v[222:223], v22 offset:41984
    v_mfma_f32_16x16x32_bf16 v[136:139], v[196:199], v[128:131], v[136:139]
    s_waitcnt lgkmcnt(12)
    v_mfma_f32_16x16x32_bf16 v[140:143], v[200:203], v[124:127], v[140:143]
    ds_read_b64_tr_b16 v[224:225], v23 offset:40960
    ds_read_b64_tr_b16 v[226:227], v23 offset:41984
    s_waitcnt lgkmcnt(10)
    v_fma_mix_f32 v244, v52, v228, v232 op_sel:[0,0,0] op_sel_hi:[1,1,1]
    v_fma_mix_f32 v245, v52, v228, v232 op_sel:[1,1,1] op_sel_hi:[1,1,1]
    s_add_u32 s43, s51, 0x487c00
    s_add_u32 m0, s39, 0x0
    s_nop 0
    buffer_load_dwordx4 v2, s[12:15], s43 offen offset:1024 lds
    v_mfma_f32_16x16x32_bf16 v[144:147], v[200:203], v[128:131], v[144:147]
    v_fma_mix_f32 v246, v53, v229, v233 op_sel:[0,0,0] op_sel_hi:[1,1,1]
    v_fma_mix_f32 v247, v53, v229, v233 op_sel:[1,1,1] op_sel_hi:[1,1,1]
    v_mfma_f32_16x16x32_bf16 v[148:151], v[204:207], v[124:127], v[148:151]
    ds_read_b64_tr_b16 v[196:197], v16 offset:49152
    ds_read_b64_tr_b16 v[198:199], v16 offset:50176
    v_fma_mix_f32 v248, v54, v230, v234 op_sel:[0,0,0] op_sel_hi:[1,1,1]
    v_fma_mix_f32 v249, v54, v230, v234 op_sel:[1,1,1] op_sel_hi:[1,1,1]
    v_mfma_f32_16x16x32_bf16 v[152:155], v[204:207], v[128:131], v[152:155]
    v_fma_mix_f32 v250, v55, v231, v235 op_sel:[0,0,0] op_sel_hi:[1,1,1]
    v_fma_mix_f32 v251, v55, v231, v235 op_sel:[1,1,1] op_sel_hi:[1,1,1]
    s_waitcnt lgkmcnt(10)
    v_mfma_f32_16x16x32_bf16 v[156:159], v[208:211], v[124:127], v[156:159]
    ds_read_b64_tr_b16 v[200:201], v17 offset:49152
    ds_read_b64_tr_b16 v[202:203], v17 offset:50176
    v_cvt_pk_bf16_f32 v116, v244, v245
    v_cvt_pk_bf16_f32 v117, v246, v247
    s_add_u32 s52, s53, 0x4c00
    buffer_load_dwordx4 v[92:95], v8, s[24:27], s52 offen sc1
    v_mfma_f32_16x16x32_bf16 v[160:163], v[208:211], v[128:131], v[160:163]
    v_cvt_pk_bf16_f32 v118, v248, v249
    v_cvt_pk_bf16_f32 v119, v250, v251
    s_waitcnt lgkmcnt(10)
    v_mfma_f32_16x16x32_bf16 v[164:167], v[212:215], v[124:127], v[164:167]
    ds_read_b64_tr_b16 v[204:205], v18 offset:49152
    ds_read_b64_tr_b16 v[206:207], v18 offset:50176
    v_fma_mix_f32 v244, v56, v228, v232 op_sel:[0,0,0] op_sel_hi:[1,1,1]
    ds_read_b128 v[236:239], v9 offset:1920
    ds_read_b128 v[240:243], v9 offset:1936
    v_mfma_f32_16x16x32_bf16 v[168:171], v[212:215], v[128:131], v[168:171]
    v_fma_mix_f32 v245, v56, v228, v232 op_sel:[1,1,1] op_sel_hi:[1,1,1]
    v_fma_mix_f32 v246, v57, v229, v233 op_sel:[0,0,0] op_sel_hi:[1,1,1]
    s_waitcnt lgkmcnt(12)
    v_mfma_f32_16x16x32_bf16 v[172:175], v[216:219], v[124:127], v[172:175]
    ds_read_b64_tr_b16 v[208:209], v19 offset:49152
    ds_read_b64_tr_b16 v[210:211], v19 offset:50176
    v_fma_mix_f32 v247, v57, v229, v233 op_sel:[1,1,1] op_sel_hi:[1,1,1]
    v_fma_mix_f32 v248, v58, v230, v234 op_sel:[0,0,0] op_sel_hi:[1,1,1]
    v_mfma_f32_16x16x32_bf16 v[176:179], v[216:219], v[128:131], v[176:179]
    v_fma_mix_f32 v249, v58, v230, v234 op_sel:[1,1,1] op_sel_hi:[1,1,1]
    v_fma_mix_f32 v250, v59, v231, v235 op_sel:[0,0,0] op_sel_hi:[1,1,1]
    s_waitcnt lgkmcnt(12)
    v_mfma_f32_16x16x32_bf16 v[180:183], v[220:223], v[124:127], v[180:183]
    ds_read_b64_tr_b16 v[212:213], v20 offset:49152
    ds_read_b64_tr_b16 v[214:215], v20 offset:50176
    v_fma_mix_f32 v251, v59, v231, v235 op_sel:[1,1,1] op_sel_hi:[1,1,1]
    v_cvt_pk_bf16_f32 v120, v244, v245
    s_add_u32 s52, s53, 0x9c00
    buffer_load_dwordx4 v[96:99], v8, s[24:27], s52 offen sc1
    v_mfma_f32_16x16x32_bf16 v[184:187], v[220:223], v[128:131], v[184:187]
    v_cvt_pk_bf16_f32 v121, v246, v247
    v_cvt_pk_bf16_f32 v122, v248, v249
    s_waitcnt lgkmcnt(12)
    v_mfma_f32_16x16x32_bf16 v[188:191], v[224:227], v[124:127], v[188:191]
    ds_read_b64_tr_b16 v[216:217], v21 offset:49152
    ds_read_b64_tr_b16 v[218:219], v21 offset:50176
    v_cvt_pk_bf16_f32 v123, v250, v251
    v_mfma_f32_16x16x32_bf16 v[192:195], v[224:227], v[128:131], v[192:195]
    s_waitcnt lgkmcnt(12)
    v_mfma_f32_16x16x32_bf16 v[132:135], v[196:199], v[116:119], v[132:135]
    ds_read_b64_tr_b16 v[220:221], v22 offset:49152
    ds_read_b64_tr_b16 v[222:223], v22 offset:50176
    v_mfma_f32_16x16x32_bf16 v[136:139], v[196:199], v[120:123], v[136:139]
    s_waitcnt lgkmcnt(12)
    v_mfma_f32_16x16x32_bf16 v[140:143], v[200:203], v[116:119], v[140:143]
    ds_read_b64_tr_b16 v[224:225], v23 offset:49152
    ds_read_b64_tr_b16 v[226:227], v23 offset:50176
    s_waitcnt vmcnt(13) lgkmcnt(10)
    v_fma_mix_f32 v244, v60, v236, v240 op_sel:[0,0,0] op_sel_hi:[1,1,1]
    v_fma_mix_f32 v245, v60, v236, v240 op_sel:[1,1,1] op_sel_hi:[1,1,1]
    s_add_u32 s43, s50, 0x0
    s_add_u32 m0, s39, 0x4000
    s_nop 0
    buffer_load_dwordx4 v4, s[16:19], s43 offen lds
    v_mfma_f32_16x16x32_bf16 v[144:147], v[200:203], v[120:123], v[144:147]
    v_fma_mix_f32 v246, v61, v237, v241 op_sel:[0,0,0] op_sel_hi:[1,1,1]
    v_fma_mix_f32 v247, v61, v237, v241 op_sel:[1,1,1] op_sel_hi:[1,1,1]
    v_mfma_f32_16x16x32_bf16 v[148:151], v[204:207], v[116:119], v[148:151]
    ds_read_b64_tr_b16 v[196:197], v16 offset:57344
    ds_read_b64_tr_b16 v[198:199], v16 offset:58368
    v_fma_mix_f32 v248, v62, v238, v242 op_sel:[0,0,0] op_sel_hi:[1,1,1]
    v_fma_mix_f32 v249, v62, v238, v242 op_sel:[1,1,1] op_sel_hi:[1,1,1]
    v_mfma_f32_16x16x32_bf16 v[152:155], v[204:207], v[120:123], v[152:155]
    v_fma_mix_f32 v250, v63, v239, v243 op_sel:[0,0,0] op_sel_hi:[1,1,1]
    v_fma_mix_f32 v251, v63, v239, v243 op_sel:[1,1,1] op_sel_hi:[1,1,1]
    s_waitcnt lgkmcnt(10)
    v_mfma_f32_16x16x32_bf16 v[156:159], v[208:211], v[116:119], v[156:159]
    ds_read_b64_tr_b16 v[200:201], v17 offset:57344
    ds_read_b64_tr_b16 v[202:203], v17 offset:58368
    v_cvt_pk_bf16_f32 v124, v244, v245
    v_cvt_pk_bf16_f32 v125, v246, v247
    v_mfma_f32_16x16x32_bf16 v[160:163], v[208:211], v[120:123], v[160:163]
    v_cvt_pk_bf16_f32 v126, v248, v249
    v_cvt_pk_bf16_f32 v127, v250, v251
    s_waitcnt lgkmcnt(10)
    v_mfma_f32_16x16x32_bf16 v[164:167], v[212:215], v[116:119], v[164:167]
    ds_read_b64_tr_b16 v[204:205], v18 offset:57344
    ds_read_b64_tr_b16 v[206:207], v18 offset:58368
    s_waitcnt vmcnt(13)
    v_fma_mix_f32 v244, v64, v236, v240 op_sel:[0,0,0] op_sel_hi:[1,1,1]
    ds_read_b128 v[228:231], v9 offset:2048
    ds_read_b128 v[232:235], v9 offset:2064
    s_add_u32 s43, s50, 0x0
    s_add_u32 m0, s39, 0x4000
    s_nop 0
    buffer_load_dwordx4 v5, s[16:19], s43 offen offset:1024 lds
    v_mfma_f32_16x16x32_bf16 v[168:171], v[212:215], v[120:123], v[168:171]
    v_fma_mix_f32 v245, v64, v236, v240 op_sel:[1,1,1] op_sel_hi:[1,1,1]
    v_fma_mix_f32 v246, v65, v237, v241 op_sel:[0,0,0] op_sel_hi:[1,1,1]
    s_waitcnt lgkmcnt(12)
    v_mfma_f32_16x16x32_bf16 v[172:175], v[216:219], v[116:119], v[172:175]
    ds_read_b64_tr_b16 v[208:209], v19 offset:57344
    ds_read_b64_tr_b16 v[210:211], v19 offset:58368
    v_fma_mix_f32 v247, v65, v237, v241 op_sel:[1,1,1] op_sel_hi:[1,1,1]
    v_fma_mix_f32 v248, v66, v238, v242 op_sel:[0,0,0] op_sel_hi:[1,1,1]
    v_mfma_f32_16x16x32_bf16 v[176:179], v[216:219], v[120:123], v[176:179]
    v_fma_mix_f32 v249, v66, v238, v242 op_sel:[1,1,1] op_sel_hi:[1,1,1]
    v_fma_mix_f32 v250, v67, v239, v243 op_sel:[0,0,0] op_sel_hi:[1,1,1]
    s_waitcnt lgkmcnt(12)
    v_mfma_f32_16x16x32_bf16 v[180:183], v[220:223], v[116:119], v[180:183]
    ds_read_b64_tr_b16 v[212:213], v20 offset:57344
    ds_read_b64_tr_b16 v[214:215], v20 offset:58368
    v_fma_mix_f32 v251, v67, v239, v243 op_sel:[1,1,1] op_sel_hi:[1,1,1]
    v_cvt_pk_bf16_f32 v128, v244, v245
    v_mfma_f32_16x16x32_bf16 v[184:187], v[220:223], v[120:123], v[184:187]
    v_cvt_pk_bf16_f32 v129, v246, v247
    v_cvt_pk_bf16_f32 v130, v248, v249
    s_waitcnt lgkmcnt(12)
    v_mfma_f32_16x16x32_bf16 v[188:191], v[224:227], v[116:119], v[188:191]
    ds_read_b64_tr_b16 v[216:217], v21 offset:57344
    ds_read_b64_tr_b16 v[218:219], v21 offset:58368
    v_cvt_pk_bf16_f32 v131, v250, v251
    s_add_u32 s43, s50, 0x4000
    s_add_u32 m0, s39, 0x8000
    s_nop 0
    buffer_load_dwordx4 v4, s[16:19], s43 offen lds
    v_mfma_f32_16x16x32_bf16 v[192:195], v[224:227], v[120:123], v[192:195]
    s_waitcnt lgkmcnt(12)
    v_mfma_f32_16x16x32_bf16 v[132:135], v[196:199], v[124:127], v[132:135]
    ds_read_b64_tr_b16 v[220:221], v22 offset:57344
    ds_read_b64_tr_b16 v[222:223], v22 offset:58368
    v_mfma_f32_16x16x32_bf16 v[136:139], v[196:199], v[128:131], v[136:139]
    s_waitcnt lgkmcnt(12)
    v_mfma_f32_16x16x32_bf16 v[140:143], v[200:203], v[124:127], v[140:143]
    ds_read_b64_tr_b16 v[224:225], v23 offset:57344
    ds_read_b64_tr_b16 v[226:227], v23 offset:58368
    s_waitcnt vmcnt(13) lgkmcnt(10)
    v_fma_mix_f32 v244, v68, v228, v232 op_sel:[0,0,0] op_sel_hi:[1,1,1]
    v_fma_mix_f32 v245, v68, v228, v232 op_sel:[1,1,1] op_sel_hi:[1,1,1]
    v_mfma_f32_16x16x32_bf16 v[144:147], v[200:203], v[128:131], v[144:147]
    v_fma_mix_f32 v246, v69, v229, v233 op_sel:[0,0,0] op_sel_hi:[1,1,1]
    v_fma_mix_f32 v247, v69, v229, v233 op_sel:[1,1,1] op_sel_hi:[1,1,1]
    v_mfma_f32_16x16x32_bf16 v[148:151], v[204:207], v[124:127], v[148:151]
    s_waitcnt vmcnt(5)
    s_barrier
    v_add_u32 v16, 0x10000, v16
    v_add_u32 v17, 0x10000, v17
    v_add_u32 v18, 0x10000, v18
    v_add_u32 v19, 0x10000, v19
    v_add_u32 v20, 0x10000, v20
    v_add_u32 v21, 0x10000, v21
    v_add_u32 v22, 0x10000, v22
    v_add_u32 v23, 0x10000, v23
    ds_read_b64_tr_b16 v[196:197], v16 offset:0
    ds_read_b64_tr_b16 v[198:199], v16 offset:1024
    v_fma_mix_f32 v248, v70, v230, v234 op_sel:[0,0,0] op_sel_hi:[1,1,1]
    v_fma_mix_f32 v249, v70, v230, v234 op_sel:[1,1,1] op_sel_hi:[1,1,1]
    s_add_u32 s43, s50, 0x4000
    s_add_u32 m0, s39, 0x8000
    s_nop 0
    buffer_load_dwordx4 v5, s[16:19], s43 offen offset:1024 lds
    v_mfma_f32_16x16x32_bf16 v[152:155], v[204:207], v[128:131], v[152:155]
    v_fma_mix_f32 v250, v71, v231, v235 op_sel:[0,0,0] op_sel_hi:[1,1,1]
    v_fma_mix_f32 v251, v71, v231, v235 op_sel:[1,1,1] op_sel_hi:[1,1,1]
    s_waitcnt lgkmcnt(10)
    v_mfma_f32_16x16x32_bf16 v[156:159], v[208:211], v[124:127], v[156:159]
    ds_read_b64_tr_b16 v[200:201], v17 offset:0
    ds_read_b64_tr_b16 v[202:203], v17 offset:1024
    v_cvt_pk_bf16_f32 v116, v244, v245
    v_cvt_pk_bf16_f32 v117, v246, v247
    v_mfma_f32_16x16x32_bf16 v[160:163], v[208:211], v[128:131], v[160:163]
    v_cvt_pk_bf16_f32 v118, v248, v249
    v_cvt_pk_bf16_f32 v119, v250, v251
    s_waitcnt lgkmcnt(10)
    v_mfma_f32_16x16x32_bf16 v[164:167], v[212:215], v[124:127], v[164:167]
    ds_read_b64_tr_b16 v[204:205], v18 offset:0
    ds_read_b64_tr_b16 v[206:207], v18 offset:1024
    v_fma_mix_f32 v244, v72, v228, v232 op_sel:[0,0,0] op_sel_hi:[1,1,1]
    ds_read_b128 v[236:239], v9 offset:2176
    ds_read_b128 v[240:243], v9 offset:2192
    v_mfma_f32_16x16x32_bf16 v[168:171], v[212:215], v[128:131], v[168:171]
    v_fma_mix_f32 v245, v72, v228, v232 op_sel:[1,1,1] op_sel_hi:[1,1,1]
    v_fma_mix_f32 v246, v73, v229, v233 op_sel:[0,0,0] op_sel_hi:[1,1,1]
    s_waitcnt lgkmcnt(12)
    v_mfma_f32_16x16x32_bf16 v[172:175], v[216:219], v[124:127], v[172:175]
    ds_read_b64_tr_b16 v[208:209], v19 offset:0
    ds_read_b64_tr_b16 v[210:211], v19 offset:1024
    v_fma_mix_f32 v247, v73, v229, v233 op_sel:[1,1,1] op_sel_hi:[1,1,1]
    v_fma_mix_f32 v248, v74, v230, v234 op_sel:[0,0,0] op_sel_hi:[1,1,1]
    s_add_u32 s43, s50, 0x0
    s_add_u32 m0, s39, 0x10000
    s_nop 0
    buffer_load_dwordx4 v6, s[20:23], s43 offen lds
    v_mfma_f32_16x16x32_bf16 v[176:179], v[216:219], v[128:131], v[176:179]
    v_fma_mix_f32 v249, v74, v230, v234 op_sel:[1,1,1] op_sel_hi:[1,1,1]
    v_fma_mix_f32 v250, v75, v231, v235 op_sel:[0,0,0] op_sel_hi:[1,1,1]
    s_waitcnt lgkmcnt(12)
    v_mfma_f32_16x16x32_bf16 v[180:183], v[220:223], v[124:127], v[180:183]
    ds_read_b64_tr_b16 v[212:213], v20 offset:0
    ds_read_b64_tr_b16 v[214:215], v20 offset:1024
    v_fma_mix_f32 v251, v75, v231, v235 op_sel:[1,1,1] op_sel_hi:[1,1,1]
    v_cvt_pk_bf16_f32 v120, v244, v245
    v_mfma_f32_16x16x32_bf16 v[184:187], v[220:223], v[128:131], v[184:187]
    v_cvt_pk_bf16_f32 v121, v246, v247
    v_cvt_pk_bf16_f32 v122, v248, v249
    s_waitcnt lgkmcnt(12)
    v_mfma_f32_16x16x32_bf16 v[188:191], v[224:227], v[124:127], v[188:191]
    ds_read_b64_tr_b16 v[216:217], v21 offset:0
    ds_read_b64_tr_b16 v[218:219], v21 offset:1024
    v_cvt_pk_bf16_f32 v123, v250, v251
    v_mfma_f32_16x16x32_bf16 v[192:195], v[224:227], v[128:131], v[192:195]
    s_waitcnt lgkmcnt(12)
    v_mfma_f32_16x16x32_bf16 v[132:135], v[196:199], v[116:119], v[132:135]
    ds_read_b64_tr_b16 v[220:221], v22 offset:0
    ds_read_b64_tr_b16 v[222:223], v22 offset:1024
    s_add_u32 s43, s50, 0x0
    s_add_u32 m0, s39, 0x10000
    s_nop 0
    buffer_load_dwordx4 v7, s[20:23], s43 offen offset:1024 lds
    v_mfma_f32_16x16x32_bf16 v[136:139], v[196:199], v[120:123], v[136:139]
    s_waitcnt lgkmcnt(12)
    v_mfma_f32_16x16x32_bf16 v[140:143], v[200:203], v[116:119], v[140:143]
    ds_read_b64_tr_b16 v[224:225], v23 offset:0
    ds_read_b64_tr_b16 v[226:227], v23 offset:1024
    s_waitcnt lgkmcnt(10)
    v_fma_mix_f32 v244, v76, v236, v240 op_sel:[0,0,0] op_sel_hi:[1,1,1]
    v_fma_mix_f32 v245, v76, v236, v240 op_sel:[1,1,1] op_sel_hi:[1,1,1]
    v_mfma_f32_16x16x32_bf16 v[144:147], v[200:203], v[120:123], v[144:147]
    v_fma_mix_f32 v246, v77, v237, v241 op_sel:[0,0,0] op_sel_hi:[1,1,1]
    v_fma_mix_f32 v247, v77, v237, v241 op_sel:[1,1,1] op_sel_hi:[1,1,1]
    v_mfma_f32_16x16x32_bf16 v[148:151], v[204:207], v[116:119], v[148:151]
    ds_read_b64_tr_b16 v[196:197], v16 offset:8192
    ds_read_b64_tr_b16 v[198:199], v16 offset:9216
    v_fma_mix_f32 v248, v78, v238, v242 op_sel:[0,0,0] op_sel_hi:[1,1,1]
    v_fma_mix_f32 v249, v78, v238, v242 op_sel:[1,1,1] op_sel_hi:[1,1,1]
    v_mfma_f32_16x16x32_bf16 v[152:155], v[204:207], v[120:123], v[152:155]
    v_fma_mix_f32 v250, v79, v239, v243 op_sel:[0,0,0] op_sel_hi:[1,1,1]
    v_fma_mix_f32 v251, v79, v239, v243 op_sel:[1,1,1] op_sel_hi:[1,1,1]
    s_waitcnt lgkmcnt(10)
    v_mfma_f32_16x16x32_bf16 v[156:159], v[208:211], v[116:119], v[156:159]
    ds_read_b64_tr_b16 v[200:201], v17 offset:8192
    ds_read_b64_tr_b16 v[202:203], v17 offset:9216
    v_cvt_pk_bf16_f32 v124, v244, v245
    v_cvt_pk_bf16_f32 v125, v246, v247
    s_add_u32 s43, s50, 0x8000
    s_add_u32 m0, s39, 0xc000
    s_nop 0
    buffer_load_dwordx4 v4, s[16:19], s43 offen lds
    v_mfma_f32_16x16x32_bf16 v[160:163], v[208:211], v[120:123], v[160:163]
    v_cvt_pk_bf16_f32 v126, v248, v249
    v_cvt_pk_bf16_f32 v127, v250, v251
    s_waitcnt lgkmcnt(10)
    v_mfma_f32_16x16x32_bf16 v[164:167], v[212:215], v[116:119], v[164:167]
    ds_read_b64_tr_b16 v[204:205], v18 offset:8192
    ds_read_b64_tr_b16 v[206:207], v18 offset:9216
    v_fma_mix_f32 v244, v80, v236, v240 op_sel:[0,0,0] op_sel_hi:[1,1,1]
    ds_read_b128 v[228:231], v9 offset:2304
    ds_read_b128 v[232:235], v9 offset:2320
    v_mfma_f32_16x16x32_bf16 v[168:171], v[212:215], v[120:123], v[168:171]
    v_fma_mix_f32 v245, v80, v236, v240 op_sel:[1,1,1] op_sel_hi:[1,1,1]
    v_fma_mix_f32 v246, v81, v237, v241 op_sel:[0,0,0] op_sel_hi:[1,1,1]
    s_waitcnt lgkmcnt(12)
    v_mfma_f32_16x16x32_bf16 v[172:175], v[216:219], v[116:119], v[172:175]
    ds_read_b64_tr_b16 v[208:209], v19 offset:8192
    ds_read_b64_tr_b16 v[210:211], v19 offset:9216
    v_fma_mix_f32 v247, v81, v237, v241 op_sel:[1,1,1] op_sel_hi:[1,1,1]
    v_fma_mix_f32 v248, v82, v238, v242 op_sel:[0,0,0] op_sel_hi:[1,1,1]
    v_mfma_f32_16x16x32_bf16 v[176:179], v[216:219], v[120:123], v[176:179]
    v_fma_mix_f32 v249, v82, v238, v242 op_sel:[1,1,1] op_sel_hi:[1,1,1]
    v_fma_mix_f32 v250, v83, v239, v243 op_sel:[0,0,0] op_sel_hi:[1,1,1]
    s_waitcnt lgkmcnt(12)
    v_mfma_f32_16x16x32_bf16 v[180:183], v[220:223], v[116:119], v[180:183]
    ds_read_b64_tr_b16 v[212:213], v20 offset:8192
    ds_read_b64_tr_b16 v[214:215], v20 offset:9216
    v_fma_mix_f32 v251, v83, v239, v243 op_sel:[1,1,1] op_sel_hi:[1,1,1]
    v_cvt_pk_bf16_f32 v128, v244, v245
    s_add_u32 s43, s50, 0x8000
    s_add_u32 m0, s39, 0xc000
    s_nop 0
    buffer_load_dwordx4 v5, s[16:19], s43 offen offset:1024 lds
    v_mfma_f32_16x16x32_bf16 v[184:187], v[220:223], v[120:123], v[184:187]
    v_cvt_pk_bf16_f32 v129, v246, v247
    v_cvt_pk_bf16_f32 v130, v248, v249
    s_waitcnt lgkmcnt(12)
    v_mfma_f32_16x16x32_bf16 v[188:191], v[224:227], v[116:119], v[188:191]
    ds_read_b64_tr_b16 v[216:217], v21 offset:8192
    ds_read_b64_tr_b16 v[218:219], v21 offset:9216
    v_cvt_pk_bf16_f32 v131, v250, v251
    v_mfma_f32_16x16x32_bf16 v[192:195], v[224:227], v[120:123], v[192:195]
    s_waitcnt lgkmcnt(12)
    v_mfma_f32_16x16x32_bf16 v[132:135], v[196:199], v[124:127], v[132:135]
    ds_read_b64_tr_b16 v[220:221], v22 offset:8192
    ds_read_b64_tr_b16 v[222:223], v22 offset:9216
    v_mfma_f32_16x16x32_bf16 v[136:139], v[196:199], v[128:131], v[136:139]
    s_waitcnt lgkmcnt(12)
    v_mfma_f32_16x16x32_bf16 v[140:143], v[200:203], v[124:127], v[140:143]
    ds_read_b64_tr_b16 v[224:225], v23 offset:8192
    ds_read_b64_tr_b16 v[226:227], v23 offset:9216
    s_waitcnt lgkmcnt(10)
    v_fma_mix_f32 v244, v84, v228, v232 op_sel:[0,0,0] op_sel_hi:[1,1,1]
    v_fma_mix_f32 v245, v84, v228, v232 op_sel:[1,1,1] op_sel_hi:[1,1,1]
    s_add_u32 s43, s50, 0x4000
    s_add_u32 m0, s39, 0x14000
    s_nop 0
    buffer_load_dwordx4 v6, s[20:23], s43 offen lds
    v_mfma_f32_16x16x32_bf16 v[144:147], v[200:203], v[128:131], v[144:147]
    v_fma_mix_f32 v246, v85, v229, v233 op_sel:[0,0,0] op_sel_hi:[1,1,1]
    v_fma_mix_f32 v247, v85, v229, v233 op_sel:[1,1,1] op_sel_hi:[1,1,1]
    v_mfma_f32_16x16x32_bf16 v[148:151], v[204:207], v[124:127], v[148:151]
    v_subrev_u32 v16, 0x20000, v16
    v_subrev_u32 v17, 0x20000, v17
    v_subrev_u32 v18, 0x20000, v18
    v_subrev_u32 v19, 0x20000, v19
    v_subrev_u32 v20, 0x20000, v20
    v_subrev_u32 v21, 0x20000, v21
    v_subrev_u32 v22, 0x20000, v22
    v_subrev_u32 v23, 0x20000, v23
    ds_read_b64_tr_b16 v[196:197], v16 offset:0
    ds_read_b64_tr_b16 v[198:199], v16 offset:1024
    v_fma_mix_f32 v248, v86, v230, v234 op_sel:[0,0,0] op_sel_hi:[1,1,1]
    v_fma_mix_f32 v249, v86, v230, v234 op_sel:[1,1,1] op_sel_hi:[1,1,1]
    v_mfma_f32_16x16x32_bf16 v[152:155], v[204:207], v[128:131], v[152:155]
    v_fma_mix_f32 v250, v87, v231, v235 op_sel:[0,0,0] op_sel_hi:[1,1,1]
    v_fma_mix_f32 v251, v87, v231, v235 op_sel:[1,1,1] op_sel_hi:[1,1,1]
    s_waitcnt lgkmcnt(10)
    v_mfma_f32_16x16x32_bf16 v[156:159], v[208:211], v[124:127], v[156:159]
    ds_read_b64_tr_b16 v[200:201], v17 offset:0
    ds_read_b64_tr_b16 v[202:203], v17 offset:1024
    v_cvt_pk_bf16_f32 v116, v244, v245
    v_cvt_pk_bf16_f32 v117, v246, v247
    v_mfma_f32_16x16x32_bf16 v[160:163], v[208:211], v[128:131], v[160:163]
    v_cvt_pk_bf16_f32 v118, v248, v249
    v_cvt_pk_bf16_f32 v119, v250, v251
    s_waitcnt lgkmcnt(10)
    v_mfma_f32_16x16x32_bf16 v[164:167], v[212:215], v[124:127], v[164:167]
    ds_read_b64_tr_b16 v[204:205], v18 offset:0
    ds_read_b64_tr_b16 v[206:207], v18 offset:1024
    v_fma_mix_f32 v244, v88, v228, v232 op_sel:[0,0,0] op_sel_hi:[1,1,1]
    ds_read_b128 v[236:239], v9 offset:2432
    ds_read_b128 v[240:243], v9 offset:2448
    s_add_u32 s43, s50, 0x4000
    s_add_u32 m0, s39, 0x14000
    s_nop 0
    buffer_load_dwordx4 v7, s[20:23], s43 offen offset:1024 lds
    v_mfma_f32_16x16x32_bf16 v[168:171], v[212:215], v[128:131], v[168:171]
    v_fma_mix_f32 v245, v88, v228, v232 op_sel:[1,1,1] op_sel_hi:[1,1,1]
    v_fma_mix_f32 v246, v89, v229, v233 op_sel:[0,0,0] op_sel_hi:[1,1,1]
    s_waitcnt lgkmcnt(12)
    v_mfma_f32_16x16x32_bf16 v[172:175], v[216:219], v[124:127], v[172:175]
    ds_read_b64_tr_b16 v[208:209], v19 offset:0
    ds_read_b64_tr_b16 v[210:211], v19 offset:1024
    v_fma_mix_f32 v247, v89, v229, v233 op_sel:[1,1,1] op_sel_hi:[1,1,1]
    v_fma_mix_f32 v248, v90, v230, v234 op_sel:[0,0,0] op_sel_hi:[1,1,1]
    v_mfma_f32_16x16x32_bf16 v[176:179], v[216:219], v[128:131], v[176:179]
    v_fma_mix_f32 v249, v90, v230, v234 op_sel:[1,1,1] op_sel_hi:[1,1,1]
    v_fma_mix_f32 v250, v91, v231, v235 op_sel:[0,0,0] op_sel_hi:[1,1,1]
    s_waitcnt lgkmcnt(12)
    v_mfma_f32_16x16x32_bf16 v[180:183], v[220:223], v[124:127], v[180:183]
    ds_read_b64_tr_b16 v[212:213], v20 offset:0
    ds_read_b64_tr_b16 v[214:215], v20 offset:1024
    v_fma_mix_f32 v251, v91, v231, v235 op_sel:[1,1,1] op_sel_hi:[1,1,1]
    v_cvt_pk_bf16_f32 v120, v244, v245
    v_mfma_f32_16x16x32_bf16 v[184:187], v[220:223], v[128:131], v[184:187]
    v_cvt_pk_bf16_f32 v121, v246, v247
    v_cvt_pk_bf16_f32 v122, v248, v249
    s_waitcnt lgkmcnt(12)
    v_mfma_f32_16x16x32_bf16 v[188:191], v[224:227], v[124:127], v[188:191]
    ds_read_b64_tr_b16 v[216:217], v21 offset:0
    ds_read_b64_tr_b16 v[218:219], v21 offset:1024
    v_cvt_pk_bf16_f32 v123, v250, v251
    s_add_u32 s43, s50, 0x8000
    s_add_u32 m0, s39, 0x18000
    s_nop 0
    buffer_load_dwordx4 v6, s[20:23], s43 offen lds
    v_mfma_f32_16x16x32_bf16 v[192:195], v[224:227], v[128:131], v[192:195]
    s_waitcnt lgkmcnt(12)
    v_mfma_f32_16x16x32_bf16 v[132:135], v[196:199], v[116:119], v[132:135]
    ds_read_b64_tr_b16 v[220:221], v22 offset:0
    ds_read_b64_tr_b16 v[222:223], v22 offset:1024
    v_mfma_f32_16x16x32_bf16 v[136:139], v[196:199], v[120:123], v[136:139]
    s_waitcnt lgkmcnt(12)
    v_mfma_f32_16x16x32_bf16 v[140:143], v[200:203], v[116:119], v[140:143]
    ds_read_b64_tr_b16 v[224:225], v23 offset:0
    ds_read_b64_tr_b16 v[226:227], v23 offset:1024
    s_waitcnt vmcnt(12) lgkmcnt(10)
    v_fma_mix_f32 v244, v92, v236, v240 op_sel:[0,0,0] op_sel_hi:[1,1,1]
    v_fma_mix_f32 v245, v92, v236, v240 op_sel:[1,1,1] op_sel_hi:[1,1,1]
    v_mfma_f32_16x16x32_bf16 v[144:147], v[200:203], v[120:123], v[144:147]
    v_fma_mix_f32 v246, v93, v237, v241 op_sel:[0,0,0] op_sel_hi:[1,1,1]
    v_fma_mix_f32 v247, v93, v237, v241 op_sel:[1,1,1] op_sel_hi:[1,1,1]
    v_mfma_f32_16x16x32_bf16 v[148:151], v[204:207], v[116:119], v[148:151]
    ds_read_b64_tr_b16 v[196:197], v16 offset:8192
    ds_read_b64_tr_b16 v[198:199], v16 offset:9216
    v_fma_mix_f32 v248, v94, v238, v242 op_sel:[0,0,0] op_sel_hi:[1,1,1]
    v_fma_mix_f32 v249, v94, v238, v242 op_sel:[1,1,1] op_sel_hi:[1,1,1]
    s_add_u32 s43, s50, 0x8000
    s_add_u32 m0, s39, 0x18000
    s_nop 0
    buffer_load_dwordx4 v7, s[20:23], s43 offen offset:1024 lds
    v_mfma_f32_16x16x32_bf16 v[152:155], v[204:207], v[120:123], v[152:155]
    v_fma_mix_f32 v250, v95, v239, v243 op_sel:[0,0,0] op_sel_hi:[1,1,1]
    v_fma_mix_f32 v251, v95, v239, v243 op_sel:[1,1,1] op_sel_hi:[1,1,1]
    s_waitcnt lgkmcnt(10)
    v_mfma_f32_16x16x32_bf16 v[156:159], v[208:211], v[116:119], v[156:159]
    ds_read_b64_tr_b16 v[200:201], v17 offset:8192
    ds_read_b64_tr_b16 v[202:203], v17 offset:9216
    v_cvt_pk_bf16_f32 v124, v244, v245
    v_cvt_pk_bf16_f32 v125, v246, v247
    v_mfma_f32_16x16x32_bf16 v[160:163], v[208:211], v[120:123], v[160:163]
    v_cvt_pk_bf16_f32 v126, v248, v249
    v_cvt_pk_bf16_f32 v127, v250, v251
    s_waitcnt lgkmcnt(10)
    v_mfma_f32_16x16x32_bf16 v[164:167], v[212:215], v[116:119], v[164:167]
    ds_read_b64_tr_b16 v[204:205], v18 offset:8192
    ds_read_b64_tr_b16 v[206:207], v18 offset:9216
    s_waitcnt vmcnt(12)
    v_fma_mix_f32 v244, v96, v236, v240 op_sel:[0,0,0] op_sel_hi:[1,1,1]
    v_mfma_f32_16x16x32_bf16 v[168:171], v[212:215], v[120:123], v[168:171]
    v_fma_mix_f32 v245, v96, v236, v240 op_sel:[1,1,1] op_sel_hi:[1,1,1]
    v_fma_mix_f32 v246, v97, v237, v241 op_sel:[0,0,0] op_sel_hi:[1,1,1]
    s_waitcnt lgkmcnt(10)
    v_mfma_f32_16x16x32_bf16 v[172:175], v[216:219], v[116:119], v[172:175]
    ds_read_b64_tr_b16 v[208:209], v19 offset:8192
    ds_read_b64_tr_b16 v[210:211], v19 offset:9216
    v_fma_mix_f32 v247, v97, v237, v241 op_sel:[1,1,1] op_sel_hi:[1,1,1]
    v_fma_mix_f32 v248, v98, v238, v242 op_sel:[0,0,0] op_sel_hi:[1,1,1]
    v_mfma_f32_16x16x32_bf16 v[176:179], v[216:219], v[120:123], v[176:179]
    v_fma_mix_f32 v249, v98, v238, v242 op_sel:[1,1,1] op_sel_hi:[1,1,1]
    v_fma_mix_f32 v250, v99, v239, v243 op_sel:[0,0,0] op_sel_hi:[1,1,1]
    s_waitcnt lgkmcnt(10)
    v_mfma_f32_16x16x32_bf16 v[180:183], v[220:223], v[116:119], v[180:183]
    ds_read_b64_tr_b16 v[212:213], v20 offset:8192
    ds_read_b64_tr_b16 v[214:215], v20 offset:9216
    v_fma_mix_f32 v251, v99, v239, v243 op_sel:[1,1,1] op_sel_hi:[1,1,1]
    v_cvt_pk_bf16_f32 v128, v244, v245
    v_mfma_f32_16x16x32_bf16 v[184:187], v[220:223], v[120:123], v[184:187]
    v_cvt_pk_bf16_f32 v129, v246, v247
    v_cvt_pk_bf16_f32 v130, v248, v249
    s_waitcnt lgkmcnt(10)
    v_mfma_f32_16x16x32_bf16 v[188:191], v[224:227], v[116:119], v[188:191]
    ds_read_b64_tr_b16 v[216:217], v21 offset:8192
    ds_read_b64_tr_b16 v[218:219], v21 offset:9216
    v_cvt_pk_bf16_f32 v131, v250, v251
    v_mfma_f32_16x16x32_bf16 v[192:195], v[224:227], v[120:123], v[192:195]
    s_waitcnt lgkmcnt(10)
    v_mfma_f32_16x16x32_bf16 v[132:135], v[196:199], v[124:127], v[132:135]
    ds_read_b64_tr_b16 v[220:221], v22 offset:8192
    ds_read_b64_tr_b16 v[222:223], v22 offset:9216
    v_mfma_f32_16x16x32_bf16 v[136:139], v[196:199], v[128:131], v[136:139]
    s_waitcnt lgkmcnt(10)
    v_mfma_f32_16x16x32_bf16 v[140:143], v[200:203], v[124:127], v[140:143]
    ds_read_b64_tr_b16 v[224:225], v23 offset:8192
    ds_read_b64_tr_b16 v[226:227], v23 offset:9216
    v_mfma_f32_16x16x32_bf16 v[144:147], v[200:203], v[128:131], v[144:147]
    s_waitcnt lgkmcnt(10)
    v_mfma_f32_16x16x32_bf16 v[148:151], v[204:207], v[124:127], v[148:151]
    s_waitcnt vmcnt(10)
    s_barrier
    ds_read_b64 v[196:197], v24 offset:16384
    ds_read_b64 v[198:199], v25 offset:16384
    v_mfma_f32_16x16x32_bf16 v[152:155], v[204:207], v[128:131], v[152:155]
    v_xor_b32 v16, 0, v3
    v_xor_b32 v17, 32, v3
    v_xor_b32 v18, 64, v3
    v_xor_b32 v19, 96, v3
    v_xor_b32 v20, 128, v3
    v_xor_b32 v21, 160, v3
    v_xor_b32 v22, 192, v3
    v_xor_b32 v23, 224, v3
    s_waitcnt lgkmcnt(10)
    v_mfma_f32_16x16x32_bf16 v[156:159], v[208:211], v[124:127], v[156:159]
    ds_read_b64 v[200:201], v26 offset:16384
    ds_read_b64 v[202:203], v27 offset:16384
    v_mul_f32 v44, s48, v132
    v_mul_f32 v45, s48, v133
    v_mul_f32 v46, s48, v134
    v_mul_f32 v47, s48, v135
    v_cvt_pk_bf16_f32 v52, v44, v45
    v_cvt_pk_bf16_f32 v53, v46, v47
    s_add_u32 s43, s50, 0xc000
    s_add_u32 m0, s39, 0x1c000
    s_nop 0
    buffer_load_dwordx4 v6, s[20:23], s43 offen lds
    v_mfma_f32_16x16x32_bf16 v[160:163], v[208:211], v[128:131], v[160:163]
    v_mul_f32 v48, s48, v140
    v_mul_f32 v49, s48, v141
    v_mul_f32 v50, s48, v142
    v_mul_f32 v51, s48, v143
    v_cvt_pk_bf16_f32 v54, v48, v49
    v_cvt_pk_bf16_f32 v55, v50, v51
    s_waitcnt lgkmcnt(10)
    v_mfma_f32_16x16x32_bf16 v[164:167], v[212:215], v[124:127], v[164:167]
    ds_read_b64 v[204:205], v28 offset:16384
    ds_read_b64 v[206:207], v29 offset:16384
    v_mul_f32 v44, s48, v136
    v_mul_f32 v45, s48, v137
    v_mul_f32 v46, s48, v138
    v_mul_f32 v47, s48, v139
    v_cvt_pk_bf16_f32 v56, v44, v45
    v_cvt_pk_bf16_f32 v57, v46, v47
    v_mfma_f32_16x16x32_bf16 v[168:171], v[212:215], v[128:131], v[168:171]
    v_mul_f32 v48, s48, v144
    v_mul_f32 v49, s48, v145
    v_mul_f32 v50, s48, v146
    v_mul_f32 v51, s48, v147
    v_cvt_pk_bf16_f32 v58, v48, v49
    v_cvt_pk_bf16_f32 v59, v50, v51
    s_waitcnt lgkmcnt(10)
    v_mfma_f32_16x16x32_bf16 v[172:175], v[216:219], v[124:127], v[172:175]
    ds_read_b64 v[208:209], v30 offset:16384
    ds_read_b64 v[210:211], v31 offset:16384
    v_mul_f32 v44, s48, v148
    v_mul_f32 v45, s48, v149
    v_mul_f32 v46, s48, v150
    v_mul_f32 v47, s48, v151
    v_cvt_pk_bf16_f32 v60, v44, v45
    v_cvt_pk_bf16_f32 v61, v46, v47
    v_mfma_f32_16x16x32_bf16 v[176:179], v[216:219], v[128:131], v[176:179]
    v_mul_f32 v48, s48, v156
    v_mul_f32 v49, s48, v157
    v_mul_f32 v50, s48, v158
    v_mul_f32 v51, s48, v159
    v_cvt_pk_bf16_f32 v62, v48, v49
    v_cvt_pk_bf16_f32 v63, v50, v51
    s_waitcnt lgkmcnt(10)
    v_mfma_f32_16x16x32_bf16 v[180:183], v[220:223], v[124:127], v[180:183]
    v_mul_f32 v44, s48, v152
    v_mul_f32 v45, s48, v153
    v_mul_f32 v46, s48, v154
    v_mul_f32 v47, s48, v155
    v_cvt_pk_bf16_f32 v64, v44, v45
    v_cvt_pk_bf16_f32 v65, v46, v47
    s_add_u32 s43, s50, 0xc000
    s_add_u32 m0, s39, 0x1c000
    s_nop 0
    buffer_load_dwordx4 v7, s[20:23], s43 offen offset:1024 lds
    v_mfma_f32_16x16x32_bf16 v[184:187], v[220:223], v[128:131], v[184:187]
    v_mul_f32 v48, s48, v160
    v_mul_f32 v49, s48, v161
    v_mul_f32 v50, s48, v162
    v_mul_f32 v51, s48, v163
    v_cvt_pk_bf16_f32 v66, v48, v49
    v_cvt_pk_bf16_f32 v67, v50, v51
    s_waitcnt lgkmcnt(8)
    v_mfma_f32_16x16x32_bf16 v[188:191], v[224:227], v[124:127], v[188:191]
    v_mul_f32 v44, s48, v164
    v_mul_f32 v45, s48, v165
    v_mul_f32 v46, s48, v166
    v_mul_f32 v47, s48, v167
    v_cvt_pk_bf16_f32 v68, v44, v45
    v_cvt_pk_bf16_f32 v69, v46, v47
    v_mul_f32 v48, s48, v172
    v_mul_f32 v49, s48, v173
    v_mul_f32 v50, s48, v174
    v_mul_f32 v51, s48, v175
    v_cvt_pk_bf16_f32 v70, v48, v49
    v_cvt_pk_bf16_f32 v71, v50, v51
    v_mfma_f32_16x16x32_bf16 v[192:195], v[224:227], v[128:131], v[192:195]
    v_mul_f32 v44, s48, v168
    v_mul_f32 v45, s48, v169
    v_mul_f32 v46, s48, v170
    v_mul_f32 v47, s48, v171
    v_cvt_pk_bf16_f32 v72, v44, v45
    v_cvt_pk_bf16_f32 v73, v46, v47
    v_mul_f32 v48, s48, v176
    v_mul_f32 v49, s48, v177
    v_mul_f32 v50, s48, v178
    v_mul_f32 v51, s48, v179
    v_cvt_pk_bf16_f32 v74, v48, v49
    v_cvt_pk_bf16_f32 v75, v50, v51
    v_mul_f32 v44, s48, v180
    v_mul_f32 v45, s48, v181
    v_mul_f32 v46, s48, v182
    v_mul_f32 v47, s48, v183
    v_cvt_pk_bf16_f32 v76, v44, v45
    v_cvt_pk_bf16_f32 v77, v46, v47
    v_mul_f32 v48, s48, v188
    v_mul_f32 v49, s48, v189
    v_mul_f32 v50, s48, v190
    v_mul_f32 v51, s48, v191
    v_cvt_pk_bf16_f32 v78, v48, v49
    v_cvt_pk_bf16_f32 v79, v50, v51
    v_mul_f32 v44, s48, v184
    v_mul_f32 v45, s48, v185
    v_mul_f32 v46, s48, v186
    v_mul_f32 v47, s48, v187
    v_cvt_pk_bf16_f32 v80, v44, v45
    v_cvt_pk_bf16_f32 v81, v46, v47
    v_mul_f32 v48, s48, v192
    v_mul_f32 v49, s48, v193
    v_mul_f32 v50, s48, v194
    v_mul_f32 v51, s48, v195
    v_cvt_pk_bf16_f32 v82, v48, v49
    v_cvt_pk_bf16_f32 v83, v50, v51
    s_waitcnt lgkmcnt(6)
    v_mfma_f32_16x16x32_bf16 v[84:87], v[196:199], v[52:55], 0
    v_mfma_f32_16x16x32_bf16 v[88:91], v[196:199], v[56:59], 0
    ds_read_b64 v[196:197], v24 offset:20480
    ds_read_b64 v[198:199], v25 offset:20480
    s_waitcnt lgkmcnt(6)
    v_mfma_f32_16x16x32_bf16 v[84:87], v[200:203], v[60:63], v[84:87]
    v_mfma_f32_16x16x32_bf16 v[88:91], v[200:203], v[64:67], v[88:91]
    ds_read_b64 v[200:201], v26 offset:20480
    ds_read_b64 v[202:203], v27 offset:20480
    s_waitcnt lgkmcnt(6)
    v_mfma_f32_16x16x32_bf16 v[84:87], v[204:207], v[68:71], v[84:87]
    v_mfma_f32_16x16x32_bf16 v[88:91], v[204:207], v[72:75], v[88:91]
    ds_read_b64 v[204:205], v28 offset:20480
    ds_read_b64 v[206:207], v29 offset:20480
    s_waitcnt lgkmcnt(6)
    v_mfma_f32_16x16x32_bf16 v[84:87], v[208:211], v[76:79], v[84:87]
    v_mfma_f32_16x16x32_bf16 v[88:91], v[208:211], v[80:83], v[88:91]
    ds_read_b64 v[208:209], v30 offset:20480
    ds_read_b64 v[210:211], v31 offset:20480
    s_waitcnt lgkmcnt(6)
    v_mfma_f32_16x16x32_bf16 v[92:95], v[196:199], v[52:55], 0
    v_mfma_f32_16x16x32_bf16 v[96:99], v[196:199], v[56:59], 0
    ds_read_b64 v[196:197], v24 offset:24576
    ds_read_b64 v[198:199], v25 offset:24576
    s_waitcnt lgkmcnt(6)
    v_mfma_f32_16x16x32_bf16 v[92:95], v[200:203], v[60:63], v[92:95]
    v_mfma_f32_16x16x32_bf16 v[96:99], v[200:203], v[64:67], v[96:99]
    ds_read_b64 v[200:201], v26 offset:24576
    ds_read_b64 v[202:203], v27 offset:24576
    s_waitcnt lgkmcnt(6)
    v_mfma_f32_16x16x32_bf16 v[92:95], v[204:207], v[68:71], v[92:95]
    v_mfma_f32_16x16x32_bf16 v[96:99], v[204:207], v[72:75], v[96:99]
    ds_read_b64 v[204:205], v28 offset:24576
    ds_read_b64 v[206:207], v29 offset:24576
    s_waitcnt lgkmcnt(6)
    v_mfma_f32_16x16x32_bf16 v[92:95], v[208:211], v[76:79], v[92:95]
    v_mfma_f32_16x16x32_bf16 v[96:99], v[208:211], v[80:83], v[96:99]
    ds_read_b64 v[208:209], v30 offset:24576
    ds_read_b64 v[210:211], v31 offset:24576
    s_waitcnt lgkmcnt(6)
    v_mfma_f32_16x16x32_bf16 v[100:103], v[196:199], v[52:55], 0
    v_mfma_f32_16x16x32_bf16 v[104:107], v[196:199], v[56:59], 0
    ds_read_b64 v[196:197], v24 offset:28672
    ds_read_b64 v[198:199], v25 offset:28672
    s_waitcnt lgkmcnt(6)
    v_mfma_f32_16x16x32_bf16 v[100:103], v[200:203], v[60:63], v[100:103]
    v_max3_f32 v124, v84, v85, v86
    v_max3_f32 v44, v87, v92, v93
    v_max3_f32 v124, v124, v94, v95
    v_max_f32 v124, v124, v44
    v_max3_f32 v125, v88, v89, v90
    v_max3_f32 v45, v91, v96, v97
    s_mul_i32 s72, s2, 8
    s_add_u32 s72, s72, s93
    s_sub_u32 s73, s72, 1280
    s_cmp_lt_u32 s72, 1280
    s_cselect_b32 s73, s72, s73
    s_cselect_b32 s78, 128, 54
    s_mov_b32 s74, 0x21c000
    s_cselect_b32 s74, 0x500000, s74
    s_mov_b32 s75, 0x2a00000
    s_cselect_b32 s75, 0x2400000, s75
    s_cselect_b32 s60, s84, s86
    s_cselect_b32 s61, s85, s87
    s_cmp_lt_u32 s72, 1280
    s_cselect_b32 s62, s74, 0
    s_mov_b32 s63, 0x20000
    s_add_u32 s64, s94, s75
    s_addc_u32 s65, s95, 0
    s_mov_b32 s66, s62
    s_mov_b32 s67, 0x20000
    s_mul_hi_u32 s76, s73, 0x1999999a
    s_mul_i32 s77, s76, 10
    s_sub_u32 s77, s73, s77
    s_mul_i32 s73, s76, 40960
    s_lshl_b32 s74, s77, 7
    s_add_u32 s73, s73, s74
    v_mfma_f32_16x16x32_bf16 v[104:107], v[200:203], v[64:67], v[104:107]
    ds_read_b64 v[200:201], v26 offset:28672
    ds_read_b64 v[202:203], v27 offset:28672
    v_max3_f32 v125, v125, v98, v99
    v_max_f32 v125, v125, v45
    v_mov_b32 v44, v124
    v_mov_b32 v45, v125
    s_nop 0
    v_permlane16_swap_b32 v124, v44
    v_permlane16_swap_b32 v125, v45
    v_lshrrev_b32 v231, 3, v1
    s_waitcnt lgkmcnt(6)
    v_mfma_f32_16x16x32_bf16 v[100:103], v[204:207], v[68:71], v[100:103]
    s_waitcnt vmcnt(8)
    s_barrier
    v_max_f32 v124, v124, v44
    v_max_f32 v125, v125, v45
    v_mov_b32 v44, v124
    v_mov_b32 v45, v125
    s_nop 0
    v_permlane32_swap_b32 v124, v44
    v_permlane32_swap_b32 v125, v45
    v_mul_u32_u24 v228, 1280, v231
    v_mfma_f32_16x16x32_bf16 v[104:107], v[204:207], v[72:75], v[104:107]
    ds_read_b64 v[204:205], v28 offset:28672
    ds_read_b64 v[206:207], v29 offset:28672
    v_max_f32 v124, v124, v44
    v_max_f32 v125, v125, v45
    v_sub_f32 v36, 0, v124
    v_sub_f32 v37, 0, v124
    v_sub_f32 v38, 0, v124
    v_sub_f32 v39, 0, v124
    s_waitcnt lgkmcnt(6)
    v_mfma_f32_16x16x32_bf16 v[100:103], v[208:211], v[76:79], v[100:103]
    v_sub_f32 v40, 0, v125
    v_sub_f32 v41, 0, v125
    v_sub_f32 v42, 0, v125
    v_sub_f32 v43, 0, v125
    v_add_f32 v44, v84, v36
    v_add_f32 v45, v85, v36
    v_and_b32 v231, 7, v1
    v_mfma_f32_16x16x32_bf16 v[104:107], v[208:211], v[80:83], v[104:107]
    ds_read_b64 v[208:209], v30 offset:28672
    ds_read_b64 v[210:211], v31 offset:28672
    v_add_f32 v46, v86, v36
    v_add_f32 v47, v87, v36
    v_exp_f32 v44, v44
    v_exp_f32 v45, v45
    v_add_f32 v48, v92, v36
    v_add_f32 v49, v93, v36
    v_lshl_add_u32 v228, v231, 4, v228
    s_waitcnt lgkmcnt(6)
    v_mfma_f32_16x16x32_bf16 v[108:111], v[196:199], v[52:55], 0
    ds_read_b64_tr_b16 v[212:213], v16 offset:0
    ds_read_b64_tr_b16 v[214:215], v16 offset:4096
    v_exp_f32 v46, v46
    v_exp_f32 v47, v47
    v_add_f32 v14, v44, v45
    v_cvt_pk_bf16_f32 v116, v44, v45
    v_add_f32 v50, v94, v36
    v_add_f32 v51, v95, v36
    s_add_u32 s43, s50, 0xc000
    s_add_u32 m0, s39, 0x0
    s_nop 0
    buffer_load_dwordx4 v4, s[16:19], s43 offen lds
    v_lshrrev_b32 v229, 2, v1
    v_mfma_f32_16x16x32_bf16 v[112:115], v[196:199], v[56:59], 0
    ds_read_b64 v[196:197], v24 offset:32768
    ds_read_b64 v[198:199], v25 offset:32768
    v_exp_f32 v48, v48
    v_exp_f32 v49, v49
    v_add_f32 v32, v46, v47
    v_add_f32 v14, v14, v32
    v_cvt_pk_bf16_f32 v117, v46, v47
    v_add_f32 v44, v88, v40
    s_waitcnt lgkmcnt(8)
    v_mfma_f32_16x16x32_bf16 v[108:111], v[200:203], v[60:63], v[108:111]
    v_add_f32 v45, v89, v40
    v_exp_f32 v50, v50
    v_exp_f32 v51, v51
    v_add_f32 v32, v48, v49
    v_add_f32 v14, v14, v32
    v_cvt_pk_bf16_f32 v118, v48, v49
    v_lshlrev_b32 v229, 7, v229
    v_mfma_f32_16x16x32_bf16 v[112:115], v[200:203], v[64:67], v[112:115]
    ds_read_b64 v[200:201], v26 offset:32768
    ds_read_b64 v[202:203], v27 offset:32768
    v_add_f32 v46, v90, v40
    v_add_f32 v47, v91, v40
    v_exp_f32 v44, v44
    v_exp_f32 v45, v45
    v_add_f32 v32, v50, v51
    v_add_f32 v14, v14, v32
    v_and_b32 v231, 3, v1
    s_waitcnt lgkmcnt(8)
    v_mfma_f32_16x16x32_bf16 v[108:111], v[204:207], v[68:71], v[108:111]
    ds_read_b64_tr_b16 v[216:217], v17 offset:0
    ds_read_b64_tr_b16 v[218:219], v17 offset:4096
    v_cvt_pk_bf16_f32 v119, v50, v51
    v_add_f32 v48, v96, v40
    v_add_f32 v49, v97, v40
    v_exp_f32 v46, v46
    v_exp_f32 v47, v47
    v_add_f32 v15, v44, v45
    v_lshl_add_u32 v229, v231, 3, v229
    v_mfma_f32_16x16x32_bf16 v[112:115], v[204:207], v[72:75], v[112:115]
    ds_read_b64 v[204:205], v28 offset:32768
    ds_read_b64 v[206:207], v29 offset:32768
    v_cvt_pk_bf16_f32 v120, v44, v45
    v_add_f32 v50, v98, v40
    v_add_f32 v51, v99, v40
    v_exp_f32 v48, v48
    v_exp_f32 v49, v49
    v_add_f32 v32, v46, v47
    s_waitcnt lgkmcnt(10)
    v_mfma_f32_16x16x32_bf16 v[108:111], v[208:211], v[76:79], v[108:111]
    v_add_f32 v15, v15, v32
    v_cvt_pk_bf16_f32 v121, v46, v47
    v_exp_f32 v50, v50
    v_exp_f32 v51, v51
    v_add_f32 v32, v48, v49
    v_add_f32 v15, v15, v32
    s_lshl_b32 s75, s93, 12
    s_add_u32 s75, s75, 0x20000
    v_mfma_f32_16x16x32_bf16 v[112:115], v[208:211], v[80:83], v[112:115]
    ds_read_b64 v[208:209], v30 offset:32768
    ds_read_b64 v[210:211], v31 offset:32768
    v_cvt_pk_bf16_f32 v122, v48, v49
    v_add_f32 v32, v50, v51
    v_add_f32 v15, v15, v32
    v_cvt_pk_bf16_f32 v123, v50, v51
    v_mov_b32 v12, v14
    v_mov_b32 v13, v15
    v_add_u32 v229, s75, v229
    s_waitcnt lgkmcnt(8)
    v_mfma_f32_16x16x32_bf16 v[84:87], v[196:199], v[52:55], v[36:39]
    ds_read_b64_tr_b16 v[220:221], v18 offset:0
    ds_read_b64_tr_b16 v[222:223], v18 offset:4096
    v_lshlrev_b32 v230, 4, v1
    v_mfma_f32_16x16x32_bf16 v[88:91], v[196:199], v[56:59], v[40:43]
    s_waitcnt lgkmcnt(8)
    v_mfma_f32_16x16x32_bf16 v[84:87], v[200:203], v[60:63], v[84:87]
    ds_read_b64 v[196:197], v24 offset:36864
    ds_read_b64 v[198:199], v25 offset:36864
    v_add_f32 v44, v100, v36
    v_add_f32 v45, v101, v36
    v_mfma_f32_16x16x32_bf16 v[88:91], v[200:203], v[64:67], v[88:91]
    v_add_f32 v46, v102, v36
    v_add_f32 v47, v103, v36
    v_mfma_f32_16x16x32_bf16 v[132:135], v[212:215], v[116:119], 0
    ds_read_b64_tr_b16 v[224:225], v19 offset:0
    ds_read_b64_tr_b16 v[226:227], v19 offset:4096
    v_exp_f32 v44, v44
    v_exp_f32 v45, v45
    s_add_u32 s43, s50, 0xc000
    s_add_u32 m0, s39, 0x0
    s_nop 0
    buffer_load_dwordx4 v5, s[16:19], s43 offen offset:1024 lds
    s_add_u32 m0, s75, 0
    s_add_u32 s80, s73, 0
    buffer_load_dwordx4 v228, s[60:63], s80 offen lds
    v_mfma_f32_16x16x32_bf16 v[136:139], v[212:215], v[120:123], 0
    v_add_f32 v48, v108, v36
    v_add_f32 v49, v109, v36
    s_waitcnt lgkmcnt(8)
    v_mfma_f32_16x16x32_bf16 v[84:87], v[204:207], v[68:71], v[84:87]
    ds_read_b64 v[200:201], v26 offset:36864
    ds_read_b64 v[202:203], v27 offset:36864
    v_exp_f32 v46, v46
    v_mfma_f32_16x16x32_bf16 v[88:91], v[204:207], v[72:75], v[88:91]
    v_exp_f32 v47, v47
    v_add_f32 v14, v44, v45
    v_mfma_f32_16x16x32_bf16 v[140:143], v[216:219], v[116:119], 0
    ds_read_b64_tr_b16 v[212:213], v20 offset:0
    ds_read_b64_tr_b16 v[214:215], v20 offset:4096
    v_cvt_pk_bf16_f32 v124, v44, v45
    v_add_f32 v50, v110, v36
    v_mfma_f32_16x16x32_bf16 v[144:147], v[216:219], v[120:123], 0
    v_add_f32 v51, v111, v36
    v_exp_f32 v48, v48
    s_waitcnt lgkmcnt(10)
    v_mfma_f32_16x16x32_bf16 v[84:87], v[208:211], v[76:79], v[84:87]
    ds_read_b64 v[204:205], v28 offset:36864
    ds_read_b64 v[206:207], v29 offset:36864
    v_exp_f32 v49, v49
    v_add_f32 v32, v46, v47
    s_add_u32 m0, s75, 1024
    s_add_u32 s80, s73, 10240
    buffer_load_dwordx4 v228, s[60:63], s80 offen lds
    v_mfma_f32_16x16x32_bf16 v[88:91], v[208:211], v[80:83], v[88:91]
    v_add_f32 v14, v14, v32
    s_waitcnt lgkmcnt(10)
    v_mfma_f32_16x16x32_bf16 v[148:151], v[220:223], v[116:119], 0
    ds_read_b64_tr_b16 v[216:217], v21 offset:0
    ds_read_b64_tr_b16 v[218:219], v21 offset:4096
    v_cvt_pk_bf16_f32 v125, v46, v47
    v_add_f32 v44, v104, v40
    v_mfma_f32_16x16x32_bf16 v[152:155], v[220:223], v[120:123], 0
    v_add_f32 v45, v105, v40
    v_exp_f32 v50, v50
    s_waitcnt lgkmcnt(10)
    v_mfma_f32_16x16x32_bf16 v[92:95], v[196:199], v[52:55], v[36:39]
    ds_read_b64 v[208:209], v30 offset:36864
    ds_read_b64 v[210:211], v31 offset:36864
    v_exp_f32 v51, v51
    v_add_f32 v32, v48, v49
    v_mfma_f32_16x16x32_bf16 v[96:99], v[196:199], v[56:59], v[40:43]
    v_add_f32 v14, v14, v32
    v_cvt_pk_bf16_f32 v126, v48, v49
    s_waitcnt lgkmcnt(10)
    v_mfma_f32_16x16x32_bf16 v[156:159], v[224:227], v[116:119], 0
    ds_read_b64_tr_b16 v[220:221], v22 offset:0
    ds_read_b64_tr_b16 v[222:223], v22 offset:4096
    v_add_f32 v46, v106, v40
    s_add_u32 m0, s75, 2048
    s_add_u32 s80, s73, 20480
    buffer_load_dwordx4 v228, s[60:63], s80 offen lds
    v_mfma_f32_16x16x32_bf16 v[160:163], v[224:227], v[120:123], 0
    v_add_f32 v47, v107, v40
    v_exp_f32 v44, v44
    s_waitcnt lgkmcnt(10)
    v_mfma_f32_16x16x32_bf16 v[92:95], v[200:203], v[60:63], v[92:95]
    ds_read_b64_tr_b16 v[224:225], v23 offset:0
    ds_read_b64_tr_b16 v[226:227], v23 offset:4096
    v_exp_f32 v45, v45
    v_add_f32 v32, v50, v51
    v_mfma_f32_16x16x32_bf16 v[96:99], v[200:203], v[64:67], v[96:99]
    v_add_f32 v14, v14, v32
    v_cvt_pk_bf16_f32 v127, v50, v51
    s_waitcnt lgkmcnt(10)
    v_mfma_f32_16x16x32_bf16 v[164:167], v[212:215], v[116:119], 0
    ds_read_b64 v[196:197], v24 offset:40960
    ds_read_b64 v[198:199], v25 offset:40960
    v_add_f32 v48, v112, v40
    v_add_f32 v49, v113, v40
    v_mfma_f32_16x16x32_bf16 v[168:171], v[212:215], v[120:123], 0
    v_exp_f32 v46, v46
    s_waitcnt lgkmcnt(10)
    v_mfma_f32_16x16x32_bf16 v[92:95], v[204:207], v[68:71], v[92:95]
    ds_read_b64 v[200:201], v26 offset:40960
    ds_read_b64 v[202:203], v27 offset:40960
    v_exp_f32 v47, v47
    v_add_f32 v15, v44, v45
    s_add_u32 m0, s75, 3072
    s_add_u32 s80, s73, 30720
    buffer_load_dwordx4 v228, s[60:63], s80 offen lds
    v_mfma_f32_16x16x32_bf16 v[96:99], v[204:207], v[72:75], v[96:99]
    v_cvt_pk_bf16_f32 v128, v44, v45
    v_add_f32 v50, v114, v40
    s_waitcnt lgkmcnt(10)
    v_mfma_f32_16x16x32_bf16 v[172:175], v[216:219], v[116:119], 0
    ds_read_b64_tr_b16 v[212:213], v16 offset:8192
    ds_read_b64_tr_b16 v[214:215], v16 offset:12288
    v_add_f32 v51, v115, v40
    v_exp_f32 v48, v48
    v_mfma_f32_16x16x32_bf16 v[176:179], v[216:219], v[120:123], 0
    v_exp_f32 v49, v49
    v_add_f32 v32, v46, v47
    s_waitcnt lgkmcnt(10)
    v_mfma_f32_16x16x32_bf16 v[92:95], v[208:211], v[76:79], v[92:95]
    ds_read_b64 v[204:205], v28 offset:40960
    ds_read_b64 v[206:207], v29 offset:40960
    v_add_f32 v15, v15, v32
    v_mfma_f32_16x16x32_bf16 v[96:99], v[208:211], v[80:83], v[96:99]
    v_cvt_pk_bf16_f32 v129, v46, v47
    v_exp_f32 v50, v50
    s_waitcnt lgkmcnt(10)
    v_mfma_f32_16x16x32_bf16 v[180:183], v[220:223], v[116:119], 0
    ds_read_b64_tr_b16 v[216:217], v17 offset:8192
    ds_read_b64_tr_b16 v[218:219], v17 offset:12288
    v_exp_f32 v51, v51
    v_add_f32 v32, v48, v49
    v_mfma_f32_16x16x32_bf16 v[184:187], v[220:223], v[120:123], 0
    v_add_f32 v15, v15, v32
    v_cvt_pk_bf16_f32 v130, v48, v49
    s_waitcnt lgkmcnt(10)
    v_mfma_f32_16x16x32_bf16 v[188:191], v[224:227], v[116:119], 0
    ds_read_b64 v[208:209], v30 offset:40960
    ds_read_b64 v[210:211], v31 offset:40960
    v_add_f32 v32, v50, v51
    v_add_f32 v15, v15, v32
    v_mfma_f32_16x16x32_bf16 v[192:195], v[224:227], v[120:123], 0
    v_cvt_pk_bf16_f32 v131, v50, v51
    v_add_f32 v32, v14, v15
    v_cmp_nge_f32 vcc, s49, v32
    s_cbranch_vccnz L_attn_cold1
L_attn_back1:
    v_add_f32 v12, v12, v14
    v_add_f32 v13, v13, v15
    s_waitcnt lgkmcnt(10)
    v_mfma_f32_16x16x32_bf16 v[100:103], v[196:199], v[52:55], v[36:39]
    ds_read_b64_tr_b16 v[220:221], v18 offset:8192
    ds_read_b64_tr_b16 v[222:223], v18 offset:12288
    v_mfma_f32_16x16x32_bf16 v[104:107], v[196:199], v[56:59], v[40:43]
    s_waitcnt lgkmcnt(10)
    v_mfma_f32_16x16x32_bf16 v[100:103], v[200:203], v[60:63], v[100:103]
    ds_read_b64 v[196:197], v24 offset:45056
    ds_read_b64 v[198:199], v25 offset:45056
    v_exp_f32 v44, v84
    v_exp_f32 v45, v85
    v_mfma_f32_16x16x32_bf16 v[104:107], v[200:203], v[64:67], v[104:107]
    v_exp_f32 v46, v86
    s_waitcnt lgkmcnt(10)
    v_mfma_f32_16x16x32_bf16 v[132:135], v[212:215], v[124:127], v[132:135]
    ds_read_b64_tr_b16 v[224:225], v19 offset:8192
    ds_read_b64_tr_b16 v[226:227], v19 offset:12288
    v_exp_f32 v47, v87
    v_mfma_f32_16x16x32_bf16 v[136:139], v[212:215], v[128:131], v[136:139]
    v_add_f32 v14, v44, v45
    v_cvt_pk_bf16_f32 v116, v44, v45
    s_waitcnt lgkmcnt(10)
    v_mfma_f32_16x16x32_bf16 v[100:103], v[204:207], v[68:71], v[100:103]
    ds_read_b64 v[200:201], v26 offset:45056
    ds_read_b64 v[202:203], v27 offset:45056
    v_exp_f32 v48, v92
    v_mfma_f32_16x16x32_bf16 v[104:107], v[204:207], v[72:75], v[104:107]
    v_exp_f32 v49, v93
    s_waitcnt lgkmcnt(10)
    v_mfma_f32_16x16x32_bf16 v[140:143], v[216:219], v[124:127], v[140:143]
    ds_read_b64_tr_b16 v[212:213], v20 offset:8192
    ds_read_b64_tr_b16 v[214:215], v20 offset:12288
    v_add_f32 v32, v46, v47
    v_mfma_f32_16x16x32_bf16 v[144:147], v[216:219], v[128:131], v[144:147]
    v_add_f32 v14, v14, v32
    v_cvt_pk_bf16_f32 v117, v46, v47
    s_waitcnt lgkmcnt(10)
    v_mfma_f32_16x16x32_bf16 v[100:103], v[208:211], v[76:79], v[100:103]
    ds_read_b64 v[204:205], v28 offset:45056
    ds_read_b64 v[206:207], v29 offset:45056
    v_exp_f32 v50, v94
    v_mfma_f32_16x16x32_bf16 v[104:107], v[208:211], v[80:83], v[104:107]
    v_exp_f32 v51, v95
    s_waitcnt lgkmcnt(10)
    v_mfma_f32_16x16x32_bf16 v[148:151], v[220:223], v[124:127], v[148:151]
    ds_read_b64_tr_b16 v[216:217], v21 offset:8192
    ds_read_b64_tr_b16 v[218:219], v21 offset:12288
    v_add_f32 v32, v48, v49
    v_mfma_f32_16x16x32_bf16 v[152:155], v[220:223], v[128:131], v[152:155]
    v_add_f32 v14, v14, v32
    v_cvt_pk_bf16_f32 v118, v48, v49
    s_waitcnt lgkmcnt(10)
    v_mfma_f32_16x16x32_bf16 v[108:111], v[196:199], v[52:55], v[36:39]
    ds_read_b64 v[208:209], v30 offset:45056
    ds_read_b64 v[210:211], v31 offset:45056
    v_exp_f32 v44, v88
    v_mfma_f32_16x16x32_bf16 v[112:115], v[196:199], v[56:59], v[40:43]
    v_exp_f32 v45, v89
    s_waitcnt lgkmcnt(10)
    v_mfma_f32_16x16x32_bf16 v[156:159], v[224:227], v[124:127], v[156:159]
    ds_read_b64_tr_b16 v[220:221], v22 offset:8192
    ds_read_b64_tr_b16 v[222:223], v22 offset:12288
    v_add_f32 v32, v50, v51
    v_mfma_f32_16x16x32_bf16 v[160:163], v[224:227], v[128:131], v[160:163]
    v_add_f32 v14, v14, v32
    v_cvt_pk_bf16_f32 v119, v50, v51
    s_waitcnt lgkmcnt(10)
    v_mfma_f32_16x16x32_bf16 v[108:111], v[200:203], v[60:63], v[108:111]
    ds_read_b64_tr_b16 v[224:225], v23 offset:8192
    ds_read_b64_tr_b16 v[226:227], v23 offset:12288
    v_exp_f32 v46, v90
    v_mfma_f32_16x16x32_bf16 v[112:115], v[200:203], v[64:67], v[112:115]
    v_exp_f32 v47, v91
    s_waitcnt lgkmcnt(10)
    v_mfma_f32_16x16x32_bf16 v[164:167], v[212:215], v[124:127], v[164:167]
    s_waitcnt vmcnt(10)
    s_barrier
    ds_read_b64 v[196:197], v24 offset:49152
    ds_read_b64 v[198:199], v25 offset:49152
    v_add_f32 v15, v44, v45
    v_cvt_pk_bf16_f32 v120, v44, v45
    v_mfma_f32_16x16x32_bf16 v[168:171], v[212:215], v[128:131], v[168:171]
    v_exp_f32 v48, v96
    s_waitcnt lgkmcnt(10)
    v_mfma_f32_16x16x32_bf16 v[108:111], v[204:207], v[68:71], v[108:111]
    ds_read_b64 v[200:201], v26 offset:49152
    ds_read_b64 v[202:203], v27 offset:49152
    v_exp_f32 v49, v97
    v_mfma_f32_16x16x32_bf16 v[112:115], v[204:207], v[72:75], v[112:115]
    v_add_f32 v32, v46, v47
    s_waitcnt lgkmcnt(10)
    v_mfma_f32_16x16x32_bf16 v[172:175], v[216:219], v[124:127], v[172:175]
    ds_read_b64_tr_b16 v[212:213], v16 offset:16384
    ds_read_b64_tr_b16 v[214:215], v16 offset:20480
    v_add_f32 v15, v15, v32
    v_cvt_pk_bf16_f32 v121, v46, v47
    s_add_u32 s43, s50, 0x10000
    s_add_u32 m0, s39, 0x4000
    s_nop 0
    buffer_load_dwordx4 v4, s[16:19], s43 offen lds
    v_mfma_f32_16x16x32_bf16 v[176:179], v[216:219], v[128:131], v[176:179]
    v_exp_f32 v50, v98
    s_waitcnt lgkmcnt(10)
    v_mfma_f32_16x16x32_bf16 v[108:111], v[208:211], v[76:79], v[108:111]
    ds_read_b64 v[204:205], v28 offset:49152
    ds_read_b64 v[206:207], v29 offset:49152
    v_exp_f32 v51, v99
    v_mfma_f32_16x16x32_bf16 v[112:115], v[208:211], v[80:83], v[112:115]
    v_add_f32 v32, v48, v49
    s_waitcnt lgkmcnt(10)
    v_mfma_f32_16x16x32_bf16 v[180:183], v[220:223], v[124:127], v[180:183]
    ds_read_b64_tr_b16 v[216:217], v17 offset:16384
    ds_read_b64_tr_b16 v[218:219], v17 offset:20480
    v_add_f32 v15, v15, v32
    v_cvt_pk_bf16_f32 v122, v48, v49
    v_mfma_f32_16x16x32_bf16 v[184:187], v[220:223], v[128:131], v[184:187]
    v_add_f32 v32, v50, v51
    s_waitcnt lgkmcnt(10)
    v_mfma_f32_16x16x32_bf16 v[188:191], v[224:227], v[124:127], v[188:191]
    ds_read_b64 v[208:209], v30 offset:49152
    ds_read_b64 v[210:211], v31 offset:49152
    v_add_f32 v15, v15, v32
    v_mfma_f32_16x16x32_bf16 v[192:195], v[224:227], v[128:131], v[192:195]
    v_cvt_pk_bf16_f32 v123, v50, v51
    v_add_f32 v32, v14, v15
    v_cmp_nge_f32 vcc, s49, v32
    s_cbranch_vccnz L_attn_cold2
L_attn_back2:
    v_add_f32 v12, v12, v14
    v_add_f32 v13, v13, v15
    s_waitcnt lgkmcnt(10)
    v_mfma_f32_16x16x32_bf16 v[84:87], v[196:199], v[52:55], v[36:39]
    ds_read_b64_tr_b16 v[220:221], v18 offset:16384
    ds_read_b64_tr_b16 v[222:223], v18 offset:20480
    v_mfma_f32_16x16x32_bf16 v[88:91], v[196:199], v[56:59], v[40:43]
    s_waitcnt lgkmcnt(10)
    v_mfma_f32_16x16x32_bf16 v[84:87], v[200:203], v[60:63], v[84:87]
    ds_read_b64 v[196:197], v24 offset:53248
    ds_read_b64 v[198:199], v25 offset:53248
    v_exp_f32 v44, v100
    v_exp_f32 v45, v101
    v_mfma_f32_16x16x32_bf16 v[88:91], v[200:203], v[64:67], v[88:91]
    v_exp_f32 v46, v102
    s_waitcnt lgkmcnt(10)
    v_mfma_f32_16x16x32_bf16 v[132:135], v[212:215], v[116:119], v[132:135]
    ds_read_b64_tr_b16 v[224:225], v19 offset:16384
    ds_read_b64_tr_b16 v[226:227], v19 offset:20480
    v_exp_f32 v47, v103
    s_add_u32 s43, s50, 0x10000
    s_add_u32 m0, s39, 0x4000
    s_nop 0
    buffer_load_dwordx4 v5, s[16:19], s43 offen offset:1024 lds
    v_mfma_f32_16x16x32_bf16 v[136:139], v[212:215], v[120:123], v[136:139]
    v_add_f32 v14, v44, v45
    v_cvt_pk_bf16_f32 v124, v44, v45
    s_waitcnt lgkmcnt(10)
    v_mfma_f32_16x16x32_bf16 v[84:87], v[204:207], v[68:71], v[84:87]
    ds_read_b64 v[200:201], v26 offset:53248
    ds_read_b64 v[202:203], v27 offset:53248
    v_exp_f32 v48, v108
    s_waitcnt vmcnt(2)
    ds_read_b64_tr_b16 v[232:233], v229 offset:0
    ds_read_b64_tr_b16 v[234:235], v229 offset:2048
    v_mfma_f32_16x16x32_bf16 v[88:91], v[204:207], v[72:75], v[88:91]
    v_exp_f32 v49, v109
    s_waitcnt lgkmcnt(12)
    v_mfma_f32_16x16x32_bf16 v[140:143], v[216:219], v[116:119], v[140:143]
    ds_read_b64_tr_b16 v[212:213], v20 offset:16384
    ds_read_b64_tr_b16 v[214:215], v20 offset:20480
    v_add_f32 v32, v46, v47
    v_mfma_f32_16x16x32_bf16 v[144:147], v[216:219], v[120:123], v[144:147]
    v_add_f32 v14, v14, v32
    v_cvt_pk_bf16_f32 v125, v46, v47
    s_waitcnt lgkmcnt(12)
    v_mfma_f32_16x16x32_bf16 v[84:87], v[208:211], v[76:79], v[84:87]
    ds_read_b64 v[204:205], v28 offset:53248
    ds_read_b64 v[206:207], v29 offset:53248
    v_exp_f32 v50, v110
    ds_read_b64_tr_b16 v[236:237], v229 offset:32
    ds_read_b64_tr_b16 v[238:239], v229 offset:2080
    v_mfma_f32_16x16x32_bf16 v[88:91], v[208:211], v[80:83], v[88:91]
    v_exp_f32 v51, v111
    s_waitcnt lgkmcnt(14)
    v_mfma_f32_16x16x32_bf16 v[148:151], v[220:223], v[116:119], v[148:151]
    ds_read_b64_tr_b16 v[216:217], v21 offset:16384
    ds_read_b64_tr_b16 v[218:219], v21 offset:20480
    v_add_f32 v32, v48, v49
    v_mfma_f32_16x16x32_bf16 v[152:155], v[220:223], v[120:123], v[152:155]
    v_add_f32 v14, v14, v32
    v_cvt_pk_bf16_f32 v126, v48, v49
    s_waitcnt lgkmcnt(14)
    v_mfma_f32_16x16x32_bf16 v[92:95], v[196:199], v[52:55], v[36:39]
    ds_read_b64 v[208:209], v30 offset:53248
    ds_read_b64 v[210:211], v31 offset:53248
    v_exp_f32 v44, v104
    ds_read_b64_tr_b16 v[240:241], v229 offset:64
    ds_read_b64_tr_b16 v[242:243], v229 offset:2112
    v_mfma_f32_16x16x32_bf16 v[96:99], v[196:199], v[56:59], v[40:43]
    v_exp_f32 v45, v105
    s_waitcnt lgkmcnt(15)
    v_mfma_f32_16x16x32_bf16 v[156:159], v[224:227], v[116:119], v[156:159]
    ds_read_b64_tr_b16 v[220:221], v22 offset:16384
    ds_read_b64_tr_b16 v[222:223], v22 offset:20480
    v_add_f32 v32, v50, v51
    v_mfma_f32_16x16x32_bf16 v[160:163], v[224:227], v[120:123], v[160:163]
    v_add_f32 v14, v14, v32
    v_cvt_pk_bf16_f32 v127, v50, v51
    s_waitcnt lgkmcnt(15)
    v_mfma_f32_16x16x32_bf16 v[92:95], v[200:203], v[60:63], v[92:95]
    ds_read_b64_tr_b16 v[224:225], v23 offset:16384
    ds_read_b64_tr_b16 v[226:227], v23 offset:20480
    v_exp_f32 v46, v106
    ds_read_b64_tr_b16 v[244:245], v229 offset:96
    ds_read_b64_tr_b16 v[246:247], v229 offset:2144
    v_mfma_f32_16x16x32_bf16 v[96:99], v[200:203], v[64:67], v[96:99]
    v_exp_f32 v47, v107
    s_waitcnt lgkmcnt(15)
    v_mfma_f32_16x16x32_bf16 v[164:167], v[212:215], v[116:119], v[164:167]
    ds_read_b64 v[196:197], v24 offset:57344
    ds_read_b64 v[198:199], v25 offset:57344
    v_add_f32 v15, v44, v45
    v_cvt_pk_bf16_f32 v128, v44, v45
    v_mfma_f32_16x16x32_bf16 v[168:171], v[212:215], v[120:123], v[168:171]
    v_exp_f32 v48, v112
    s_waitcnt lgkmcnt(15)
    v_mfma_f32_16x16x32_bf16 v[92:95], v[204:207], v[68:71], v[92:95]
    ds_read_b64 v[200:201], v26 offset:57344
    ds_read_b64 v[202:203], v27 offset:57344
    v_exp_f32 v49, v113
    v_mfma_f32_16x16x32_bf16 v[96:99], v[204:207], v[72:75], v[96:99]
    v_add_f32 v32, v46, v47
    s_waitcnt lgkmcnt(14)
    v_mfma_f32_16x16x32_bf16 v[172:175], v[216:219], v[116:119], v[172:175]
    ds_read_b64_tr_b16 v[212:213], v16 offset:24576
    ds_read_b64_tr_b16 v[214:215], v16 offset:28672
    v_add_f32 v15, v15, v32
    v_cvt_pk_bf16_f32 v129, v46, v47
    v_mfma_f32_16x16x32_bf16 v[176:179], v[216:219], v[120:123], v[176:179]
    v_exp_f32 v50, v114
    s_waitcnt lgkmcnt(14)
    v_mfma_f32_16x16x32_bf16 v[92:95], v[208:211], v[76:79], v[92:95]
    ds_read_b64 v[204:205], v28 offset:57344
    ds_read_b64 v[206:207], v29 offset:57344
    v_exp_f32 v51, v115
    s_lshl_b32 s80, s77, 2
    s_add_u32 s80, s80, 0
    s_mul_i32 s82, s80, 52429
    s_lshr_b32 s82, s82, 18
    s_mul_i32 s81, s82, 5
    s_sub_u32 s80, s80, s81
    s_mul_i32 s81, s82, s78
    s_add_u32 s81, s81, s76
    s_mul_i32 s81, s81, 5
    s_add_u32 s80, s80, s81
    s_lshl_b32 s80, s80, 10
    buffer_store_dwordx4 v[232:235], v230, s[64:67], s80 offen sc1
    v_mfma_f32_16x16x32_bf16 v[96:99], v[208:211], v[80:83], v[96:99]
    v_add_f32 v32, v48, v49
    s_waitcnt lgkmcnt(12)
    v_mfma_f32_16x16x32_bf16 v[180:183], v[220:223], v[116:119], v[180:183]
    ds_read_b64_tr_b16 v[216:217], v17 offset:24576
    ds_read_b64_tr_b16 v[218:219], v17 offset:28672
    v_add_f32 v15, v15, v32
    v_cvt_pk_bf16_f32 v130, v48, v49
    v_mfma_f32_16x16x32_bf16 v[184:187], v[220:223], v[120:123], v[184:187]
    v_add_f32 v32, v50, v51
    s_waitcnt lgkmcnt(12)
    v_mfma_f32_16x16x32_bf16 v[188:191], v[224:227], v[116:119], v[188:191]
    ds_read_b64 v[208:209], v30 offset:57344
    ds_read_b64 v[210:211], v31 offset:57344
    v_add_f32 v15, v15, v32
    s_lshl_b32 s80, s77, 2
    s_add_u32 s80, s80, 1
    s_mul_i32 s82, s80, 52429
    s_lshr_b32 s82, s82, 18
    s_mul_i32 s81, s82, 5
    s_sub_u32 s80, s80, s81
    s_mul_i32 s81, s82, s78
    s_add_u32 s81, s81, s76
    s_mul_i32 s81, s81, 5
    s_add_u32 s80, s80, s81
    s_lshl_b32 s80, s80, 10
    buffer_store_dwordx4 v[236:239], v230, s[64:67], s80 offen sc1
    v_mfma_f32_16x16x32_bf16 v[192:195], v[224:227], v[120:123], v[192:195]
    v_cvt_pk_bf16_f32 v131, v50, v51
    v_add_f32 v32, v14, v15
    v_cmp_nge_f32 vcc, s49, v32
    s_cbranch_vccnz L_attn_cold3
L_attn_back3:
    v_add_f32 v12, v12, v14
    v_add_f32 v13, v13, v15
    s_waitcnt lgkmcnt(10)
    v_mfma_f32_16x16x32_bf16 v[100:103], v[196:199], v[52:55], v[36:39]
    ds_read_b64_tr_b16 v[220:221], v18 offset:24576
    ds_read_b64_tr_b16 v[222:223], v18 offset:28672
    v_mfma_f32_16x16x32_bf16 v[104:107], v[196:199], v[56:59], v[40:43]
    s_waitcnt lgkmcnt(10)
    v_mfma_f32_16x16x32_bf16 v[100:103], v[200:203], v[60:63], v[100:103]
    ds_read_b64 v[196:197], v24 offset:61440
    ds_read_b64 v[198:199], v25 offset:61440
    v_exp_f32 v44, v84
    v_exp_f32 v45, v85
    s_lshl_b32 s80, s77, 2
    s_add_u32 s80, s80, 2
    s_mul_i32 s82, s80, 52429
    s_lshr_b32 s82, s82, 18
    s_mul_i32 s81, s82, 5
    s_sub_u32 s80, s80, s81
    s_mul_i32 s81, s82, s78
    s_add_u32 s81, s81, s76
    s_mul_i32 s81, s81, 5
    s_add_u32 s80, s80, s81
    s_lshl_b32 s80, s80, 10
    buffer_store_dwordx4 v[240:243], v230, s[64:67], s80 offen sc1
    v_mfma_f32_16x16x32_bf16 v[104:107], v[200:203], v[64:67], v[104:107]
    v_exp_f32 v46, v86
    s_waitcnt lgkmcnt(10)
    v_mfma_f32_16x16x32_bf16 v[132:135], v[212:215], v[124:127], v[132:135]
    ds_read_b64_tr_b16 v[224:225], v19 offset:24576
    ds_read_b64_tr_b16 v[226:227], v19 offset:28672
    v_exp_f32 v47, v87
    v_mfma_f32_16x16x32_bf16 v[136:139], v[212:215], v[128:131], v[136:139]
    v_add_f32 v14, v44, v45
    v_cvt_pk_bf16_f32 v116, v44, v45
    s_waitcnt lgkmcnt(10)
    v_mfma_f32_16x16x32_bf16 v[100:103], v[204:207], v[68:71], v[100:103]
    ds_read_b64 v[200:201], v26 offset:61440
    ds_read_b64 v[202:203], v27 offset:61440
    v_exp_f32 v48, v92
    s_lshl_b32 s80, s77, 2
    s_add_u32 s80, s80, 3
    s_mul_i32 s82, s80, 52429
    s_lshr_b32 s82, s82, 18
    s_mul_i32 s81, s82, 5
    s_sub_u32 s80, s80, s81
    s_mul_i32 s81, s82, s78
    s_add_u32 s81, s81, s76
    s_mul_i32 s81, s81, 5
    s_add_u32 s80, s80, s81
    s_lshl_b32 s80, s80, 10
    buffer_store_dwordx4 v[244:247], v230, s[64:67], s80 offen sc1
    v_mfma_f32_16x16x32_bf16 v[104:107], v[204:207], v[72:75], v[104:107]
    v_exp_f32 v49, v93
    s_waitcnt lgkmcnt(10)
    v_mfma_f32_16x16x32_bf16 v[140:143], v[216:219], v[124:127], v[140:143]
    ds_read_b64_tr_b16 v[212:213], v20 offset:24576
    ds_read_b64_tr_b16 v[214:215], v20 offset:28672
    v_add_f32 v32, v46, v47
    v_mfma_f32_16x16x32_bf16 v[144:147], v[216:219], v[128:131], v[144:147]
    v_add_f32 v14, v14, v32
    v_cvt_pk_bf16_f32 v117, v46, v47
    s_waitcnt lgkmcnt(10)
    v_mfma_f32_16x16x32_bf16 v[100:103], v[208:211], v[76:79], v[100:103]
    ds_read_b64 v[204:205], v28 offset:61440
    ds_read_b64 v[206:207], v29 offset:61440
    v_exp_f32 v50, v94
    v_mfma_f32_16x16x32_bf16 v[104:107], v[208:211], v[80:83], v[104:107]
    v_exp_f32 v51, v95
    s_waitcnt lgkmcnt(10)
    v_mfma_f32_16x16x32_bf16 v[148:151], v[220:223], v[124:127], v[148:151]
    ds_read_b64_tr_b16 v[216:217], v21 offset:24576
    ds_read_b64_tr_b16 v[218:219], v21 offset:28672
    v_add_f32 v32, v48, v49
    s_and_b32 s72, s2, 7
    s_mul_i32 s72, s72, 20
    s_lshr_b32 s73, s2, 3
    s_add_u32 s72, s72, s73
    s_add_u32 s72, s72, 68
    s_cmp_ge_u32 s73, 12
    s_cselect_b32 s62, 0x4b0000, 0
    s_cselect_b32 s70, 0xd9e00, 0
    s_mov_b32 s60, s90
    s_mov_b32 s61, s91
    s_mov_b32 s63, 0x20000
    s_mov_b32 s64, s88
    s_mov_b32 s65, s89
    s_movk_i32 s66, 1280
    s_mov_b32 s67, 0x20000
    s_mov_b32 s68, s94
    s_mov_b32 s69, s95
    s_mov_b32 s71, 0x20000
    v_lshrrev_b32 v231, 1, v0
    v_mfma_f32_16x16x32_bf16 v[152:155], v[220:223], v[128:131], v[152:155]
    v_add_f32 v14, v14, v32
    v_cvt_pk_bf16_f32 v118, v48, v49
    v_mul_u32_u24 v228, 7680, v231
    s_waitcnt lgkmcnt(10)
    v_mfma_f32_16x16x32_bf16 v[108:111], v[196:199], v[52:55], v[36:39]
    ds_read_b64 v[208:209], v30 offset:61440
    ds_read_b64 v[210:211], v31 offset:61440
    v_exp_f32 v44, v88
    v_lshlrev_b32 v229, 1, v231
    v_and_b32 v231, 1, v0
    v_mfma_f32_16x16x32_bf16 v[112:115], v[196:199], v[56:59], v[40:43]
    v_exp_f32 v45, v89
    v_lshl_add_u32 v228, v231, 4, v228
    s_waitcnt lgkmcnt(10)
    v_mfma_f32_16x16x32_bf16 v[156:159], v[224:227], v[124:127], v[156:159]
    ds_read_b64_tr_b16 v[220:221], v22 offset:24576
    ds_read_b64_tr_b16 v[222:223], v22 offset:28672
    v_add_f32 v32, v50, v51
    s_lshl_b32 s73, s72, 5
    v_add_u32 v228, s73, v228
    v_mfma_f32_16x16x32_bf16 v[160:163], v[224:227], v[128:131], v[160:163]
    v_add_f32 v14, v14, v32
    v_cvt_pk_bf16_f32 v119, v50, v51
    s_lshl_b32 s73, s93, 6
    s_add_u32 s73, s73, 0x26800
    s_waitcnt lgkmcnt(10)
    v_mfma_f32_16x16x32_bf16 v[108:111], v[200:203], v[60:63], v[108:111]
    ds_read_b64_tr_b16 v[224:225], v23 offset:24576
    ds_read_b64_tr_b16 v[226:227], v23 offset:28672
    v_exp_f32 v46, v90
    v_lshlrev_b32 v230, 5, v231
    v_add_u32 v230, s73, v230
    v_mfma_f32_16x16x32_bf16 v[112:115], v[200:203], v[64:67], v[112:115]
    v_exp_f32 v47, v91
    s_add_u32 s64, s94, 0xd4000
    s_addc_u32 s65, s95, 0
    s_lshl_b32 s73, s93, 6
    v_lshrrev_b32 v229, 4, v1
    v_lshlrev_b32 v229, 4, v229
    v_add_u32 v229, s73, v229
    v_add_u32 v230, 0x26800, v229
    s_waitcnt lgkmcnt(10)
    v_mfma_f32_16x16x32_bf16 v[164:167], v[212:215], v[124:127], v[164:167]
    s_barrier
    ds_read_b64 v[196:197], v24 offset:0
    ds_read_b64 v[198:199], v25 offset:0
    v_add_f32 v15, v44, v45
    v_cvt_pk_bf16_f32 v120, v44, v45
    v_mfma_f32_16x16x32_bf16 v[168:171], v[212:215], v[128:131], v[168:171]
    v_exp_f32 v48, v96
    s_waitcnt lgkmcnt(10)
    v_mfma_f32_16x16x32_bf16 v[108:111], v[204:207], v[68:71], v[108:111]
    ds_read_b64 v[200:201], v26 offset:0
    ds_read_b64 v[202:203], v27 offset:0
    v_exp_f32 v49, v97
    v_mfma_f32_16x16x32_bf16 v[112:115], v[204:207], v[72:75], v[112:115]
    v_add_f32 v32, v46, v47
    s_waitcnt lgkmcnt(10)
    v_mfma_f32_16x16x32_bf16 v[172:175], v[216:219], v[124:127], v[172:175]
    ds_read_b64_tr_b16 v[212:213], v16 offset:32768
    ds_read_b64_tr_b16 v[214:215], v16 offset:36864
    v_add_f32 v15, v15, v32
    v_cvt_pk_bf16_f32 v121, v46, v47
    s_add_u32 s43, s50, 0x14000
    s_add_u32 m0, s39, 0x8000
    s_nop 0
    buffer_load_dwordx4 v4, s[16:19], s43 offen lds
    v_mfma_f32_16x16x32_bf16 v[176:179], v[216:219], v[128:131], v[176:179]
    v_exp_f32 v50, v98
    s_waitcnt lgkmcnt(10)
    v_mfma_f32_16x16x32_bf16 v[108:111], v[208:211], v[76:79], v[108:111]
    ds_read_b64 v[204:205], v28 offset:0
    ds_read_b64 v[206:207], v29 offset:0
    v_exp_f32 v51, v99
    s_lshl_b32 s80, s93, 10
    s_add_u32 m0, s80, 0x20000
    s_mov_b32 s80, 0x0
    buffer_load_dwordx4 v228, s[60:63], s80 offen lds
    buffer_load_dwordx4 v[240:243], v229, s[64:67], 0 offen offset:0 sc1
    v_mfma_f32_16x16x32_bf16 v[112:115], v[208:211], v[80:83], v[112:115]
    v_add_f32 v32, v48, v49
    s_waitcnt lgkmcnt(10)
    v_mfma_f32_16x16x32_bf16 v[180:183], v[220:223], v[124:127], v[180:183]
    ds_read_b64_tr_b16 v[216:217], v17 offset:32768
    ds_read_b64_tr_b16 v[218:219], v17 offset:36864
    v_add_f32 v15, v15, v32
    v_cvt_pk_bf16_f32 v122, v48, v49
    v_mfma_f32_16x16x32_bf16 v[184:187], v[220:223], v[128:131], v[184:187]
    v_add_f32 v32, v50, v51
    s_waitcnt lgkmcnt(10)
    v_mfma_f32_16x16x32_bf16 v[188:191], v[224:227], v[124:127], v[188:191]
    ds_read_b64 v[208:209], v30 offset:0
    ds_read_b64 v[210:211], v31 offset:0
    v_add_f32 v15, v15, v32
    v_mfma_f32_16x16x32_bf16 v[192:195], v[224:227], v[128:131], v[192:195]
    v_cvt_pk_bf16_f32 v123, v50, v51
    v_add_f32 v32, v14, v15
    v_cmp_nge_f32 vcc, s49, v32
    s_cbranch_vccnz L_attn_cold4
L_attn_back4:
    v_add_f32 v12, v12, v14
    v_add_f32 v13, v13, v15
    s_waitcnt lgkmcnt(10)
    v_mfma_f32_16x16x32_bf16 v[84:87], v[196:199], v[52:55], v[36:39]
    ds_read_b64_tr_b16 v[220:221], v18 offset:32768
    ds_read_b64_tr_b16 v[222:223], v18 offset:36864
    s_lshl_b32 s80, s93, 10
    s_add_u32 m0, s80, 0x22000
    s_mov_b32 s80, 0x1e0000
    buffer_load_dwordx4 v228, s[60:63], s80 offen lds
    buffer_load_dwordx4 v[244:247], v229, s[64:67], 0 offen offset:512 sc1
    v_mfma_f32_16x16x32_bf16 v[88:91], v[196:199], v[56:59], v[40:43]
    s_waitcnt lgkmcnt(10)
    v_mfma_f32_16x16x32_bf16 v[84:87], v[200:203], v[60:63], v[84:87]
    ds_read_b64 v[196:197], v24 offset:4096
    ds_read_b64 v[198:199], v25 offset:4096
    v_exp_f32 v44, v100
    v_exp_f32 v45, v101
    v_mfma_f32_16x16x32_bf16 v[88:91], v[200:203], v[64:67], v[88:91]
    v_exp_f32 v46, v102
    s_waitcnt lgkmcnt(10)
    v_mfma_f32_16x16x32_bf16 v[132:135], v[212:215], v[116:119], v[132:135]
    ds_read_b64_tr_b16 v[224:225], v19 offset:32768
    ds_read_b64_tr_b16 v[226:227], v19 offset:36864
    v_exp_f32 v47, v103
    s_add_u32 s43, s50, 0x14000
    s_add_u32 m0, s39, 0x8000
    s_nop 0
    buffer_load_dwordx4 v5, s[16:19], s43 offen offset:1024 lds
    v_mfma_f32_16x16x32_bf16 v[136:139], v[212:215], v[120:123], v[136:139]
    v_add_f32 v14, v44, v45
    v_cvt_pk_bf16_f32 v124, v44, v45
    s_waitcnt lgkmcnt(10)
    v_mfma_f32_16x16x32_bf16 v[84:87], v[204:207], v[68:71], v[84:87]
    ds_read_b64 v[200:201], v26 offset:4096
    ds_read_b64 v[202:203], v27 offset:4096
    v_exp_f32 v48, v108
    s_lshl_b32 s80, s93, 10
    s_add_u32 m0, s80, 0x24000
    s_mov_b32 s80, 0x3c0000
    buffer_load_dwordx4 v228, s[60:63], s80 offen lds
    buffer_load_dwordx4 v[248:251], v229, s[64:67], 0 offen offset:1024 sc1
    v_mfma_f32_16x16x32_bf16 v[88:91], v[204:207], v[72:75], v[88:91]
    v_exp_f32 v49, v109
    s_waitcnt lgkmcnt(10)
    v_mfma_f32_16x16x32_bf16 v[140:143], v[216:219], v[116:119], v[140:143]
    ds_read_b64_tr_b16 v[212:213], v20 offset:32768
    ds_read_b64_tr_b16 v[214:215], v20 offset:36864
    v_add_f32 v32, v46, v47
    v_mfma_f32_16x16x32_bf16 v[144:147], v[216:219], v[120:123], v[144:147]
    v_add_f32 v14, v14, v32
    v_cvt_pk_bf16_f32 v125, v46, v47
    s_waitcnt lgkmcnt(10)
    v_mfma_f32_16x16x32_bf16 v[84:87], v[208:211], v[76:79], v[84:87]
    ds_read_b64 v[204:205], v28 offset:4096
    ds_read_b64 v[206:207], v29 offset:4096
    v_exp_f32 v50, v110
    v_mfma_f32_16x16x32_bf16 v[88:91], v[208:211], v[80:83], v[88:91]
    v_exp_f32 v51, v111
    s_waitcnt lgkmcnt(10)
    v_mfma_f32_16x16x32_bf16 v[148:151], v[220:223], v[116:119], v[148:151]
    ds_read_b64_tr_b16 v[216:217], v21 offset:32768
    ds_read_b64_tr_b16 v[218:219], v21 offset:36864
    v_add_f32 v32, v48, v49
    v_mfma_f32_16x16x32_bf16 v[152:155], v[220:223], v[120:123], v[152:155]
    v_add_f32 v14, v14, v32
    v_cvt_pk_bf16_f32 v126, v48, v49
    s_waitcnt lgkmcnt(10)
    v_mfma_f32_16x16x32_bf16 v[92:95], v[196:199], v[52:55], v[36:39]
    ds_read_b64 v[208:209], v30 offset:4096
    ds_read_b64 v[210:211], v31 offset:4096
    v_exp_f32 v44, v104
    v_mfma_f32_16x16x32_bf16 v[96:99], v[196:199], v[56:59], v[40:43]
    v_exp_f32 v45, v105
    s_waitcnt lgkmcnt(10)
    v_mfma_f32_16x16x32_bf16 v[156:159], v[224:227], v[116:119], v[156:159]
    ds_read_b64_tr_b16 v[220:221], v22 offset:32768
    ds_read_b64_tr_b16 v[222:223], v22 offset:36864
    v_add_f32 v32, v50, v51
    s_add_u32 s43, s50, 0x10000
    s_add_u32 m0, s39, 0x10000
    s_nop 0
    buffer_load_dwordx4 v6, s[20:23], s43 offen lds
    v_mfma_f32_16x16x32_bf16 v[160:163], v[224:227], v[120:123], v[160:163]
    v_add_f32 v14, v14, v32
    v_cvt_pk_bf16_f32 v127, v50, v51
    s_waitcnt lgkmcnt(10)
    v_mfma_f32_16x16x32_bf16 v[92:95], v[200:203], v[60:63], v[92:95]
    ds_read_b64_tr_b16 v[224:225], v23 offset:32768
    ds_read_b64_tr_b16 v[226:227], v23 offset:36864
    v_exp_f32 v46, v106
    v_mfma_f32_16x16x32_bf16 v[96:99], v[200:203], v[64:67], v[96:99]
    v_exp_f32 v47, v107
    s_waitcnt lgkmcnt(10)
    v_mfma_f32_16x16x32_bf16 v[164:167], v[212:215], v[116:119], v[164:167]
    ds_read_b64 v[196:197], v24 offset:8192
    ds_read_b64 v[198:199], v25 offset:8192
    v_add_f32 v15, v44, v45
    v_cvt_pk_bf16_f32 v128, v44, v45
    v_mfma_f32_16x16x32_bf16 v[168:171], v[212:215], v[120:123], v[168:171]
    v_exp_f32 v48, v112
    s_waitcnt lgkmcnt(10)
    v_mfma_f32_16x16x32_bf16 v[92:95], v[204:207], v[68:71], v[92:95]
    ds_read_b64 v[200:201], v26 offset:8192
    ds_read_b64 v[202:203], v27 offset:8192
    v_exp_f32 v49, v113
    v_mfma_f32_16x16x32_bf16 v[96:99], v[204:207], v[72:75], v[96:99]
    v_add_f32 v32, v46, v47
    s_waitcnt lgkmcnt(10)
    v_mfma_f32_16x16x32_bf16 v[172:175], v[216:219], v[116:119], v[172:175]
    ds_read_b64_tr_b16 v[212:213], v16 offset:40960
    ds_read_b64_tr_b16 v[214:215], v16 offset:45056
    v_add_f32 v15, v15, v32
    v_cvt_pk_bf16_f32 v129, v46, v47
    v_mfma_f32_16x16x32_bf16 v[176:179], v[216:219], v[120:123], v[176:179]
    v_exp_f32 v50, v114
    s_waitcnt lgkmcnt(10)
    v_mfma_f32_16x16x32_bf16 v[92:95], v[208:211], v[76:79], v[92:95]
    ds_read_b64 v[204:205], v28 offset:8192
    ds_read_b64 v[206:207], v29 offset:8192
    v_exp_f32 v51, v115
    v_mfma_f32_16x16x32_bf16 v[96:99], v[208:211], v[80:83], v[96:99]
    v_add_f32 v32, v48, v49
    s_waitcnt lgkmcnt(10)
    v_mfma_f32_16x16x32_bf16 v[180:183], v[220:223], v[116:119], v[180:183]
    ds_read_b64_tr_b16 v[216:217], v17 offset:40960
    ds_read_b64_tr_b16 v[218:219], v17 offset:45056
    v_add_f32 v15, v15, v32
    v_cvt_pk_bf16_f32 v130, v48, v49
    s_add_u32 s43, s50, 0x10000
    s_add_u32 m0, s39, 0x10000
    s_nop 0
    buffer_load_dwordx4 v7, s[20:23], s43 offen offset:1024 lds
    v_mfma_f32_16x16x32_bf16 v[184:187], v[220:223], v[120:123], v[184:187]
    v_add_f32 v32, v50, v51
    s_waitcnt lgkmcnt(10)
    v_mfma_f32_16x16x32_bf16 v[188:191], v[224:227], v[116:119], v[188:191]
    ds_read_b64 v[208:209], v30 offset:8192
    ds_read_b64 v[210:211], v31 offset:8192
    v_add_f32 v15, v15, v32
    v_mfma_f32_16x16x32_bf16 v[192:195], v[224:227], v[120:123], v[192:195]
    v_cvt_pk_bf16_f32 v131, v50, v51
    v_add_f32 v32, v14, v15
    v_cmp_nge_f32 vcc, s49, v32
    s_cbranch_vccnz L_attn_cold5
L_attn_back5:
    v_add_f32 v12, v12, v14
    v_add_f32 v13, v13, v15
    s_waitcnt lgkmcnt(10)
    v_mfma_f32_16x16x32_bf16 v[100:103], v[196:199], v[52:55], v[36:39]
    ds_read_b64_tr_b16 v[220:221], v18 offset:40960
    ds_read_b64_tr_b16 v[222:223], v18 offset:45056
    v_cmp_eq_u32 vcc, 0, v33
    s_cbranch_vccnz L_adaLN_cond__sliding_block_cached__swiglu_ffn__prompt_kernel_24
L_adaLN_cond__sliding_block_cached__swiglu_ffn__prompt_kernel_23:
    v_readfirstlane_b32 s98, v33
    v_mfma_f32_16x16x32_bf16 v[104:107], v[196:199], v[56:59], v[40:43]
    s_waitcnt lgkmcnt(10)
    v_mfma_f32_16x16x32_bf16 v[100:103], v[200:203], v[60:63], v[100:103]
    ds_read_b64 v[196:197], v24 offset:12288
    ds_read_b64 v[198:199], v25 offset:12288
    v_exp_f32 v44, v84
    v_exp_f32 v45, v85
    v_mfma_f32_16x16x32_bf16 v[104:107], v[200:203], v[64:67], v[104:107]
    v_exp_f32 v46, v86
    s_waitcnt lgkmcnt(10)
    v_mfma_f32_16x16x32_bf16 v[132:135], v[212:215], v[124:127], v[132:135]
    ds_read_b64_tr_b16 v[224:225], v19 offset:40960
    ds_read_b64_tr_b16 v[226:227], v19 offset:45056
    v_exp_f32 v47, v87
    v_mfma_f32_16x16x32_bf16 v[136:139], v[212:215], v[128:131], v[136:139]
    v_add_f32 v14, v44, v45
    v_cvt_pk_bf16_f32 v116, v44, v45
    s_waitcnt lgkmcnt(10)
    v_mfma_f32_16x16x32_bf16 v[100:103], v[204:207], v[68:71], v[100:103]
    ds_read_b64 v[200:201], v26 offset:12288
    ds_read_b64 v[202:203], v27 offset:12288
    v_exp_f32 v48, v92
    v_mfma_f32_16x16x32_bf16 v[104:107], v[204:207], v[72:75], v[104:107]
    v_exp_f32 v49, v93
    s_waitcnt lgkmcnt(10)
    v_mfma_f32_16x16x32_bf16 v[140:143], v[216:219], v[124:127], v[140:143]
    ds_read_b64_tr_b16 v[212:213], v20 offset:40960
    ds_read_b64_tr_b16 v[214:215], v20 offset:45056
    v_add_f32 v32, v46, v47
    v_mfma_f32_16x16x32_bf16 v[144:147], v[216:219], v[128:131], v[144:147]
    v_add_f32 v14, v14, v32
    v_cvt_pk_bf16_f32 v117, v46, v47
    s_waitcnt lgkmcnt(10)
    v_mfma_f32_16x16x32_bf16 v[100:103], v[208:211], v[76:79], v[100:103]
    ds_read_b64 v[204:205], v28 offset:12288
    ds_read_b64 v[206:207], v29 offset:12288
    v_exp_f32 v50, v94
    v_mfma_f32_16x16x32_bf16 v[104:107], v[208:211], v[80:83], v[104:107]
    v_exp_f32 v51, v95
    s_waitcnt lgkmcnt(10)
    v_mfma_f32_16x16x32_bf16 v[148:151], v[220:223], v[124:127], v[148:151]
    ds_read_b64_tr_b16 v[216:217], v21 offset:40960
    ds_read_b64_tr_b16 v[218:219], v21 offset:45056
    v_add_f32 v32, v48, v49
    v_mfma_f32_16x16x32_bf16 v[152:155], v[220:223], v[128:131], v[152:155]
    v_add_f32 v14, v14, v32
    v_cvt_pk_bf16_f32 v118, v48, v49
    s_waitcnt lgkmcnt(10)
    v_mfma_f32_16x16x32_bf16 v[108:111], v[196:199], v[52:55], v[36:39]
    ds_read_b64 v[208:209], v30 offset:12288
    ds_read_b64 v[210:211], v31 offset:12288
    v_exp_f32 v44, v88
    v_mfma_f32_16x16x32_bf16 v[112:115], v[196:199], v[56:59], v[40:43]
    v_exp_f32 v45, v89
    s_waitcnt lgkmcnt(10)
    v_mfma_f32_16x16x32_bf16 v[156:159], v[224:227], v[124:127], v[156:159]
    ds_read_b64_tr_b16 v[220:221], v22 offset:40960
    ds_read_b64_tr_b16 v[222:223], v22 offset:45056
    v_add_f32 v32, v50, v51
    v_mfma_f32_16x16x32_bf16 v[160:163], v[224:227], v[128:131], v[160:163]
    v_add_f32 v14, v14, v32
    v_cvt_pk_bf16_f32 v119, v50, v51
    s_waitcnt lgkmcnt(10)
    v_mfma_f32_16x16x32_bf16 v[108:111], v[200:203], v[60:63], v[108:111]
    ds_read_b64_tr_b16 v[224:225], v23 offset:40960
    ds_read_b64_tr_b16 v[226:227], v23 offset:45056
    v_exp_f32 v46, v90
    v_mfma_f32_16x16x32_bf16 v[112:115], v[200:203], v[64:67], v[112:115]
    v_exp_f32 v47, v91
    s_waitcnt lgkmcnt(10)
    v_mfma_f32_16x16x32_bf16 v[164:167], v[212:215], v[124:127], v[164:167]
    s_waitcnt vmcnt(14)
    s_barrier
    ds_read_b64 v[196:197], v24 offset:16384
    ds_read_b64 v[198:199], v25 offset:16384
    v_add_f32 v15, v44, v45
    v_cvt_pk_bf16_f32 v120, v44, v45
    v_mfma_f32_16x16x32_bf16 v[168:171], v[212:215], v[128:131], v[168:171]
    v_exp_f32 v48, v96
    s_waitcnt lgkmcnt(10)
    v_mfma_f32_16x16x32_bf16 v[108:111], v[204:207], v[68:71], v[108:111]
    ds_read_b64 v[200:201], v26 offset:16384
    ds_read_b64 v[202:203], v27 offset:16384
    v_exp_f32 v49, v97
    v_mfma_f32_16x16x32_bf16 v[112:115], v[204:207], v[72:75], v[112:115]
    v_add_f32 v32, v46, v47
    s_waitcnt lgkmcnt(10)
    v_mfma_f32_16x16x32_bf16 v[172:175], v[216:219], v[124:127], v[172:175]
    ds_read_b64_tr_b16 v[212:213], v16 offset:49152
    ds_read_b64_tr_b16 v[214:215], v16 offset:53248
    v_add_f32 v15, v15, v32
    v_cvt_pk_bf16_f32 v121, v46, v47
    s_add_u32 s43, s50, 0x18000
    s_add_u32 m0, s39, 0xc000
    s_nop 0
    buffer_load_dwordx4 v4, s[16:19], s43 offen lds
    v_mfma_f32_16x16x32_bf16 v[176:179], v[216:219], v[128:131], v[176:179]
    v_exp_f32 v50, v98
    s_waitcnt lgkmcnt(10)
    v_mfma_f32_16x16x32_bf16 v[108:111], v[208:211], v[76:79], v[108:111]
    ds_read_b64 v[204:205], v28 offset:16384
    ds_read_b64 v[206:207], v29 offset:16384
    v_exp_f32 v51, v99
    v_mfma_f32_16x16x32_bf16 v[112:115], v[208:211], v[80:83], v[112:115]
    v_add_f32 v32, v48, v49
    s_waitcnt lgkmcnt(10)
    v_mfma_f32_16x16x32_bf16 v[180:183], v[220:223], v[124:127], v[180:183]
    ds_read_b64_tr_b16 v[216:217], v17 offset:49152
    ds_read_b64_tr_b16 v[218:219], v17 offset:53248
    v_add_f32 v15, v15, v32
    v_cvt_pk_bf16_f32 v122, v48, v49
    v_mfma_f32_16x16x32_bf16 v[184:187], v[220:223], v[128:131], v[184:187]
    v_add_f32 v32, v50, v51
    s_waitcnt lgkmcnt(10)
    v_mfma_f32_16x16x32_bf16 v[188:191], v[224:227], v[124:127], v[188:191]
    ds_read_b64 v[208:209], v30 offset:16384
    ds_read_b64 v[210:211], v31 offset:16384
    v_add_f32 v15, v15, v32
    v_mfma_f32_16x16x32_bf16 v[192:195], v[224:227], v[128:131], v[192:195]
    v_cvt_pk_bf16_f32 v123, v50, v51
    v_add_f32 v32, v14, v15
    v_cmp_nge_f32 vcc, s49, v32
    s_cbranch_vccnz L_attn_cold6
L_attn_back6:
    v_add_f32 v12, v12, v14
    v_add_f32 v13, v13, v15
    s_waitcnt lgkmcnt(10)
    v_mfma_f32_16x16x32_bf16 v[84:87], v[196:199], v[52:55], v[36:39]
    ds_read_b64_tr_b16 v[220:221], v18 offset:49152
    ds_read_b64_tr_b16 v[222:223], v18 offset:53248
    v_mfma_f32_16x16x32_bf16 v[88:91], v[196:199], v[56:59], v[40:43]
    s_waitcnt lgkmcnt(10)
    v_mfma_f32_16x16x32_bf16 v[84:87], v[200:203], v[60:63], v[84:87]
    ds_read_b64 v[196:197], v24 offset:20480
    ds_read_b64 v[198:199], v25 offset:20480
    v_exp_f32 v44, v100
    v_exp_f32 v45, v101
    v_mfma_f32_16x16x32_bf16 v[88:91], v[200:203], v[64:67], v[88:91]
    v_exp_f32 v46, v102
    s_waitcnt lgkmcnt(10)
    v_mfma_f32_16x16x32_bf16 v[132:135], v[212:215], v[116:119], v[132:135]
    ds_read_b64_tr_b16 v[224:225], v19 offset:49152
    ds_read_b64_tr_b16 v[226:227], v19 offset:53248
    v_exp_f32 v47, v103
    s_add_u32 s43, s50, 0x18000
    s_add_u32 m0, s39, 0xc000
    s_nop 0
    buffer_load_dwordx4 v5, s[16:19], s43 offen offset:1024 lds
    v_mfma_f32_16x16x32_bf16 v[136:139], v[212:215], v[120:123], v[136:139]
    v_add_f32 v14, v44, v45
    v_cvt_pk_bf16_f32 v124, v44, v45
    s_waitcnt lgkmcnt(10)
    v_mfma_f32_16x16x32_bf16 v[84:87], v[204:207], v[68:71], v[84:87]
    ds_read_b64 v[200:201], v26 offset:20480
    ds_read_b64 v[202:203], v27 offset:20480
    v_exp_f32 v48, v108
    s_and_b32 s80, s93, 7
    s_lshl_b32 s80, s80, 10
    s_add_u32 s80, s80, 0x20000
    v_lshrrev_b32 v228, 4, v1
    v_bfe_u32 v231, v1, 2, 2
    v_lshl_add_u32 v228, v228, 3, v231
    v_lshlrev_b32 v228, 5, v228
    v_and_b32 v231, 3, v1
    v_lshl_add_u32 v228, v231, 3, v228
    v_add_u32 v228, s80, v228
    v_mfma_f32_16x16x32_bf16 v[88:91], v[204:207], v[72:75], v[88:91]
    v_exp_f32 v49, v109
    s_waitcnt lgkmcnt(10)
    v_mfma_f32_16x16x32_bf16 v[140:143], v[216:219], v[116:119], v[140:143]
    ds_read_b64_tr_b16 v[212:213], v20 offset:49152
    ds_read_b64_tr_b16 v[214:215], v20 offset:53248
    v_add_f32 v32, v46, v47
    s_waitcnt vmcnt(5)
    ds_read_b64_tr_b16 v[232:233], v228 offset:0
    ds_read_b64_tr_b16 v[234:235], v228 offset:128
    v_mfma_f32_16x16x32_bf16 v[144:147], v[216:219], v[120:123], v[144:147]
    v_add_f32 v14, v14, v32
    v_cvt_pk_bf16_f32 v125, v46, v47
    s_waitcnt lgkmcnt(12)
    v_mfma_f32_16x16x32_bf16 v[84:87], v[208:211], v[76:79], v[84:87]
    ds_read_b64 v[204:205], v28 offset:20480
    ds_read_b64 v[206:207], v29 offset:20480
    v_exp_f32 v50, v110
    v_mfma_f32_16x16x32_bf16 v[88:91], v[208:211], v[80:83], v[88:91]
    v_exp_f32 v51, v111
    s_waitcnt lgkmcnt(12)
    v_mfma_f32_16x16x32_bf16 v[148:151], v[220:223], v[116:119], v[148:151]
    ds_read_b64_tr_b16 v[216:217], v21 offset:49152
    ds_read_b64_tr_b16 v[218:219], v21 offset:53248
    v_add_f32 v32, v48, v49
    s_waitcnt lgkmcnt(4)
    v_mfma_f32_16x16x32_bf16 v[236:239], v[232:235], v[240:243], 0
    v_mfma_f32_16x16x32_bf16 v[152:155], v[220:223], v[120:123], v[152:155]
    v_add_f32 v14, v14, v32
    v_cvt_pk_bf16_f32 v126, v48, v49
    v_mfma_f32_16x16x32_bf16 v[92:95], v[196:199], v[52:55], v[36:39]
    ds_read_b64 v[208:209], v30 offset:20480
    ds_read_b64 v[210:211], v31 offset:20480
    v_exp_f32 v44, v104
    ds_read_b64_tr_b16 v[232:233], v228 offset:8192
    ds_read_b64_tr_b16 v[234:235], v228 offset:8320
    v_mfma_f32_16x16x32_bf16 v[96:99], v[196:199], v[56:59], v[40:43]
    v_exp_f32 v45, v105
    v_mfma_f32_16x16x32_bf16 v[156:159], v[224:227], v[116:119], v[156:159]
    ds_read_b64_tr_b16 v[220:221], v22 offset:49152
    ds_read_b64_tr_b16 v[222:223], v22 offset:53248
    v_add_f32 v32, v50, v51
    s_add_u32 s43, s50, 0x14000
    s_add_u32 m0, s39, 0x14000
    s_nop 0
    buffer_load_dwordx4 v6, s[20:23], s43 offen lds
    v_mfma_f32_16x16x32_bf16 v[160:163], v[224:227], v[120:123], v[160:163]
    v_add_f32 v14, v14, v32
    v_cvt_pk_bf16_f32 v127, v50, v51
    v_mfma_f32_16x16x32_bf16 v[92:95], v[200:203], v[60:63], v[92:95]
    ds_read_b64_tr_b16 v[224:225], v23 offset:49152
    ds_read_b64_tr_b16 v[226:227], v23 offset:53248
    v_exp_f32 v46, v106
    s_waitcnt lgkmcnt(4)
    v_mfma_f32_16x16x32_bf16 v[236:239], v[232:235], v[244:247], v[236:239]
    v_mfma_f32_16x16x32_bf16 v[96:99], v[200:203], v[64:67], v[96:99]
    v_exp_f32 v47, v107
    v_mfma_f32_16x16x32_bf16 v[164:167], v[212:215], v[116:119], v[164:167]
    ds_read_b64 v[196:197], v24 offset:24576
    ds_read_b64 v[198:199], v25 offset:24576
    v_add_f32 v15, v44, v45
    v_cvt_pk_bf16_f32 v128, v44, v45
    ds_read_b64_tr_b16 v[232:233], v228 offset:16384
    ds_read_b64_tr_b16 v[234:235], v228 offset:16512
    v_mfma_f32_16x16x32_bf16 v[168:171], v[212:215], v[120:123], v[168:171]
    v_exp_f32 v48, v112
    v_mfma_f32_16x16x32_bf16 v[92:95], v[204:207], v[68:71], v[92:95]
    ds_read_b64 v[200:201], v26 offset:24576
    ds_read_b64 v[202:203], v27 offset:24576
    v_exp_f32 v49, v113
    v_mfma_f32_16x16x32_bf16 v[96:99], v[204:207], v[72:75], v[96:99]
    v_add_f32 v32, v46, v47
    v_mfma_f32_16x16x32_bf16 v[172:175], v[216:219], v[116:119], v[172:175]
    ds_read_b64_tr_b16 v[212:213], v16 offset:57344
    ds_read_b64_tr_b16 v[214:215], v16 offset:61440
    v_add_f32 v15, v15, v32
    v_cvt_pk_bf16_f32 v129, v46, v47
    s_waitcnt vmcnt(5) lgkmcnt(4)
    v_mfma_f32_16x16x32_bf16 v[236:239], v[232:235], v[248:251], v[236:239]
    v_mfma_f32_16x16x32_bf16 v[176:179], v[216:219], v[120:123], v[176:179]
    v_exp_f32 v50, v114
    v_mfma_f32_16x16x32_bf16 v[92:95], v[208:211], v[76:79], v[92:95]
    ds_read_b64 v[204:205], v28 offset:24576
    ds_read_b64 v[206:207], v29 offset:24576
    v_exp_f32 v51, v115
    v_mfma_f32_16x16x32_bf16 v[96:99], v[208:211], v[80:83], v[96:99]
    v_add_f32 v32, v48, v49
    v_mfma_f32_16x16x32_bf16 v[180:183], v[220:223], v[116:119], v[180:183]
    ds_read_b64_tr_b16 v[216:217], v17 offset:57344
    ds_read_b64_tr_b16 v[218:219], v17 offset:61440
    v_add_f32 v15, v15, v32
    v_cvt_pk_bf16_f32 v130, v48, v49
    s_add_u32 s43, s50, 0x14000
    s_add_u32 m0, s39, 0x14000
    s_nop 0
    buffer_load_dwordx4 v7, s[20:23], s43 offen offset:1024 lds
    v_mfma_f32_16x16x32_bf16 v[184:187], v[220:223], v[120:123], v[184:187]
    v_add_f32 v32, v50, v51
    v_mfma_f32_16x16x32_bf16 v[188:191], v[224:227], v[116:119], v[188:191]
    ds_read_b64 v[208:209], v30 offset:24576
    ds_read_b64 v[210:211], v31 offset:24576
    v_add_f32 v15, v15, v32
    v_mfma_f32_16x16x32_bf16 v[192:195], v[224:227], v[120:123], v[192:195]
    v_cvt_pk_bf16_f32 v131, v50, v51
    v_add_f32 v32, v14, v15
    v_cmp_nge_f32 vcc, s49, v32
    s_cbranch_vccnz L_attn_cold7
L_attn_back7:
    v_add_f32 v12, v12, v14
    v_add_f32 v13, v13, v15
    v_mfma_f32_16x16x32_bf16 v[100:103], v[196:199], v[52:55], v[36:39]
    ds_read_b64_tr_b16 v[220:221], v18 offset:57344
    ds_read_b64_tr_b16 v[222:223], v18 offset:61440
    v_mfma_f32_16x16x32_bf16 v[104:107], v[196:199], v[56:59], v[40:43]
    s_waitcnt lgkmcnt(10)
    v_mfma_f32_16x16x32_bf16 v[100:103], v[200:203], v[60:63], v[100:103]
    ds_read_b64 v[196:197], v24 offset:28672
    ds_read_b64 v[198:199], v25 offset:28672
    v_exp_f32 v44, v84
    v_exp_f32 v45, v85
    v_mfma_f32_16x16x32_bf16 v[104:107], v[200:203], v[64:67], v[104:107]
    v_exp_f32 v46, v86
    s_waitcnt lgkmcnt(10)
    v_mfma_f32_16x16x32_bf16 v[132:135], v[212:215], v[124:127], v[132:135]
    ds_read_b64_tr_b16 v[224:225], v19 offset:57344
    ds_read_b64_tr_b16 v[226:227], v19 offset:61440
    v_exp_f32 v47, v87
    ds_write_b128 v230, v[236:239]
    v_mfma_f32_16x16x32_bf16 v[136:139], v[212:215], v[128:131], v[136:139]
    v_add_f32 v14, v44, v45
    v_cvt_pk_bf16_f32 v116, v44, v45
    s_waitcnt lgkmcnt(11)
    v_mfma_f32_16x16x32_bf16 v[100:103], v[204:207], v[68:71], v[100:103]
    ds_read_b64 v[200:201], v26 offset:28672
    ds_read_b64 v[202:203], v27 offset:28672
    v_exp_f32 v48, v92
    v_mfma_f32_16x16x32_bf16 v[104:107], v[204:207], v[72:75], v[104:107]
    v_exp_f32 v49, v93
    s_waitcnt lgkmcnt(11)
    v_mfma_f32_16x16x32_bf16 v[140:143], v[216:219], v[124:127], v[140:143]
    ds_read_b64_tr_b16 v[212:213], v20 offset:57344
    ds_read_b64_tr_b16 v[214:215], v20 offset:61440
    v_add_f32 v32, v46, v47
    v_mfma_f32_16x16x32_bf16 v[144:147], v[216:219], v[128:131], v[144:147]
    v_add_f32 v14, v14, v32
    v_cvt_pk_bf16_f32 v117, v46, v47
    s_waitcnt lgkmcnt(11)
    v_mfma_f32_16x16x32_bf16 v[100:103], v[208:211], v[76:79], v[100:103]
    ds_read_b64 v[204:205], v28 offset:28672
    ds_read_b64 v[206:207], v29 offset:28672
    v_exp_f32 v50, v94
    v_mfma_f32_16x16x32_bf16 v[104:107], v[208:211], v[80:83], v[104:107]
    v_exp_f32 v51, v95
    s_waitcnt lgkmcnt(11)
    v_mfma_f32_16x16x32_bf16 v[148:151], v[220:223], v[124:127], v[148:151]
    ds_read_b64_tr_b16 v[216:217], v21 offset:57344
    ds_read_b64_tr_b16 v[218:219], v21 offset:61440
    v_add_f32 v32, v48, v49
    v_mfma_f32_16x16x32_bf16 v[152:155], v[220:223], v[128:131], v[152:155]
    v_add_f32 v14, v14, v32
    v_cvt_pk_bf16_f32 v118, v48, v49
    s_waitcnt lgkmcnt(11)
    v_mfma_f32_16x16x32_bf16 v[108:111], v[196:199], v[52:55], v[36:39]
    ds_read_b64 v[208:209], v30 offset:28672
    ds_read_b64 v[210:211], v31 offset:28672
    v_exp_f32 v44, v88
    v_mfma_f32_16x16x32_bf16 v[112:115], v[196:199], v[56:59], v[40:43]
    v_exp_f32 v45, v89
    s_waitcnt lgkmcnt(11)
    v_mfma_f32_16x16x32_bf16 v[156:159], v[224:227], v[124:127], v[156:159]
    ds_read_b64_tr_b16 v[220:221], v22 offset:57344
    ds_read_b64_tr_b16 v[222:223], v22 offset:61440
    v_add_f32 v32, v50, v51
    v_mfma_f32_16x16x32_bf16 v[160:163], v[224:227], v[128:131], v[160:163]
    v_add_f32 v14, v14, v32
    v_cvt_pk_bf16_f32 v119, v50, v51
    s_waitcnt lgkmcnt(10)
    v_mfma_f32_16x16x32_bf16 v[108:111], v[200:203], v[60:63], v[108:111]
    ds_read_b64_tr_b16 v[224:225], v23 offset:57344
    ds_read_b64_tr_b16 v[226:227], v23 offset:61440
    v_exp_f32 v46, v90
    v_mfma_f32_16x16x32_bf16 v[112:115], v[200:203], v[64:67], v[112:115]
    v_exp_f32 v47, v91
    s_waitcnt lgkmcnt(0)
    v_mfma_f32_16x16x32_bf16 v[164:167], v[212:215], v[124:127], v[164:167]
    s_waitcnt vmcnt(4)
    s_barrier
    ds_read_b64 v[196:197], v24 offset:32768
    ds_read_b64 v[198:199], v25 offset:32768
    v_add_f32 v15, v44, v45
    v_cvt_pk_bf16_f32 v120, v44, v45
    v_mfma_f32_16x16x32_bf16 v[168:171], v[212:215], v[128:131], v[168:171]
    v_exp_f32 v48, v96
    v_and_b32 v228, 15, v1
    v_lshlrev_b32 v228, 2, v228
    v_mfma_f32_16x16x32_bf16 v[108:111], v[204:207], v[68:71], v[108:111]
    ds_read_b64 v[200:201], v26 offset:32768
    ds_read_b64 v[202:203], v27 offset:32768
    v_exp_f32 v49, v97
    v_add_u32 v229, 0x26800, v228
    v_mfma_f32_16x16x32_bf16 v[112:115], v[204:207], v[72:75], v[112:115]
    v_add_f32 v32, v46, v47
    ds_read_b32 v244, v229 offset:0
    ds_read_b32 v245, v229 offset:64
    v_mfma_f32_16x16x32_bf16 v[172:175], v[216:219], v[124:127], v[172:175]
    ds_read_b64_tr_b16 v[212:213], v16 offset:0
    ds_read_b64_tr_b16 v[214:215], v16 offset:4096
    v_add_f32 v15, v15, v32
    v_cvt_pk_bf16_f32 v121, v46, v47
    s_add_u32 s43, s50, 0x1c000
    s_add_u32 m0, s39, 0x0
    s_nop 0
    buffer_load_dwordx4 v4, s[16:19], s43 offen lds
    ds_read_b32 v246, v229 offset:128
    v_mfma_f32_16x16x32_bf16 v[176:179], v[216:219], v[128:131], v[176:179]
    v_exp_f32 v50, v98
    ds_read_b32 v247, v229 offset:192
    ds_read_b32 v248, v229 offset:256
    v_mfma_f32_16x16x32_bf16 v[108:111], v[208:211], v[76:79], v[108:111]
    ds_read_b64 v[204:205], v28 offset:32768
    ds_read_b64 v[206:207], v29 offset:32768
    v_exp_f32 v51, v99
    ds_read_b32 v249, v229 offset:320
    v_mfma_f32_16x16x32_bf16 v[112:115], v[208:211], v[80:83], v[112:115]
    v_add_f32 v32, v48, v49
    ds_read_b32 v250, v229 offset:384
    v_mfma_f32_16x16x32_bf16 v[180:183], v[220:223], v[124:127], v[180:183]
    ds_read_b64_tr_b16 v[216:217], v17 offset:0
    ds_read_b64_tr_b16 v[218:219], v17 offset:4096
    v_add_f32 v15, v15, v32
    v_cvt_pk_bf16_f32 v122, v48, v49
    ds_read_b32 v251, v229 offset:448
    s_waitcnt lgkmcnt(12)
    v_add_f32 v244, v244, v245
    v_mfma_f32_16x16x32_bf16 v[184:187], v[220:223], v[128:131], v[184:187]
    v_add_f32 v32, v50, v51
    s_waitcnt lgkmcnt(8)
    v_add_f32 v246, v246, v247
    v_mfma_f32_16x16x32_bf16 v[188:191], v[224:227], v[124:127], v[188:191]
    ds_read_b64 v[208:209], v30 offset:32768
    ds_read_b64 v[210:211], v31 offset:32768
    v_add_f32 v15, v15, v32
    s_waitcnt lgkmcnt(6)
    v_add_f32 v248, v248, v249
    s_waitcnt lgkmcnt(2)
    v_add_f32 v250, v250, v251
    v_mfma_f32_16x16x32_bf16 v[192:195], v[224:227], v[128:131], v[192:195]
    v_cvt_pk_bf16_f32 v123, v50, v51
    v_add_f32 v32, v14, v15
    v_cmp_nge_f32 vcc, s49, v32
    s_cbranch_vccnz L_attn_cold8
L_attn_back8:
    v_add_f32 v12, v12, v14
    v_add_f32 v13, v13, v15
    v_add_f32 v244, v244, v246
    v_mfma_f32_16x16x32_bf16 v[84:87], v[196:199], v[52:55], v[36:39]
    ds_read_b64_tr_b16 v[220:221], v18 offset:0
    ds_read_b64_tr_b16 v[222:223], v18 offset:4096
    v_add_f32 v248, v248, v250
    v_mfma_f32_16x16x32_bf16 v[88:91], v[196:199], v[56:59], v[40:43]
    v_add_f32 v244, v244, v248
    v_cvt_pk_bf16_f32 v244, v244, v244
    v_mfma_f32_16x16x32_bf16 v[84:87], v[200:203], v[60:63], v[84:87]
    ds_read_b64 v[196:197], v24 offset:36864
    ds_read_b64 v[198:199], v25 offset:36864
    v_exp_f32 v44, v100
    v_exp_f32 v45, v101
    v_lshlrev_b32 v244, 16, v244
    v_mfma_f32_16x16x32_bf16 v[88:91], v[200:203], v[64:67], v[88:91]
    v_exp_f32 v46, v102
    v_add_f32 v245, 1.0, v244
    v_cvt_pk_bf16_f32 v245, v245, v245
    v_mfma_f32_16x16x32_bf16 v[132:135], v[212:215], v[116:119], v[132:135]
    ds_read_b64_tr_b16 v[224:225], v19 offset:0
    ds_read_b64_tr_b16 v[226:227], v19 offset:4096
    v_exp_f32 v47, v103
    s_add_u32 s43, s50, 0x1c000
    s_add_u32 m0, s39, 0x0
    s_nop 0
    buffer_load_dwordx4 v5, s[16:19], s43 offen offset:1024 lds
    v_lshlrev_b32 v245, 16, v245
    v_mfma_f32_16x16x32_bf16 v[136:139], v[212:215], v[120:123], v[136:139]
    v_add_f32 v14, v44, v45
    v_cvt_pk_bf16_f32 v124, v44, v45
    s_sub_u32 s80, s72, 160
    s_cmp_lt_u32 s80, 40
    s_cselect_b64 s[82:83], -1, 0
    v_cndmask_b32 v244, v244, v245, s[82:83]
    s_lshl_b32 s80, s72, 6
    s_cmp_eq_u32 s93, 0
    s_cselect_b32 s80, s80, 0x7fff0000
    s_mov_b64 exec, 0xffff
    buffer_store_dword v244, v228, s[68:71], s80 offen sc1
    s_lshr_b32 s81, s80, 1
    s_add_u32 s81, s81, 0xd8000
    v_lshrrev_b32 v229, 1, v228
    buffer_store_short_d16_hi v244, v229, s[68:71], s81 offen sc1
    s_mov_b64 exec, -1
    v_mfma_f32_16x16x32_bf16 v[84:87], v[204:207], v[68:71], v[84:87]
    ds_read_b64 v[200:201], v26 offset:36864
    ds_read_b64 v[202:203], v27 offset:36864
    v_exp_f32 v48, v108
    v_mfma_f32_16x16x32_bf16 v[88:91], v[204:207], v[72:75], v[88:91]
    v_exp_f32 v49, v109
    v_mfma_f32_16x16x32_bf16 v[140:143], v[216:219], v[116:119], v[140:143]
    ds_read_b64_tr_b16 v[212:213], v20 offset:0
    ds_read_b64_tr_b16 v[214:215], v20 offset:4096
    v_add_f32 v32, v46, v47
    s_cmp_ge_u32 s2, 108
    s_cselect_b32 s72, 1, 0
    s_cselect_b32 s75, 108, 0
    s_cselect_b32 s60, s30, s28
    s_cselect_b32 s61, s31, s29
    s_sub_u32 s75, s2, s75
    s_lshr_b32 s73, s75, 2
    s_and_b32 s74, s75, 3
    s_cmp_lt_u32 s2, 216
    s_cselect_b32 s62, 0x21c000, 0
    s_cselect_b32 s70, 0x1b000, 0
    s_mov_b32 s63, 0x20000
    s_mov_b32 s64, s94
    s_mov_b32 s65, s95
    s_mov_b32 s66, 0x3c00
    s_mov_b32 s67, 0x20000
    s_add_u32 s68, s94, 0xa0000
    s_addc_u32 s69, s95, 0
    s_mov_b32 s71, 0x20000
    s_cmp_lt_u32 s93, 4
    s_movk_i32 s75, 7680
    s_cselect_b32 s76, 10240, s75
    s_lshl_b32 s77, s73, 7
    s_mul_i32 s75, s74, 160
    v_mfma_f32_16x16x32_bf16 v[144:147], v[216:219], v[120:123], v[144:147]
    v_add_f32 v14, v14, v32
    v_cvt_pk_bf16_f32 v125, v46, v47
    v_bfe_u32 v231, v0, 3, 5
    s_waitcnt lgkmcnt(10)
    v_mfma_f32_16x16x32_bf16 v[84:87], v[208:211], v[76:79], v[84:87]
    ds_read_b64 v[204:205], v28 offset:36864
    ds_read_b64 v[206:207], v29 offset:36864
    v_exp_f32 v50, v110
    v_add_u32 v231, s75, v231
    v_mfma_f32_16x16x32_bf16 v[88:91], v[208:211], v[80:83], v[88:91]
    v_exp_f32 v51, v111
    v_mul_u32_u24 v228, 3456, v231
    s_waitcnt lgkmcnt(10)
    v_mfma_f32_16x16x32_bf16 v[148:151], v[220:223], v[116:119], v[148:151]
    ds_read_b64_tr_b16 v[216:217], v21 offset:0
    ds_read_b64_tr_b16 v[218:219], v21 offset:4096
    v_add_f32 v32, v48, v49
    v_lshlrev_b32 v229, 2, v231
    v_mfma_f32_16x16x32_bf16 v[152:155], v[220:223], v[120:123], v[152:155]
    v_add_f32 v14, v14, v32
    v_cvt_pk_bf16_f32 v126, v48, v49
    v_and_b32 v231, 7, v0
    s_waitcnt lgkmcnt(10)
    v_mfma_f32_16x16x32_bf16 v[92:95], v[196:199], v[52:55], v[36:39]
    ds_read_b64 v[208:209], v30 offset:36864
    ds_read_b64 v[210:211], v31 offset:36864
    v_exp_f32 v44, v104
    v_lshl_add_u32 v228, v231, 4, v228
    v_mfma_f32_16x16x32_bf16 v[96:99], v[196:199], v[56:59], v[40:43]
    v_exp_f32 v45, v105
    s_lshl_b32 s75, s93, 8
    s_add_u32 s75, s75, 0x26800
    s_waitcnt lgkmcnt(10)
    v_mfma_f32_16x16x32_bf16 v[156:159], v[224:227], v[116:119], v[156:159]
    ds_read_b64_tr_b16 v[220:221], v22 offset:0
    ds_read_b64_tr_b16 v[222:223], v22 offset:4096
    v_add_f32 v32, v50, v51
    s_add_u32 s43, s50, 0x18000
    s_add_u32 m0, s39, 0x18000
    s_nop 0
    buffer_load_dwordx4 v6, s[20:23], s43 offen lds
    v_lshlrev_b32 v230, 5, v231
    v_mfma_f32_16x16x32_bf16 v[160:163], v[224:227], v[120:123], v[160:163]
    v_add_f32 v14, v14, v32
    v_cvt_pk_bf16_f32 v127, v50, v51
    v_add_u32 v230, s75, v230
    s_waitcnt lgkmcnt(10)
    v_mfma_f32_16x16x32_bf16 v[92:95], v[200:203], v[60:63], v[92:95]
    ds_read_b64_tr_b16 v[224:225], v23 offset:0
    ds_read_b64_tr_b16 v[226:227], v23 offset:4096
    v_exp_f32 v46, v106
    s_add_u32 s64, s94, 0xd8000
    s_addc_u32 s65, s95, 0
    s_mul_i32 s75, s74, 320
    s_add_u32 s75, s75, 5120
    v_lshrrev_b32 v229, 4, v1
    v_lshlrev_b32 v229, 4, v229
    v_add_u32 v229, s75, v229
    v_and_b32 v230, 1, v1
    v_mul_u32_u24 v230, 1280, v230
    v_sub_u32 v229, v229, v230
    v_and_b32 v230, 1, v1
    v_lshlrev_b32 v230, 6, v230
    v_lshrrev_b32 v231, 4, v1
    v_lshl_add_u32 v230, v231, 4, v230
    v_mfma_f32_16x16x32_bf16 v[96:99], v[200:203], v[64:67], v[96:99]
    v_exp_f32 v47, v107
    s_waitcnt lgkmcnt(10)
    v_mfma_f32_16x16x32_bf16 v[164:167], v[212:215], v[116:119], v[164:167]
    ds_read_b64 v[196:197], v24 offset:40960
    ds_read_b64 v[198:199], v25 offset:40960
    v_add_f32 v15, v44, v45
    v_cvt_pk_bf16_f32 v128, v44, v45
    v_mfma_f32_16x16x32_bf16 v[168:171], v[212:215], v[120:123], v[168:171]
    v_exp_f32 v48, v112
    s_waitcnt lgkmcnt(10)
    v_mfma_f32_16x16x32_bf16 v[92:95], v[204:207], v[68:71], v[92:95]
    ds_read_b64 v[200:201], v26 offset:40960
    ds_read_b64 v[202:203], v27 offset:40960
    v_exp_f32 v49, v113
    s_lshr_b32 s81, s93, 2
    s_add_u32 s81, s81, 0
    s_lshl_b32 s80, s81, 2
    s_and_b32 s82, s93, 3
    s_add_u32 s80, s80, s82
    s_lshl_b32 s80, s80, 10
    s_add_u32 m0, s80, 0x20000
    s_mul_i32 s80, s81, 110592
    s_add_u32 s80, s80, s77
    buffer_load_dwordx4 v228, s[60:63], s80 offen lds
    v_mfma_f32_16x16x32_bf16 v[96:99], v[204:207], v[72:75], v[96:99]
    v_add_f32 v32, v46, v47
    s_waitcnt lgkmcnt(10)
    v_mfma_f32_16x16x32_bf16 v[172:175], v[216:219], v[116:119], v[172:175]
    ds_read_b64_tr_b16 v[212:213], v16 offset:8192
    ds_read_b64_tr_b16 v[214:215], v16 offset:12288
    v_add_f32 v15, v15, v32
    v_cvt_pk_bf16_f32 v129, v46, v47
    v_mfma_f32_16x16x32_bf16 v[176:179], v[216:219], v[120:123], v[176:179]
    v_exp_f32 v50, v114
    s_waitcnt lgkmcnt(10)
    v_mfma_f32_16x16x32_bf16 v[92:95], v[208:211], v[76:79], v[92:95]
    ds_read_b64 v[204:205], v28 offset:40960
    ds_read_b64 v[206:207], v29 offset:40960
    v_exp_f32 v51, v115
    v_mfma_f32_16x16x32_bf16 v[96:99], v[208:211], v[80:83], v[96:99]
    v_add_f32 v32, v48, v49
    s_waitcnt lgkmcnt(10)
    v_mfma_f32_16x16x32_bf16 v[180:183], v[220:223], v[116:119], v[180:183]
    ds_read_b64_tr_b16 v[216:217], v17 offset:8192
    ds_read_b64_tr_b16 v[218:219], v17 offset:12288
    v_add_f32 v15, v15, v32
    v_cvt_pk_bf16_f32 v130, v48, v49
    s_add_u32 s43, s50, 0x18000
    s_add_u32 m0, s39, 0x18000
    s_nop 0
    buffer_load_dwordx4 v7, s[20:23], s43 offen offset:1024 lds
    s_lshr_b32 s81, s93, 2
    s_add_u32 s81, s81, 2
    s_lshl_b32 s80, s81, 2
    s_and_b32 s82, s93, 3
    s_add_u32 s80, s80, s82
    s_lshl_b32 s80, s80, 10
    s_add_u32 m0, s80, 0x20000
    s_mul_i32 s80, s81, 110592
    s_add_u32 s80, s80, s77
    buffer_load_dwordx4 v228, s[60:63], s80 offen lds
    v_mfma_f32_16x16x32_bf16 v[184:187], v[220:223], v[120:123], v[184:187]
    v_add_f32 v32, v50, v51
    s_waitcnt lgkmcnt(10)
    v_mfma_f32_16x16x32_bf16 v[188:191], v[224:227], v[116:119], v[188:191]
    ds_read_b64 v[208:209], v30 offset:40960
    ds_read_b64 v[210:211], v31 offset:40960
    v_add_f32 v15, v15, v32
    v_mfma_f32_16x16x32_bf16 v[192:195], v[224:227], v[120:123], v[192:195]
    v_cvt_pk_bf16_f32 v131, v50, v51
    v_add_f32 v32, v14, v15
    v_cmp_nge_f32 vcc, s49, v32
    s_cbranch_vccnz L_attn_cold9
L_attn_back9:
    v_add_f32 v12, v12, v14
    v_add_f32 v13, v13, v15
    s_waitcnt lgkmcnt(10)
    v_mfma_f32_16x16x32_bf16 v[100:103], v[196:199], v[52:55], v[36:39]
    ds_read_b64_tr_b16 v[220:221], v18 offset:8192
    ds_read_b64_tr_b16 v[222:223], v18 offset:12288
    v_mfma_f32_16x16x32_bf16 v[104:107], v[196:199], v[56:59], v[40:43]
    s_waitcnt lgkmcnt(10)
    v_mfma_f32_16x16x32_bf16 v[100:103], v[200:203], v[60:63], v[100:103]
    ds_read_b64 v[196:197], v24 offset:45056
    ds_read_b64 v[198:199], v25 offset:45056
    v_exp_f32 v44, v84
    v_exp_f32 v45, v85
    s_lshr_b32 s81, s93, 2
    s_add_u32 s81, s81, 4
    s_lshl_b32 s80, s81, 2
    s_and_b32 s82, s93, 3
    s_add_u32 s80, s80, s82
    s_lshl_b32 s80, s80, 10
    s_add_u32 m0, s80, 0x20000
    s_mul_i32 s80, s81, 110592
    s_add_u32 s80, s80, s77
    s_cmp_lt_u32 s81, 5
    s_cselect_b32 s80, s80, 0x7fff0000
    buffer_load_dwordx4 v228, s[60:63], s80 offen lds
    v_mfma_f32_16x16x32_bf16 v[104:107], v[200:203], v[64:67], v[104:107]
    v_exp_f32 v46, v86
    s_waitcnt lgkmcnt(10)
    v_mfma_f32_16x16x32_bf16 v[132:135], v[212:215], v[124:127], v[132:135]
    ds_read_b64_tr_b16 v[224:225], v19 offset:8192
    ds_read_b64_tr_b16 v[226:227], v19 offset:12288
    v_exp_f32 v47, v87
    v_mfma_f32_16x16x32_bf16 v[136:139], v[212:215], v[128:131], v[136:139]
    v_add_f32 v14, v44, v45
    v_cvt_pk_bf16_f32 v116, v44, v45
    s_waitcnt lgkmcnt(10)
    v_mfma_f32_16x16x32_bf16 v[100:103], v[204:207], v[68:71], v[100:103]
    ds_read_b64 v[200:201], v26 offset:45056
    ds_read_b64 v[202:203], v27 offset:45056
    v_exp_f32 v48, v92
    v_mfma_f32_16x16x32_bf16 v[104:107], v[204:207], v[72:75], v[104:107]
    v_exp_f32 v49, v93
    s_waitcnt lgkmcnt(10)
    v_mfma_f32_16x16x32_bf16 v[140:143], v[216:219], v[124:127], v[140:143]
    ds_read_b64_tr_b16 v[212:213], v20 offset:8192
    ds_read_b64_tr_b16 v[214:215], v20 offset:12288
    v_add_f32 v32, v46, v47
    v_mfma_f32_16x16x32_bf16 v[144:147], v[216:219], v[128:131], v[144:147]
    v_add_f32 v14, v14, v32
    v_cvt_pk_bf16_f32 v117, v46, v47
    s_waitcnt lgkmcnt(10)
    v_mfma_f32_16x16x32_bf16 v[100:103], v[208:211], v[76:79], v[100:103]
    ds_read_b64 v[204:205], v28 offset:45056
    ds_read_b64 v[206:207], v29 offset:45056
    v_exp_f32 v50, v94
    v_mfma_f32_16x16x32_bf16 v[104:107], v[208:211], v[80:83], v[104:107]
    v_exp_f32 v51, v95
    s_waitcnt lgkmcnt(10)
    v_mfma_f32_16x16x32_bf16 v[148:151], v[220:223], v[124:127], v[148:151]
    ds_read_b64_tr_b16 v[216:217], v21 offset:8192
    ds_read_b64_tr_b16 v[218:219], v21 offset:12288
    v_add_f32 v32, v48, v49
    v_mfma_f32_16x16x32_bf16 v[152:155], v[220:223], v[128:131], v[152:155]
    v_add_f32 v14, v14, v32
    v_cvt_pk_bf16_f32 v118, v48, v49
    s_waitcnt lgkmcnt(10)
    v_mfma_f32_16x16x32_bf16 v[108:111], v[196:199], v[52:55], v[36:39]
    ds_read_b64 v[208:209], v30 offset:45056
    ds_read_b64 v[210:211], v31 offset:45056
    v_exp_f32 v44, v88
    v_mfma_f32_16x16x32_bf16 v[112:115], v[196:199], v[56:59], v[40:43]
    v_exp_f32 v45, v89
    s_waitcnt lgkmcnt(10)
    v_mfma_f32_16x16x32_bf16 v[156:159], v[224:227], v[124:127], v[156:159]
    ds_read_b64_tr_b16 v[220:221], v22 offset:8192
    ds_read_b64_tr_b16 v[222:223], v22 offset:12288
    v_add_f32 v32, v50, v51
    v_mfma_f32_16x16x32_bf16 v[160:163], v[224:227], v[128:131], v[160:163]
    v_add_f32 v14, v14, v32
    v_cvt_pk_bf16_f32 v119, v50, v51
    s_waitcnt lgkmcnt(10)
    v_mfma_f32_16x16x32_bf16 v[108:111], v[200:203], v[60:63], v[108:111]
    ds_read_b64_tr_b16 v[224:225], v23 offset:8192
    ds_read_b64_tr_b16 v[226:227], v23 offset:12288
    v_exp_f32 v46, v90
    v_mfma_f32_16x16x32_bf16 v[112:115], v[200:203], v[64:67], v[112:115]
    v_exp_f32 v47, v91
    s_waitcnt vmcnt(5)
    s_waitcnt lgkmcnt(10)
    v_mfma_f32_16x16x32_bf16 v[164:167], v[212:215], v[124:127], v[164:167]
    s_barrier
    ds_read_b64 v[196:197], v24 offset:49152
    ds_read_b64 v[198:199], v25 offset:49152
    v_add_f32 v15, v44, v45
    v_cvt_pk_bf16_f32 v120, v44, v45
    v_mfma_f32_16x16x32_bf16 v[168:171], v[212:215], v[128:131], v[168:171]
    v_exp_f32 v48, v96
    s_cmp_lg_u32 s93, 0
    s_cbranch_scc1 L_adaLN_cond__sliding_block_cached__swiglu_ffn__prompt_kernel_27
    s_mov_b32 s44, 0
    s_lshl_b32 s45, s44, 6
    s_add_u32 s45, s45, s2
    s_lshl_b32 s45, s45, 7
    s_add_u32 s45, s45, 0x50000
    s_add_u32 s4, s94, 0x380000
    s_addc_u32 s5, s95, 0
    s_mov_b32 s6, 0x80000
    s_mov_b32 s7, 0x20000
    s_mov_b64 exec, 1
    v_mov_b32 v33, s98
    v_mov_b32 v34, 0
    buffer_store_dword v33, v34, s[4:7], s45 offen sc1
    s_mov_b64 exec, -1
L_adaLN_cond__sliding_block_cached__swiglu_ffn__prompt_kernel_27:
    s_waitcnt lgkmcnt(10)
    v_mfma_f32_16x16x32_bf16 v[108:111], v[204:207], v[68:71], v[108:111]
    ds_read_b64 v[200:201], v26 offset:49152
    ds_read_b64 v[202:203], v27 offset:49152
    v_exp_f32 v49, v97
    v_mfma_f32_16x16x32_bf16 v[112:115], v[204:207], v[72:75], v[112:115]
    v_add_f32 v32, v46, v47
    s_waitcnt lgkmcnt(10)
    v_mfma_f32_16x16x32_bf16 v[172:175], v[216:219], v[124:127], v[172:175]
    ds_read_b64_tr_b16 v[212:213], v16 offset:16384
    ds_read_b64_tr_b16 v[214:215], v16 offset:20480
    v_add_f32 v15, v15, v32
    v_cvt_pk_bf16_f32 v121, v46, v47
    s_add_u32 s43, s50, 0x1c000
    s_add_u32 m0, s39, 0x1c000
    s_nop 0
    buffer_load_dwordx4 v6, s[20:23], s43 offen lds
    v_mfma_f32_16x16x32_bf16 v[176:179], v[216:219], v[128:131], v[176:179]
    v_exp_f32 v50, v98
    s_waitcnt lgkmcnt(10)
    v_mfma_f32_16x16x32_bf16 v[108:111], v[208:211], v[76:79], v[108:111]
    ds_read_b64 v[204:205], v28 offset:49152
    ds_read_b64 v[206:207], v29 offset:49152
    v_exp_f32 v51, v99
    v_mfma_f32_16x16x32_bf16 v[112:115], v[208:211], v[80:83], v[112:115]
    v_add_f32 v32, v48, v49
    s_waitcnt lgkmcnt(10)
    v_mfma_f32_16x16x32_bf16 v[180:183], v[220:223], v[124:127], v[180:183]
    ds_read_b64_tr_b16 v[216:217], v17 offset:16384
    ds_read_b64_tr_b16 v[218:219], v17 offset:20480
    v_add_f32 v15, v15, v32
    v_cvt_pk_bf16_f32 v122, v48, v49
    v_mfma_f32_16x16x32_bf16 v[184:187], v[220:223], v[128:131], v[184:187]
    v_add_f32 v32, v50, v51
    s_waitcnt lgkmcnt(10)
    v_mfma_f32_16x16x32_bf16 v[188:191], v[224:227], v[124:127], v[188:191]
    ds_read_b64 v[208:209], v30 offset:49152
    ds_read_b64 v[210:211], v31 offset:49152
    v_add_f32 v15, v15, v32
    v_mfma_f32_16x16x32_bf16 v[192:195], v[224:227], v[128:131], v[192:195]
    v_cvt_pk_bf16_f32 v123, v50, v51
    v_add_f32 v32, v14, v15
    v_cmp_nge_f32 vcc, s49, v32
    s_cbranch_vccnz L_attn_cold10
L_attn_back10:
    v_add_f32 v12, v12, v14
    v_add_f32 v13, v13, v15
    s_waitcnt lgkmcnt(10)
    v_mfma_f32_16x16x32_bf16 v[84:87], v[196:199], v[52:55], v[36:39]
    ds_read_b64_tr_b16 v[220:221], v18 offset:16384
    ds_read_b64_tr_b16 v[222:223], v18 offset:20480
    v_mfma_f32_16x16x32_bf16 v[88:91], v[196:199], v[56:59], v[40:43]
    s_waitcnt lgkmcnt(10)
    v_mfma_f32_16x16x32_bf16 v[84:87], v[200:203], v[60:63], v[84:87]
    ds_read_b64 v[196:197], v24 offset:53248
    ds_read_b64 v[198:199], v25 offset:53248
    v_exp_f32 v44, v100
    v_exp_f32 v45, v101
    v_mfma_f32_16x16x32_bf16 v[88:91], v[200:203], v[64:67], v[88:91]
    v_exp_f32 v46, v102
    s_waitcnt lgkmcnt(10)
    v_mfma_f32_16x16x32_bf16 v[132:135], v[212:215], v[116:119], v[132:135]
    ds_read_b64_tr_b16 v[224:225], v19 offset:16384
    ds_read_b64_tr_b16 v[226:227], v19 offset:20480
    v_exp_f32 v47, v103
    s_add_u32 s43, s50, 0x1c000
    s_add_u32 m0, s39, 0x1c000
    s_nop 0
    buffer_load_dwordx4 v7, s[20:23], s43 offen offset:1024 lds
    v_mfma_f32_16x16x32_bf16 v[136:139], v[212:215], v[120:123], v[136:139]
    v_add_f32 v14, v44, v45
    v_cvt_pk_bf16_f32 v124, v44, v45
    s_waitcnt lgkmcnt(10)
    v_mfma_f32_16x16x32_bf16 v[84:87], v[204:207], v[68:71], v[84:87]
    ds_read_b64 v[200:201], v26 offset:53248
    ds_read_b64 v[202:203], v27 offset:53248
    v_exp_f32 v48, v108
    v_mfma_f32_16x16x32_bf16 v[88:91], v[204:207], v[72:75], v[88:91]
    v_exp_f32 v49, v109
    s_waitcnt lgkmcnt(10)
    v_mfma_f32_16x16x32_bf16 v[140:143], v[216:219], v[116:119], v[140:143]
    ds_read_b64_tr_b16 v[212:213], v20 offset:16384
    ds_read_b64_tr_b16 v[214:215], v20 offset:20480
    v_add_f32 v32, v46, v47
    v_mfma_f32_16x16x32_bf16 v[144:147], v[216:219], v[120:123], v[144:147]
    v_add_f32 v14, v14, v32
    v_cvt_pk_bf16_f32 v125, v46, v47
    s_waitcnt lgkmcnt(10)
    v_mfma_f32_16x16x32_bf16 v[84:87], v[208:211], v[76:79], v[84:87]
    ds_read_b64 v[204:205], v28 offset:53248
    ds_read_b64 v[206:207], v29 offset:53248
    v_exp_f32 v50, v110
    v_mfma_f32_16x16x32_bf16 v[88:91], v[208:211], v[80:83], v[88:91]
    v_exp_f32 v51, v111
    s_waitcnt lgkmcnt(10)
    v_mfma_f32_16x16x32_bf16 v[148:151], v[220:223], v[116:119], v[148:151]
    ds_read_b64_tr_b16 v[216:217], v21 offset:16384
    ds_read_b64_tr_b16 v[218:219], v21 offset:20480
    v_add_f32 v32, v48, v49
    v_mfma_f32_16x16x32_bf16 v[152:155], v[220:223], v[120:123], v[152:155]
    v_add_f32 v14, v14, v32
    v_cvt_pk_bf16_f32 v126, v48, v49
    s_waitcnt lgkmcnt(10)
    v_mfma_f32_16x16x32_bf16 v[92:95], v[196:199], v[52:55], v[36:39]
    ds_read_b64 v[208:209], v30 offset:53248
    ds_read_b64 v[210:211], v31 offset:53248
    v_exp_f32 v44, v104
    v_mfma_f32_16x16x32_bf16 v[96:99], v[196:199], v[56:59], v[40:43]
    v_exp_f32 v45, v105
    s_waitcnt lgkmcnt(10)
    v_mfma_f32_16x16x32_bf16 v[156:159], v[224:227], v[116:119], v[156:159]
    ds_read_b64_tr_b16 v[220:221], v22 offset:16384
    ds_read_b64_tr_b16 v[222:223], v22 offset:20480
    v_add_f32 v32, v50, v51
    v_mfma_f32_16x16x32_bf16 v[160:163], v[224:227], v[120:123], v[160:163]
    v_add_f32 v14, v14, v32
    v_cvt_pk_bf16_f32 v127, v50, v51
    s_waitcnt lgkmcnt(10)
    v_mfma_f32_16x16x32_bf16 v[92:95], v[200:203], v[60:63], v[92:95]
    ds_read_b64_tr_b16 v[224:225], v23 offset:16384
    ds_read_b64_tr_b16 v[226:227], v23 offset:20480
    v_exp_f32 v46, v106
    v_mfma_f32_16x16x32_bf16 v[96:99], v[200:203], v[64:67], v[96:99]
    v_exp_f32 v47, v107
    s_waitcnt lgkmcnt(10)
    v_mfma_f32_16x16x32_bf16 v[164:167], v[212:215], v[116:119], v[164:167]
    ds_read_b64 v[196:197], v24 offset:57344
    ds_read_b64 v[198:199], v25 offset:57344
    v_add_f32 v15, v44, v45
    v_cvt_pk_bf16_f32 v128, v44, v45
    v_mfma_f32_16x16x32_bf16 v[168:171], v[212:215], v[120:123], v[168:171]
    v_exp_f32 v48, v112
    s_waitcnt lgkmcnt(10)
    v_mfma_f32_16x16x32_bf16 v[92:95], v[204:207], v[68:71], v[92:95]
    ds_read_b64 v[200:201], v26 offset:57344
    ds_read_b64 v[202:203], v27 offset:57344
    v_exp_f32 v49, v113
    v_mfma_f32_16x16x32_bf16 v[96:99], v[204:207], v[72:75], v[96:99]
    v_add_f32 v32, v46, v47
    s_waitcnt lgkmcnt(10)
    v_mfma_f32_16x16x32_bf16 v[172:175], v[216:219], v[116:119], v[172:175]
    ds_read_b64_tr_b16 v[212:213], v16 offset:24576
    ds_read_b64_tr_b16 v[214:215], v16 offset:28672
    v_add_f32 v15, v15, v32
    v_cvt_pk_bf16_f32 v129, v46, v47
    v_mfma_f32_16x16x32_bf16 v[176:179], v[216:219], v[120:123], v[176:179]
    v_exp_f32 v50, v114
    s_waitcnt lgkmcnt(10)
    v_mfma_f32_16x16x32_bf16 v[92:95], v[208:211], v[76:79], v[92:95]
    ds_read_b64 v[204:205], v28 offset:57344
    ds_read_b64 v[206:207], v29 offset:57344
    v_exp_f32 v51, v115
    s_cmp_lg_u32 s93, 4
    s_cbranch_scc1 L_adaLN_cond__sliding_block_cached__swiglu_ffn__prompt_kernel_28
    v_lshlrev_b32 v2, 7, v1
    v_add_u32 v2, 0x50000, v2
    v_add_u32 v3, 0x2000, v2
    v_add_u32 v4, 0x4000, v2
    v_add_u32 v5, 0x6000, v2
    s_add_u32 s4, s94, 0x380000
    s_addc_u32 s5, s95, 0
    s_mov_b32 s6, 0x80000
    s_mov_b32 s7, 0x20000
    buffer_load_dword v232, v2, s[4:7], 0 offen sc1
    buffer_load_dword v233, v3, s[4:7], 0 offen sc1
    buffer_load_dword v234, v4, s[4:7], 0 offen sc1
    buffer_load_dword v235, v5, s[4:7], 0 offen sc1
L_adaLN_cond__sliding_block_cached__swiglu_ffn__prompt_kernel_28:
    v_mfma_f32_16x16x32_bf16 v[96:99], v[208:211], v[80:83], v[96:99]
    v_add_f32 v32, v48, v49
    s_waitcnt lgkmcnt(10)
    v_mfma_f32_16x16x32_bf16 v[180:183], v[220:223], v[116:119], v[180:183]
    ds_read_b64_tr_b16 v[216:217], v17 offset:24576
    ds_read_b64_tr_b16 v[218:219], v17 offset:28672
    v_add_f32 v15, v15, v32
    v_cvt_pk_bf16_f32 v130, v48, v49
    v_mfma_f32_16x16x32_bf16 v[184:187], v[220:223], v[120:123], v[184:187]
    v_add_f32 v32, v50, v51
    s_waitcnt lgkmcnt(10)
    v_mfma_f32_16x16x32_bf16 v[188:191], v[224:227], v[116:119], v[188:191]
    ds_read_b64 v[208:209], v30 offset:57344
    ds_read_b64 v[210:211], v31 offset:57344
    v_add_f32 v15, v15, v32
    v_mfma_f32_16x16x32_bf16 v[192:195], v[224:227], v[120:123], v[192:195]
    v_cvt_pk_bf16_f32 v131, v50, v51
    v_add_f32 v32, v14, v15
    v_cmp_nge_f32 vcc, s49, v32
    s_cbranch_vccnz L_attn_cold11
L_attn_back11:
    v_add_f32 v12, v12, v14
    v_add_f32 v13, v13, v15
    s_waitcnt lgkmcnt(10)
    v_mfma_f32_16x16x32_bf16 v[100:103], v[196:199], v[52:55], v[36:39]
    ds_read_b64_tr_b16 v[220:221], v18 offset:24576
    ds_read_b64_tr_b16 v[222:223], v18 offset:28672
    v_mfma_f32_16x16x32_bf16 v[104:107], v[196:199], v[56:59], v[40:43]
    s_waitcnt lgkmcnt(10)
    v_mfma_f32_16x16x32_bf16 v[100:103], v[200:203], v[60:63], v[100:103]
    ds_read_b64 v[196:197], v24 offset:61440
    ds_read_b64 v[198:199], v25 offset:61440
    v_exp_f32 v44, v84
    v_exp_f32 v45, v85
    v_mfma_f32_16x16x32_bf16 v[104:107], v[200:203], v[64:67], v[104:107]
    v_exp_f32 v46, v86
    s_waitcnt lgkmcnt(10)
    v_mfma_f32_16x16x32_bf16 v[132:135], v[212:215], v[124:127], v[132:135]
    ds_read_b64_tr_b16 v[224:225], v19 offset:24576
    ds_read_b64_tr_b16 v[226:227], v19 offset:28672
    v_exp_f32 v47, v87
    v_mfma_f32_16x16x32_bf16 v[136:139], v[212:215], v[128:131], v[136:139]
    v_add_f32 v14, v44, v45
    v_cvt_pk_bf16_f32 v116, v44, v45
    s_waitcnt lgkmcnt(10)
    v_mfma_f32_16x16x32_bf16 v[100:103], v[204:207], v[68:71], v[100:103]
    ds_read_b64 v[200:201], v26 offset:61440
    ds_read_b64 v[202:203], v27 offset:61440
    v_exp_f32 v48, v92
    v_mfma_f32_16x16x32_bf16 v[104:107], v[204:207], v[72:75], v[104:107]
    v_exp_f32 v49, v93
    s_waitcnt lgkmcnt(10)
    v_mfma_f32_16x16x32_bf16 v[140:143], v[216:219], v[124:127], v[140:143]
    ds_read_b64_tr_b16 v[212:213], v20 offset:24576
    ds_read_b64_tr_b16 v[214:215], v20 offset:28672
    v_add_f32 v32, v46, v47
    v_mfma_f32_16x16x32_bf16 v[144:147], v[216:219], v[128:131], v[144:147]
    v_add_f32 v14, v14, v32
    v_cvt_pk_bf16_f32 v117, v46, v47
    s_waitcnt lgkmcnt(10)
    v_mfma_f32_16x16x32_bf16 v[100:103], v[208:211], v[76:79], v[100:103]
    ds_read_b64 v[204:205], v28 offset:61440
    ds_read_b64 v[206:207], v29 offset:61440
    v_exp_f32 v50, v94
    v_mfma_f32_16x16x32_bf16 v[104:107], v[208:211], v[80:83], v[104:107]
    v_exp_f32 v51, v95
    s_waitcnt lgkmcnt(10)
    v_mfma_f32_16x16x32_bf16 v[148:151], v[220:223], v[124:127], v[148:151]
    ds_read_b64_tr_b16 v[216:217], v21 offset:24576
    ds_read_b64_tr_b16 v[218:219], v21 offset:28672
    v_add_f32 v32, v48, v49
    v_mfma_f32_16x16x32_bf16 v[152:155], v[220:223], v[128:131], v[152:155]
    v_add_f32 v14, v14, v32
    v_cvt_pk_bf16_f32 v118, v48, v49
    s_waitcnt lgkmcnt(10)
    v_mfma_f32_16x16x32_bf16 v[108:111], v[196:199], v[52:55], v[36:39]
    ds_read_b64 v[208:209], v30 offset:61440
    ds_read_b64 v[210:211], v31 offset:61440
    v_exp_f32 v44, v88
    v_mfma_f32_16x16x32_bf16 v[112:115], v[196:199], v[56:59], v[40:43]
    v_exp_f32 v45, v89
    s_waitcnt lgkmcnt(10)
    v_mfma_f32_16x16x32_bf16 v[156:159], v[224:227], v[124:127], v[156:159]
    ds_read_b64_tr_b16 v[220:221], v22 offset:24576
    ds_read_b64_tr_b16 v[222:223], v22 offset:28672
    v_add_f32 v32, v50, v51
    v_mfma_f32_16x16x32_bf16 v[160:163], v[224:227], v[128:131], v[160:163]
    v_add_f32 v14, v14, v32
    v_cvt_pk_bf16_f32 v119, v50, v51
    s_waitcnt lgkmcnt(10)
    v_mfma_f32_16x16x32_bf16 v[108:111], v[200:203], v[60:63], v[108:111]
    ds_read_b64_tr_b16 v[224:225], v23 offset:24576
    ds_read_b64_tr_b16 v[226:227], v23 offset:28672
    v_exp_f32 v46, v90
    s_cmp_lg_u32 s93, 4
    s_cbranch_scc1 L_adaLN_cond__sliding_block_cached__swiglu_ffn__prompt_kernel_29
    s_waitcnt vmcnt(3)
    v_xor_b32 v232, s98, v232
    s_waitcnt vmcnt(2)
    v_xor_b32 v233, s98, v233
    s_waitcnt vmcnt(1)
    v_xor_b32 v234, s98, v234
    s_waitcnt vmcnt(0)
    v_xor_b32 v235, s98, v235
    v_or_b32 v232, v232, v233
    v_or_b32 v232, v232, v234
    v_or_b32 v232, v232, v235
    v_cmp_ne_u32 vcc, 0, v232
    s_cbranch_vccnz L_adaLN_cond__sliding_block_cached__swiglu_ffn__prompt_kernel_30
L_adaLN_cond__sliding_block_cached__swiglu_ffn__prompt_kernel_29:
    v_mfma_f32_16x16x32_bf16 v[112:115], v[200:203], v[64:67], v[112:115]
    v_exp_f32 v47, v91
    s_waitcnt vmcnt(2)
    s_waitcnt lgkmcnt(10)
    v_mfma_f32_16x16x32_bf16 v[164:167], v[212:215], v[124:127], v[164:167]
    s_barrier
    ds_read_b64 v[196:197], v24 offset:0
    ds_read_b64 v[198:199], v25 offset:0
    v_add_f32 v15, v44, v45
    v_cvt_pk_bf16_f32 v120, v44, v45
    v_mfma_f32_16x16x32_bf16 v[168:171], v[212:215], v[128:131], v[168:171]
    v_exp_f32 v48, v96
    buffer_load_dwordx4 v[240:243], v229, s[64:67], 0 offen offset:0 sc1
    buffer_load_dwordx4 v[244:247], v229, s[64:67], 0 offen offset:64 sc1
    buffer_load_dwordx4 v[248:251], v229, s[64:67], 0 offen offset:128 sc1
    buffer_load_dwordx4 v[252:255], v229, s[64:67], 0 offen offset:192 sc1
    buffer_load_dwordx4 v[4:7], v229, s[64:67], 0 offen offset:256 sc1
    s_waitcnt lgkmcnt(10)
    v_mfma_f32_16x16x32_bf16 v[108:111], v[204:207], v[68:71], v[108:111]
    ds_read_b64 v[200:201], v26 offset:0
    ds_read_b64 v[202:203], v27 offset:0
    v_exp_f32 v49, v97
    v_mfma_f32_16x16x32_bf16 v[112:115], v[204:207], v[72:75], v[112:115]
    v_add_f32 v32, v46, v47
    s_waitcnt lgkmcnt(10)
    v_mfma_f32_16x16x32_bf16 v[172:175], v[216:219], v[124:127], v[172:175]
    ds_read_b64_tr_b16 v[212:213], v16 offset:32768
    ds_read_b64_tr_b16 v[214:215], v16 offset:36864
    v_add_f32 v15, v15, v32
    v_cvt_pk_bf16_f32 v121, v46, v47
    v_mfma_f32_16x16x32_bf16 v[176:179], v[216:219], v[128:131], v[176:179]
    v_exp_f32 v50, v98
    s_waitcnt lgkmcnt(10)
    v_mfma_f32_16x16x32_bf16 v[108:111], v[208:211], v[76:79], v[108:111]
    ds_read_b64 v[204:205], v28 offset:0
    ds_read_b64 v[206:207], v29 offset:0
    v_exp_f32 v51, v99
    v_mfma_f32_16x16x32_bf16 v[112:115], v[208:211], v[80:83], v[112:115]
    v_add_f32 v32, v48, v49
    s_waitcnt lgkmcnt(10)
    v_mfma_f32_16x16x32_bf16 v[180:183], v[220:223], v[124:127], v[180:183]
    ds_read_b64_tr_b16 v[216:217], v17 offset:32768
    ds_read_b64_tr_b16 v[218:219], v17 offset:36864
    v_add_f32 v15, v15, v32
    v_cvt_pk_bf16_f32 v122, v48, v49
    v_mfma_f32_16x16x32_bf16 v[184:187], v[220:223], v[128:131], v[184:187]
    v_add_f32 v32, v50, v51
    s_waitcnt lgkmcnt(10)
    v_mfma_f32_16x16x32_bf16 v[188:191], v[224:227], v[124:127], v[188:191]
    ds_read_b64 v[208:209], v30 offset:0
    ds_read_b64 v[210:211], v31 offset:0
    v_add_f32 v15, v15, v32
    v_mfma_f32_16x16x32_bf16 v[192:195], v[224:227], v[128:131], v[192:195]
    v_cvt_pk_bf16_f32 v123, v50, v51
    v_add_f32 v32, v14, v15
    v_cmp_nge_f32 vcc, s49, v32
    s_cbranch_vccnz L_attn_cold12
L_attn_back12:
    v_add_f32 v12, v12, v14
    v_add_f32 v13, v13, v15
    s_waitcnt lgkmcnt(10)
    v_mfma_f32_16x16x32_bf16 v[84:87], v[196:199], v[52:55], v[36:39]
    ds_read_b64_tr_b16 v[220:221], v18 offset:32768
    ds_read_b64_tr_b16 v[222:223], v18 offset:36864
    v_mfma_f32_16x16x32_bf16 v[88:91], v[196:199], v[56:59], v[40:43]
    s_waitcnt lgkmcnt(10)
    v_mfma_f32_16x16x32_bf16 v[84:87], v[200:203], v[60:63], v[84:87]
    ds_read_b64 v[196:197], v24 offset:4096
    ds_read_b64 v[198:199], v25 offset:4096
    v_exp_f32 v44, v100
    v_exp_f32 v45, v101
    v_mfma_f32_16x16x32_bf16 v[88:91], v[200:203], v[64:67], v[88:91]
    v_exp_f32 v46, v102
    s_waitcnt lgkmcnt(10)
    v_mfma_f32_16x16x32_bf16 v[132:135], v[212:215], v[116:119], v[132:135]
    ds_read_b64_tr_b16 v[224:225], v19 offset:32768
    ds_read_b64_tr_b16 v[226:227], v19 offset:36864
    v_exp_f32 v47, v103
    v_mfma_f32_16x16x32_bf16 v[136:139], v[212:215], v[120:123], v[136:139]
    v_add_f32 v14, v44, v45
    v_cvt_pk_bf16_f32 v124, v44, v45
    s_waitcnt lgkmcnt(10)
    v_mfma_f32_16x16x32_bf16 v[84:87], v[204:207], v[68:71], v[84:87]
    ds_read_b64 v[200:201], v26 offset:4096
    ds_read_b64 v[202:203], v27 offset:4096
    v_exp_f32 v48, v108
    v_mfma_f32_16x16x32_bf16 v[88:91], v[204:207], v[72:75], v[88:91]
    v_exp_f32 v49, v109
    s_waitcnt lgkmcnt(10)
    v_mfma_f32_16x16x32_bf16 v[140:143], v[216:219], v[116:119], v[140:143]
    ds_read_b64_tr_b16 v[212:213], v20 offset:32768
    ds_read_b64_tr_b16 v[214:215], v20 offset:36864
    v_add_f32 v32, v46, v47
    v_mfma_f32_16x16x32_bf16 v[144:147], v[216:219], v[120:123], v[144:147]
    v_add_f32 v14, v14, v32
    v_cvt_pk_bf16_f32 v125, v46, v47
    s_waitcnt lgkmcnt(10)
    v_mfma_f32_16x16x32_bf16 v[84:87], v[208:211], v[76:79], v[84:87]
    ds_read_b64 v[204:205], v28 offset:4096
    ds_read_b64 v[206:207], v29 offset:4096
    v_exp_f32 v50, v110
    v_mfma_f32_16x16x32_bf16 v[88:91], v[208:211], v[80:83], v[88:91]
    v_exp_f32 v51, v111
    s_waitcnt lgkmcnt(10)
    v_mfma_f32_16x16x32_bf16 v[148:151], v[220:223], v[116:119], v[148:151]
    ds_read_b64_tr_b16 v[216:217], v21 offset:32768
    ds_read_b64_tr_b16 v[218:219], v21 offset:36864
    v_add_f32 v32, v48, v49
    v_mfma_f32_16x16x32_bf16 v[152:155], v[220:223], v[120:123], v[152:155]
    v_add_f32 v14, v14, v32
    v_cvt_pk_bf16_f32 v126, v48, v49
    s_waitcnt lgkmcnt(10)
    v_mfma_f32_16x16x32_bf16 v[92:95], v[196:199], v[52:55], v[36:39]
    ds_read_b64 v[208:209], v30 offset:4096
    ds_read_b64 v[210:211], v31 offset:4096
    v_exp_f32 v44, v104
    v_mfma_f32_16x16x32_bf16 v[96:99], v[196:199], v[56:59], v[40:43]
    v_exp_f32 v45, v105
    s_waitcnt lgkmcnt(10)
    v_mfma_f32_16x16x32_bf16 v[156:159], v[224:227], v[116:119], v[156:159]
    ds_read_b64_tr_b16 v[220:221], v22 offset:32768
    ds_read_b64_tr_b16 v[222:223], v22 offset:36864
    v_add_f32 v32, v50, v51
    v_mfma_f32_16x16x32_bf16 v[160:163], v[224:227], v[120:123], v[160:163]
    v_add_f32 v14, v14, v32
    v_cvt_pk_bf16_f32 v127, v50, v51
    s_waitcnt lgkmcnt(10)
    v_mfma_f32_16x16x32_bf16 v[92:95], v[200:203], v[60:63], v[92:95]
    ds_read_b64_tr_b16 v[224:225], v23 offset:32768
    ds_read_b64_tr_b16 v[226:227], v23 offset:36864
    v_exp_f32 v46, v106
    v_mfma_f32_16x16x32_bf16 v[96:99], v[200:203], v[64:67], v[96:99]
    v_exp_f32 v47, v107
    s_waitcnt lgkmcnt(10)
    v_mfma_f32_16x16x32_bf16 v[164:167], v[212:215], v[116:119], v[164:167]
    ds_read_b64 v[196:197], v24 offset:8192
    ds_read_b64 v[198:199], v25 offset:8192
    v_add_f32 v15, v44, v45
    v_cvt_pk_bf16_f32 v128, v44, v45
    v_mfma_f32_16x16x32_bf16 v[168:171], v[212:215], v[120:123], v[168:171]
    v_exp_f32 v48, v112
    s_waitcnt lgkmcnt(10)
    v_mfma_f32_16x16x32_bf16 v[92:95], v[204:207], v[68:71], v[92:95]
    ds_read_b64 v[200:201], v26 offset:8192
    ds_read_b64 v[202:203], v27 offset:8192
    v_exp_f32 v49, v113
    v_mfma_f32_16x16x32_bf16 v[96:99], v[204:207], v[72:75], v[96:99]
    v_add_f32 v32, v46, v47
    s_waitcnt lgkmcnt(10)
    v_mfma_f32_16x16x32_bf16 v[172:175], v[216:219], v[116:119], v[172:175]
    ds_read_b64_tr_b16 v[212:213], v16 offset:40960
    ds_read_b64_tr_b16 v[214:215], v16 offset:45056
    v_add_f32 v15, v15, v32
    v_cvt_pk_bf16_f32 v129, v46, v47
    v_mfma_f32_16x16x32_bf16 v[176:179], v[216:219], v[120:123], v[176:179]
    v_exp_f32 v50, v114
    s_waitcnt lgkmcnt(10)
    v_mfma_f32_16x16x32_bf16 v[92:95], v[208:211], v[76:79], v[92:95]
    ds_read_b64 v[204:205], v28 offset:8192
    ds_read_b64 v[206:207], v29 offset:8192
    v_exp_f32 v51, v115
    s_and_b32 s80, s93, 3
    s_lshl_b32 s80, s80, 5
    s_add_u32 s80, s80, 0x20000
    v_lshrrev_b32 v228, 4, v1
    v_bfe_u32 v231, v1, 2, 2
    v_lshl_add_u32 v228, v228, 3, v231
    v_lshlrev_b32 v228, 7, v228
    v_and_b32 v231, 3, v1
    v_lshl_add_u32 v228, v231, 3, v228
    v_add_u32 v228, s80, v228
    v_mfma_f32_16x16x32_bf16 v[96:99], v[208:211], v[80:83], v[96:99]
    v_add_f32 v32, v48, v49
    s_waitcnt lgkmcnt(10)
    v_mfma_f32_16x16x32_bf16 v[180:183], v[220:223], v[116:119], v[180:183]
    ds_read_b64_tr_b16 v[216:217], v17 offset:40960
    ds_read_b64_tr_b16 v[218:219], v17 offset:45056
    v_add_f32 v15, v15, v32
    v_cvt_pk_bf16_f32 v130, v48, v49
    ds_read_b64_tr_b16 v[232:233], v228 offset:0
    ds_read_b64_tr_b16 v[234:235], v228 offset:512
    v_mfma_f32_16x16x32_bf16 v[184:187], v[220:223], v[120:123], v[184:187]
    v_add_f32 v32, v50, v51
    s_waitcnt lgkmcnt(12)
    v_mfma_f32_16x16x32_bf16 v[188:191], v[224:227], v[116:119], v[188:191]
    ds_read_b64 v[208:209], v30 offset:8192
    ds_read_b64 v[210:211], v31 offset:8192
    v_add_f32 v15, v15, v32
    v_mfma_f32_16x16x32_bf16 v[192:195], v[224:227], v[120:123], v[192:195]
    v_cvt_pk_bf16_f32 v131, v50, v51
    v_add_f32 v32, v14, v15
    v_cmp_nge_f32 vcc, s49, v32
    s_cbranch_vccnz L_attn_cold13
L_attn_back13:
    v_add_f32 v12, v12, v14
    v_add_f32 v13, v13, v15
    s_waitcnt lgkmcnt(12)
    v_mfma_f32_16x16x32_bf16 v[100:103], v[196:199], v[52:55], v[36:39]
    ds_read_b64_tr_b16 v[220:221], v18 offset:40960
    ds_read_b64_tr_b16 v[222:223], v18 offset:45056
    s_waitcnt vmcnt(4) lgkmcnt(4)
    v_mfma_f32_16x16x32_bf16 v[236:239], v[232:235], v[240:243], 0
    v_mfma_f32_16x16x32_bf16 v[104:107], v[196:199], v[56:59], v[40:43]
    ds_read_b64_tr_b16 v[232:233], v228 offset:4096
    ds_read_b64_tr_b16 v[234:235], v228 offset:4608
    v_mfma_f32_16x16x32_bf16 v[100:103], v[200:203], v[60:63], v[100:103]
    ds_read_b64 v[196:197], v24 offset:12288
    ds_read_b64 v[198:199], v25 offset:12288
    v_exp_f32 v44, v84
    v_exp_f32 v45, v85
    v_mfma_f32_16x16x32_bf16 v[104:107], v[200:203], v[64:67], v[104:107]
    v_exp_f32 v46, v86
    v_mfma_f32_16x16x32_bf16 v[132:135], v[212:215], v[124:127], v[132:135]
    ds_read_b64_tr_b16 v[224:225], v19 offset:40960
    ds_read_b64_tr_b16 v[226:227], v19 offset:45056
    v_exp_f32 v47, v87
    v_mfma_f32_16x16x32_bf16 v[136:139], v[212:215], v[128:131], v[136:139]
    v_add_f32 v14, v44, v45
    v_cvt_pk_bf16_f32 v116, v44, v45
    s_waitcnt vmcnt(3) lgkmcnt(4)
    v_mfma_f32_16x16x32_bf16 v[236:239], v[232:235], v[244:247], v[236:239]
    v_mfma_f32_16x16x32_bf16 v[100:103], v[204:207], v[68:71], v[100:103]
    ds_read_b64 v[200:201], v26 offset:12288
    ds_read_b64 v[202:203], v27 offset:12288
    v_exp_f32 v48, v92
    ds_read_b64_tr_b16 v[232:233], v228 offset:8192
    ds_read_b64_tr_b16 v[234:235], v228 offset:8704
    v_mfma_f32_16x16x32_bf16 v[104:107], v[204:207], v[72:75], v[104:107]
    v_exp_f32 v49, v93
    v_mfma_f32_16x16x32_bf16 v[140:143], v[216:219], v[124:127], v[140:143]
    ds_read_b64_tr_b16 v[212:213], v20 offset:40960
    ds_read_b64_tr_b16 v[214:215], v20 offset:45056
    v_add_f32 v32, v46, v47
    v_mfma_f32_16x16x32_bf16 v[144:147], v[216:219], v[128:131], v[144:147]
    v_add_f32 v14, v14, v32
    v_cvt_pk_bf16_f32 v117, v46, v47
    v_mfma_f32_16x16x32_bf16 v[100:103], v[208:211], v[76:79], v[100:103]
    ds_read_b64 v[204:205], v28 offset:12288
    ds_read_b64 v[206:207], v29 offset:12288
    v_exp_f32 v50, v94
    s_waitcnt vmcnt(2) lgkmcnt(4)
    v_mfma_f32_16x16x32_bf16 v[236:239], v[232:235], v[248:251], v[236:239]
    v_mfma_f32_16x16x32_bf16 v[104:107], v[208:211], v[80:83], v[104:107]
    v_exp_f32 v51, v95
    ds_read_b64_tr_b16 v[232:233], v228 offset:12288
    ds_read_b64_tr_b16 v[234:235], v228 offset:12800
    v_mfma_f32_16x16x32_bf16 v[148:151], v[220:223], v[124:127], v[148:151]
    ds_read_b64_tr_b16 v[216:217], v21 offset:40960
    ds_read_b64_tr_b16 v[218:219], v21 offset:45056
    v_add_f32 v32, v48, v49
    v_mfma_f32_16x16x32_bf16 v[152:155], v[220:223], v[128:131], v[152:155]
    v_add_f32 v14, v14, v32
    v_cvt_pk_bf16_f32 v118, v48, v49
    v_mfma_f32_16x16x32_bf16 v[108:111], v[196:199], v[52:55], v[36:39]
    ds_read_b64 v[208:209], v30 offset:12288
    ds_read_b64 v[210:211], v31 offset:12288
    v_exp_f32 v44, v88
    v_mfma_f32_16x16x32_bf16 v[112:115], v[196:199], v[56:59], v[40:43]
    v_exp_f32 v45, v89
    s_waitcnt vmcnt(1) lgkmcnt(4)
    v_mfma_f32_16x16x32_bf16 v[236:239], v[232:235], v[252:255], v[236:239]
    v_mfma_f32_16x16x32_bf16 v[156:159], v[224:227], v[124:127], v[156:159]
    ds_read_b64_tr_b16 v[220:221], v22 offset:40960
    ds_read_b64_tr_b16 v[222:223], v22 offset:45056
    v_add_f32 v32, v50, v51
    ds_read_b64_tr_b16 v[232:233], v228 offset:16384
    ds_read_b64_tr_b16 v[234:235], v228 offset:16896
    v_mfma_f32_16x16x32_bf16 v[160:163], v[224:227], v[128:131], v[160:163]
    v_add_f32 v14, v14, v32
    v_cvt_pk_bf16_f32 v119, v50, v51
    v_mfma_f32_16x16x32_bf16 v[108:111], v[200:203], v[60:63], v[108:111]
    ds_read_b64_tr_b16 v[224:225], v23 offset:40960
    ds_read_b64_tr_b16 v[226:227], v23 offset:45056
    v_exp_f32 v46, v90
    v_mfma_f32_16x16x32_bf16 v[112:115], v[200:203], v[64:67], v[112:115]
    v_exp_f32 v47, v91
    v_mfma_f32_16x16x32_bf16 v[164:167], v[212:215], v[124:127], v[164:167]
    s_barrier
    v_add_f32 v15, v44, v45
    v_cvt_pk_bf16_f32 v120, v44, v45
    s_waitcnt vmcnt(0) lgkmcnt(2)
    v_mfma_f32_16x16x32_bf16 v[236:239], v[232:235], v[4:7], v[236:239]
    v_mfma_f32_16x16x32_bf16 v[168:171], v[212:215], v[128:131], v[168:171]
    ds_read_b64_tr_b16 v[212:213], v16 offset:49152
    ds_read_b64_tr_b16 v[214:215], v16 offset:53248
    v_exp_f32 v48, v96
    v_mfma_f32_16x16x32_bf16 v[108:111], v[204:207], v[68:71], v[108:111]
    v_exp_f32 v49, v97
    v_mfma_f32_16x16x32_bf16 v[112:115], v[204:207], v[72:75], v[112:115]
    v_add_f32 v32, v46, v47
    v_mfma_f32_16x16x32_bf16 v[172:175], v[216:219], v[124:127], v[172:175]
    v_add_f32 v15, v15, v32
    v_cvt_pk_bf16_f32 v121, v46, v47
    v_mfma_f32_16x16x32_bf16 v[176:179], v[216:219], v[128:131], v[176:179]
    ds_read_b64_tr_b16 v[216:217], v17 offset:49152
    ds_read_b64_tr_b16 v[218:219], v17 offset:53248
    v_exp_f32 v50, v98
    v_mfma_f32_16x16x32_bf16 v[108:111], v[208:211], v[76:79], v[108:111]
    v_exp_f32 v51, v99
    v_mfma_f32_16x16x32_bf16 v[112:115], v[208:211], v[80:83], v[112:115]
    v_add_f32 v32, v48, v49
    v_mfma_f32_16x16x32_bf16 v[180:183], v[220:223], v[124:127], v[180:183]
    v_add_f32 v15, v15, v32
    v_cvt_pk_bf16_f32 v122, v48, v49
    s_mul_i32 s80, s74, 27
    s_add_u32 s80, s80, s73
    s_lshl_b32 s80, s80, 2
    s_add_u32 s80, s80, s93
    s_lshl_b32 s80, s80, 8
    s_lshl_b32 s81, s72, 7
    s_add_u32 s80, s80, s81
    s_cmp_lt_u32 s93, 4
    s_cselect_b32 s80, s80, 0x7fff0000
    s_mov_b32 exec_lo, 0x00030003
    s_mov_b32 exec_hi, 0x00030003
    buffer_store_dwordx4 v[236:239], v230, s[68:71], s80 offen sc1
    s_mov_b64 exec, -1
    v_mfma_f32_16x16x32_bf16 v[184:187], v[220:223], v[128:131], v[184:187]
    ds_read_b64_tr_b16 v[220:221], v18 offset:49152
    ds_read_b64_tr_b16 v[222:223], v18 offset:53248
    v_add_f32 v32, v50, v51
    s_waitcnt lgkmcnt(6)
    v_mfma_f32_16x16x32_bf16 v[188:191], v[224:227], v[124:127], v[188:191]
    v_add_f32 v15, v15, v32
    v_mfma_f32_16x16x32_bf16 v[192:195], v[224:227], v[128:131], v[192:195]
    ds_read_b64_tr_b16 v[224:225], v19 offset:49152
    ds_read_b64_tr_b16 v[226:227], v19 offset:53248
    v_cvt_pk_bf16_f32 v123, v50, v51
    v_add_f32 v32, v14, v15
    v_cmp_nge_f32 vcc, s49, v32
    s_cbranch_vccnz L_attn_cold14
L_attn_back14:
    v_add_f32 v12, v12, v14
    v_add_f32 v13, v13, v15
    s_waitcnt lgkmcnt(6)
    v_mfma_f32_16x16x32_bf16 v[132:135], v[212:215], v[116:119], v[132:135]
    v_mfma_f32_16x16x32_bf16 v[136:139], v[212:215], v[120:123], v[136:139]
    ds_read_b64_tr_b16 v[212:213], v20 offset:49152
    ds_read_b64_tr_b16 v[214:215], v20 offset:53248
    s_waitcnt lgkmcnt(6)
    v_mfma_f32_16x16x32_bf16 v[140:143], v[216:219], v[116:119], v[140:143]
    v_exp_f32 v44, v100
    v_exp_f32 v45, v101
    v_exp_f32 v46, v102
    v_mfma_f32_16x16x32_bf16 v[144:147], v[216:219], v[120:123], v[144:147]
    ds_read_b64_tr_b16 v[216:217], v21 offset:49152
    ds_read_b64_tr_b16 v[218:219], v21 offset:53248
    v_exp_f32 v47, v103
    v_add_f32 v14, v44, v45
    v_cvt_pk_bf16_f32 v124, v44, v45
    s_waitcnt lgkmcnt(6)
    v_mfma_f32_16x16x32_bf16 v[148:151], v[220:223], v[116:119], v[148:151]
    v_exp_f32 v48, v108
    v_exp_f32 v49, v109
    v_add_f32 v32, v46, v47
    v_mfma_f32_16x16x32_bf16 v[152:155], v[220:223], v[120:123], v[152:155]
    ds_read_b64_tr_b16 v[220:221], v22 offset:49152
    ds_read_b64_tr_b16 v[222:223], v22 offset:53248
    v_add_f32 v14, v14, v32
    v_cvt_pk_bf16_f32 v125, v46, v47
    s_waitcnt lgkmcnt(6)
    v_mfma_f32_16x16x32_bf16 v[156:159], v[224:227], v[116:119], v[156:159]
    v_exp_f32 v50, v110
    v_exp_f32 v51, v111
    v_add_f32 v32, v48, v49
    v_mfma_f32_16x16x32_bf16 v[160:163], v[224:227], v[120:123], v[160:163]
    ds_read_b64_tr_b16 v[224:225], v23 offset:49152
    ds_read_b64_tr_b16 v[226:227], v23 offset:53248
    v_add_f32 v14, v14, v32
    v_cvt_pk_bf16_f32 v126, v48, v49
    v_exp_f32 v44, v104
    s_waitcnt lgkmcnt(6)
    v_mfma_f32_16x16x32_bf16 v[164:167], v[212:215], v[116:119], v[164:167]
    v_exp_f32 v45, v105
    v_add_f32 v32, v50, v51
    v_mfma_f32_16x16x32_bf16 v[168:171], v[212:215], v[120:123], v[168:171]
    ds_read_b64_tr_b16 v[212:213], v16 offset:57344
    ds_read_b64_tr_b16 v[214:215], v16 offset:61440
    v_add_f32 v14, v14, v32
    v_cvt_pk_bf16_f32 v127, v50, v51
    v_exp_f32 v46, v106
    s_waitcnt lgkmcnt(6)
    v_mfma_f32_16x16x32_bf16 v[172:175], v[216:219], v[116:119], v[172:175]
    v_exp_f32 v47, v107
    v_add_f32 v15, v44, v45
    v_cvt_pk_bf16_f32 v128, v44, v45
    v_mfma_f32_16x16x32_bf16 v[176:179], v[216:219], v[120:123], v[176:179]
    ds_read_b64_tr_b16 v[216:217], v17 offset:57344
    ds_read_b64_tr_b16 v[218:219], v17 offset:61440
    v_exp_f32 v48, v112
    v_exp_f32 v49, v113
    v_add_f32 v32, v46, v47
    s_waitcnt lgkmcnt(6)
    v_mfma_f32_16x16x32_bf16 v[180:183], v[220:223], v[116:119], v[180:183]
    v_add_f32 v15, v15, v32
    v_cvt_pk_bf16_f32 v129, v46, v47
    v_mfma_f32_16x16x32_bf16 v[184:187], v[220:223], v[120:123], v[184:187]
    ds_read_b64_tr_b16 v[220:221], v18 offset:57344
    ds_read_b64_tr_b16 v[222:223], v18 offset:61440
    v_exp_f32 v50, v114
    v_exp_f32 v51, v115
    v_add_f32 v32, v48, v49
    s_waitcnt lgkmcnt(6)
    v_mfma_f32_16x16x32_bf16 v[188:191], v[224:227], v[116:119], v[188:191]
    v_add_f32 v15, v15, v32
    v_cvt_pk_bf16_f32 v130, v48, v49
    v_add_f32 v32, v50, v51
    v_mfma_f32_16x16x32_bf16 v[192:195], v[224:227], v[120:123], v[192:195]
    ds_read_b64_tr_b16 v[224:225], v19 offset:57344
    ds_read_b64_tr_b16 v[226:227], v19 offset:61440
    v_add_f32 v15, v15, v32
    v_cvt_pk_bf16_f32 v131, v50, v51
    v_add_f32 v32, v14, v15
    v_cmp_nge_f32 vcc, s49, v32
    s_cbranch_vccnz L_attn_cold15
L_attn_back15:
    v_add_f32 v12, v12, v14
    v_add_f32 v13, v13, v15
    s_waitcnt lgkmcnt(6)
    v_mfma_f32_16x16x32_bf16 v[132:135], v[212:215], v[124:127], v[132:135]
    v_mov_b32 v14, v12
    v_mov_b32 v15, v13
    s_nop 0
    v_permlane16_swap_b32 v12, v14
    v_mfma_f32_16x16x32_bf16 v[136:139], v[212:215], v[128:131], v[136:139]
    ds_read_b64_tr_b16 v[212:213], v20 offset:57344
    ds_read_b64_tr_b16 v[214:215], v20 offset:61440
    v_permlane16_swap_b32 v13, v15
    v_add_f32 v12, v12, v14
    v_add_f32 v13, v13, v15
    s_waitcnt lgkmcnt(6)
    v_mfma_f32_16x16x32_bf16 v[140:143], v[216:219], v[124:127], v[140:143]
    v_mov_b32 v14, v12
    v_mov_b32 v15, v13
    s_nop 0
    v_permlane32_swap_b32 v12, v14
    v_mfma_f32_16x16x32_bf16 v[144:147], v[216:219], v[128:131], v[144:147]
    ds_read_b64_tr_b16 v[216:217], v21 offset:57344
    ds_read_b64_tr_b16 v[218:219], v21 offset:61440
    v_permlane32_swap_b32 v13, v15
    v_add_f32 v12, v12, v14
    v_add_f32 v13, v13, v15
    s_waitcnt lgkmcnt(6)
    v_mfma_f32_16x16x32_bf16 v[148:151], v[220:223], v[124:127], v[148:151]
    v_rcp_f32 v12, v12
    v_rcp_f32 v13, v13
    v_mfma_f32_16x16x32_bf16 v[152:155], v[220:223], v[128:131], v[152:155]
    ds_read_b64_tr_b16 v[220:221], v22 offset:57344
    ds_read_b64_tr_b16 v[222:223], v22 offset:61440
    s_waitcnt lgkmcnt(6)
    v_mfma_f32_16x16x32_bf16 v[156:159], v[224:227], v[124:127], v[156:159]
    v_mul_f32 v44, v132, v12
    v_mul_f32 v45, v133, v12
    v_mul_f32 v46, v134, v12
    v_mul_f32 v47, v135, v12
    v_cvt_pk_bf16_f32 v84, v44, v45
    v_cvt_pk_bf16_f32 v85, v46, v47
    v_mul_f32 v48, v140, v12
    v_mfma_f32_16x16x32_bf16 v[160:163], v[224:227], v[128:131], v[160:163]
    ds_read_b64_tr_b16 v[224:225], v23 offset:57344
    ds_read_b64_tr_b16 v[226:227], v23 offset:61440
    v_mul_f32 v49, v141, v12
    v_mul_f32 v50, v142, v12
    v_mul_f32 v51, v143, v12
    v_cvt_pk_bf16_f32 v86, v48, v49
    v_cvt_pk_bf16_f32 v87, v50, v51
    s_add_u32 s44, s54, 0
    buffer_store_dwordx4 v[84:87], v8, s[32:35], s44 offen offset:0 sc1
    s_waitcnt lgkmcnt(6)
    v_mfma_f32_16x16x32_bf16 v[164:167], v[212:215], v[124:127], v[164:167]
    v_mul_f32 v44, v136, v13
    v_mul_f32 v45, v137, v13
    v_mul_f32 v46, v138, v13
    v_mul_f32 v47, v139, v13
    v_cvt_pk_bf16_f32 v88, v44, v45
    v_cvt_pk_bf16_f32 v89, v46, v47
    v_mul_f32 v48, v144, v13
    v_mfma_f32_16x16x32_bf16 v[168:171], v[212:215], v[128:131], v[168:171]
    v_mul_f32 v49, v145, v13
    v_mul_f32 v50, v146, v13
    v_mul_f32 v51, v147, v13
    v_cvt_pk_bf16_f32 v90, v48, v49
    v_cvt_pk_bf16_f32 v91, v50, v51
    buffer_store_dwordx4 v[88:91], v8, s[32:35], s44 offen offset:1024 sc1
    s_waitcnt lgkmcnt(4)
    v_mfma_f32_16x16x32_bf16 v[172:175], v[216:219], v[124:127], v[172:175]
    v_mul_f32 v44, v148, v12
    v_mul_f32 v45, v149, v12
    v_mul_f32 v46, v150, v12
    v_mul_f32 v47, v151, v12
    v_cvt_pk_bf16_f32 v92, v44, v45
    v_cvt_pk_bf16_f32 v93, v46, v47
    v_mul_f32 v48, v156, v12
    v_mfma_f32_16x16x32_bf16 v[176:179], v[216:219], v[128:131], v[176:179]
    v_mul_f32 v49, v157, v12
    v_mul_f32 v50, v158, v12
    v_mul_f32 v51, v159, v12
    v_cvt_pk_bf16_f32 v94, v48, v49
    v_cvt_pk_bf16_f32 v95, v50, v51
    s_add_u32 s44, s54, 4096
    buffer_store_dwordx4 v[92:95], v8, s[32:35], s44 offen offset:0 sc1
    s_waitcnt lgkmcnt(2)
    v_mfma_f32_16x16x32_bf16 v[180:183], v[220:223], v[124:127], v[180:183]
    v_mul_f32 v44, v152, v13
    v_mul_f32 v45, v153, v13
    v_mul_f32 v46, v154, v13
    v_mul_f32 v47, v155, v13
    v_cvt_pk_bf16_f32 v96, v44, v45
    v_cvt_pk_bf16_f32 v97, v46, v47
    v_mul_f32 v48, v160, v13
    v_mfma_f32_16x16x32_bf16 v[184:187], v[220:223], v[128:131], v[184:187]
    v_mul_f32 v49, v161, v13
    v_mul_f32 v50, v162, v13
    v_mul_f32 v51, v163, v13
    v_cvt_pk_bf16_f32 v98, v48, v49
    v_cvt_pk_bf16_f32 v99, v50, v51
    buffer_store_dwordx4 v[96:99], v8, s[32:35], s44 offen offset:1024 sc1
    s_waitcnt lgkmcnt(0)
    v_mfma_f32_16x16x32_bf16 v[188:191], v[224:227], v[124:127], v[188:191]
    v_mul_f32 v44, v164, v12
    v_mul_f32 v45, v165, v12
    v_mul_f32 v46, v166, v12
    v_mul_f32 v47, v167, v12
    v_cvt_pk_bf16_f32 v100, v44, v45
    v_cvt_pk_bf16_f32 v101, v46, v47
    v_mul_f32 v48, v172, v12
    v_mul_f32 v49, v173, v12
    v_mul_f32 v50, v174, v12
    v_mul_f32 v51, v175, v12
    v_cvt_pk_bf16_f32 v102, v48, v49
    v_cvt_pk_bf16_f32 v103, v50, v51
    s_add_u32 s44, s54, 8192
    buffer_store_dwordx4 v[100:103], v8, s[32:35], s44 offen offset:0 sc1
    v_mfma_f32_16x16x32_bf16 v[192:195], v[224:227], v[128:131], v[192:195]
    v_mul_f32 v44, v168, v13
    v_mul_f32 v45, v169, v13
    v_mul_f32 v46, v170, v13
    v_mul_f32 v47, v171, v13
    v_cvt_pk_bf16_f32 v104, v44, v45
    v_cvt_pk_bf16_f32 v105, v46, v47
    v_mul_f32 v48, v176, v13
    v_mul_f32 v49, v177, v13
    v_mul_f32 v50, v178, v13
    v_mul_f32 v51, v179, v13
    v_cvt_pk_bf16_f32 v106, v48, v49
    v_cvt_pk_bf16_f32 v107, v50, v51
    buffer_store_dwordx4 v[104:107], v8, s[32:35], s44 offen offset:1024 sc1
    v_mul_f32 v44, v180, v12
    v_mul_f32 v45, v181, v12
    v_mul_f32 v46, v182, v12
    v_mul_f32 v47, v183, v12
    v_cvt_pk_bf16_f32 v108, v44, v45
    v_cvt_pk_bf16_f32 v109, v46, v47
    v_mul_f32 v48, v188, v12
    v_mul_f32 v49, v189, v12
    v_mul_f32 v50, v190, v12
    v_mul_f32 v51, v191, v12
    v_cvt_pk_bf16_f32 v110, v48, v49
    v_cvt_pk_bf16_f32 v111, v50, v51
    s_add_u32 s44, s54, 12288
    buffer_store_dwordx4 v[108:111], v8, s[32:35], s44 offen offset:0 sc1
    v_mul_f32 v44, v184, v13
    v_mul_f32 v45, v185, v13
    v_mul_f32 v46, v186, v13
    v_mul_f32 v47, v187, v13
    v_cvt_pk_bf16_f32 v112, v44, v45
    v_cvt_pk_bf16_f32 v113, v46, v47
    v_mul_f32 v48, v192, v13
    v_mul_f32 v49, v193, v13
    v_mul_f32 v50, v194, v13
    v_mul_f32 v51, v195, v13
    v_cvt_pk_bf16_f32 v114, v48, v49
    v_cvt_pk_bf16_f32 v115, v50, v51
    buffer_store_dwordx4 v[112:115], v8, s[32:35], s44 offen offset:1024 sc1
    s_lshl_b32 s92, s38, 6
    s_add_u32 s92, s92, s37
    s_lshl_b32 s92, s92, 7
    s_add_u32 s92, s92, 0x20000
    s_load_dwordx2 s[8:9], s[0:1], 0
    s_and_b32 s46, s2, 7
    s_lshr_b32 s47, s2, 3
    s_and_b32 s48, s47, 3
    s_lshl_b32 s41, s46, 2
    s_add_u32 s41, s41, s48
    s_lshr_b32 s42, s47, 2
    v_and_b32 v1, 63, v0
    v_lshlrev_b32 v2, 4, v1
    s_waitcnt vmcnt(0)
    s_barrier
    s_cmp_lg_u32 s93, 0
    s_cbranch_scc1 L_adaLN_cond__sliding_block_cached__swiglu_ffn__prompt_kernel_35
    s_add_u32 s4, s94, 0x380000
    s_addc_u32 s5, s95, 0
    s_mov_b32 s6, 0x80000
    s_mov_b32 s7, 0x20000
    s_mov_b64 exec, 1
    v_mov_b32 v252, s98
    v_mov_b32 v253, 0
    buffer_store_dword v252, v253, s[4:7], s92 offen sc1
    s_mov_b64 exec, -1
L_adaLN_cond__sliding_block_cached__swiglu_ffn__prompt_kernel_35:
    s_add_u32 s49, s93, 0
    s_and_b32 s49, s49, 3
    s_lshl_b32 s49, s49, 10
    v_add_u32 v10, s49, v2
    s_add_u32 s49, s93, 1
    s_and_b32 s49, s49, 3
    s_lshl_b32 s49, s49, 10
    v_add_u32 v11, s49, v2
    s_add_u32 s49, s93, 2
    s_and_b32 s49, s49, 3
    s_lshl_b32 s49, s49, 10
    v_add_u32 v12, s49, v2
    s_add_u32 s49, s93, 3
    s_and_b32 s49, s49, 3
    s_lshl_b32 s49, s49, 10
    v_add_u32 v13, s49, v2
    s_and_b32 s50, s93, 3
    s_lshl_b32 s49, s50, 5
    s_mul_i32 s43, s42, 128
    s_add_u32 s43, s43, s49
    s_mul_i32 s43, s43, 5120
    s_mul_i32 s44, s41, 128
    s_add_u32 s44, s44, s49
    s_lshl_b32 s44, s44, 12
    s_mov_b32 s20, s94
    s_mov_b32 s21, s95
    s_mov_b32 s22, 0x3c00
    s_mov_b32 s23, 0x20000
    s_add_u32 s16, s94, 0x1400000
    s_addc_u32 s17, s95, 0
    s_mov_b32 s18, 0x1000000
    s_mov_b32 s19, 0x20000
    s_add_u32 s12, s94, 0x2400000
    s_addc_u32 s13, s95, 0
    s_mov_b32 s14, 0x500000
    s_mov_b32 s15, 0x20000
    s_cmp_ge_u32 s93, 4
    s_cbranch_scc1 L_adaLN_cond__sliding_block_cached__swiglu_ffn__prompt_kernel_36
    buffer_load_dwordx4 v[112:115], v2, s[12:15], s43 offen offset:0 sc1
    buffer_load_dwordx4 v[116:119], v2, s[12:15], s43 offen offset:1024 sc1
    buffer_load_dwordx4 v[120:123], v2, s[12:15], s43 offen offset:2048 sc1
    buffer_load_dwordx4 v[124:127], v2, s[12:15], s43 offen offset:3072 sc1
    s_add_u32 s51, s43, 4096
    buffer_load_dwordx4 v[128:131], v2, s[12:15], s51 offen sc1
    s_add_u32 s43, s43, 5120
    buffer_load_dwordx4 v[148:151], v2, s[12:15], s43 offen offset:0 sc1
    buffer_load_dwordx4 v[152:155], v2, s[12:15], s43 offen offset:1024 sc1
    buffer_load_dwordx4 v[156:159], v2, s[12:15], s43 offen offset:2048 sc1
    buffer_load_dwordx4 v[160:163], v2, s[12:15], s43 offen offset:3072 sc1
    s_add_u32 s51, s43, 4096
    buffer_load_dwordx4 v[164:167], v2, s[12:15], s51 offen sc1
    s_add_u32 s43, s43, 5120
L_adaLN_cond__sliding_block_cached__swiglu_ffn__prompt_kernel_36:
    s_cmp_lg_u32 s93, 4
    s_cbranch_scc1 L_adaLN_cond__sliding_block_cached__swiglu_ffn__prompt_kernel_37
    s_lshr_b32 s50, s41, 2
    s_lshl_b32 s51, s50, 6
    s_add_u32 s51, s51, 0
    s_lshl_b32 s51, s51, 7
    s_add_u32 s51, s51, 0x20000
    v_and_b32 v252, 31, v1
    v_lshlrev_b32 v252, 7, v252
    v_add_u32 v252, s51, v252
    s_add_u32 s4, s94, 0x380000
    s_addc_u32 s5, s95, 0
    s_mov_b32 s6, 0x80000
    s_mov_b32 s7, 0x20000
    s_mov_b32 s3, 60000
L_adaLN_cond__sliding_block_cached__swiglu_ffn__prompt_kernel_39:
    buffer_load_dword v254, v252, s[4:7], 0 offen sc1
    s_waitcnt vmcnt(0)
    v_cmp_ne_u32 vcc, s98, v254
    s_cbranch_vccz L_adaLN_cond__sliding_block_cached__swiglu_ffn__prompt_kernel_38
    s_sleep 1
    s_sub_u32 s3, s3, 1
    s_cmp_lg_u32 s3, 0
    s_cbranch_scc1 L_adaLN_cond__sliding_block_cached__swiglu_ffn__prompt_kernel_39
L_adaLN_cond__sliding_block_cached__swiglu_ffn__prompt_kernel_38:
L_adaLN_cond__sliding_block_cached__swiglu_ffn__prompt_kernel_37:
    s_barrier
    s_cmp_ge_u32 s93, 4
    s_cbranch_scc1 L_adaLN_cond__sliding_block_cached__swiglu_ffn__prompt_kernel_33
    buffer_load_dwordx4 v[96:99], v10, s[16:19], s44 offen sc1
    buffer_load_dwordx4 v[100:103], v11, s[16:19], s44 offen sc1
    buffer_load_dwordx4 v[104:107], v12, s[16:19], s44 offen sc1
    buffer_load_dwordx4 v[108:111], v13, s[16:19], s44 offen sc1
    s_add_u32 s44, s44, 4096
    buffer_load_dwordx4 v[132:135], v10, s[16:19], s44 offen sc1
    buffer_load_dwordx4 v[136:139], v11, s[16:19], s44 offen sc1
    buffer_load_dwordx4 v[140:143], v12, s[16:19], s44 offen sc1
    buffer_load_dwordx4 v[144:147], v13, s[16:19], s44 offen sc1
    s_add_u32 s44, s44, 4096
    s_waitcnt lgkmcnt(0)
    s_mov_b32 s24, s8
    s_mov_b32 s25, s9
    s_mov_b32 s26, 0x280000
    s_mov_b32 s27, 0x20000
    s_add_u32 s32, s94, 0x400000
    s_addc_u32 s33, s95, 0
    s_mov_b32 s34, 0x280000
    s_mov_b32 s35, 0x20000
    s_add_u32 s36, s94, 0x10000
    s_addc_u32 s37, s95, 0
    s_mov_b32 s38, 0x20000
    s_mov_b32 s39, 0x20000
    v_and_b32 v4, 15, v1
    v_lshrrev_b32 v5, 4, v1
    s_mul_i32 s46, s42, 320
    v_lshlrev_b32 v9, 4, v5
    s_add_u32 s66, s46, 5120
    s_lshl_b32 s48, s41, 6
    s_lshl_b32 s49, s93, 4
    s_add_u32 s48, s48, s49
    v_add_u32 v7, s48, v4
    v_mul_u32_u24 v8, 1280, v7
    v_lshl_add_u32 v8, v5, 3, v8
    s_mul_i32 s60, s42, 160
    s_mul_i32 s61, s93, 5120
    s_add_u32 s61, s61, 0x21000
    v_add_u32 v254, s61, v2
    s_add_u32 s67, s46, 10240
    s_add_u32 s28, s94, 0xd0000
    s_addc_u32 s29, s95, 0
    s_mov_b32 s30, 0x2000
    s_mov_b32 s31, 0x20000
    v_lshlrev_b32 v255, 2, v7
    s_lshr_b32 s63, s48, 4
    s_mul_i32 s63, s63, 20480
    v_lshlrev_b32 v7, 4, v4
    s_lshr_b32 s65, s48, 4
    s_lshl_b32 s65, s65, 10
    s_lshr_b32 s47, s42, 1
    s_lshl_b32 s47, s47, 8
    s_add_u32 s65, s65, s47
    s_and_b32 s47, s42, 1
    s_lshl_b32 s47, s47, 3
    s_add_u32 s65, s65, s47
    s_mul_i32 s53, s93, 15360
    v_add_u32 v6, s53, v2
    s_add_u32 s53, s93, 1
    s_and_b32 s53, s53, 3
    s_mul_i32 s53, s53, 15360
    v_add_u32 v14, s53, v2
    s_add_u32 s53, s93, 2
    s_and_b32 s53, s53, 3
    s_mul_i32 s53, s53, 15360
    v_add_u32 v15, s53, v2
    s_add_u32 s53, s93, 3
    s_and_b32 s53, s53, 3
    s_mul_i32 s53, s53, 15360
    v_add_u32 v3, s53, v2
    buffer_load_dwordx4 v[168:171], v10, s[16:19], s44 offen sc1
    buffer_load_dwordx4 v[172:175], v11, s[16:19], s44 offen sc1
    buffer_load_dwordx4 v[176:179], v12, s[16:19], s44 offen sc1
    buffer_load_dwordx4 v[180:183], v13, s[16:19], s44 offen sc1
    s_add_u32 s44, s44, 4096
    buffer_load_dwordx4 v[184:187], v2, s[12:15], s43 offen offset:0 sc1
    buffer_load_dwordx4 v[188:191], v2, s[12:15], s43 offen offset:1024 sc1
    buffer_load_dwordx4 v[192:195], v2, s[12:15], s43 offen offset:2048 sc1
    buffer_load_dwordx4 v[196:199], v2, s[12:15], s43 offen offset:3072 sc1
    s_add_u32 s51, s43, 4096
    buffer_load_dwordx4 v[200:203], v2, s[12:15], s51 offen sc1
    s_add_u32 s43, s43, 5120
    s_waitcnt vmcnt(16)
    v_mfma_f32_16x16x32_bf16 v[16:19], v[112:115], v[96:99], 0
    s_waitcnt vmcnt(15)
    v_mfma_f32_16x16x32_bf16 v[36:39], v[112:115], v[100:103], 0
    s_waitcnt vmcnt(14)
    v_mfma_f32_16x16x32_bf16 v[56:59], v[112:115], v[104:107], 0
    s_waitcnt vmcnt(13)
    v_mfma_f32_16x16x32_bf16 v[76:79], v[112:115], v[108:111], 0
    v_mfma_f32_16x16x32_bf16 v[20:23], v[116:119], v[96:99], 0
    v_mfma_f32_16x16x32_bf16 v[40:43], v[116:119], v[100:103], 0
    v_mfma_f32_16x16x32_bf16 v[60:63], v[116:119], v[104:107], 0
    v_mfma_f32_16x16x32_bf16 v[80:83], v[116:119], v[108:111], 0
    v_mfma_f32_16x16x32_bf16 v[24:27], v[120:123], v[96:99], 0
    v_mfma_f32_16x16x32_bf16 v[44:47], v[120:123], v[100:103], 0
    v_mfma_f32_16x16x32_bf16 v[64:67], v[120:123], v[104:107], 0
    v_mfma_f32_16x16x32_bf16 v[84:87], v[120:123], v[108:111], 0
    v_mfma_f32_16x16x32_bf16 v[28:31], v[124:127], v[96:99], 0
    v_mfma_f32_16x16x32_bf16 v[48:51], v[124:127], v[100:103], 0
    v_mfma_f32_16x16x32_bf16 v[68:71], v[124:127], v[104:107], 0
    v_mfma_f32_16x16x32_bf16 v[88:91], v[124:127], v[108:111], 0
    v_mfma_f32_16x16x32_bf16 v[32:35], v[128:131], v[96:99], 0
    v_mfma_f32_16x16x32_bf16 v[52:55], v[128:131], v[100:103], 0
    v_mfma_f32_16x16x32_bf16 v[72:75], v[128:131], v[104:107], 0
    v_mfma_f32_16x16x32_bf16 v[92:95], v[128:131], v[108:111], 0
    buffer_load_dwordx4 v[96:99], v10, s[16:19], s44 offen sc1
    buffer_load_dwordx4 v[100:103], v11, s[16:19], s44 offen sc1
    buffer_load_dwordx4 v[104:107], v12, s[16:19], s44 offen sc1
    buffer_load_dwordx4 v[108:111], v13, s[16:19], s44 offen sc1
    s_add_u32 s44, s44, 4096
    buffer_load_dwordx4 v[112:115], v2, s[12:15], s43 offen offset:0 sc1
    buffer_load_dwordx4 v[116:119], v2, s[12:15], s43 offen offset:1024 sc1
    buffer_load_dwordx4 v[120:123], v2, s[12:15], s43 offen offset:2048 sc1
    buffer_load_dwordx4 v[124:127], v2, s[12:15], s43 offen offset:3072 sc1
    s_add_u32 s51, s43, 4096
    buffer_load_dwordx4 v[128:131], v2, s[12:15], s51 offen sc1
    s_add_u32 s43, s43, 5120
    s_waitcnt vmcnt(21)
    v_mfma_f32_16x16x32_bf16 v[16:19], v[148:151], v[132:135], v[16:19]
    s_waitcnt vmcnt(20)
    v_mfma_f32_16x16x32_bf16 v[36:39], v[148:151], v[136:139], v[36:39]
    s_waitcnt vmcnt(19)
    v_mfma_f32_16x16x32_bf16 v[56:59], v[148:151], v[140:143], v[56:59]
    s_waitcnt vmcnt(18)
    v_mfma_f32_16x16x32_bf16 v[76:79], v[148:151], v[144:147], v[76:79]
    v_mfma_f32_16x16x32_bf16 v[20:23], v[152:155], v[132:135], v[20:23]
    v_mfma_f32_16x16x32_bf16 v[40:43], v[152:155], v[136:139], v[40:43]
    v_mfma_f32_16x16x32_bf16 v[60:63], v[152:155], v[140:143], v[60:63]
    v_mfma_f32_16x16x32_bf16 v[80:83], v[152:155], v[144:147], v[80:83]
    v_mfma_f32_16x16x32_bf16 v[24:27], v[156:159], v[132:135], v[24:27]
    v_mfma_f32_16x16x32_bf16 v[44:47], v[156:159], v[136:139], v[44:47]
    v_mfma_f32_16x16x32_bf16 v[64:67], v[156:159], v[140:143], v[64:67]
    v_mfma_f32_16x16x32_bf16 v[84:87], v[156:159], v[144:147], v[84:87]
    v_mfma_f32_16x16x32_bf16 v[28:31], v[160:163], v[132:135], v[28:31]
    v_mfma_f32_16x16x32_bf16 v[48:51], v[160:163], v[136:139], v[48:51]
    v_mfma_f32_16x16x32_bf16 v[68:71], v[160:163], v[140:143], v[68:71]
    v_mfma_f32_16x16x32_bf16 v[88:91], v[160:163], v[144:147], v[88:91]
    v_mfma_f32_16x16x32_bf16 v[32:35], v[164:167], v[132:135], v[32:35]
    v_mfma_f32_16x16x32_bf16 v[52:55], v[164:167], v[136:139], v[52:55]
    v_mfma_f32_16x16x32_bf16 v[72:75], v[164:167], v[140:143], v[72:75]
    v_mfma_f32_16x16x32_bf16 v[92:95], v[164:167], v[144:147], v[92:95]
    buffer_load_dwordx4 v[132:135], v10, s[16:19], s44 offen sc1
    buffer_load_dwordx4 v[136:139], v11, s[16:19], s44 offen sc1
    buffer_load_dwordx4 v[140:143], v12, s[16:19], s44 offen sc1
    buffer_load_dwordx4 v[144:147], v13, s[16:19], s44 offen sc1
    s_add_u32 s44, s44, 4096
    buffer_load_dwordx4 v[148:151], v2, s[12:15], s43 offen offset:0 sc1
    buffer_load_dwordx4 v[152:155], v2, s[12:15], s43 offen offset:1024 sc1
    buffer_load_dwordx4 v[156:159], v2, s[12:15], s43 offen offset:2048 sc1
    buffer_load_dwordx4 v[160:163], v2, s[12:15], s43 offen offset:3072 sc1
    s_add_u32 s51, s43, 4096
    buffer_load_dwordx4 v[164:167], v2, s[12:15], s51 offen sc1
    s_add_u32 s43, s43, 5120
    s_waitcnt vmcnt(22)
    v_mfma_f32_16x16x32_bf16 v[16:19], v[184:187], v[168:171], v[16:19]
    v_mfma_f32_16x16x32_bf16 v[36:39], v[184:187], v[172:175], v[36:39]
    v_mfma_f32_16x16x32_bf16 v[56:59], v[184:187], v[176:179], v[56:59]
    v_mfma_f32_16x16x32_bf16 v[76:79], v[184:187], v[180:183], v[76:79]
    s_waitcnt vmcnt(21)
    v_mfma_f32_16x16x32_bf16 v[20:23], v[188:191], v[168:171], v[20:23]
    v_mfma_f32_16x16x32_bf16 v[40:43], v[188:191], v[172:175], v[40:43]
    v_mfma_f32_16x16x32_bf16 v[60:63], v[188:191], v[176:179], v[60:63]
    v_mfma_f32_16x16x32_bf16 v[80:83], v[188:191], v[180:183], v[80:83]
    s_waitcnt vmcnt(20)
    v_mfma_f32_16x16x32_bf16 v[24:27], v[192:195], v[168:171], v[24:27]
    v_mfma_f32_16x16x32_bf16 v[44:47], v[192:195], v[172:175], v[44:47]
    v_mfma_f32_16x16x32_bf16 v[64:67], v[192:195], v[176:179], v[64:67]
    v_mfma_f32_16x16x32_bf16 v[84:87], v[192:195], v[180:183], v[84:87]
    s_waitcnt vmcnt(19)
    v_mfma_f32_16x16x32_bf16 v[28:31], v[196:199], v[168:171], v[28:31]
    v_mfma_f32_16x16x32_bf16 v[48:51], v[196:199], v[172:175], v[48:51]
    v_mfma_f32_16x16x32_bf16 v[68:71], v[196:199], v[176:179], v[68:71]
    v_mfma_f32_16x16x32_bf16 v[88:91], v[196:199], v[180:183], v[88:91]
    s_waitcnt vmcnt(18)
    v_mfma_f32_16x16x32_bf16 v[32:35], v[200:203], v[168:171], v[32:35]
    v_mfma_f32_16x16x32_bf16 v[52:55], v[200:203], v[172:175], v[52:55]
    v_mfma_f32_16x16x32_bf16 v[72:75], v[200:203], v[176:179], v[72:75]
    v_mfma_f32_16x16x32_bf16 v[92:95], v[200:203], v[180:183], v[92:95]
    buffer_load_dwordx4 v[168:171], v10, s[16:19], s44 offen sc1
    buffer_load_dwordx4 v[172:175], v11, s[16:19], s44 offen sc1
    buffer_load_dwordx4 v[176:179], v12, s[16:19], s44 offen sc1
    buffer_load_dwordx4 v[180:183], v13, s[16:19], s44 offen sc1
    s_add_u32 s44, s44, 4096
    buffer_load_dwordx4 v[184:187], v2, s[12:15], s43 offen offset:0 sc1
    buffer_load_dwordx4 v[188:191], v2, s[12:15], s43 offen offset:1024 sc1
    buffer_load_dwordx4 v[192:195], v2, s[12:15], s43 offen offset:2048 sc1
    buffer_load_dwordx4 v[196:199], v2, s[12:15], s43 offen offset:3072 sc1
    s_add_u32 s51, s43, 4096
    buffer_load_dwordx4 v[200:203], v2, s[12:15], s51 offen sc1
    s_add_u32 s43, s43, 5120
    s_waitcnt vmcnt(22)
    v_mfma_f32_16x16x32_bf16 v[16:19], v[112:115], v[96:99], v[16:19]
    v_mfma_f32_16x16x32_bf16 v[36:39], v[112:115], v[100:103], v[36:39]
    v_mfma_f32_16x16x32_bf16 v[56:59], v[112:115], v[104:107], v[56:59]
    v_mfma_f32_16x16x32_bf16 v[76:79], v[112:115], v[108:111], v[76:79]
    s_waitcnt vmcnt(21)
    v_mfma_f32_16x16x32_bf16 v[20:23], v[116:119], v[96:99], v[20:23]
    v_mfma_f32_16x16x32_bf16 v[40:43], v[116:119], v[100:103], v[40:43]
    v_mfma_f32_16x16x32_bf16 v[60:63], v[116:119], v[104:107], v[60:63]
    v_mfma_f32_16x16x32_bf16 v[80:83], v[116:119], v[108:111], v[80:83]
    s_waitcnt vmcnt(20)
    v_mfma_f32_16x16x32_bf16 v[24:27], v[120:123], v[96:99], v[24:27]
    v_mfma_f32_16x16x32_bf16 v[44:47], v[120:123], v[100:103], v[44:47]
    v_mfma_f32_16x16x32_bf16 v[64:67], v[120:123], v[104:107], v[64:67]
    v_mfma_f32_16x16x32_bf16 v[84:87], v[120:123], v[108:111], v[84:87]
    s_waitcnt vmcnt(19)
    v_mfma_f32_16x16x32_bf16 v[28:31], v[124:127], v[96:99], v[28:31]
    v_mfma_f32_16x16x32_bf16 v[48:51], v[124:127], v[100:103], v[48:51]
    v_mfma_f32_16x16x32_bf16 v[68:71], v[124:127], v[104:107], v[68:71]
    v_mfma_f32_16x16x32_bf16 v[88:91], v[124:127], v[108:111], v[88:91]
    s_waitcnt vmcnt(18)
    v_mfma_f32_16x16x32_bf16 v[32:35], v[128:131], v[96:99], v[32:35]
    v_mfma_f32_16x16x32_bf16 v[52:55], v[128:131], v[100:103], v[52:55]
    v_mfma_f32_16x16x32_bf16 v[72:75], v[128:131], v[104:107], v[72:75]
    v_mfma_f32_16x16x32_bf16 v[92:95], v[128:131], v[108:111], v[92:95]
    buffer_load_dwordx4 v[96:99], v10, s[16:19], s44 offen sc1
    buffer_load_dwordx4 v[100:103], v11, s[16:19], s44 offen sc1
    buffer_load_dwordx4 v[104:107], v12, s[16:19], s44 offen sc1
    buffer_load_dwordx4 v[108:111], v13, s[16:19], s44 offen sc1
    s_add_u32 s44, s44, 4096
    buffer_load_dwordx4 v[112:115], v2, s[12:15], s43 offen offset:0 sc1
    buffer_load_dwordx4 v[116:119], v2, s[12:15], s43 offen offset:1024 sc1
    buffer_load_dwordx4 v[120:123], v2, s[12:15], s43 offen offset:2048 sc1
    buffer_load_dwordx4 v[124:127], v2, s[12:15], s43 offen offset:3072 sc1
    s_add_u32 s51, s43, 4096
    buffer_load_dwordx4 v[128:131], v2, s[12:15], s51 offen sc1
    s_add_u32 s43, s43, 5120
    s_waitcnt vmcnt(22)
    v_mfma_f32_16x16x32_bf16 v[16:19], v[148:151], v[132:135], v[16:19]
    v_mfma_f32_16x16x32_bf16 v[36:39], v[148:151], v[136:139], v[36:39]
    v_mfma_f32_16x16x32_bf16 v[56:59], v[148:151], v[140:143], v[56:59]
    v_mfma_f32_16x16x32_bf16 v[76:79], v[148:151], v[144:147], v[76:79]
    s_waitcnt vmcnt(21)
    v_mfma_f32_16x16x32_bf16 v[20:23], v[152:155], v[132:135], v[20:23]
    v_mfma_f32_16x16x32_bf16 v[40:43], v[152:155], v[136:139], v[40:43]
    v_mfma_f32_16x16x32_bf16 v[60:63], v[152:155], v[140:143], v[60:63]
    v_mfma_f32_16x16x32_bf16 v[80:83], v[152:155], v[144:147], v[80:83]
    s_waitcnt vmcnt(20)
    v_mfma_f32_16x16x32_bf16 v[24:27], v[156:159], v[132:135], v[24:27]
    v_mfma_f32_16x16x32_bf16 v[44:47], v[156:159], v[136:139], v[44:47]
    v_mfma_f32_16x16x32_bf16 v[64:67], v[156:159], v[140:143], v[64:67]
    v_mfma_f32_16x16x32_bf16 v[84:87], v[156:159], v[144:147], v[84:87]
    s_waitcnt vmcnt(19)
    v_mfma_f32_16x16x32_bf16 v[28:31], v[160:163], v[132:135], v[28:31]
    v_mfma_f32_16x16x32_bf16 v[48:51], v[160:163], v[136:139], v[48:51]
    v_mfma_f32_16x16x32_bf16 v[68:71], v[160:163], v[140:143], v[68:71]
    v_mfma_f32_16x16x32_bf16 v[88:91], v[160:163], v[144:147], v[88:91]
    s_waitcnt vmcnt(18)
    v_mfma_f32_16x16x32_bf16 v[32:35], v[164:167], v[132:135], v[32:35]
    v_mfma_f32_16x16x32_bf16 v[52:55], v[164:167], v[136:139], v[52:55]
    v_mfma_f32_16x16x32_bf16 v[72:75], v[164:167], v[140:143], v[72:75]
    v_mfma_f32_16x16x32_bf16 v[92:95], v[164:167], v[144:147], v[92:95]
    buffer_load_dwordx4 v[132:135], v10, s[16:19], s44 offen sc1
    buffer_load_dwordx4 v[136:139], v11, s[16:19], s44 offen sc1
    buffer_load_dwordx4 v[140:143], v12, s[16:19], s44 offen sc1
    buffer_load_dwordx4 v[144:147], v13, s[16:19], s44 offen sc1
    s_add_u32 s44, s44, 4096
    buffer_load_dwordx4 v[148:151], v2, s[12:15], s43 offen offset:0 sc1
    buffer_load_dwordx4 v[152:155], v2, s[12:15], s43 offen offset:1024 sc1
    buffer_load_dwordx4 v[156:159], v2, s[12:15], s43 offen offset:2048 sc1
    buffer_load_dwordx4 v[160:163], v2, s[12:15], s43 offen offset:3072 sc1
    s_add_u32 s51, s43, 4096
    buffer_load_dwordx4 v[164:167], v2, s[12:15], s51 offen sc1
    s_add_u32 s43, s43, 5120
    s_waitcnt vmcnt(22)
    v_mfma_f32_16x16x32_bf16 v[16:19], v[184:187], v[168:171], v[16:19]
    v_mfma_f32_16x16x32_bf16 v[36:39], v[184:187], v[172:175], v[36:39]
    v_mfma_f32_16x16x32_bf16 v[56:59], v[184:187], v[176:179], v[56:59]
    v_mfma_f32_16x16x32_bf16 v[76:79], v[184:187], v[180:183], v[76:79]
    s_waitcnt vmcnt(21)
    v_mfma_f32_16x16x32_bf16 v[20:23], v[188:191], v[168:171], v[20:23]
    v_mfma_f32_16x16x32_bf16 v[40:43], v[188:191], v[172:175], v[40:43]
    v_mfma_f32_16x16x32_bf16 v[60:63], v[188:191], v[176:179], v[60:63]
    v_mfma_f32_16x16x32_bf16 v[80:83], v[188:191], v[180:183], v[80:83]
    s_waitcnt vmcnt(20)
    v_mfma_f32_16x16x32_bf16 v[24:27], v[192:195], v[168:171], v[24:27]
    v_mfma_f32_16x16x32_bf16 v[44:47], v[192:195], v[172:175], v[44:47]
    v_mfma_f32_16x16x32_bf16 v[64:67], v[192:195], v[176:179], v[64:67]
    v_mfma_f32_16x16x32_bf16 v[84:87], v[192:195], v[180:183], v[84:87]
    s_waitcnt vmcnt(19)
    v_mfma_f32_16x16x32_bf16 v[28:31], v[196:199], v[168:171], v[28:31]
    v_mfma_f32_16x16x32_bf16 v[48:51], v[196:199], v[172:175], v[48:51]
    v_mfma_f32_16x16x32_bf16 v[68:71], v[196:199], v[176:179], v[68:71]
    v_mfma_f32_16x16x32_bf16 v[88:91], v[196:199], v[180:183], v[88:91]
    s_waitcnt vmcnt(18)
    v_mfma_f32_16x16x32_bf16 v[32:35], v[200:203], v[168:171], v[32:35]
    v_mfma_f32_16x16x32_bf16 v[52:55], v[200:203], v[172:175], v[52:55]
    v_mfma_f32_16x16x32_bf16 v[72:75], v[200:203], v[176:179], v[72:75]
    v_mfma_f32_16x16x32_bf16 v[92:95], v[200:203], v[180:183], v[92:95]
    buffer_load_dwordx4 v[168:171], v10, s[16:19], s44 offen sc1
    buffer_load_dwordx4 v[172:175], v11, s[16:19], s44 offen sc1
    buffer_load_dwordx4 v[176:179], v12, s[16:19], s44 offen sc1
    buffer_load_dwordx4 v[180:183], v13, s[16:19], s44 offen sc1
    s_add_u32 s44, s44, 4096
    buffer_load_dwordx4 v[184:187], v2, s[12:15], s43 offen offset:0 sc1
    buffer_load_dwordx4 v[188:191], v2, s[12:15], s43 offen offset:1024 sc1
    buffer_load_dwordx4 v[192:195], v2, s[12:15], s43 offen offset:2048 sc1
    buffer_load_dwordx4 v[196:199], v2, s[12:15], s43 offen offset:3072 sc1
    s_add_u32 s51, s43, 4096
    buffer_load_dwordx4 v[200:203], v2, s[12:15], s51 offen sc1
    s_add_u32 s43, s43, 5120
    s_waitcnt vmcnt(22)
    v_mfma_f32_16x16x32_bf16 v[16:19], v[112:115], v[96:99], v[16:19]
    v_mfma_f32_16x16x32_bf16 v[36:39], v[112:115], v[100:103], v[36:39]
    v_mfma_f32_16x16x32_bf16 v[56:59], v[112:115], v[104:107], v[56:59]
    v_mfma_f32_16x16x32_bf16 v[76:79], v[112:115], v[108:111], v[76:79]
    s_waitcnt vmcnt(21)
    v_mfma_f32_16x16x32_bf16 v[20:23], v[116:119], v[96:99], v[20:23]
    v_mfma_f32_16x16x32_bf16 v[40:43], v[116:119], v[100:103], v[40:43]
    v_mfma_f32_16x16x32_bf16 v[60:63], v[116:119], v[104:107], v[60:63]
    v_mfma_f32_16x16x32_bf16 v[80:83], v[116:119], v[108:111], v[80:83]
    s_waitcnt vmcnt(20)
    v_mfma_f32_16x16x32_bf16 v[24:27], v[120:123], v[96:99], v[24:27]
    v_mfma_f32_16x16x32_bf16 v[44:47], v[120:123], v[100:103], v[44:47]
    v_mfma_f32_16x16x32_bf16 v[64:67], v[120:123], v[104:107], v[64:67]
    v_mfma_f32_16x16x32_bf16 v[84:87], v[120:123], v[108:111], v[84:87]
    s_waitcnt vmcnt(19)
    v_mfma_f32_16x16x32_bf16 v[28:31], v[124:127], v[96:99], v[28:31]
    v_mfma_f32_16x16x32_bf16 v[48:51], v[124:127], v[100:103], v[48:51]
    v_mfma_f32_16x16x32_bf16 v[68:71], v[124:127], v[104:107], v[68:71]
    v_mfma_f32_16x16x32_bf16 v[88:91], v[124:127], v[108:111], v[88:91]
    s_waitcnt vmcnt(18)
    v_mfma_f32_16x16x32_bf16 v[32:35], v[128:131], v[96:99], v[32:35]
    v_mfma_f32_16x16x32_bf16 v[52:55], v[128:131], v[100:103], v[52:55]
    v_mfma_f32_16x16x32_bf16 v[72:75], v[128:131], v[104:107], v[72:75]
    v_mfma_f32_16x16x32_bf16 v[92:95], v[128:131], v[108:111], v[92:95]
    buffer_load_dwordx4 v[96:99], v10, s[16:19], s44 offen sc1
    buffer_load_dwordx4 v[100:103], v11, s[16:19], s44 offen sc1
    buffer_load_dwordx4 v[104:107], v12, s[16:19], s44 offen sc1
    buffer_load_dwordx4 v[108:111], v13, s[16:19], s44 offen sc1
    s_add_u32 s44, s44, 4096
    buffer_load_dwordx4 v[112:115], v2, s[12:15], s43 offen offset:0 sc1
    buffer_load_dwordx4 v[116:119], v2, s[12:15], s43 offen offset:1024 sc1
    buffer_load_dwordx4 v[120:123], v2, s[12:15], s43 offen offset:2048 sc1
    buffer_load_dwordx4 v[124:127], v2, s[12:15], s43 offen offset:3072 sc1
    s_add_u32 s51, s43, 4096
    buffer_load_dwordx4 v[128:131], v2, s[12:15], s51 offen sc1
    s_add_u32 s43, s43, 5120
    s_waitcnt vmcnt(22)
    v_mfma_f32_16x16x32_bf16 v[16:19], v[148:151], v[132:135], v[16:19]
    v_mfma_f32_16x16x32_bf16 v[36:39], v[148:151], v[136:139], v[36:39]
    v_mfma_f32_16x16x32_bf16 v[56:59], v[148:151], v[140:143], v[56:59]
    v_mfma_f32_16x16x32_bf16 v[76:79], v[148:151], v[144:147], v[76:79]
    s_waitcnt vmcnt(21)
    v_mfma_f32_16x16x32_bf16 v[20:23], v[152:155], v[132:135], v[20:23]
    v_mfma_f32_16x16x32_bf16 v[40:43], v[152:155], v[136:139], v[40:43]
    v_mfma_f32_16x16x32_bf16 v[60:63], v[152:155], v[140:143], v[60:63]
    v_mfma_f32_16x16x32_bf16 v[80:83], v[152:155], v[144:147], v[80:83]
    s_waitcnt vmcnt(20)
    v_mfma_f32_16x16x32_bf16 v[24:27], v[156:159], v[132:135], v[24:27]
    v_mfma_f32_16x16x32_bf16 v[44:47], v[156:159], v[136:139], v[44:47]
    v_mfma_f32_16x16x32_bf16 v[64:67], v[156:159], v[140:143], v[64:67]
    v_mfma_f32_16x16x32_bf16 v[84:87], v[156:159], v[144:147], v[84:87]
    s_waitcnt vmcnt(19)
    v_mfma_f32_16x16x32_bf16 v[28:31], v[160:163], v[132:135], v[28:31]
    v_mfma_f32_16x16x32_bf16 v[48:51], v[160:163], v[136:139], v[48:51]
    v_mfma_f32_16x16x32_bf16 v[68:71], v[160:163], v[140:143], v[68:71]
    v_mfma_f32_16x16x32_bf16 v[88:91], v[160:163], v[144:147], v[88:91]
    s_waitcnt vmcnt(18)
    v_mfma_f32_16x16x32_bf16 v[32:35], v[164:167], v[132:135], v[32:35]
    v_mfma_f32_16x16x32_bf16 v[52:55], v[164:167], v[136:139], v[52:55]
    v_mfma_f32_16x16x32_bf16 v[72:75], v[164:167], v[140:143], v[72:75]
    v_mfma_f32_16x16x32_bf16 v[92:95], v[164:167], v[144:147], v[92:95]
    buffer_load_dwordx4 v[132:135], v10, s[16:19], s44 offen sc1
    buffer_load_dwordx4 v[136:139], v11, s[16:19], s44 offen sc1
    buffer_load_dwordx4 v[140:143], v12, s[16:19], s44 offen sc1
    buffer_load_dwordx4 v[144:147], v13, s[16:19], s44 offen sc1
    s_add_u32 s44, s44, 4096
    buffer_load_dwordx4 v[148:151], v2, s[12:15], s43 offen offset:0 sc1
    buffer_load_dwordx4 v[152:155], v2, s[12:15], s43 offen offset:1024 sc1
    buffer_load_dwordx4 v[156:159], v2, s[12:15], s43 offen offset:2048 sc1
    buffer_load_dwordx4 v[160:163], v2, s[12:15], s43 offen offset:3072 sc1
    s_add_u32 s51, s43, 4096
    buffer_load_dwordx4 v[164:167], v2, s[12:15], s51 offen sc1
    s_add_u32 s43, s43, 5120
    s_waitcnt vmcnt(22)
    v_mfma_f32_16x16x32_bf16 v[16:19], v[184:187], v[168:171], v[16:19]
    v_mfma_f32_16x16x32_bf16 v[36:39], v[184:187], v[172:175], v[36:39]
    v_mfma_f32_16x16x32_bf16 v[56:59], v[184:187], v[176:179], v[56:59]
    v_mfma_f32_16x16x32_bf16 v[76:79], v[184:187], v[180:183], v[76:79]
    s_waitcnt vmcnt(21)
    v_mfma_f32_16x16x32_bf16 v[20:23], v[188:191], v[168:171], v[20:23]
    v_mfma_f32_16x16x32_bf16 v[40:43], v[188:191], v[172:175], v[40:43]
    v_mfma_f32_16x16x32_bf16 v[60:63], v[188:191], v[176:179], v[60:63]
    v_mfma_f32_16x16x32_bf16 v[80:83], v[188:191], v[180:183], v[80:83]
    s_waitcnt vmcnt(20)
    v_mfma_f32_16x16x32_bf16 v[24:27], v[192:195], v[168:171], v[24:27]
    v_mfma_f32_16x16x32_bf16 v[44:47], v[192:195], v[172:175], v[44:47]
    v_mfma_f32_16x16x32_bf16 v[64:67], v[192:195], v[176:179], v[64:67]
    v_mfma_f32_16x16x32_bf16 v[84:87], v[192:195], v[180:183], v[84:87]
    s_waitcnt vmcnt(19)
    v_mfma_f32_16x16x32_bf16 v[28:31], v[196:199], v[168:171], v[28:31]
    v_mfma_f32_16x16x32_bf16 v[48:51], v[196:199], v[172:175], v[48:51]
    v_mfma_f32_16x16x32_bf16 v[68:71], v[196:199], v[176:179], v[68:71]
    v_mfma_f32_16x16x32_bf16 v[88:91], v[196:199], v[180:183], v[88:91]
    s_waitcnt vmcnt(18)
    v_mfma_f32_16x16x32_bf16 v[32:35], v[200:203], v[168:171], v[32:35]
    v_mfma_f32_16x16x32_bf16 v[52:55], v[200:203], v[172:175], v[52:55]
    v_mfma_f32_16x16x32_bf16 v[72:75], v[200:203], v[176:179], v[72:75]
    v_mfma_f32_16x16x32_bf16 v[92:95], v[200:203], v[180:183], v[92:95]
    buffer_load_dwordx4 v[168:171], v10, s[16:19], s44 offen sc1
    buffer_load_dwordx4 v[172:175], v11, s[16:19], s44 offen sc1
    buffer_load_dwordx4 v[176:179], v12, s[16:19], s44 offen sc1
    buffer_load_dwordx4 v[180:183], v13, s[16:19], s44 offen sc1
    s_add_u32 s44, s44, 4096
    buffer_load_dwordx4 v[184:187], v2, s[12:15], s43 offen offset:0 sc1
    buffer_load_dwordx4 v[188:191], v2, s[12:15], s43 offen offset:1024 sc1
    buffer_load_dwordx4 v[192:195], v2, s[12:15], s43 offen offset:2048 sc1
    buffer_load_dwordx4 v[196:199], v2, s[12:15], s43 offen offset:3072 sc1
    s_add_u32 s51, s43, 4096
    buffer_load_dwordx4 v[200:203], v2, s[12:15], s51 offen sc1
    s_add_u32 s43, s43, 5120
    s_waitcnt vmcnt(22)
    v_mfma_f32_16x16x32_bf16 v[16:19], v[112:115], v[96:99], v[16:19]
    v_mfma_f32_16x16x32_bf16 v[36:39], v[112:115], v[100:103], v[36:39]
    v_mfma_f32_16x16x32_bf16 v[56:59], v[112:115], v[104:107], v[56:59]
    v_mfma_f32_16x16x32_bf16 v[76:79], v[112:115], v[108:111], v[76:79]
    s_waitcnt vmcnt(21)
    v_mfma_f32_16x16x32_bf16 v[20:23], v[116:119], v[96:99], v[20:23]
    v_mfma_f32_16x16x32_bf16 v[40:43], v[116:119], v[100:103], v[40:43]
    v_mfma_f32_16x16x32_bf16 v[60:63], v[116:119], v[104:107], v[60:63]
    v_mfma_f32_16x16x32_bf16 v[80:83], v[116:119], v[108:111], v[80:83]
    s_waitcnt vmcnt(20)
    v_mfma_f32_16x16x32_bf16 v[24:27], v[120:123], v[96:99], v[24:27]
    v_mfma_f32_16x16x32_bf16 v[44:47], v[120:123], v[100:103], v[44:47]
    v_mfma_f32_16x16x32_bf16 v[64:67], v[120:123], v[104:107], v[64:67]
    v_mfma_f32_16x16x32_bf16 v[84:87], v[120:123], v[108:111], v[84:87]
    s_waitcnt vmcnt(19)
    v_mfma_f32_16x16x32_bf16 v[28:31], v[124:127], v[96:99], v[28:31]
    v_mfma_f32_16x16x32_bf16 v[48:51], v[124:127], v[100:103], v[48:51]
    v_mfma_f32_16x16x32_bf16 v[68:71], v[124:127], v[104:107], v[68:71]
    v_mfma_f32_16x16x32_bf16 v[88:91], v[124:127], v[108:111], v[88:91]
    s_waitcnt vmcnt(18)
    v_mfma_f32_16x16x32_bf16 v[32:35], v[128:131], v[96:99], v[32:35]
    v_mfma_f32_16x16x32_bf16 v[52:55], v[128:131], v[100:103], v[52:55]
    v_mfma_f32_16x16x32_bf16 v[72:75], v[128:131], v[104:107], v[72:75]
    v_mfma_f32_16x16x32_bf16 v[92:95], v[128:131], v[108:111], v[92:95]
    buffer_load_dwordx4 v[96:99], v10, s[16:19], s44 offen sc1
    buffer_load_dwordx4 v[100:103], v11, s[16:19], s44 offen sc1
    buffer_load_dwordx4 v[104:107], v12, s[16:19], s44 offen sc1
    buffer_load_dwordx4 v[108:111], v13, s[16:19], s44 offen sc1
    s_add_u32 s44, s44, 4096
    buffer_load_dwordx4 v[112:115], v2, s[12:15], s43 offen offset:0 sc1
    buffer_load_dwordx4 v[116:119], v2, s[12:15], s43 offen offset:1024 sc1
    buffer_load_dwordx4 v[120:123], v2, s[12:15], s43 offen offset:2048 sc1
    buffer_load_dwordx4 v[124:127], v2, s[12:15], s43 offen offset:3072 sc1
    s_add_u32 s51, s43, 4096
    buffer_load_dwordx4 v[128:131], v2, s[12:15], s51 offen sc1
    s_add_u32 s43, s43, 5120
    s_waitcnt vmcnt(22)
    v_mfma_f32_16x16x32_bf16 v[16:19], v[148:151], v[132:135], v[16:19]
    v_mfma_f32_16x16x32_bf16 v[36:39], v[148:151], v[136:139], v[36:39]
    v_mfma_f32_16x16x32_bf16 v[56:59], v[148:151], v[140:143], v[56:59]
    v_mfma_f32_16x16x32_bf16 v[76:79], v[148:151], v[144:147], v[76:79]
    s_waitcnt vmcnt(21)
    v_mfma_f32_16x16x32_bf16 v[20:23], v[152:155], v[132:135], v[20:23]
    v_mfma_f32_16x16x32_bf16 v[40:43], v[152:155], v[136:139], v[40:43]
    v_mfma_f32_16x16x32_bf16 v[60:63], v[152:155], v[140:143], v[60:63]
    v_mfma_f32_16x16x32_bf16 v[80:83], v[152:155], v[144:147], v[80:83]
    s_waitcnt vmcnt(20)
    v_mfma_f32_16x16x32_bf16 v[24:27], v[156:159], v[132:135], v[24:27]
    v_mfma_f32_16x16x32_bf16 v[44:47], v[156:159], v[136:139], v[44:47]
    v_mfma_f32_16x16x32_bf16 v[64:67], v[156:159], v[140:143], v[64:67]
    v_mfma_f32_16x16x32_bf16 v[84:87], v[156:159], v[144:147], v[84:87]
    s_waitcnt vmcnt(19)
    v_mfma_f32_16x16x32_bf16 v[28:31], v[160:163], v[132:135], v[28:31]
    v_mfma_f32_16x16x32_bf16 v[48:51], v[160:163], v[136:139], v[48:51]
    v_mfma_f32_16x16x32_bf16 v[68:71], v[160:163], v[140:143], v[68:71]
    v_mfma_f32_16x16x32_bf16 v[88:91], v[160:163], v[144:147], v[88:91]
    s_waitcnt vmcnt(18)
    v_mfma_f32_16x16x32_bf16 v[32:35], v[164:167], v[132:135], v[32:35]
    v_mfma_f32_16x16x32_bf16 v[52:55], v[164:167], v[136:139], v[52:55]
    v_mfma_f32_16x16x32_bf16 v[72:75], v[164:167], v[140:143], v[72:75]
    v_mfma_f32_16x16x32_bf16 v[92:95], v[164:167], v[144:147], v[92:95]
    buffer_load_dwordx4 v[132:135], v10, s[16:19], s44 offen sc1
    buffer_load_dwordx4 v[136:139], v11, s[16:19], s44 offen sc1
    buffer_load_dwordx4 v[140:143], v12, s[16:19], s44 offen sc1
    buffer_load_dwordx4 v[144:147], v13, s[16:19], s44 offen sc1
    s_add_u32 s44, s44, 4096
    buffer_load_dwordx4 v[148:151], v2, s[12:15], s43 offen offset:0 sc1
    buffer_load_dwordx4 v[152:155], v2, s[12:15], s43 offen offset:1024 sc1
    buffer_load_dwordx4 v[156:159], v2, s[12:15], s43 offen offset:2048 sc1
    buffer_load_dwordx4 v[160:163], v2, s[12:15], s43 offen offset:3072 sc1
    s_add_u32 s51, s43, 4096
    buffer_load_dwordx4 v[164:167], v2, s[12:15], s51 offen sc1
    s_add_u32 s43, s43, 5120
    s_waitcnt vmcnt(22)
    v_mfma_f32_16x16x32_bf16 v[16:19], v[184:187], v[168:171], v[16:19]
    v_mfma_f32_16x16x32_bf16 v[36:39], v[184:187], v[172:175], v[36:39]
    v_mfma_f32_16x16x32_bf16 v[56:59], v[184:187], v[176:179], v[56:59]
    v_mfma_f32_16x16x32_bf16 v[76:79], v[184:187], v[180:183], v[76:79]
    s_waitcnt vmcnt(21)
    v_mfma_f32_16x16x32_bf16 v[20:23], v[188:191], v[168:171], v[20:23]
    v_mfma_f32_16x16x32_bf16 v[40:43], v[188:191], v[172:175], v[40:43]
    v_mfma_f32_16x16x32_bf16 v[60:63], v[188:191], v[176:179], v[60:63]
    v_mfma_f32_16x16x32_bf16 v[80:83], v[188:191], v[180:183], v[80:83]
    s_waitcnt vmcnt(20)
    v_mfma_f32_16x16x32_bf16 v[24:27], v[192:195], v[168:171], v[24:27]
    v_mfma_f32_16x16x32_bf16 v[44:47], v[192:195], v[172:175], v[44:47]
    v_mfma_f32_16x16x32_bf16 v[64:67], v[192:195], v[176:179], v[64:67]
    v_mfma_f32_16x16x32_bf16 v[84:87], v[192:195], v[180:183], v[84:87]
    s_waitcnt vmcnt(19)
    v_mfma_f32_16x16x32_bf16 v[28:31], v[196:199], v[168:171], v[28:31]
    v_mfma_f32_16x16x32_bf16 v[48:51], v[196:199], v[172:175], v[48:51]
    v_mfma_f32_16x16x32_bf16 v[68:71], v[196:199], v[176:179], v[68:71]
    v_mfma_f32_16x16x32_bf16 v[88:91], v[196:199], v[180:183], v[88:91]
    s_waitcnt vmcnt(18)
    v_mfma_f32_16x16x32_bf16 v[32:35], v[200:203], v[168:171], v[32:35]
    v_mfma_f32_16x16x32_bf16 v[52:55], v[200:203], v[172:175], v[52:55]
    v_mfma_f32_16x16x32_bf16 v[72:75], v[200:203], v[176:179], v[72:75]
    v_mfma_f32_16x16x32_bf16 v[92:95], v[200:203], v[180:183], v[92:95]
    buffer_load_dwordx4 v[168:171], v10, s[16:19], s44 offen sc1
    buffer_load_dwordx4 v[172:175], v11, s[16:19], s44 offen sc1
    buffer_load_dwordx4 v[176:179], v12, s[16:19], s44 offen sc1
    buffer_load_dwordx4 v[180:183], v13, s[16:19], s44 offen sc1
    s_add_u32 s44, s44, 4096
    buffer_load_dwordx4 v[184:187], v2, s[12:15], s43 offen offset:0 sc1
    buffer_load_dwordx4 v[188:191], v2, s[12:15], s43 offen offset:1024 sc1
    buffer_load_dwordx4 v[192:195], v2, s[12:15], s43 offen offset:2048 sc1
    buffer_load_dwordx4 v[196:199], v2, s[12:15], s43 offen offset:3072 sc1
    s_add_u32 s51, s43, 4096
    buffer_load_dwordx4 v[200:203], v2, s[12:15], s51 offen sc1
    s_add_u32 s43, s43, 5120
    s_waitcnt vmcnt(22)
    v_mfma_f32_16x16x32_bf16 v[16:19], v[112:115], v[96:99], v[16:19]
    v_mfma_f32_16x16x32_bf16 v[36:39], v[112:115], v[100:103], v[36:39]
    v_mfma_f32_16x16x32_bf16 v[56:59], v[112:115], v[104:107], v[56:59]
    v_mfma_f32_16x16x32_bf16 v[76:79], v[112:115], v[108:111], v[76:79]
    s_waitcnt vmcnt(21)
    v_mfma_f32_16x16x32_bf16 v[20:23], v[116:119], v[96:99], v[20:23]
    v_mfma_f32_16x16x32_bf16 v[40:43], v[116:119], v[100:103], v[40:43]
    v_mfma_f32_16x16x32_bf16 v[60:63], v[116:119], v[104:107], v[60:63]
    v_mfma_f32_16x16x32_bf16 v[80:83], v[116:119], v[108:111], v[80:83]
    s_waitcnt vmcnt(20)
    v_mfma_f32_16x16x32_bf16 v[24:27], v[120:123], v[96:99], v[24:27]
    v_mfma_f32_16x16x32_bf16 v[44:47], v[120:123], v[100:103], v[44:47]
    v_mfma_f32_16x16x32_bf16 v[64:67], v[120:123], v[104:107], v[64:67]
    v_mfma_f32_16x16x32_bf16 v[84:87], v[120:123], v[108:111], v[84:87]
    s_waitcnt vmcnt(19)
    v_mfma_f32_16x16x32_bf16 v[28:31], v[124:127], v[96:99], v[28:31]
    v_mfma_f32_16x16x32_bf16 v[48:51], v[124:127], v[100:103], v[48:51]
    v_mfma_f32_16x16x32_bf16 v[68:71], v[124:127], v[104:107], v[68:71]
    v_mfma_f32_16x16x32_bf16 v[88:91], v[124:127], v[108:111], v[88:91]
    s_waitcnt vmcnt(18)
    v_mfma_f32_16x16x32_bf16 v[32:35], v[128:131], v[96:99], v[32:35]
    v_mfma_f32_16x16x32_bf16 v[52:55], v[128:131], v[100:103], v[52:55]
    v_mfma_f32_16x16x32_bf16 v[72:75], v[128:131], v[104:107], v[72:75]
    v_mfma_f32_16x16x32_bf16 v[92:95], v[128:131], v[108:111], v[92:95]
    buffer_load_dwordx4 v[96:99], v10, s[16:19], s44 offen sc1
    buffer_load_dwordx4 v[100:103], v11, s[16:19], s44 offen sc1
    buffer_load_dwordx4 v[104:107], v12, s[16:19], s44 offen sc1
    buffer_load_dwordx4 v[108:111], v13, s[16:19], s44 offen sc1
    s_add_u32 s44, s44, 4096
    buffer_load_dwordx4 v[112:115], v2, s[12:15], s43 offen offset:0 sc1
    buffer_load_dwordx4 v[116:119], v2, s[12:15], s43 offen offset:1024 sc1
    buffer_load_dwordx4 v[120:123], v2, s[12:15], s43 offen offset:2048 sc1
    buffer_load_dwordx4 v[124:127], v2, s[12:15], s43 offen offset:3072 sc1
    s_add_u32 s51, s43, 4096
    buffer_load_dwordx4 v[128:131], v2, s[12:15], s51 offen sc1
    s_add_u32 s43, s43, 5120
    s_waitcnt vmcnt(22)
    v_mfma_f32_16x16x32_bf16 v[16:19], v[148:151], v[132:135], v[16:19]
    v_mfma_f32_16x16x32_bf16 v[36:39], v[148:151], v[136:139], v[36:39]
    v_mfma_f32_16x16x32_bf16 v[56:59], v[148:151], v[140:143], v[56:59]
    v_mfma_f32_16x16x32_bf16 v[76:79], v[148:151], v[144:147], v[76:79]
    s_waitcnt vmcnt(21)
    v_mfma_f32_16x16x32_bf16 v[20:23], v[152:155], v[132:135], v[20:23]
    v_mfma_f32_16x16x32_bf16 v[40:43], v[152:155], v[136:139], v[40:43]
    v_mfma_f32_16x16x32_bf16 v[60:63], v[152:155], v[140:143], v[60:63]
    v_mfma_f32_16x16x32_bf16 v[80:83], v[152:155], v[144:147], v[80:83]
    s_waitcnt vmcnt(20)
    v_mfma_f32_16x16x32_bf16 v[24:27], v[156:159], v[132:135], v[24:27]
    v_mfma_f32_16x16x32_bf16 v[44:47], v[156:159], v[136:139], v[44:47]
    v_mfma_f32_16x16x32_bf16 v[64:67], v[156:159], v[140:143], v[64:67]
    v_mfma_f32_16x16x32_bf16 v[84:87], v[156:159], v[144:147], v[84:87]
    s_waitcnt vmcnt(19)
    v_mfma_f32_16x16x32_bf16 v[28:31], v[160:163], v[132:135], v[28:31]
    v_mfma_f32_16x16x32_bf16 v[48:51], v[160:163], v[136:139], v[48:51]
    v_mfma_f32_16x16x32_bf16 v[68:71], v[160:163], v[140:143], v[68:71]
    v_mfma_f32_16x16x32_bf16 v[88:91], v[160:163], v[144:147], v[88:91]
    s_waitcnt vmcnt(18)
    v_mfma_f32_16x16x32_bf16 v[32:35], v[164:167], v[132:135], v[32:35]
    v_mfma_f32_16x16x32_bf16 v[52:55], v[164:167], v[136:139], v[52:55]
    v_mfma_f32_16x16x32_bf16 v[72:75], v[164:167], v[140:143], v[72:75]
    v_mfma_f32_16x16x32_bf16 v[92:95], v[164:167], v[144:147], v[92:95]
    buffer_load_dwordx4 v[132:135], v10, s[16:19], s44 offen sc1
    buffer_load_dwordx4 v[136:139], v11, s[16:19], s44 offen sc1
    buffer_load_dwordx4 v[140:143], v12, s[16:19], s44 offen sc1
    buffer_load_dwordx4 v[144:147], v13, s[16:19], s44 offen sc1
    s_add_u32 s44, s44, 4096
    buffer_load_dwordx4 v[148:151], v2, s[12:15], s43 offen offset:0 sc1
    buffer_load_dwordx4 v[152:155], v2, s[12:15], s43 offen offset:1024 sc1
    buffer_load_dwordx4 v[156:159], v2, s[12:15], s43 offen offset:2048 sc1
    buffer_load_dwordx4 v[160:163], v2, s[12:15], s43 offen offset:3072 sc1
    s_add_u32 s51, s43, 4096
    buffer_load_dwordx4 v[164:167], v2, s[12:15], s51 offen sc1
    s_add_u32 s43, s43, 5120
    s_waitcnt vmcnt(22)
    v_mfma_f32_16x16x32_bf16 v[16:19], v[184:187], v[168:171], v[16:19]
    v_mfma_f32_16x16x32_bf16 v[36:39], v[184:187], v[172:175], v[36:39]
    v_mfma_f32_16x16x32_bf16 v[56:59], v[184:187], v[176:179], v[56:59]
    v_mfma_f32_16x16x32_bf16 v[76:79], v[184:187], v[180:183], v[76:79]
    s_waitcnt vmcnt(21)
    v_mfma_f32_16x16x32_bf16 v[20:23], v[188:191], v[168:171], v[20:23]
    v_mfma_f32_16x16x32_bf16 v[40:43], v[188:191], v[172:175], v[40:43]
    v_mfma_f32_16x16x32_bf16 v[60:63], v[188:191], v[176:179], v[60:63]
    v_mfma_f32_16x16x32_bf16 v[80:83], v[188:191], v[180:183], v[80:83]
    s_waitcnt vmcnt(20)
    v_mfma_f32_16x16x32_bf16 v[24:27], v[192:195], v[168:171], v[24:27]
    v_mfma_f32_16x16x32_bf16 v[44:47], v[192:195], v[172:175], v[44:47]
    v_mfma_f32_16x16x32_bf16 v[64:67], v[192:195], v[176:179], v[64:67]
    v_mfma_f32_16x16x32_bf16 v[84:87], v[192:195], v[180:183], v[84:87]
    s_waitcnt vmcnt(19)
    v_mfma_f32_16x16x32_bf16 v[28:31], v[196:199], v[168:171], v[28:31]
    v_mfma_f32_16x16x32_bf16 v[48:51], v[196:199], v[172:175], v[48:51]
    v_mfma_f32_16x16x32_bf16 v[68:71], v[196:199], v[176:179], v[68:71]
    v_mfma_f32_16x16x32_bf16 v[88:91], v[196:199], v[180:183], v[88:91]
    s_waitcnt vmcnt(18)
    v_mfma_f32_16x16x32_bf16 v[32:35], v[200:203], v[168:171], v[32:35]
    v_mfma_f32_16x16x32_bf16 v[52:55], v[200:203], v[172:175], v[52:55]
    v_mfma_f32_16x16x32_bf16 v[72:75], v[200:203], v[176:179], v[72:75]
    v_mfma_f32_16x16x32_bf16 v[92:95], v[200:203], v[180:183], v[92:95]
    buffer_load_dwordx4 v[168:171], v10, s[16:19], s44 offen sc1
    buffer_load_dwordx4 v[172:175], v11, s[16:19], s44 offen sc1
    buffer_load_dwordx4 v[176:179], v12, s[16:19], s44 offen sc1
    buffer_load_dwordx4 v[180:183], v13, s[16:19], s44 offen sc1
    s_add_u32 s44, s44, 4096
    buffer_load_dwordx4 v[184:187], v2, s[12:15], s43 offen offset:0 sc1
    buffer_load_dwordx4 v[188:191], v2, s[12:15], s43 offen offset:1024 sc1
    buffer_load_dwordx4 v[192:195], v2, s[12:15], s43 offen offset:2048 sc1
    buffer_load_dwordx4 v[196:199], v2, s[12:15], s43 offen offset:3072 sc1
    s_add_u32 s51, s43, 4096
    buffer_load_dwordx4 v[200:203], v2, s[12:15], s51 offen sc1
    s_add_u32 s43, s43, 5120
    s_waitcnt vmcnt(22)
    v_mfma_f32_16x16x32_bf16 v[16:19], v[112:115], v[96:99], v[16:19]
    v_mfma_f32_16x16x32_bf16 v[36:39], v[112:115], v[100:103], v[36:39]
    v_mfma_f32_16x16x32_bf16 v[56:59], v[112:115], v[104:107], v[56:59]
    v_mfma_f32_16x16x32_bf16 v[76:79], v[112:115], v[108:111], v[76:79]
    s_waitcnt vmcnt(21)
    v_mfma_f32_16x16x32_bf16 v[20:23], v[116:119], v[96:99], v[20:23]
    v_mfma_f32_16x16x32_bf16 v[40:43], v[116:119], v[100:103], v[40:43]
    v_mfma_f32_16x16x32_bf16 v[60:63], v[116:119], v[104:107], v[60:63]
    v_mfma_f32_16x16x32_bf16 v[80:83], v[116:119], v[108:111], v[80:83]
    s_waitcnt vmcnt(20)
    v_mfma_f32_16x16x32_bf16 v[24:27], v[120:123], v[96:99], v[24:27]
    v_mfma_f32_16x16x32_bf16 v[44:47], v[120:123], v[100:103], v[44:47]
    v_mfma_f32_16x16x32_bf16 v[64:67], v[120:123], v[104:107], v[64:67]
    v_mfma_f32_16x16x32_bf16 v[84:87], v[120:123], v[108:111], v[84:87]
    s_waitcnt vmcnt(19)
    v_mfma_f32_16x16x32_bf16 v[28:31], v[124:127], v[96:99], v[28:31]
    v_mfma_f32_16x16x32_bf16 v[48:51], v[124:127], v[100:103], v[48:51]
    v_mfma_f32_16x16x32_bf16 v[68:71], v[124:127], v[104:107], v[68:71]
    v_mfma_f32_16x16x32_bf16 v[88:91], v[124:127], v[108:111], v[88:91]
    s_waitcnt vmcnt(18)
    v_mfma_f32_16x16x32_bf16 v[32:35], v[128:131], v[96:99], v[32:35]
    v_mfma_f32_16x16x32_bf16 v[52:55], v[128:131], v[100:103], v[52:55]
    v_mfma_f32_16x16x32_bf16 v[72:75], v[128:131], v[104:107], v[72:75]
    v_mfma_f32_16x16x32_bf16 v[92:95], v[128:131], v[108:111], v[92:95]
    buffer_load_dwordx4 v[96:99], v10, s[16:19], s44 offen sc1
    buffer_load_dwordx4 v[100:103], v11, s[16:19], s44 offen sc1
    buffer_load_dwordx4 v[104:107], v12, s[16:19], s44 offen sc1
    buffer_load_dwordx4 v[108:111], v13, s[16:19], s44 offen sc1
    s_add_u32 s44, s44, 4096
    buffer_load_dwordx4 v[112:115], v2, s[12:15], s43 offen offset:0 sc1
    buffer_load_dwordx4 v[116:119], v2, s[12:15], s43 offen offset:1024 sc1
    buffer_load_dwordx4 v[120:123], v2, s[12:15], s43 offen offset:2048 sc1
    buffer_load_dwordx4 v[124:127], v2, s[12:15], s43 offen offset:3072 sc1
    s_add_u32 s51, s43, 4096
    buffer_load_dwordx4 v[128:131], v2, s[12:15], s51 offen sc1
    s_add_u32 s43, s43, 5120
    s_waitcnt vmcnt(22)
    v_mfma_f32_16x16x32_bf16 v[16:19], v[148:151], v[132:135], v[16:19]
    v_mfma_f32_16x16x32_bf16 v[36:39], v[148:151], v[136:139], v[36:39]
    v_mfma_f32_16x16x32_bf16 v[56:59], v[148:151], v[140:143], v[56:59]
    v_mfma_f32_16x16x32_bf16 v[76:79], v[148:151], v[144:147], v[76:79]
    s_waitcnt vmcnt(21)
    v_mfma_f32_16x16x32_bf16 v[20:23], v[152:155], v[132:135], v[20:23]
    v_mfma_f32_16x16x32_bf16 v[40:43], v[152:155], v[136:139], v[40:43]
    v_mfma_f32_16x16x32_bf16 v[60:63], v[152:155], v[140:143], v[60:63]
    v_mfma_f32_16x16x32_bf16 v[80:83], v[152:155], v[144:147], v[80:83]
    s_waitcnt vmcnt(20)
    v_mfma_f32_16x16x32_bf16 v[24:27], v[156:159], v[132:135], v[24:27]
    v_mfma_f32_16x16x32_bf16 v[44:47], v[156:159], v[136:139], v[44:47]
    v_mfma_f32_16x16x32_bf16 v[64:67], v[156:159], v[140:143], v[64:67]
    v_mfma_f32_16x16x32_bf16 v[84:87], v[156:159], v[144:147], v[84:87]
    s_waitcnt vmcnt(19)
    v_mfma_f32_16x16x32_bf16 v[28:31], v[160:163], v[132:135], v[28:31]
    v_mfma_f32_16x16x32_bf16 v[48:51], v[160:163], v[136:139], v[48:51]
    v_mfma_f32_16x16x32_bf16 v[68:71], v[160:163], v[140:143], v[68:71]
    v_mfma_f32_16x16x32_bf16 v[88:91], v[160:163], v[144:147], v[88:91]
    s_waitcnt vmcnt(18)
    v_mfma_f32_16x16x32_bf16 v[32:35], v[164:167], v[132:135], v[32:35]
    v_mfma_f32_16x16x32_bf16 v[52:55], v[164:167], v[136:139], v[52:55]
    v_mfma_f32_16x16x32_bf16 v[72:75], v[164:167], v[140:143], v[72:75]
    v_mfma_f32_16x16x32_bf16 v[92:95], v[164:167], v[144:147], v[92:95]
    buffer_load_dwordx4 v[132:135], v10, s[16:19], s44 offen sc1
    buffer_load_dwordx4 v[136:139], v11, s[16:19], s44 offen sc1
    buffer_load_dwordx4 v[140:143], v12, s[16:19], s44 offen sc1
    buffer_load_dwordx4 v[144:147], v13, s[16:19], s44 offen sc1
    s_add_u32 s44, s44, 4096
    buffer_load_dwordx4 v[148:151], v2, s[12:15], s43 offen offset:0 sc1
    buffer_load_dwordx4 v[152:155], v2, s[12:15], s43 offen offset:1024 sc1
    buffer_load_dwordx4 v[156:159], v2, s[12:15], s43 offen offset:2048 sc1
    buffer_load_dwordx4 v[160:163], v2, s[12:15], s43 offen offset:3072 sc1
    s_add_u32 s51, s43, 4096
    buffer_load_dwordx4 v[164:167], v2, s[12:15], s51 offen sc1
    s_add_u32 s43, s43, 5120
    s_waitcnt vmcnt(22)
    v_mfma_f32_16x16x32_bf16 v[16:19], v[184:187], v[168:171], v[16:19]
    v_mfma_f32_16x16x32_bf16 v[36:39], v[184:187], v[172:175], v[36:39]
    v_mfma_f32_16x16x32_bf16 v[56:59], v[184:187], v[176:179], v[56:59]
    v_mfma_f32_16x16x32_bf16 v[76:79], v[184:187], v[180:183], v[76:79]
    s_waitcnt vmcnt(21)
    v_mfma_f32_16x16x32_bf16 v[20:23], v[188:191], v[168:171], v[20:23]
    v_mfma_f32_16x16x32_bf16 v[40:43], v[188:191], v[172:175], v[40:43]
    v_mfma_f32_16x16x32_bf16 v[60:63], v[188:191], v[176:179], v[60:63]
    v_mfma_f32_16x16x32_bf16 v[80:83], v[188:191], v[180:183], v[80:83]
    s_waitcnt vmcnt(20)
    v_mfma_f32_16x16x32_bf16 v[24:27], v[192:195], v[168:171], v[24:27]
    v_mfma_f32_16x16x32_bf16 v[44:47], v[192:195], v[172:175], v[44:47]
    v_mfma_f32_16x16x32_bf16 v[64:67], v[192:195], v[176:179], v[64:67]
    v_mfma_f32_16x16x32_bf16 v[84:87], v[192:195], v[180:183], v[84:87]
    s_waitcnt vmcnt(19)
    v_mfma_f32_16x16x32_bf16 v[28:31], v[196:199], v[168:171], v[28:31]
    v_mfma_f32_16x16x32_bf16 v[48:51], v[196:199], v[172:175], v[48:51]
    v_mfma_f32_16x16x32_bf16 v[68:71], v[196:199], v[176:179], v[68:71]
    v_mfma_f32_16x16x32_bf16 v[88:91], v[196:199], v[180:183], v[88:91]
    s_waitcnt vmcnt(18)
    v_mfma_f32_16x16x32_bf16 v[32:35], v[200:203], v[168:171], v[32:35]
    v_mfma_f32_16x16x32_bf16 v[52:55], v[200:203], v[172:175], v[52:55]
    v_mfma_f32_16x16x32_bf16 v[72:75], v[200:203], v[176:179], v[72:75]
    v_mfma_f32_16x16x32_bf16 v[92:95], v[200:203], v[180:183], v[92:95]
    buffer_load_dwordx4 v[168:171], v10, s[16:19], s44 offen sc1
    buffer_load_dwordx4 v[172:175], v11, s[16:19], s44 offen sc1
    buffer_load_dwordx4 v[176:179], v12, s[16:19], s44 offen sc1
    buffer_load_dwordx4 v[180:183], v13, s[16:19], s44 offen sc1
    s_add_u32 s44, s44, 4096
    buffer_load_dwordx4 v[184:187], v2, s[12:15], s43 offen offset:0 sc1
    buffer_load_dwordx4 v[188:191], v2, s[12:15], s43 offen offset:1024 sc1
    buffer_load_dwordx4 v[192:195], v2, s[12:15], s43 offen offset:2048 sc1
    buffer_load_dwordx4 v[196:199], v2, s[12:15], s43 offen offset:3072 sc1
    s_add_u32 s51, s43, 4096
    buffer_load_dwordx4 v[200:203], v2, s[12:15], s51 offen sc1
    s_add_u32 s43, s43, 5120
    s_waitcnt vmcnt(22)
    v_mfma_f32_16x16x32_bf16 v[16:19], v[112:115], v[96:99], v[16:19]
    v_mfma_f32_16x16x32_bf16 v[36:39], v[112:115], v[100:103], v[36:39]
    v_mfma_f32_16x16x32_bf16 v[56:59], v[112:115], v[104:107], v[56:59]
    v_mfma_f32_16x16x32_bf16 v[76:79], v[112:115], v[108:111], v[76:79]
    s_waitcnt vmcnt(21)
    v_mfma_f32_16x16x32_bf16 v[20:23], v[116:119], v[96:99], v[20:23]
    v_mfma_f32_16x16x32_bf16 v[40:43], v[116:119], v[100:103], v[40:43]
    v_mfma_f32_16x16x32_bf16 v[60:63], v[116:119], v[104:107], v[60:63]
    v_mfma_f32_16x16x32_bf16 v[80:83], v[116:119], v[108:111], v[80:83]
    s_waitcnt vmcnt(20)
    v_mfma_f32_16x16x32_bf16 v[24:27], v[120:123], v[96:99], v[24:27]
    v_mfma_f32_16x16x32_bf16 v[44:47], v[120:123], v[100:103], v[44:47]
    v_mfma_f32_16x16x32_bf16 v[64:67], v[120:123], v[104:107], v[64:67]
    v_mfma_f32_16x16x32_bf16 v[84:87], v[120:123], v[108:111], v[84:87]
    s_waitcnt vmcnt(19)
    v_mfma_f32_16x16x32_bf16 v[28:31], v[124:127], v[96:99], v[28:31]
    v_mfma_f32_16x16x32_bf16 v[48:51], v[124:127], v[100:103], v[48:51]
    v_mfma_f32_16x16x32_bf16 v[68:71], v[124:127], v[104:107], v[68:71]
    v_mfma_f32_16x16x32_bf16 v[88:91], v[124:127], v[108:111], v[88:91]
    s_waitcnt vmcnt(18)
    v_mfma_f32_16x16x32_bf16 v[32:35], v[128:131], v[96:99], v[32:35]
    v_mfma_f32_16x16x32_bf16 v[52:55], v[128:131], v[100:103], v[52:55]
    v_mfma_f32_16x16x32_bf16 v[72:75], v[128:131], v[104:107], v[72:75]
    v_mfma_f32_16x16x32_bf16 v[92:95], v[128:131], v[108:111], v[92:95]
    buffer_load_dwordx4 v[96:99], v10, s[16:19], s44 offen sc1
    buffer_load_dwordx4 v[100:103], v11, s[16:19], s44 offen sc1
    buffer_load_dwordx4 v[104:107], v12, s[16:19], s44 offen sc1
    buffer_load_dwordx4 v[108:111], v13, s[16:19], s44 offen sc1
    s_add_u32 s44, s44, 4096
    buffer_load_dwordx4 v[112:115], v2, s[12:15], s43 offen offset:0 sc1
    buffer_load_dwordx4 v[116:119], v2, s[12:15], s43 offen offset:1024 sc1
    buffer_load_dwordx4 v[120:123], v2, s[12:15], s43 offen offset:2048 sc1
    buffer_load_dwordx4 v[124:127], v2, s[12:15], s43 offen offset:3072 sc1
    s_add_u32 s51, s43, 4096
    buffer_load_dwordx4 v[128:131], v2, s[12:15], s51 offen sc1
    s_add_u32 s43, s43, 5120
    s_waitcnt vmcnt(22)
    v_mfma_f32_16x16x32_bf16 v[16:19], v[148:151], v[132:135], v[16:19]
    v_mfma_f32_16x16x32_bf16 v[36:39], v[148:151], v[136:139], v[36:39]
    v_mfma_f32_16x16x32_bf16 v[56:59], v[148:151], v[140:143], v[56:59]
    v_mfma_f32_16x16x32_bf16 v[76:79], v[148:151], v[144:147], v[76:79]
    s_waitcnt vmcnt(21)
    v_mfma_f32_16x16x32_bf16 v[20:23], v[152:155], v[132:135], v[20:23]
    v_mfma_f32_16x16x32_bf16 v[40:43], v[152:155], v[136:139], v[40:43]
    v_mfma_f32_16x16x32_bf16 v[60:63], v[152:155], v[140:143], v[60:63]
    v_mfma_f32_16x16x32_bf16 v[80:83], v[152:155], v[144:147], v[80:83]
    s_waitcnt vmcnt(20)
    v_mfma_f32_16x16x32_bf16 v[24:27], v[156:159], v[132:135], v[24:27]
    v_mfma_f32_16x16x32_bf16 v[44:47], v[156:159], v[136:139], v[44:47]
    v_mfma_f32_16x16x32_bf16 v[64:67], v[156:159], v[140:143], v[64:67]
    v_mfma_f32_16x16x32_bf16 v[84:87], v[156:159], v[144:147], v[84:87]
    s_waitcnt vmcnt(19)
    v_mfma_f32_16x16x32_bf16 v[28:31], v[160:163], v[132:135], v[28:31]
    v_mfma_f32_16x16x32_bf16 v[48:51], v[160:163], v[136:139], v[48:51]
    v_mfma_f32_16x16x32_bf16 v[68:71], v[160:163], v[140:143], v[68:71]
    v_mfma_f32_16x16x32_bf16 v[88:91], v[160:163], v[144:147], v[88:91]
    s_waitcnt vmcnt(18)
    v_mfma_f32_16x16x32_bf16 v[32:35], v[164:167], v[132:135], v[32:35]
    v_mfma_f32_16x16x32_bf16 v[52:55], v[164:167], v[136:139], v[52:55]
    v_mfma_f32_16x16x32_bf16 v[72:75], v[164:167], v[140:143], v[72:75]
    v_mfma_f32_16x16x32_bf16 v[92:95], v[164:167], v[144:147], v[92:95]
    buffer_load_dwordx4 v[132:135], v10, s[16:19], s44 offen sc1
    buffer_load_dwordx4 v[136:139], v11, s[16:19], s44 offen sc1
    buffer_load_dwordx4 v[140:143], v12, s[16:19], s44 offen sc1
    buffer_load_dwordx4 v[144:147], v13, s[16:19], s44 offen sc1
    s_add_u32 s44, s44, 4096
    buffer_load_dwordx4 v[148:151], v2, s[12:15], s43 offen offset:0 sc1
    buffer_load_dwordx4 v[152:155], v2, s[12:15], s43 offen offset:1024 sc1
    buffer_load_dwordx4 v[156:159], v2, s[12:15], s43 offen offset:2048 sc1
    buffer_load_dwordx4 v[160:163], v2, s[12:15], s43 offen offset:3072 sc1
    s_add_u32 s51, s43, 4096
    buffer_load_dwordx4 v[164:167], v2, s[12:15], s51 offen sc1
    s_add_u32 s43, s43, 5120
    s_waitcnt vmcnt(22)
    v_mfma_f32_16x16x32_bf16 v[16:19], v[184:187], v[168:171], v[16:19]
    v_mfma_f32_16x16x32_bf16 v[36:39], v[184:187], v[172:175], v[36:39]
    v_mfma_f32_16x16x32_bf16 v[56:59], v[184:187], v[176:179], v[56:59]
    v_mfma_f32_16x16x32_bf16 v[76:79], v[184:187], v[180:183], v[76:79]
    s_waitcnt vmcnt(21)
    v_mfma_f32_16x16x32_bf16 v[20:23], v[188:191], v[168:171], v[20:23]
    v_mfma_f32_16x16x32_bf16 v[40:43], v[188:191], v[172:175], v[40:43]
    v_mfma_f32_16x16x32_bf16 v[60:63], v[188:191], v[176:179], v[60:63]
    v_mfma_f32_16x16x32_bf16 v[80:83], v[188:191], v[180:183], v[80:83]
    s_waitcnt vmcnt(20)
    v_mfma_f32_16x16x32_bf16 v[24:27], v[192:195], v[168:171], v[24:27]
    v_mfma_f32_16x16x32_bf16 v[44:47], v[192:195], v[172:175], v[44:47]
    v_mfma_f32_16x16x32_bf16 v[64:67], v[192:195], v[176:179], v[64:67]
    v_mfma_f32_16x16x32_bf16 v[84:87], v[192:195], v[180:183], v[84:87]
    s_waitcnt vmcnt(19)
    v_mfma_f32_16x16x32_bf16 v[28:31], v[196:199], v[168:171], v[28:31]
    v_mfma_f32_16x16x32_bf16 v[48:51], v[196:199], v[172:175], v[48:51]
    v_mfma_f32_16x16x32_bf16 v[68:71], v[196:199], v[176:179], v[68:71]
    v_mfma_f32_16x16x32_bf16 v[88:91], v[196:199], v[180:183], v[88:91]
    s_waitcnt vmcnt(18)
    v_mfma_f32_16x16x32_bf16 v[32:35], v[200:203], v[168:171], v[32:35]
    v_mfma_f32_16x16x32_bf16 v[52:55], v[200:203], v[172:175], v[52:55]
    v_mfma_f32_16x16x32_bf16 v[72:75], v[200:203], v[176:179], v[72:75]
    v_mfma_f32_16x16x32_bf16 v[92:95], v[200:203], v[180:183], v[92:95]
    buffer_load_dwordx4 v[168:171], v10, s[16:19], s44 offen sc1
    buffer_load_dwordx4 v[172:175], v11, s[16:19], s44 offen sc1
    buffer_load_dwordx4 v[176:179], v12, s[16:19], s44 offen sc1
    buffer_load_dwordx4 v[180:183], v13, s[16:19], s44 offen sc1
    s_add_u32 s44, s44, 4096
    buffer_load_dwordx4 v[184:187], v2, s[12:15], s43 offen offset:0 sc1
    buffer_load_dwordx4 v[188:191], v2, s[12:15], s43 offen offset:1024 sc1
    buffer_load_dwordx4 v[192:195], v2, s[12:15], s43 offen offset:2048 sc1
    buffer_load_dwordx4 v[196:199], v2, s[12:15], s43 offen offset:3072 sc1
    s_add_u32 s51, s43, 4096
    buffer_load_dwordx4 v[200:203], v2, s[12:15], s51 offen sc1
    s_add_u32 s43, s43, 5120
    s_waitcnt vmcnt(22)
    v_mfma_f32_16x16x32_bf16 v[16:19], v[112:115], v[96:99], v[16:19]
    v_mfma_f32_16x16x32_bf16 v[36:39], v[112:115], v[100:103], v[36:39]
    v_mfma_f32_16x16x32_bf16 v[56:59], v[112:115], v[104:107], v[56:59]
    v_mfma_f32_16x16x32_bf16 v[76:79], v[112:115], v[108:111], v[76:79]
    s_waitcnt vmcnt(21)
    v_mfma_f32_16x16x32_bf16 v[20:23], v[116:119], v[96:99], v[20:23]
    v_mfma_f32_16x16x32_bf16 v[40:43], v[116:119], v[100:103], v[40:43]
    v_mfma_f32_16x16x32_bf16 v[60:63], v[116:119], v[104:107], v[60:63]
    v_mfma_f32_16x16x32_bf16 v[80:83], v[116:119], v[108:111], v[80:83]
    s_waitcnt vmcnt(20)
    v_mfma_f32_16x16x32_bf16 v[24:27], v[120:123], v[96:99], v[24:27]
    v_mfma_f32_16x16x32_bf16 v[44:47], v[120:123], v[100:103], v[44:47]
    v_mfma_f32_16x16x32_bf16 v[64:67], v[120:123], v[104:107], v[64:67]
    v_mfma_f32_16x16x32_bf16 v[84:87], v[120:123], v[108:111], v[84:87]
    s_waitcnt vmcnt(19)
    v_mfma_f32_16x16x32_bf16 v[28:31], v[124:127], v[96:99], v[28:31]
    v_mfma_f32_16x16x32_bf16 v[48:51], v[124:127], v[100:103], v[48:51]
    v_mfma_f32_16x16x32_bf16 v[68:71], v[124:127], v[104:107], v[68:71]
    v_mfma_f32_16x16x32_bf16 v[88:91], v[124:127], v[108:111], v[88:91]
    s_waitcnt vmcnt(18)
    v_mfma_f32_16x16x32_bf16 v[32:35], v[128:131], v[96:99], v[32:35]
    v_mfma_f32_16x16x32_bf16 v[52:55], v[128:131], v[100:103], v[52:55]
    v_mfma_f32_16x16x32_bf16 v[72:75], v[128:131], v[104:107], v[72:75]
    v_mfma_f32_16x16x32_bf16 v[92:95], v[128:131], v[108:111], v[92:95]
    buffer_load_dwordx4 v[96:99], v10, s[16:19], s44 offen sc1
    buffer_load_dwordx4 v[100:103], v11, s[16:19], s44 offen sc1
    buffer_load_dwordx4 v[104:107], v12, s[16:19], s44 offen sc1
    buffer_load_dwordx4 v[108:111], v13, s[16:19], s44 offen sc1
    s_add_u32 s44, s44, 4096
    buffer_load_dwordx4 v[112:115], v2, s[12:15], s43 offen offset:0 sc1
    buffer_load_dwordx4 v[116:119], v2, s[12:15], s43 offen offset:1024 sc1
    buffer_load_dwordx4 v[120:123], v2, s[12:15], s43 offen offset:2048 sc1
    buffer_load_dwordx4 v[124:127], v2, s[12:15], s43 offen offset:3072 sc1
    s_add_u32 s51, s43, 4096
    buffer_load_dwordx4 v[128:131], v2, s[12:15], s51 offen sc1
    s_add_u32 s43, s43, 5120
    s_waitcnt vmcnt(22)
    v_mfma_f32_16x16x32_bf16 v[16:19], v[148:151], v[132:135], v[16:19]
    v_mfma_f32_16x16x32_bf16 v[36:39], v[148:151], v[136:139], v[36:39]
    v_mfma_f32_16x16x32_bf16 v[56:59], v[148:151], v[140:143], v[56:59]
    v_mfma_f32_16x16x32_bf16 v[76:79], v[148:151], v[144:147], v[76:79]
    s_waitcnt vmcnt(21)
    v_mfma_f32_16x16x32_bf16 v[20:23], v[152:155], v[132:135], v[20:23]
    v_mfma_f32_16x16x32_bf16 v[40:43], v[152:155], v[136:139], v[40:43]
    v_mfma_f32_16x16x32_bf16 v[60:63], v[152:155], v[140:143], v[60:63]
    v_mfma_f32_16x16x32_bf16 v[80:83], v[152:155], v[144:147], v[80:83]
    s_waitcnt vmcnt(20)
    v_mfma_f32_16x16x32_bf16 v[24:27], v[156:159], v[132:135], v[24:27]
    v_mfma_f32_16x16x32_bf16 v[44:47], v[156:159], v[136:139], v[44:47]
    v_mfma_f32_16x16x32_bf16 v[64:67], v[156:159], v[140:143], v[64:67]
    v_mfma_f32_16x16x32_bf16 v[84:87], v[156:159], v[144:147], v[84:87]
    s_waitcnt vmcnt(19)
    v_mfma_f32_16x16x32_bf16 v[28:31], v[160:163], v[132:135], v[28:31]
    v_mfma_f32_16x16x32_bf16 v[48:51], v[160:163], v[136:139], v[48:51]
    v_mfma_f32_16x16x32_bf16 v[68:71], v[160:163], v[140:143], v[68:71]
    v_mfma_f32_16x16x32_bf16 v[88:91], v[160:163], v[144:147], v[88:91]
    s_waitcnt vmcnt(18)
    v_mfma_f32_16x16x32_bf16 v[32:35], v[164:167], v[132:135], v[32:35]
    v_mfma_f32_16x16x32_bf16 v[52:55], v[164:167], v[136:139], v[52:55]
    v_mfma_f32_16x16x32_bf16 v[72:75], v[164:167], v[140:143], v[72:75]
    v_mfma_f32_16x16x32_bf16 v[92:95], v[164:167], v[144:147], v[92:95]
    buffer_load_dwordx4 v[132:135], v10, s[16:19], s44 offen sc1
    buffer_load_dwordx4 v[136:139], v11, s[16:19], s44 offen sc1
    buffer_load_dwordx4 v[140:143], v12, s[16:19], s44 offen sc1
    buffer_load_dwordx4 v[144:147], v13, s[16:19], s44 offen sc1
    s_add_u32 s44, s44, 4096
    buffer_load_dwordx4 v[148:151], v2, s[12:15], s43 offen offset:0 sc1
    buffer_load_dwordx4 v[152:155], v2, s[12:15], s43 offen offset:1024 sc1
    buffer_load_dwordx4 v[156:159], v2, s[12:15], s43 offen offset:2048 sc1
    buffer_load_dwordx4 v[160:163], v2, s[12:15], s43 offen offset:3072 sc1
    s_add_u32 s51, s43, 4096
    buffer_load_dwordx4 v[164:167], v2, s[12:15], s51 offen sc1
    s_add_u32 s43, s43, 5120
    s_waitcnt vmcnt(22)
    v_mfma_f32_16x16x32_bf16 v[16:19], v[184:187], v[168:171], v[16:19]
    v_mfma_f32_16x16x32_bf16 v[36:39], v[184:187], v[172:175], v[36:39]
    v_mfma_f32_16x16x32_bf16 v[56:59], v[184:187], v[176:179], v[56:59]
    v_mfma_f32_16x16x32_bf16 v[76:79], v[184:187], v[180:183], v[76:79]
    s_waitcnt vmcnt(21)
    v_mfma_f32_16x16x32_bf16 v[20:23], v[188:191], v[168:171], v[20:23]
    v_mfma_f32_16x16x32_bf16 v[40:43], v[188:191], v[172:175], v[40:43]
    v_mfma_f32_16x16x32_bf16 v[60:63], v[188:191], v[176:179], v[60:63]
    v_mfma_f32_16x16x32_bf16 v[80:83], v[188:191], v[180:183], v[80:83]
    s_waitcnt vmcnt(20)
    v_mfma_f32_16x16x32_bf16 v[24:27], v[192:195], v[168:171], v[24:27]
    v_mfma_f32_16x16x32_bf16 v[44:47], v[192:195], v[172:175], v[44:47]
    v_mfma_f32_16x16x32_bf16 v[64:67], v[192:195], v[176:179], v[64:67]
    v_mfma_f32_16x16x32_bf16 v[84:87], v[192:195], v[180:183], v[84:87]
    s_waitcnt vmcnt(19)
    v_mfma_f32_16x16x32_bf16 v[28:31], v[196:199], v[168:171], v[28:31]
    v_mfma_f32_16x16x32_bf16 v[48:51], v[196:199], v[172:175], v[48:51]
    v_mfma_f32_16x16x32_bf16 v[68:71], v[196:199], v[176:179], v[68:71]
    v_mfma_f32_16x16x32_bf16 v[88:91], v[196:199], v[180:183], v[88:91]
    s_waitcnt vmcnt(18)
    v_mfma_f32_16x16x32_bf16 v[32:35], v[200:203], v[168:171], v[32:35]
    v_mfma_f32_16x16x32_bf16 v[52:55], v[200:203], v[172:175], v[52:55]
    v_mfma_f32_16x16x32_bf16 v[72:75], v[200:203], v[176:179], v[72:75]
    v_mfma_f32_16x16x32_bf16 v[92:95], v[200:203], v[180:183], v[92:95]
    buffer_load_dwordx4 v[168:171], v10, s[16:19], s44 offen sc1
    buffer_load_dwordx4 v[172:175], v11, s[16:19], s44 offen sc1
    buffer_load_dwordx4 v[176:179], v12, s[16:19], s44 offen sc1
    buffer_load_dwordx4 v[180:183], v13, s[16:19], s44 offen sc1
    s_add_u32 s44, s44, 4096
    buffer_load_dwordx4 v[184:187], v2, s[12:15], s43 offen offset:0 sc1
    buffer_load_dwordx4 v[188:191], v2, s[12:15], s43 offen offset:1024 sc1
    buffer_load_dwordx4 v[192:195], v2, s[12:15], s43 offen offset:2048 sc1
    buffer_load_dwordx4 v[196:199], v2, s[12:15], s43 offen offset:3072 sc1
    s_add_u32 s51, s43, 4096
    buffer_load_dwordx4 v[200:203], v2, s[12:15], s51 offen sc1
    s_add_u32 s43, s43, 5120
    s_waitcnt vmcnt(22)
    v_mfma_f32_16x16x32_bf16 v[16:19], v[112:115], v[96:99], v[16:19]
    v_mfma_f32_16x16x32_bf16 v[36:39], v[112:115], v[100:103], v[36:39]
    v_mfma_f32_16x16x32_bf16 v[56:59], v[112:115], v[104:107], v[56:59]
    v_mfma_f32_16x16x32_bf16 v[76:79], v[112:115], v[108:111], v[76:79]
    s_waitcnt vmcnt(21)
    v_mfma_f32_16x16x32_bf16 v[20:23], v[116:119], v[96:99], v[20:23]
    v_mfma_f32_16x16x32_bf16 v[40:43], v[116:119], v[100:103], v[40:43]
    v_mfma_f32_16x16x32_bf16 v[60:63], v[116:119], v[104:107], v[60:63]
    v_mfma_f32_16x16x32_bf16 v[80:83], v[116:119], v[108:111], v[80:83]
    s_waitcnt vmcnt(20)
    v_mfma_f32_16x16x32_bf16 v[24:27], v[120:123], v[96:99], v[24:27]
    v_mfma_f32_16x16x32_bf16 v[44:47], v[120:123], v[100:103], v[44:47]
    v_mfma_f32_16x16x32_bf16 v[64:67], v[120:123], v[104:107], v[64:67]
    v_mfma_f32_16x16x32_bf16 v[84:87], v[120:123], v[108:111], v[84:87]
    s_waitcnt vmcnt(19)
    v_mfma_f32_16x16x32_bf16 v[28:31], v[124:127], v[96:99], v[28:31]
    v_mfma_f32_16x16x32_bf16 v[48:51], v[124:127], v[100:103], v[48:51]
    v_mfma_f32_16x16x32_bf16 v[68:71], v[124:127], v[104:107], v[68:71]
    v_mfma_f32_16x16x32_bf16 v[88:91], v[124:127], v[108:111], v[88:91]
    s_waitcnt vmcnt(18)
    v_mfma_f32_16x16x32_bf16 v[32:35], v[128:131], v[96:99], v[32:35]
    v_mfma_f32_16x16x32_bf16 v[52:55], v[128:131], v[100:103], v[52:55]
    v_mfma_f32_16x16x32_bf16 v[72:75], v[128:131], v[104:107], v[72:75]
    v_mfma_f32_16x16x32_bf16 v[92:95], v[128:131], v[108:111], v[92:95]
    buffer_load_dwordx4 v[96:99], v10, s[16:19], s44 offen sc1
    buffer_load_dwordx4 v[100:103], v11, s[16:19], s44 offen sc1
    buffer_load_dwordx4 v[104:107], v12, s[16:19], s44 offen sc1
    buffer_load_dwordx4 v[108:111], v13, s[16:19], s44 offen sc1
    s_add_u32 s44, s44, 4096
    buffer_load_dwordx4 v[112:115], v2, s[12:15], s43 offen offset:0 sc1
    buffer_load_dwordx4 v[116:119], v2, s[12:15], s43 offen offset:1024 sc1
    buffer_load_dwordx4 v[120:123], v2, s[12:15], s43 offen offset:2048 sc1
    buffer_load_dwordx4 v[124:127], v2, s[12:15], s43 offen offset:3072 sc1
    s_add_u32 s51, s43, 4096
    buffer_load_dwordx4 v[128:131], v2, s[12:15], s51 offen sc1
    s_add_u32 s43, s43, 5120
    s_waitcnt vmcnt(22)
    v_mfma_f32_16x16x32_bf16 v[16:19], v[148:151], v[132:135], v[16:19]
    v_mfma_f32_16x16x32_bf16 v[36:39], v[148:151], v[136:139], v[36:39]
    v_mfma_f32_16x16x32_bf16 v[56:59], v[148:151], v[140:143], v[56:59]
    v_mfma_f32_16x16x32_bf16 v[76:79], v[148:151], v[144:147], v[76:79]
    s_waitcnt vmcnt(21)
    v_mfma_f32_16x16x32_bf16 v[20:23], v[152:155], v[132:135], v[20:23]
    v_mfma_f32_16x16x32_bf16 v[40:43], v[152:155], v[136:139], v[40:43]
    v_mfma_f32_16x16x32_bf16 v[60:63], v[152:155], v[140:143], v[60:63]
    v_mfma_f32_16x16x32_bf16 v[80:83], v[152:155], v[144:147], v[80:83]
    s_waitcnt vmcnt(20)
    v_mfma_f32_16x16x32_bf16 v[24:27], v[156:159], v[132:135], v[24:27]
    v_mfma_f32_16x16x32_bf16 v[44:47], v[156:159], v[136:139], v[44:47]
    v_mfma_f32_16x16x32_bf16 v[64:67], v[156:159], v[140:143], v[64:67]
    v_mfma_f32_16x16x32_bf16 v[84:87], v[156:159], v[144:147], v[84:87]
    s_waitcnt vmcnt(19)
    v_mfma_f32_16x16x32_bf16 v[28:31], v[160:163], v[132:135], v[28:31]
    v_mfma_f32_16x16x32_bf16 v[48:51], v[160:163], v[136:139], v[48:51]
    v_mfma_f32_16x16x32_bf16 v[68:71], v[160:163], v[140:143], v[68:71]
    v_mfma_f32_16x16x32_bf16 v[88:91], v[160:163], v[144:147], v[88:91]
    s_waitcnt vmcnt(18)
    v_mfma_f32_16x16x32_bf16 v[32:35], v[164:167], v[132:135], v[32:35]
    v_mfma_f32_16x16x32_bf16 v[52:55], v[164:167], v[136:139], v[52:55]
    v_mfma_f32_16x16x32_bf16 v[72:75], v[164:167], v[140:143], v[72:75]
    v_mfma_f32_16x16x32_bf16 v[92:95], v[164:167], v[144:147], v[92:95]
    buffer_load_dwordx4 v[132:135], v10, s[16:19], s44 offen sc1
    buffer_load_dwordx4 v[136:139], v11, s[16:19], s44 offen sc1
    buffer_load_dwordx4 v[140:143], v12, s[16:19], s44 offen sc1
    buffer_load_dwordx4 v[144:147], v13, s[16:19], s44 offen sc1
    s_add_u32 s44, s44, 4096
    buffer_load_dwordx4 v[148:151], v2, s[12:15], s43 offen offset:0 sc1
    buffer_load_dwordx4 v[152:155], v2, s[12:15], s43 offen offset:1024 sc1
    buffer_load_dwordx4 v[156:159], v2, s[12:15], s43 offen offset:2048 sc1
    buffer_load_dwordx4 v[160:163], v2, s[12:15], s43 offen offset:3072 sc1
    s_add_u32 s51, s43, 4096
    buffer_load_dwordx4 v[164:167], v2, s[12:15], s51 offen sc1
    s_add_u32 s43, s43, 5120
    s_waitcnt vmcnt(22)
    v_mfma_f32_16x16x32_bf16 v[16:19], v[184:187], v[168:171], v[16:19]
    v_mfma_f32_16x16x32_bf16 v[36:39], v[184:187], v[172:175], v[36:39]
    v_mfma_f32_16x16x32_bf16 v[56:59], v[184:187], v[176:179], v[56:59]
    v_mfma_f32_16x16x32_bf16 v[76:79], v[184:187], v[180:183], v[76:79]
    s_waitcnt vmcnt(21)
    v_mfma_f32_16x16x32_bf16 v[20:23], v[188:191], v[168:171], v[20:23]
    v_mfma_f32_16x16x32_bf16 v[40:43], v[188:191], v[172:175], v[40:43]
    v_mfma_f32_16x16x32_bf16 v[60:63], v[188:191], v[176:179], v[60:63]
    v_mfma_f32_16x16x32_bf16 v[80:83], v[188:191], v[180:183], v[80:83]
    s_waitcnt vmcnt(20)
    v_mfma_f32_16x16x32_bf16 v[24:27], v[192:195], v[168:171], v[24:27]
    v_mfma_f32_16x16x32_bf16 v[44:47], v[192:195], v[172:175], v[44:47]
    v_mfma_f32_16x16x32_bf16 v[64:67], v[192:195], v[176:179], v[64:67]
    v_mfma_f32_16x16x32_bf16 v[84:87], v[192:195], v[180:183], v[84:87]
    s_waitcnt vmcnt(19)
    v_mfma_f32_16x16x32_bf16 v[28:31], v[196:199], v[168:171], v[28:31]
    v_mfma_f32_16x16x32_bf16 v[48:51], v[196:199], v[172:175], v[48:51]
    v_mfma_f32_16x16x32_bf16 v[68:71], v[196:199], v[176:179], v[68:71]
    v_mfma_f32_16x16x32_bf16 v[88:91], v[196:199], v[180:183], v[88:91]
    s_waitcnt vmcnt(18)
    v_mfma_f32_16x16x32_bf16 v[32:35], v[200:203], v[168:171], v[32:35]
    v_mfma_f32_16x16x32_bf16 v[52:55], v[200:203], v[172:175], v[52:55]
    v_mfma_f32_16x16x32_bf16 v[72:75], v[200:203], v[176:179], v[72:75]
    v_mfma_f32_16x16x32_bf16 v[92:95], v[200:203], v[180:183], v[92:95]
    buffer_load_dwordx4 v[168:171], v10, s[16:19], s44 offen sc1
    buffer_load_dwordx4 v[172:175], v11, s[16:19], s44 offen sc1
    buffer_load_dwordx4 v[176:179], v12, s[16:19], s44 offen sc1
    buffer_load_dwordx4 v[180:183], v13, s[16:19], s44 offen sc1
    s_add_u32 s44, s44, 4096
    buffer_load_dwordx4 v[184:187], v2, s[12:15], s43 offen offset:0 sc1
    buffer_load_dwordx4 v[188:191], v2, s[12:15], s43 offen offset:1024 sc1
    buffer_load_dwordx4 v[192:195], v2, s[12:15], s43 offen offset:2048 sc1
    buffer_load_dwordx4 v[196:199], v2, s[12:15], s43 offen offset:3072 sc1
    s_add_u32 s51, s43, 4096
    buffer_load_dwordx4 v[200:203], v2, s[12:15], s51 offen sc1
    s_add_u32 s43, s43, 5120
    s_waitcnt vmcnt(22)
    v_mfma_f32_16x16x32_bf16 v[16:19], v[112:115], v[96:99], v[16:19]
    v_mfma_f32_16x16x32_bf16 v[36:39], v[112:115], v[100:103], v[36:39]
    v_mfma_f32_16x16x32_bf16 v[56:59], v[112:115], v[104:107], v[56:59]
    v_mfma_f32_16x16x32_bf16 v[76:79], v[112:115], v[108:111], v[76:79]
    s_waitcnt vmcnt(21)
    v_mfma_f32_16x16x32_bf16 v[20:23], v[116:119], v[96:99], v[20:23]
    v_mfma_f32_16x16x32_bf16 v[40:43], v[116:119], v[100:103], v[40:43]
    v_mfma_f32_16x16x32_bf16 v[60:63], v[116:119], v[104:107], v[60:63]
    v_mfma_f32_16x16x32_bf16 v[80:83], v[116:119], v[108:111], v[80:83]
    s_waitcnt vmcnt(20)
    v_mfma_f32_16x16x32_bf16 v[24:27], v[120:123], v[96:99], v[24:27]
    v_mfma_f32_16x16x32_bf16 v[44:47], v[120:123], v[100:103], v[44:47]
    v_mfma_f32_16x16x32_bf16 v[64:67], v[120:123], v[104:107], v[64:67]
    v_mfma_f32_16x16x32_bf16 v[84:87], v[120:123], v[108:111], v[84:87]
    s_waitcnt vmcnt(19)
    v_mfma_f32_16x16x32_bf16 v[28:31], v[124:127], v[96:99], v[28:31]
    v_mfma_f32_16x16x32_bf16 v[48:51], v[124:127], v[100:103], v[48:51]
    v_mfma_f32_16x16x32_bf16 v[68:71], v[124:127], v[104:107], v[68:71]
    v_mfma_f32_16x16x32_bf16 v[88:91], v[124:127], v[108:111], v[88:91]
    s_waitcnt vmcnt(18)
    v_mfma_f32_16x16x32_bf16 v[32:35], v[128:131], v[96:99], v[32:35]
    v_mfma_f32_16x16x32_bf16 v[52:55], v[128:131], v[100:103], v[52:55]
    v_mfma_f32_16x16x32_bf16 v[72:75], v[128:131], v[104:107], v[72:75]
    v_mfma_f32_16x16x32_bf16 v[92:95], v[128:131], v[108:111], v[92:95]
    buffer_load_dwordx4 v[96:99], v10, s[16:19], s44 offen sc1
    buffer_load_dwordx4 v[100:103], v11, s[16:19], s44 offen sc1
    buffer_load_dwordx4 v[104:107], v12, s[16:19], s44 offen sc1
    buffer_load_dwordx4 v[108:111], v13, s[16:19], s44 offen sc1
    s_add_u32 s44, s44, 4096
    buffer_load_dwordx4 v[112:115], v2, s[12:15], s43 offen offset:0 sc1
    buffer_load_dwordx4 v[116:119], v2, s[12:15], s43 offen offset:1024 sc1
    buffer_load_dwordx4 v[120:123], v2, s[12:15], s43 offen offset:2048 sc1
    buffer_load_dwordx4 v[124:127], v2, s[12:15], s43 offen offset:3072 sc1
    s_add_u32 s51, s43, 4096
    buffer_load_dwordx4 v[128:131], v2, s[12:15], s51 offen sc1
    s_add_u32 s43, s43, 5120
    s_waitcnt vmcnt(22)
    v_mfma_f32_16x16x32_bf16 v[16:19], v[148:151], v[132:135], v[16:19]
    v_mfma_f32_16x16x32_bf16 v[36:39], v[148:151], v[136:139], v[36:39]
    v_mfma_f32_16x16x32_bf16 v[56:59], v[148:151], v[140:143], v[56:59]
    v_mfma_f32_16x16x32_bf16 v[76:79], v[148:151], v[144:147], v[76:79]
    s_waitcnt vmcnt(21)
    v_mfma_f32_16x16x32_bf16 v[20:23], v[152:155], v[132:135], v[20:23]
    v_mfma_f32_16x16x32_bf16 v[40:43], v[152:155], v[136:139], v[40:43]
    v_mfma_f32_16x16x32_bf16 v[60:63], v[152:155], v[140:143], v[60:63]
    v_mfma_f32_16x16x32_bf16 v[80:83], v[152:155], v[144:147], v[80:83]
    s_waitcnt vmcnt(20)
    v_mfma_f32_16x16x32_bf16 v[24:27], v[156:159], v[132:135], v[24:27]
    v_mfma_f32_16x16x32_bf16 v[44:47], v[156:159], v[136:139], v[44:47]
    v_mfma_f32_16x16x32_bf16 v[64:67], v[156:159], v[140:143], v[64:67]
    v_mfma_f32_16x16x32_bf16 v[84:87], v[156:159], v[144:147], v[84:87]
    s_waitcnt vmcnt(19)
    v_mfma_f32_16x16x32_bf16 v[28:31], v[160:163], v[132:135], v[28:31]
    v_mfma_f32_16x16x32_bf16 v[48:51], v[160:163], v[136:139], v[48:51]
    v_mfma_f32_16x16x32_bf16 v[68:71], v[160:163], v[140:143], v[68:71]
    v_mfma_f32_16x16x32_bf16 v[88:91], v[160:163], v[144:147], v[88:91]
    s_waitcnt vmcnt(18)
    v_mfma_f32_16x16x32_bf16 v[32:35], v[164:167], v[132:135], v[32:35]
    v_mfma_f32_16x16x32_bf16 v[52:55], v[164:167], v[136:139], v[52:55]
    v_mfma_f32_16x16x32_bf16 v[72:75], v[164:167], v[140:143], v[72:75]
    v_mfma_f32_16x16x32_bf16 v[92:95], v[164:167], v[144:147], v[92:95]
    buffer_load_dwordx4 v[132:135], v10, s[16:19], s44 offen sc1
    buffer_load_dwordx4 v[136:139], v11, s[16:19], s44 offen sc1
    buffer_load_dwordx4 v[140:143], v12, s[16:19], s44 offen sc1
    buffer_load_dwordx4 v[144:147], v13, s[16:19], s44 offen sc1
    s_add_u32 s44, s44, 4096
    buffer_load_dwordx4 v[148:151], v2, s[12:15], s43 offen offset:0 sc1
    buffer_load_dwordx4 v[152:155], v2, s[12:15], s43 offen offset:1024 sc1
    buffer_load_dwordx4 v[156:159], v2, s[12:15], s43 offen offset:2048 sc1
    buffer_load_dwordx4 v[160:163], v2, s[12:15], s43 offen offset:3072 sc1
    s_add_u32 s51, s43, 4096
    buffer_load_dwordx4 v[164:167], v2, s[12:15], s51 offen sc1
    s_add_u32 s43, s43, 5120
    buffer_load_dwordx4 v[204:207], v9, s[20:23], s66 offen offset:0 sc1
    buffer_load_dwordx4 v[208:211], v9, s[20:23], s66 offen offset:64 sc1
    buffer_load_dwordx4 v[212:215], v9, s[20:23], s66 offen offset:128 sc1
    buffer_load_dwordx4 v[216:219], v9, s[20:23], s66 offen offset:192 sc1
    buffer_load_dwordx4 v[220:223], v9, s[20:23], s66 offen offset:256 sc1
    buffer_load_dwordx4 v[224:227], v9, s[20:23], s67 offen offset:0 sc1
    buffer_load_dwordx4 v[228:231], v9, s[20:23], s67 offen offset:64 sc1
    buffer_load_dwordx4 v[232:235], v9, s[20:23], s67 offen offset:128 sc1
    buffer_load_dwordx4 v[236:239], v9, s[20:23], s67 offen offset:192 sc1
    buffer_load_dwordx4 v[240:243], v9, s[20:23], s67 offen offset:256 sc1
    buffer_load_dwordx2 v[244:245], v8, s[24:27], s60 offen offset:0
    buffer_load_dwordx2 v[246:247], v8, s[24:27], s60 offen offset:32
    buffer_load_dwordx2 v[248:249], v8, s[24:27], s60 offen offset:64
    buffer_load_dwordx2 v[250:251], v8, s[24:27], s60 offen offset:96
    buffer_load_dwordx2 v[252:253], v8, s[24:27], s60 offen offset:128
    buffer_load_dword v4, v255, s[28:31], 0 offen sc1
    s_waitcnt vmcnt(38)
    v_mfma_f32_16x16x32_bf16 v[16:19], v[184:187], v[168:171], v[16:19]
    v_mfma_f32_16x16x32_bf16 v[36:39], v[184:187], v[172:175], v[36:39]
    v_mfma_f32_16x16x32_bf16 v[56:59], v[184:187], v[176:179], v[56:59]
    v_mfma_f32_16x16x32_bf16 v[76:79], v[184:187], v[180:183], v[76:79]
    s_waitcnt vmcnt(37)
    v_mfma_f32_16x16x32_bf16 v[20:23], v[188:191], v[168:171], v[20:23]
    v_mfma_f32_16x16x32_bf16 v[40:43], v[188:191], v[172:175], v[40:43]
    v_mfma_f32_16x16x32_bf16 v[60:63], v[188:191], v[176:179], v[60:63]
    v_mfma_f32_16x16x32_bf16 v[80:83], v[188:191], v[180:183], v[80:83]
    s_waitcnt vmcnt(36)
    v_mfma_f32_16x16x32_bf16 v[24:27], v[192:195], v[168:171], v[24:27]
    v_mfma_f32_16x16x32_bf16 v[44:47], v[192:195], v[172:175], v[44:47]
    v_mfma_f32_16x16x32_bf16 v[64:67], v[192:195], v[176:179], v[64:67]
    v_mfma_f32_16x16x32_bf16 v[84:87], v[192:195], v[180:183], v[84:87]
    s_waitcnt vmcnt(35)
    v_mfma_f32_16x16x32_bf16 v[28:31], v[196:199], v[168:171], v[28:31]
    v_mfma_f32_16x16x32_bf16 v[48:51], v[196:199], v[172:175], v[48:51]
    v_mfma_f32_16x16x32_bf16 v[68:71], v[196:199], v[176:179], v[68:71]
    v_mfma_f32_16x16x32_bf16 v[88:91], v[196:199], v[180:183], v[88:91]
    s_waitcnt vmcnt(34)
    v_mfma_f32_16x16x32_bf16 v[32:35], v[200:203], v[168:171], v[32:35]
    v_mfma_f32_16x16x32_bf16 v[52:55], v[200:203], v[172:175], v[52:55]
    v_mfma_f32_16x16x32_bf16 v[72:75], v[200:203], v[176:179], v[72:75]
    v_mfma_f32_16x16x32_bf16 v[92:95], v[200:203], v[180:183], v[92:95]
    s_waitcnt vmcnt(29)
    v_mfma_f32_16x16x32_bf16 v[16:19], v[112:115], v[96:99], v[16:19]
    v_mfma_f32_16x16x32_bf16 v[36:39], v[112:115], v[100:103], v[36:39]
    v_mfma_f32_16x16x32_bf16 v[56:59], v[112:115], v[104:107], v[56:59]
    v_mfma_f32_16x16x32_bf16 v[76:79], v[112:115], v[108:111], v[76:79]
    s_waitcnt vmcnt(28)
    v_mfma_f32_16x16x32_bf16 v[20:23], v[116:119], v[96:99], v[20:23]
    v_mfma_f32_16x16x32_bf16 v[40:43], v[116:119], v[100:103], v[40:43]
    v_mfma_f32_16x16x32_bf16 v[60:63], v[116:119], v[104:107], v[60:63]
    v_mfma_f32_16x16x32_bf16 v[80:83], v[116:119], v[108:111], v[80:83]
    s_waitcnt vmcnt(27)
    v_mfma_f32_16x16x32_bf16 v[24:27], v[120:123], v[96:99], v[24:27]
    v_mfma_f32_16x16x32_bf16 v[44:47], v[120:123], v[100:103], v[44:47]
    v_mfma_f32_16x16x32_bf16 v[64:67], v[120:123], v[104:107], v[64:67]
    v_mfma_f32_16x16x32_bf16 v[84:87], v[120:123], v[108:111], v[84:87]
    s_waitcnt vmcnt(26)
    v_mfma_f32_16x16x32_bf16 v[28:31], v[124:127], v[96:99], v[28:31]
    v_mfma_f32_16x16x32_bf16 v[48:51], v[124:127], v[100:103], v[48:51]
    v_mfma_f32_16x16x32_bf16 v[68:71], v[124:127], v[104:107], v[68:71]
    v_mfma_f32_16x16x32_bf16 v[88:91], v[124:127], v[108:111], v[88:91]
    s_waitcnt vmcnt(25)
    v_mfma_f32_16x16x32_bf16 v[32:35], v[128:131], v[96:99], v[32:35]
    v_mfma_f32_16x16x32_bf16 v[52:55], v[128:131], v[100:103], v[52:55]
    v_mfma_f32_16x16x32_bf16 v[72:75], v[128:131], v[104:107], v[72:75]
    v_mfma_f32_16x16x32_bf16 v[92:95], v[128:131], v[108:111], v[92:95]
    s_waitcnt vmcnt(20)
    v_mfma_f32_16x16x32_bf16 v[36:39], v[148:151], v[136:139], v[36:39]
    s_waitcnt vmcnt(19)
    v_mfma_f32_16x16x32_bf16 v[40:43], v[152:155], v[136:139], v[40:43]
    s_waitcnt vmcnt(18)
    v_mfma_f32_16x16x32_bf16 v[44:47], v[156:159], v[136:139], v[44:47]
    s_waitcnt vmcnt(17)
    v_mfma_f32_16x16x32_bf16 v[48:51], v[160:163], v[136:139], v[48:51]
    s_waitcnt vmcnt(16)
    v_mfma_f32_16x16x32_bf16 v[52:55], v[164:167], v[136:139], v[52:55]
    v_mfma_f32_16x16x32_bf16 v[56:59], v[148:151], v[140:143], v[56:59]
    v_mfma_f32_16x16x32_bf16 v[60:63], v[152:155], v[140:143], v[60:63]
    v_mfma_f32_16x16x32_bf16 v[64:67], v[156:159], v[140:143], v[64:67]
    ds_write_b128 v14, v[36:39] offset:10240
    v_mfma_f32_16x16x32_bf16 v[68:71], v[160:163], v[140:143], v[68:71]
    ds_write_b128 v14, v[40:43] offset:11264
    v_mfma_f32_16x16x32_bf16 v[72:75], v[164:167], v[140:143], v[72:75]
    ds_write_b128 v14, v[44:47] offset:12288
    v_mfma_f32_16x16x32_bf16 v[76:79], v[148:151], v[144:147], v[76:79]
    ds_write_b128 v14, v[48:51] offset:13312
    v_mfma_f32_16x16x32_bf16 v[80:83], v[152:155], v[144:147], v[80:83]
    ds_write_b128 v14, v[52:55] offset:14336
    v_mfma_f32_16x16x32_bf16 v[84:87], v[156:159], v[144:147], v[84:87]
    ds_write_b128 v15, v[56:59] offset:5120
    v_mfma_f32_16x16x32_bf16 v[88:91], v[160:163], v[144:147], v[88:91]
    ds_write_b128 v15, v[60:63] offset:6144
    v_mfma_f32_16x16x32_bf16 v[92:95], v[164:167], v[144:147], v[92:95]
    ds_write_b128 v15, v[64:67] offset:7168
    v_mfma_f32_16x16x32_bf16 v[16:19], v[148:151], v[132:135], v[16:19]
    ds_write_b128 v15, v[68:71] offset:8192
    v_mfma_f32_16x16x32_bf16 v[20:23], v[152:155], v[132:135], v[20:23]
    ds_write_b128 v15, v[72:75] offset:9216
    v_mfma_f32_16x16x32_bf16 v[24:27], v[156:159], v[132:135], v[24:27]
    ds_write_b128 v3, v[76:79] offset:0
    v_mfma_f32_16x16x32_bf16 v[28:31], v[160:163], v[132:135], v[28:31]
    ds_write_b128 v3, v[80:83] offset:1024
    v_mfma_f32_16x16x32_bf16 v[32:35], v[164:167], v[132:135], v[32:35]
    ds_write_b128 v3, v[84:87] offset:2048
    ds_write_b128 v3, v[88:91] offset:3072
    ds_write_b128 v3, v[92:95] offset:4096
    s_waitcnt vmcnt(0) lgkmcnt(0)
    s_barrier
    ds_read_b128 v[96:99], v6 offset:0
    ds_read_b128 v[100:103], v6 offset:1024
    ds_read_b128 v[104:107], v6 offset:2048
    ds_read_b128 v[108:111], v6 offset:3072
    ds_read_b128 v[112:115], v6 offset:4096
    ds_read_b128 v[116:119], v6 offset:5120
    ds_read_b128 v[120:123], v6 offset:6144
    ds_read_b128 v[124:127], v6 offset:7168
    ds_read_b128 v[128:131], v6 offset:8192
    ds_read_b128 v[132:135], v6 offset:9216
    ds_read_b128 v[136:139], v6 offset:10240
    ds_read_b128 v[140:143], v6 offset:11264
    ds_read_b128 v[144:147], v6 offset:12288
    ds_read_b128 v[148:151], v6 offset:13312
    ds_read_b128 v[152:155], v6 offset:14336
    v_lshlrev_b32 v36, 16, v244
    v_and_b32 v37, 0xffff0000, v244
    v_lshlrev_b32 v38, 16, v245
    v_and_b32 v39, 0xffff0000, v245
    v_lshlrev_b32 v40, 16, v246
    v_and_b32 v41, 0xffff0000, v246
    v_lshlrev_b32 v42, 16, v247
    v_and_b32 v43, 0xffff0000, v247
    v_lshlrev_b32 v44, 16, v248
    v_and_b32 v45, 0xffff0000, v248
    v_lshlrev_b32 v46, 16, v249
    v_and_b32 v47, 0xffff0000, v249
    v_lshlrev_b32 v48, 16, v250
    v_and_b32 v49, 0xffff0000, v250
    v_lshlrev_b32 v50, 16, v251
    v_and_b32 v51, 0xffff0000, v251
    v_lshlrev_b32 v52, 16, v252
    v_and_b32 v53, 0xffff0000, v252
    v_lshlrev_b32 v54, 16, v253
    v_and_b32 v55, 0xffff0000, v253
    s_waitcnt lgkmcnt(14)
    v_pk_add_f32 v[16:17], v[16:17], v[96:97]
    v_pk_add_f32 v[18:19], v[18:19], v[98:99]
    s_waitcnt lgkmcnt(13)
    v_pk_add_f32 v[20:21], v[20:21], v[100:101]
    v_pk_add_f32 v[22:23], v[22:23], v[102:103]
    s_waitcnt lgkmcnt(12)
    v_pk_add_f32 v[24:25], v[24:25], v[104:105]
    v_pk_add_f32 v[26:27], v[26:27], v[106:107]
    s_waitcnt lgkmcnt(11)
    v_pk_add_f32 v[28:29], v[28:29], v[108:109]
    v_pk_add_f32 v[30:31], v[30:31], v[110:111]
    s_waitcnt lgkmcnt(10)
    v_pk_add_f32 v[32:33], v[32:33], v[112:113]
    v_pk_add_f32 v[34:35], v[34:35], v[114:115]
    s_waitcnt lgkmcnt(4)
    v_pk_add_f32 v[116:117], v[116:117], v[136:137]
    v_pk_add_f32 v[118:119], v[118:119], v[138:139]
    s_waitcnt lgkmcnt(3)
    v_pk_add_f32 v[120:121], v[120:121], v[140:141]
    v_pk_add_f32 v[122:123], v[122:123], v[142:143]
    s_waitcnt lgkmcnt(2)
    v_pk_add_f32 v[124:125], v[124:125], v[144:145]
    v_pk_add_f32 v[126:127], v[126:127], v[146:147]
    s_waitcnt lgkmcnt(1)
    v_pk_add_f32 v[128:129], v[128:129], v[148:149]
    v_pk_add_f32 v[130:131], v[130:131], v[150:151]
    s_waitcnt lgkmcnt(0)
    v_pk_add_f32 v[132:133], v[132:133], v[152:153]
    v_pk_add_f32 v[134:135], v[134:135], v[154:155]
    v_pk_add_f32 v[16:17], v[16:17], v[116:117]
    v_pk_add_f32 v[18:19], v[18:19], v[118:119]
    v_pk_add_f32 v[20:21], v[20:21], v[120:121]
    v_pk_add_f32 v[22:23], v[22:23], v[122:123]
    v_pk_add_f32 v[24:25], v[24:25], v[124:125]
    v_pk_add_f32 v[26:27], v[26:27], v[126:127]
    v_pk_add_f32 v[28:29], v[28:29], v[128:129]
    v_pk_add_f32 v[30:31], v[30:31], v[130:131]
    v_pk_add_f32 v[32:33], v[32:33], v[132:133]
    v_pk_add_f32 v[34:35], v[34:35], v[134:135]
    v_pk_fma_f32 v[16:17], v[16:17], v[204:205], v[36:37]
    v_pk_fma_f32 v[18:19], v[18:19], v[206:207], v[38:39]
    v_pk_fma_f32 v[20:21], v[20:21], v[208:209], v[40:41]
    v_pk_fma_f32 v[22:23], v[22:23], v[210:211], v[42:43]
    v_pk_fma_f32 v[24:25], v[24:25], v[212:213], v[44:45]
    v_pk_fma_f32 v[26:27], v[26:27], v[214:215], v[46:47]
    v_pk_fma_f32 v[28:29], v[28:29], v[216:217], v[48:49]
    v_pk_fma_f32 v[30:31], v[30:31], v[218:219], v[50:51]
    v_pk_fma_f32 v[32:33], v[32:33], v[220:221], v[52:53]
    v_pk_fma_f32 v[34:35], v[34:35], v[222:223], v[54:55]
    ds_write_b128 v254, v[16:19] offset:0
    ds_write_b128 v254, v[20:23] offset:1024
    ds_write_b128 v254, v[24:27] offset:2048
    ds_write_b128 v254, v[28:31] offset:3072
    ds_write_b128 v254, v[32:35] offset:4096
    v_mov_b32 v5, v4
    v_pk_add_f32 v[96:97], v[16:17], v[4:5]
    v_pk_add_f32 v[98:99], v[18:19], v[4:5]
    v_pk_add_f32 v[100:101], v[20:21], v[4:5]
    v_pk_add_f32 v[102:103], v[22:23], v[4:5]
    v_pk_add_f32 v[104:105], v[24:25], v[4:5]
    v_pk_add_f32 v[106:107], v[26:27], v[4:5]
    v_pk_add_f32 v[108:109], v[28:29], v[4:5]
    v_pk_add_f32 v[110:111], v[30:31], v[4:5]
    v_pk_add_f32 v[112:113], v[32:33], v[4:5]
    v_pk_add_f32 v[114:115], v[34:35], v[4:5]
    v_pk_mul_f32 v[116:117], v[96:97], v[224:225]
    v_pk_mul_f32 v[118:119], v[98:99], v[226:227]
    v_cvt_pk_bf16_f32 v136, v116, v117
    v_cvt_pk_bf16_f32 v137, v118, v119
    v_pk_mul_f32 v[120:121], v[100:101], v[228:229]
    v_pk_mul_f32 v[122:123], v[102:103], v[230:231]
    v_cvt_pk_bf16_f32 v138, v120, v121
    v_cvt_pk_bf16_f32 v139, v122, v123
    v_pk_mul_f32 v[124:125], v[104:105], v[232:233]
    v_pk_mul_f32 v[126:127], v[106:107], v[234:235]
    v_cvt_pk_bf16_f32 v140, v124, v125
    v_cvt_pk_bf16_f32 v141, v126, v127
    v_pk_mul_f32 v[128:129], v[108:109], v[236:237]
    v_pk_mul_f32 v[130:131], v[110:111], v[238:239]
    v_cvt_pk_bf16_f32 v142, v128, v129
    v_cvt_pk_bf16_f32 v143, v130, v131
    v_pk_mul_f32 v[132:133], v[112:113], v[240:241]
    v_pk_mul_f32 v[134:135], v[114:115], v[242:243]
    v_cvt_pk_bf16_f32 v144, v132, v133
    v_cvt_pk_bf16_f32 v145, v134, v135
    s_mul_i32 s46, s42, 5
    s_lshr_b32 s47, s46, 1
    s_lshl_b32 s47, s47, 10
    s_add_u32 s47, s47, s63
    s_bitcmp1_b32 s42, 0
    s_cbranch_scc1 L_adaLN_cond__sliding_block_cached__swiglu_ffn__prompt_kernel_40
    buffer_store_dwordx4 v[136:139], v2, s[32:35], s47 offen sc1
    buffer_store_dwordx4 v[140:143], v2, s[32:35], s47 offen offset:1024 sc1
    buffer_store_dwordx2 v[144:145], v2, s[32:35], s47 offen offset:2048 sc1
    s_branch L_adaLN_cond__sliding_block_cached__swiglu_ffn__prompt_kernel_41
L_adaLN_cond__sliding_block_cached__swiglu_ffn__prompt_kernel_40:
    buffer_store_dwordx2 v[136:137], v2, s[32:35], s47 offen offset:8 sc1
    buffer_store_dwordx4 v[138:141], v2, s[32:35], s47 offen offset:1024 sc1
    buffer_store_dwordx4 v[142:145], v2, s[32:35], s47 offen offset:2048 sc1
L_adaLN_cond__sliding_block_cached__swiglu_ffn__prompt_kernel_41:
    v_pk_add_f32 v[12:13], v[96:97], v[98:99]
    v_pk_add_f32 v[12:13], v[12:13], v[100:101]
    v_pk_add_f32 v[12:13], v[12:13], v[102:103]
    v_pk_add_f32 v[12:13], v[12:13], v[104:105]
    v_pk_add_f32 v[12:13], v[12:13], v[106:107]
    v_pk_add_f32 v[12:13], v[12:13], v[108:109]
    v_pk_add_f32 v[12:13], v[12:13], v[110:111]
    v_pk_add_f32 v[12:13], v[12:13], v[112:113]
    v_pk_add_f32 v[12:13], v[12:13], v[114:115]
    v_add_f32 v12, v12, v13
    v_mov_b32 v13, v12
    s_nop 1
    v_permlane16_swap_b32 v12, v13
    v_add_f32 v12, v12, v13
    v_mov_b32 v13, v12
    s_nop 1
    v_permlane32_swap_b32 v12, v13
    v_add_f32 v12, v12, v13
    v_mul_f32 v12, 0x3c4ccccd, v12
    v_sub_f32 v14, 0, v12
    v_sub_f32 v15, 0, v12
    v_pk_add_f32 v[116:117], v[96:97], v[14:15]
    v_pk_add_f32 v[118:119], v[98:99], v[14:15]
    v_pk_add_f32 v[120:121], v[100:101], v[14:15]
    v_pk_add_f32 v[122:123], v[102:103], v[14:15]
    v_pk_add_f32 v[124:125], v[104:105], v[14:15]
    v_pk_add_f32 v[126:127], v[106:107], v[14:15]
    v_pk_add_f32 v[128:129], v[108:109], v[14:15]
    v_pk_add_f32 v[130:131], v[110:111], v[14:15]
    v_pk_add_f32 v[132:133], v[112:113], v[14:15]
    v_pk_add_f32 v[134:135], v[114:115], v[14:15]
    v_pk_mul_f32 v[14:15], v[116:117], v[116:117]
    v_pk_fma_f32 v[14:15], v[118:119], v[118:119], v[14:15]
    v_pk_fma_f32 v[14:15], v[120:121], v[120:121], v[14:15]
    v_pk_fma_f32 v[14:15], v[122:123], v[122:123], v[14:15]
    v_pk_fma_f32 v[14:15], v[124:125], v[124:125], v[14:15]
    v_pk_fma_f32 v[14:15], v[126:127], v[126:127], v[14:15]
    v_pk_fma_f32 v[14:15], v[128:129], v[128:129], v[14:15]
    v_pk_fma_f32 v[14:15], v[130:131], v[130:131], v[14:15]
    v_pk_fma_f32 v[14:15], v[132:133], v[132:133], v[14:15]
    v_pk_fma_f32 v[14:15], v[134:135], v[134:135], v[14:15]
    v_add_f32 v13, v14, v15
    v_mov_b32 v14, v13
    s_nop 1
    v_permlane16_swap_b32 v13, v14
    v_add_f32 v13, v13, v14
    v_mov_b32 v14, v13
    s_nop 1
    v_permlane32_swap_b32 v13, v14
    v_add_f32 v13, v13, v14
    s_mov_b64 exec, 0xffff
    buffer_store_dwordx2 v[12:13], v7, s[36:39], s65 offen sc1
    s_mov_b64 exec, -1
    s_waitcnt vmcnt(0) lgkmcnt(0)
    s_branch L_adaLN_cond__sliding_block_cached__swiglu_ffn__prompt_kernel_34
L_adaLN_cond__sliding_block_cached__swiglu_ffn__prompt_kernel_33:
    s_waitcnt lgkmcnt(0)
    s_load_dwordx4 s[8:11], s[0:1], 48
    s_and_b32 s12, s2, 7
    s_mul_i32 s12, s12, 27
    s_lshr_b32 s13, s2, 3
    s_add_u32 s12, s12, s13
    s_lshr_b32 s12, s12, 3
    s_lshl_b32 s12, s12, 7
    v_lshrrev_b32 v4, 3, v1
    v_lshrrev_b32 v5, 4, v1
    v_lshlrev_b32 v5, 1, v5
    v_and_b32 v6, 7, v1
    v_xor_b32 v6, v6, v5
    s_lshl_b32 s13, s93, 3
    v_add_u32 v4, s13, v4
    v_mul_u32_u24 v4, 3456, v4
    v_lshl_add_u32 v6, v6, 4, v4
    v_subrev_u32 v7, 110592, v6
    s_lshl_b32 s13, s93, 10
    s_waitcnt lgkmcnt(0)
    s_mov_b32 s16, s8
    s_mov_b32 s17, s9
    s_mov_b32 s18, 0x21c000
    s_mov_b32 s19, 0x20000
    s_mov_b32 s20, s10
    s_mov_b32 s21, s11
    s_mov_b32 s22, 0x21c000
    s_mov_b32 s23, 0x20000
    s_barrier
    s_cmp_ge_u32 s2, 216
    s_cbranch_scc1 L_adaLN_cond__sliding_block_cached__swiglu_ffn__prompt_kernel_42
    s_add_u32 s14, s12, 0x0
    s_add_u32 m0, s13, 0x10000
    s_nop 0
    buffer_load_dwordx4 v6, s[16:19], s14 offen lds
    s_add_u32 m0, s13, 0xf000
    s_nop 0
    buffer_load_dwordx4 v7, s[16:19], s14 offen lds
    s_add_u32 m0, s13, 0x12000
    s_nop 0
    buffer_load_dwordx4 v6, s[20:23], s14 offen lds
    s_add_u32 m0, s13, 0x11000
    s_nop 0
    buffer_load_dwordx4 v7, s[20:23], s14 offen lds
    s_add_u32 s14, s12, 0x36000
    s_add_u32 m0, s13, 0x14000
    s_nop 0
    buffer_load_dwordx4 v6, s[16:19], s14 offen lds
    s_add_u32 m0, s13, 0x13000
    s_nop 0
    buffer_load_dwordx4 v7, s[16:19], s14 offen lds
    s_add_u32 m0, s13, 0x16000
    s_nop 0
    buffer_load_dwordx4 v6, s[20:23], s14 offen lds
    s_add_u32 m0, s13, 0x15000
    s_nop 0
    buffer_load_dwordx4 v7, s[20:23], s14 offen lds
    s_add_u32 s14, s12, 0x6c000
    s_add_u32 m0, s13, 0x18000
    s_nop 0
    buffer_load_dwordx4 v6, s[16:19], s14 offen lds
    s_add_u32 m0, s13, 0x17000
    s_nop 0
    buffer_load_dwordx4 v7, s[16:19], s14 offen lds
    s_add_u32 m0, s13, 0x1a000
    s_nop 0
    buffer_load_dwordx4 v6, s[20:23], s14 offen lds
    s_add_u32 m0, s13, 0x19000
    s_nop 0
    buffer_load_dwordx4 v7, s[20:23], s14 offen lds
    s_add_u32 s14, s12, 0xa2000
    s_add_u32 m0, s13, 0x1c000
    s_nop 0
    buffer_load_dwordx4 v6, s[16:19], s14 offen lds
    s_add_u32 m0, s13, 0x1b000
    s_nop 0
    buffer_load_dwordx4 v7, s[16:19], s14 offen lds
    s_add_u32 m0, s13, 0x1e000
    s_nop 0
    buffer_load_dwordx4 v6, s[20:23], s14 offen lds
    s_add_u32 m0, s13, 0x1d000
    s_nop 0
    buffer_load_dwordx4 v7, s[20:23], s14 offen lds
L_adaLN_cond__sliding_block_cached__swiglu_ffn__prompt_kernel_42:
L_adaLN_cond__sliding_block_cached__swiglu_ffn__prompt_kernel_34:
    s_lshr_b32 s50, s41, 2
    s_lshr_b32 s52, s2, 3
    s_lshl_b32 s92, s50, 6
    s_add_u32 s92, s92, s52
    s_lshl_b32 s92, s92, 7
    s_add_u32 s92, s92, 0x30000
    s_barrier
    s_cmp_lg_u32 s93, 0
    s_cbranch_scc1 L_adaLN_cond__sliding_block_cached__swiglu_ffn__prompt_kernel_43
    s_add_u32 s4, s94, 0x380000
    s_addc_u32 s5, s95, 0
    s_mov_b32 s6, 0x80000
    s_mov_b32 s7, 0x20000
    s_mov_b64 exec, 1
    v_mov_b32 v252, s98
    v_mov_b32 v253, 0
    buffer_store_dword v252, v253, s[4:7], s92 offen sc1
    s_mov_b64 exec, -1
L_adaLN_cond__sliding_block_cached__swiglu_ffn__prompt_kernel_43:
    s_lshr_b32 s3, s2, 3
    s_cmp_ge_u32 s3, 27
    s_cbranch_scc1 L_adaLN_cond__sliding_block_cached__swiglu_ffn__prompt_kernel_44
    s_load_dwordx4 s[8:11], s[0:1], 48
    v_and_b32 v1, 63, v0
    s_and_b32 s40, s2, 7
    s_mul_i32 s40, s40, 27
    s_add_u32 s40, s40, s3
    s_lshr_b32 s37, s40, 3
    s_and_b32 s38, s40, 7
    v_lshrrev_b32 v4, 4, v1
    v_lshlrev_b32 v6, 4, v1
    s_lshl_b32 s39, s93, 10
    s_lshl_b32 s40, s38, 3
    s_add_u32 s40, s40, s93
    s_mul_i32 s51, s40, 40960
    v_lshrrev_b32 v2, 3, v1
    v_lshlrev_b32 v3, 1, v4
    v_and_b32 v5, 7, v1
    v_xor_b32 v5, v5, v3
    s_lshl_b32 s42, s93, 3
    v_add_u32 v2, s42, v2
    v_mul_u32_u24 v2, 3456, v2
    v_lshl_add_u32 v5, v5, 4, v2
    s_add_u32 s20, s94, 0x400000
    s_addc_u32 s21, s95, 0
    s_mov_b32 s22, 0x280000
    s_mov_b32 s23, 0x20000
    s_add_u32 s24, s94, 0xa0000
    s_addc_u32 s25, s95, 0
    s_mov_b32 s26, 0x1b000
    s_mov_b32 s27, 0x20000
    s_add_u32 s28, s94, 0x10000
    s_addc_u32 s29, s95, 0
    s_mov_b32 s30, 0x20000
    s_mov_b32 s31, 0x20000
    s_add_u32 s32, s94, 0xc00000
    s_addc_u32 s33, s95, 0
    s_mov_b32 s34, 0x6c0000
    s_mov_b32 s35, 0x20000
    s_lshl_b32 s48, s37, 7
    s_lshl_b32 s45, s40, 11
    s_waitcnt lgkmcnt(0)
    s_mov_b32 s12, s8
    s_mov_b32 s13, s9
    s_mov_b32 s14, 0x21c000
    s_mov_b32 s15, 0x20000
    s_mov_b32 s16, s10
    s_mov_b32 s17, s11
    s_mov_b32 s18, 0x21c000
    s_mov_b32 s19, 0x20000
    s_cmp_eq_u32 s93, 4
    s_cbranch_scc1 L_adaLN_cond__sliding_block_cached__swiglu_ffn__prompt_kernel_46
    s_add_u32 s43, s48, 0xd8000
    s_add_u32 m0, s39, 0x0
    s_nop 0
    buffer_load_dwordx4 v5, s[12:15], s43 offen lds
    s_add_u32 s43, s48, 0xd8000
    s_add_u32 m0, s39, 0x2000
    s_nop 0
    buffer_load_dwordx4 v5, s[16:19], s43 offen lds
    s_add_u32 s43, s48, 0x10e000
    s_add_u32 m0, s39, 0x4000
    s_nop 0
    buffer_load_dwordx4 v5, s[12:15], s43 offen lds
    s_add_u32 s43, s48, 0x10e000
    s_add_u32 m0, s39, 0x6000
    s_nop 0
    buffer_load_dwordx4 v5, s[16:19], s43 offen lds
    s_add_u32 s43, s48, 0x144000
    s_add_u32 m0, s39, 0x8000
    s_nop 0
    buffer_load_dwordx4 v5, s[12:15], s43 offen lds
    s_add_u32 s43, s48, 0x144000
    s_add_u32 m0, s39, 0xa000
    s_nop 0
    buffer_load_dwordx4 v5, s[16:19], s43 offen lds
    s_cmp_lg_u32 s93, 5
    s_cbranch_scc1 L_adaLN_cond__sliding_block_cached__swiglu_ffn__prompt_kernel_47
    v_subrev_u32 v2, 27648, v5
    s_add_u32 s43, s48, 0xd8000
    s_add_u32 m0, s39, 0xfffffc00
    s_nop 0
    buffer_load_dwordx4 v2, s[12:15], s43 offen lds
    s_add_u32 s43, s48, 0xd8000
    s_add_u32 m0, s39, 0x1c00
    s_nop 0
    buffer_load_dwordx4 v2, s[16:19], s43 offen lds
    s_add_u32 s43, s48, 0x10e000
    s_add_u32 m0, s39, 0x3c00
    s_nop 0
    buffer_load_dwordx4 v2, s[12:15], s43 offen lds
    s_add_u32 s43, s48, 0x10e000
    s_add_u32 m0, s39, 0x5c00
    s_nop 0
    buffer_load_dwordx4 v2, s[16:19], s43 offen lds
    s_add_u32 s43, s48, 0x144000
    s_add_u32 m0, s39, 0x7c00
    s_nop 0
    buffer_load_dwordx4 v2, s[12:15], s43 offen lds
    s_add_u32 s43, s48, 0x144000
    s_add_u32 m0, s39, 0x9c00
    s_nop 0
    buffer_load_dwordx4 v2, s[16:19], s43 offen lds
L_adaLN_cond__sliding_block_cached__swiglu_ffn__prompt_kernel_47:
L_adaLN_cond__sliding_block_cached__swiglu_ffn__prompt_kernel_46:
    s_mov_b32 s50, 0xbfb8aa3b
    s_mov_b32 s53, 0xbf317218
    v_lshrrev_b32 v2, 2, v1
    v_bfe_u32 v3, v1, 3, 2
    v_lshlrev_b32 v3, 5, v3
    v_lshl_add_u32 v3, v2, 7, v3
    v_and_b32 v2, 3, v1
    v_lshl_add_u32 v18, v2, 3, v3
    v_xor_b32 v19, 32, v18
    v_xor_b32 v20, 64, v18
    v_xor_b32 v21, 96, v18
    v_lshlrev_b32 v7, 4, v4
    v_add_u32 v7, 0x20000, v7
    s_lshr_b32 s41, s40, 1
    s_mul_i32 s52, s41, 221184
    s_and_b32 s41, s40, 1
    s_lshl_b32 s41, s41, 11
    s_add_u32 s52, s52, s41
    s_lshl_b32 s41, s37, 13
    s_add_u32 s52, s52, s41
    s_waitcnt vmcnt(8)
    s_cmp_lg_u32 s93, 4
    s_cbranch_scc1 L_adaLN_cond__sliding_block_cached__swiglu_ffn__prompt_kernel_48
    s_lshl_b32 s46, s38, 6
    s_add_u32 s46, s46, 0
    s_lshl_b32 s46, s46, 7
    s_add_u32 s46, s46, 0x30000
    v_and_b32 v252, 31, v1
    v_lshlrev_b32 v252, 7, v252
    v_add_u32 v252, s46, v252
    s_lshl_b32 s47, s37, 2
    v_and_b32 v253, 3, v1
    v_add_u32 v253, s47, v253
    v_bfe_u32 v254, v1, 2, 1
    v_mul_u32_u24 v254, 108, v254
    v_add_u32 v253, v253, v254
    v_and_b32 v254, 7, v253
    v_lshrrev_b32 v253, 3, v253
    v_lshl_add_u32 v253, v254, 6, v253
    v_lshlrev_b32 v253, 7, v253
    v_add_u32 v253, 0x30000, v253
    v_cmp_lt_u32 vcc, 31, v1
    s_nop 1
    v_cndmask_b32 v252, v252, v253, vcc
    s_add_u32 s4, s94, 0x380000
    s_addc_u32 s5, s95, 0
    s_mov_b32 s6, 0x80000
    s_mov_b32 s7, 0x20000
    s_mov_b32 s3, 60000
L_adaLN_cond__sliding_block_cached__swiglu_ffn__prompt_kernel_50:
    buffer_load_dword v254, v252, s[4:7], 0 offen sc1
    s_waitcnt vmcnt(0)
    v_cmp_ne_u32 vcc, s98, v254
    s_cbranch_vccz L_adaLN_cond__sliding_block_cached__swiglu_ffn__prompt_kernel_49
    s_sleep 1
    s_sub_u32 s3, s3, 1
    s_cmp_lg_u32 s3, 0
    s_cbranch_scc1 L_adaLN_cond__sliding_block_cached__swiglu_ffn__prompt_kernel_50
L_adaLN_cond__sliding_block_cached__swiglu_ffn__prompt_kernel_49:
L_adaLN_cond__sliding_block_cached__swiglu_ffn__prompt_kernel_48:
    s_barrier
    s_add_u32 s49, s51, 0x0
    buffer_load_dwordx4 v[184:187], v6, s[20:23], s49 offen sc1
    s_add_u32 s49, s51, 0x5000
    buffer_load_dwordx4 v[188:191], v6, s[20:23], s49 offen sc1
    s_add_u32 s49, s51, 0x400
    buffer_load_dwordx4 v[192:195], v6, s[20:23], s49 offen sc1
    s_add_u32 s49, s51, 0x5400
    buffer_load_dwordx4 v[196:199], v6, s[20:23], s49 offen sc1
    v_add_u32 v8, 0x20000, v6
    v_add_u32 v18, 0x10000, v18
    v_add_u32 v19, 0x10000, v19
    v_add_u32 v20, 0x10000, v20
    v_add_u32 v21, 0x10000, v21
    ds_read_b64_tr_b16 v[152:153], v18 offset:0
    ds_read_b64_tr_b16 v[154:155], v18 offset:2048
    ds_read_b64_tr_b16 v[156:157], v19 offset:0
    ds_read_b64_tr_b16 v[158:159], v19 offset:2048
    ds_read_b64_tr_b16 v[160:161], v20 offset:0
    ds_read_b64_tr_b16 v[162:163], v20 offset:2048
    ds_read_b64_tr_b16 v[164:165], v21 offset:0
    ds_read_b64_tr_b16 v[166:167], v21 offset:2048
    ds_read_b64_tr_b16 v[168:169], v18 offset:8192
    ds_read_b64_tr_b16 v[170:171], v18 offset:10240
    ds_read_b64_tr_b16 v[172:173], v19 offset:8192
    ds_read_b64_tr_b16 v[174:175], v19 offset:10240
    s_add_u32 s49, s51, 0x800
    buffer_load_dwordx4 v[200:203], v6, s[20:23], s49 offen sc1
    s_add_u32 s49, s51, 0x5800
    buffer_load_dwordx4 v[204:207], v6, s[20:23], s49 offen sc1
    s_add_u32 s49, s51, 0xc00
    buffer_load_dwordx4 v[208:211], v6, s[20:23], s49 offen sc1
    s_add_u32 s49, s51, 0x5c00
    buffer_load_dwordx4 v[212:215], v6, s[20:23], s49 offen sc1
    s_waitcnt vmcnt(7) lgkmcnt(10)
    v_mfma_f32_16x16x32_bf16 v[24:27], v[152:155], v[184:187], 0
    ds_read_b64_tr_b16 v[176:177], v20 offset:8192
    ds_read_b64_tr_b16 v[178:179], v20 offset:10240
    s_add_u32 s49, s51, 0x1000
    buffer_load_dwordx4 v[216:219], v6, s[20:23], s49 offen sc1
    s_waitcnt vmcnt(7)
    v_mfma_f32_16x16x32_bf16 v[28:31], v[152:155], v[188:191], 0
    s_add_u32 s49, s51, 0x6000
    buffer_load_dwordx4 v[220:223], v6, s[20:23], s49 offen sc1
    s_waitcnt lgkmcnt(10)
    v_mfma_f32_16x16x32_bf16 v[32:35], v[156:159], v[184:187], 0
    ds_read_b64_tr_b16 v[180:181], v21 offset:8192
    ds_read_b64_tr_b16 v[182:183], v21 offset:10240
    s_add_u32 s49, s51, 0x1400
    buffer_load_dwordx4 v[224:227], v6, s[20:23], s49 offen sc1
    v_mfma_f32_16x16x32_bf16 v[36:39], v[156:159], v[188:191], 0
    s_add_u32 s49, s51, 0x6400
    buffer_load_dwordx4 v[228:231], v6, s[20:23], s49 offen sc1
    s_waitcnt lgkmcnt(10)
    v_mfma_f32_16x16x32_bf16 v[40:43], v[160:163], v[184:187], 0
    ds_read_b64_tr_b16 v[152:153], v18 offset:4096
    ds_read_b64_tr_b16 v[154:155], v18 offset:6144
    v_mfma_f32_16x16x32_bf16 v[44:47], v[160:163], v[188:191], 0
    buffer_load_dwordx4 v[88:91], v6, s[28:31], s45 offen offset:0 sc1
    buffer_load_dwordx4 v[92:95], v6, s[28:31], s45 offen offset:1024 sc1
    s_lshl_b32 s44, s37, 10
    buffer_load_dwordx4 v[104:107], v6, s[24:27], s44 offen sc1
    s_add_u32 s44, s44, 27648
    buffer_load_dwordx4 v[108:111], v6, s[24:27], s44 offen sc1
    s_add_u32 s44, s44, 27648
    buffer_load_dwordx4 v[112:115], v6, s[24:27], s44 offen sc1
    s_add_u32 s44, s44, 27648
    buffer_load_dwordx4 v[116:119], v6, s[24:27], s44 offen sc1
    s_add_u32 s44, s44, 27648
    s_waitcnt lgkmcnt(10)
    v_mfma_f32_16x16x32_bf16 v[48:51], v[164:167], v[184:187], 0
    ds_read_b64_tr_b16 v[156:157], v19 offset:4096
    ds_read_b64_tr_b16 v[158:159], v19 offset:6144
    s_add_u32 s49, s51, 0x1800
    buffer_load_dwordx4 v[232:235], v6, s[20:23], s49 offen sc1
    v_mfma_f32_16x16x32_bf16 v[52:55], v[164:167], v[188:191], 0
    s_waitcnt lgkmcnt(10)
    v_mfma_f32_16x16x32_bf16 v[56:59], v[168:171], v[184:187], 0
    ds_read_b64_tr_b16 v[160:161], v20 offset:4096
    ds_read_b64_tr_b16 v[162:163], v20 offset:6144
    v_mfma_f32_16x16x32_bf16 v[60:63], v[168:171], v[188:191], 0
    s_waitcnt lgkmcnt(10)
    v_mfma_f32_16x16x32_bf16 v[64:67], v[172:175], v[184:187], 0
    ds_read_b64_tr_b16 v[164:165], v21 offset:4096
    ds_read_b64_tr_b16 v[166:167], v21 offset:6144
    v_mfma_f32_16x16x32_bf16 v[68:71], v[172:175], v[188:191], 0
    s_waitcnt lgkmcnt(10)
    v_mfma_f32_16x16x32_bf16 v[72:75], v[176:179], v[184:187], 0
    ds_read_b64_tr_b16 v[168:169], v18 offset:12288
    ds_read_b64_tr_b16 v[170:171], v18 offset:14336
    s_add_u32 s49, s51, 0x6800
    buffer_load_dwordx4 v[236:239], v6, s[20:23], s49 offen sc1
    v_mfma_f32_16x16x32_bf16 v[76:79], v[176:179], v[188:191], 0
    s_waitcnt lgkmcnt(10)
    v_mfma_f32_16x16x32_bf16 v[80:83], v[180:183], v[184:187], 0
    ds_read_b64_tr_b16 v[172:173], v19 offset:12288
    ds_read_b64_tr_b16 v[174:175], v19 offset:14336
    v_mfma_f32_16x16x32_bf16 v[84:87], v[180:183], v[188:191], 0
    s_waitcnt vmcnt(17) lgkmcnt(10)
    v_mfma_f32_16x16x32_bf16 v[24:27], v[152:155], v[192:195], v[24:27]
    ds_read_b64_tr_b16 v[176:177], v20 offset:12288
    ds_read_b64_tr_b16 v[178:179], v20 offset:14336
    s_waitcnt vmcnt(16)
    v_mfma_f32_16x16x32_bf16 v[28:31], v[152:155], v[196:199], v[28:31]
    s_waitcnt lgkmcnt(10)
    v_mfma_f32_16x16x32_bf16 v[32:35], v[156:159], v[192:195], v[32:35]
    ds_read_b64_tr_b16 v[180:181], v21 offset:12288
    ds_read_b64_tr_b16 v[182:183], v21 offset:14336
    v_mfma_f32_16x16x32_bf16 v[36:39], v[156:159], v[196:199], v[36:39]
    s_waitcnt lgkmcnt(10)
    v_mfma_f32_16x16x32_bf16 v[40:43], v[160:163], v[192:195], v[40:43]
    ds_read_b64_tr_b16 v[152:153], v18 offset:16384
    ds_read_b64_tr_b16 v[154:155], v18 offset:18432
    v_mfma_f32_16x16x32_bf16 v[44:47], v[160:163], v[196:199], v[44:47]
    s_waitcnt lgkmcnt(10)
    v_mfma_f32_16x16x32_bf16 v[48:51], v[164:167], v[192:195], v[48:51]
    ds_read_b64_tr_b16 v[156:157], v19 offset:16384
    ds_read_b64_tr_b16 v[158:159], v19 offset:18432
    s_add_u32 s49, s51, 0x1c00
    buffer_load_dwordx4 v[240:243], v6, s[20:23], s49 offen sc1
    v_mfma_f32_16x16x32_bf16 v[52:55], v[164:167], v[196:199], v[52:55]
    s_waitcnt lgkmcnt(10)
    v_mfma_f32_16x16x32_bf16 v[56:59], v[168:171], v[192:195], v[56:59]
    ds_read_b64_tr_b16 v[160:161], v20 offset:16384
    ds_read_b64_tr_b16 v[162:163], v20 offset:18432
    v_mfma_f32_16x16x32_bf16 v[60:63], v[168:171], v[196:199], v[60:63]
    s_waitcnt lgkmcnt(10)
    v_mfma_f32_16x16x32_bf16 v[64:67], v[172:175], v[192:195], v[64:67]
    ds_read_b64_tr_b16 v[164:165], v21 offset:16384
    ds_read_b64_tr_b16 v[166:167], v21 offset:18432
    v_mfma_f32_16x16x32_bf16 v[68:71], v[172:175], v[196:199], v[68:71]
    s_waitcnt lgkmcnt(10)
    v_mfma_f32_16x16x32_bf16 v[72:75], v[176:179], v[192:195], v[72:75]
    ds_read_b64_tr_b16 v[168:169], v18 offset:24576
    ds_read_b64_tr_b16 v[170:171], v18 offset:26624
    s_add_u32 s49, s51, 0x6c00
    buffer_load_dwordx4 v[244:247], v6, s[20:23], s49 offen sc1
    v_mfma_f32_16x16x32_bf16 v[76:79], v[176:179], v[196:199], v[76:79]
    s_waitcnt lgkmcnt(10)
    v_mfma_f32_16x16x32_bf16 v[80:83], v[180:183], v[192:195], v[80:83]
    ds_read_b64_tr_b16 v[172:173], v19 offset:24576
    ds_read_b64_tr_b16 v[174:175], v19 offset:26624
    v_mfma_f32_16x16x32_bf16 v[84:87], v[180:183], v[196:199], v[84:87]
    s_waitcnt vmcnt(17) lgkmcnt(10)
    v_mfma_f32_16x16x32_bf16 v[24:27], v[152:155], v[200:203], v[24:27]
    ds_read_b64_tr_b16 v[176:177], v20 offset:24576
    ds_read_b64_tr_b16 v[178:179], v20 offset:26624
    s_waitcnt vmcnt(16)
    v_mfma_f32_16x16x32_bf16 v[28:31], v[152:155], v[204:207], v[28:31]
    s_waitcnt lgkmcnt(10)
    v_mfma_f32_16x16x32_bf16 v[32:35], v[156:159], v[200:203], v[32:35]
    ds_read_b64_tr_b16 v[180:181], v21 offset:24576
    ds_read_b64_tr_b16 v[182:183], v21 offset:26624
    v_mfma_f32_16x16x32_bf16 v[36:39], v[156:159], v[204:207], v[36:39]
    s_waitcnt lgkmcnt(10)
    v_mfma_f32_16x16x32_bf16 v[40:43], v[160:163], v[200:203], v[40:43]
    ds_read_b64_tr_b16 v[152:153], v18 offset:20480
    ds_read_b64_tr_b16 v[154:155], v18 offset:22528
    v_mfma_f32_16x16x32_bf16 v[44:47], v[160:163], v[204:207], v[44:47]
    s_waitcnt lgkmcnt(10)
    v_mfma_f32_16x16x32_bf16 v[48:51], v[164:167], v[200:203], v[48:51]
    ds_read_b64_tr_b16 v[156:157], v19 offset:20480
    ds_read_b64_tr_b16 v[158:159], v19 offset:22528
    s_add_u32 s49, s51, 0x2000
    buffer_load_dwordx4 v[184:187], v6, s[20:23], s49 offen sc1
    v_mfma_f32_16x16x32_bf16 v[52:55], v[164:167], v[204:207], v[52:55]
    s_waitcnt lgkmcnt(10)
    v_mfma_f32_16x16x32_bf16 v[56:59], v[168:171], v[200:203], v[56:59]
    ds_read_b64_tr_b16 v[160:161], v20 offset:20480
    ds_read_b64_tr_b16 v[162:163], v20 offset:22528
    v_mfma_f32_16x16x32_bf16 v[60:63], v[168:171], v[204:207], v[60:63]
    s_waitcnt lgkmcnt(10)
    v_mfma_f32_16x16x32_bf16 v[64:67], v[172:175], v[200:203], v[64:67]
    ds_read_b64_tr_b16 v[164:165], v21 offset:20480
    ds_read_b64_tr_b16 v[166:167], v21 offset:22528
    v_mfma_f32_16x16x32_bf16 v[68:71], v[172:175], v[204:207], v[68:71]
    s_waitcnt lgkmcnt(10)
    v_mfma_f32_16x16x32_bf16 v[72:75], v[176:179], v[200:203], v[72:75]
    ds_read_b64_tr_b16 v[168:169], v18 offset:28672
    ds_read_b64_tr_b16 v[170:171], v18 offset:30720
    s_waitcnt vmcnt(7)
    v_pk_add_f32 v[104:105], v[104:105], v[108:109]
    s_waitcnt vmcnt(5)
    v_pk_add_f32 v[112:113], v[112:113], v[116:117]
    v_pk_add_f32 v[104:105], v[104:105], v[112:113]
    v_pk_add_f32 v[106:107], v[106:107], v[110:111]
    v_pk_add_f32 v[114:115], v[114:115], v[118:119]
    v_pk_add_f32 v[106:107], v[106:107], v[114:115]
    ds_write_b128 v8, v[104:107]
    s_add_u32 s49, s51, 0x7000
    buffer_load_dwordx4 v[188:191], v6, s[20:23], s49 offen sc1
    v_mfma_f32_16x16x32_bf16 v[76:79], v[176:179], v[204:207], v[76:79]
    s_waitcnt lgkmcnt(11)
    v_mfma_f32_16x16x32_bf16 v[80:83], v[180:183], v[200:203], v[80:83]
    ds_read_b64_tr_b16 v[172:173], v19 offset:28672
    ds_read_b64_tr_b16 v[174:175], v19 offset:30720
    v_mfma_f32_16x16x32_bf16 v[84:87], v[180:183], v[204:207], v[84:87]
    s_waitcnt lgkmcnt(11)
    v_mfma_f32_16x16x32_bf16 v[24:27], v[152:155], v[208:211], v[24:27]
    ds_read_b64_tr_b16 v[176:177], v20 offset:28672
    ds_read_b64_tr_b16 v[178:179], v20 offset:30720
    v_mfma_f32_16x16x32_bf16 v[28:31], v[152:155], v[212:215], v[28:31]
    s_waitcnt lgkmcnt(11)
    v_mfma_f32_16x16x32_bf16 v[32:35], v[156:159], v[208:211], v[32:35]
    ds_read_b64_tr_b16 v[180:181], v21 offset:28672
    ds_read_b64_tr_b16 v[182:183], v21 offset:30720
    v_mfma_f32_16x16x32_bf16 v[36:39], v[156:159], v[212:215], v[36:39]
    s_waitcnt lgkmcnt(0)
    v_mfma_f32_16x16x32_bf16 v[40:43], v[160:163], v[208:211], v[40:43]
    s_barrier
    ds_read_b64_tr_b16 v[152:153], v18 offset:32768
    ds_read_b64_tr_b16 v[154:155], v18 offset:34816
    v_mfma_f32_16x16x32_bf16 v[44:47], v[160:163], v[212:215], v[44:47]
    v_mfma_f32_16x16x32_bf16 v[48:51], v[164:167], v[208:211], v[48:51]
    ds_read_b64_tr_b16 v[156:157], v19 offset:32768
    ds_read_b64_tr_b16 v[158:159], v19 offset:34816
    s_add_u32 s49, s51, 0x2400
    buffer_load_dwordx4 v[192:195], v6, s[20:23], s49 offen sc1
    v_mfma_f32_16x16x32_bf16 v[52:55], v[164:167], v[212:215], v[52:55]
    v_mfma_f32_16x16x32_bf16 v[56:59], v[168:171], v[208:211], v[56:59]
    ds_read_b64_tr_b16 v[160:161], v20 offset:32768
    ds_read_b64_tr_b16 v[162:163], v20 offset:34816
    v_mfma_f32_16x16x32_bf16 v[60:63], v[168:171], v[212:215], v[60:63]
    v_mfma_f32_16x16x32_bf16 v[64:67], v[172:175], v[208:211], v[64:67]
    ds_read_b64_tr_b16 v[164:165], v21 offset:32768
    ds_read_b64_tr_b16 v[166:167], v21 offset:34816
    v_mfma_f32_16x16x32_bf16 v[68:71], v[172:175], v[212:215], v[68:71]
    v_mfma_f32_16x16x32_bf16 v[72:75], v[176:179], v[208:211], v[72:75]
    ds_read_b64_tr_b16 v[168:169], v18 offset:40960
    ds_read_b64_tr_b16 v[170:171], v18 offset:43008
    s_add_u32 s49, s51, 0x7400
    buffer_load_dwordx4 v[196:199], v6, s[20:23], s49 offen sc1
    v_mfma_f32_16x16x32_bf16 v[76:79], v[176:179], v[212:215], v[76:79]
    v_mfma_f32_16x16x32_bf16 v[80:83], v[180:183], v[208:211], v[80:83]
    ds_read_b64_tr_b16 v[172:173], v19 offset:40960
    ds_read_b64_tr_b16 v[174:175], v19 offset:43008
    v_mfma_f32_16x16x32_bf16 v[84:87], v[180:183], v[212:215], v[84:87]
    s_waitcnt lgkmcnt(10)
    v_mfma_f32_16x16x32_bf16 v[24:27], v[152:155], v[216:219], v[24:27]
    ds_read_b64_tr_b16 v[176:177], v20 offset:40960
    ds_read_b64_tr_b16 v[178:179], v20 offset:43008
    v_add_f32 v96, v88, v90
    v_mfma_f32_16x16x32_bf16 v[28:31], v[152:155], v[220:223], v[28:31]
    v_add_f32 v97, v92, v94
    s_waitcnt lgkmcnt(10)
    v_mfma_f32_16x16x32_bf16 v[32:35], v[156:159], v[216:219], v[32:35]
    ds_read_b64_tr_b16 v[180:181], v21 offset:40960
    ds_read_b64_tr_b16 v[182:183], v21 offset:43008
    v_mov_b32 v100, v96
    s_add_u32 s43, s48, 0x17a000
    s_add_u32 m0, s39, 0xc000
    s_nop 0
    buffer_load_dwordx4 v5, s[12:15], s43 offen lds
    v_mfma_f32_16x16x32_bf16 v[36:39], v[156:159], v[220:223], v[36:39]
    v_mov_b32 v101, v97
    s_waitcnt lgkmcnt(10)
    v_mfma_f32_16x16x32_bf16 v[40:43], v[160:163], v[216:219], v[40:43]
    ds_read_b64_tr_b16 v[152:153], v18 offset:36864
    ds_read_b64_tr_b16 v[154:155], v18 offset:38912
    v_permlane16_swap_b32 v96, v100
    v_mfma_f32_16x16x32_bf16 v[44:47], v[160:163], v[220:223], v[44:47]
    s_waitcnt lgkmcnt(10)
    v_mfma_f32_16x16x32_bf16 v[48:51], v[164:167], v[216:219], v[48:51]
    ds_read_b64_tr_b16 v[156:157], v19 offset:36864
    ds_read_b64_tr_b16 v[158:159], v19 offset:38912
    v_permlane16_swap_b32 v97, v101
    s_add_u32 s49, s51, 0x2800
    buffer_load_dwordx4 v[200:203], v6, s[20:23], s49 offen sc1
    v_mfma_f32_16x16x32_bf16 v[52:55], v[164:167], v[220:223], v[52:55]
    v_add_f32 v96, v96, v100
    s_waitcnt lgkmcnt(10)
    v_mfma_f32_16x16x32_bf16 v[56:59], v[168:171], v[216:219], v[56:59]
    ds_read_b64_tr_b16 v[160:161], v20 offset:36864
    ds_read_b64_tr_b16 v[162:163], v20 offset:38912
    v_add_f32 v97, v97, v101
    v_mfma_f32_16x16x32_bf16 v[60:63], v[168:171], v[220:223], v[60:63]
    v_mov_b32 v100, v96
    s_waitcnt lgkmcnt(10)
    v_mfma_f32_16x16x32_bf16 v[64:67], v[172:175], v[216:219], v[64:67]
    ds_read_b64_tr_b16 v[164:165], v21 offset:36864
    ds_read_b64_tr_b16 v[166:167], v21 offset:38912
    v_mov_b32 v101, v97
    v_mfma_f32_16x16x32_bf16 v[68:71], v[172:175], v[220:223], v[68:71]
    s_waitcnt lgkmcnt(10)
    v_mfma_f32_16x16x32_bf16 v[72:75], v[176:179], v[216:219], v[72:75]
    ds_read_b64_tr_b16 v[168:169], v18 offset:45056
    ds_read_b64_tr_b16 v[170:171], v18 offset:47104
    v_permlane32_swap_b32 v96, v100
    s_add_u32 s49, s51, 0x7800
    buffer_load_dwordx4 v[204:207], v6, s[20:23], s49 offen sc1
    v_mfma_f32_16x16x32_bf16 v[76:79], v[176:179], v[220:223], v[76:79]
    v_permlane32_swap_b32 v97, v101
    s_waitcnt lgkmcnt(10)
    v_mfma_f32_16x16x32_bf16 v[80:83], v[180:183], v[216:219], v[80:83]
    ds_read_b64_tr_b16 v[172:173], v19 offset:45056
    ds_read_b64_tr_b16 v[174:175], v19 offset:47104
    v_add_f32 v96, v96, v100
    v_mfma_f32_16x16x32_bf16 v[84:87], v[180:183], v[220:223], v[84:87]
    v_add_f32 v97, v97, v101
    s_waitcnt lgkmcnt(10)
    v_mfma_f32_16x16x32_bf16 v[24:27], v[152:155], v[224:227], v[24:27]
    ds_read_b64_tr_b16 v[176:177], v20 offset:45056
    ds_read_b64_tr_b16 v[178:179], v20 offset:47104
    v_mul_f32 v96, 0.125, v96
    v_mfma_f32_16x16x32_bf16 v[28:31], v[152:155], v[228:231], v[28:31]
    s_waitcnt lgkmcnt(10)
    v_mfma_f32_16x16x32_bf16 v[32:35], v[156:159], v[224:227], v[32:35]
    ds_read_b64_tr_b16 v[180:181], v21 offset:45056
    ds_read_b64_tr_b16 v[182:183], v21 offset:47104
    v_sub_f32 v88, v88, v96
    s_add_u32 s43, s48, 0x17a000
    s_add_u32 m0, s39, 0xe000
    s_nop 0
    buffer_load_dwordx4 v5, s[16:19], s43 offen lds
    v_mfma_f32_16x16x32_bf16 v[36:39], v[156:159], v[228:231], v[36:39]
    v_sub_f32 v90, v90, v96
    s_waitcnt lgkmcnt(10)
    v_mfma_f32_16x16x32_bf16 v[40:43], v[160:163], v[224:227], v[40:43]
    ds_read_b64_tr_b16 v[152:153], v18 offset:49152
    ds_read_b64_tr_b16 v[154:155], v18 offset:51200
    v_mul_f32 v88, v88, v88
    v_mfma_f32_16x16x32_bf16 v[44:47], v[160:163], v[228:231], v[44:47]
    v_fmac_f32 v88, v90, v90
    s_waitcnt lgkmcnt(10)
    v_mfma_f32_16x16x32_bf16 v[48:51], v[164:167], v[224:227], v[48:51]
    ds_read_b64_tr_b16 v[156:157], v19 offset:49152
    ds_read_b64_tr_b16 v[158:159], v19 offset:51200
    v_add_f32 v10, v89, v91
    s_add_u32 s49, s51, 0x2c00
    buffer_load_dwordx4 v[208:211], v6, s[20:23], s49 offen sc1
    v_mfma_f32_16x16x32_bf16 v[52:55], v[164:167], v[228:231], v[52:55]
    s_waitcnt lgkmcnt(10)
    v_mfma_f32_16x16x32_bf16 v[56:59], v[168:171], v[224:227], v[56:59]
    ds_read_b64_tr_b16 v[160:161], v20 offset:49152
    ds_read_b64_tr_b16 v[162:163], v20 offset:51200
    v_fmac_f32 v10, 0x42a00000, v88
    v_mfma_f32_16x16x32_bf16 v[60:63], v[168:171], v[228:231], v[60:63]
    v_mul_f32 v97, 0.125, v97
    s_waitcnt lgkmcnt(10)
    v_mfma_f32_16x16x32_bf16 v[64:67], v[172:175], v[224:227], v[64:67]
    ds_read_b64_tr_b16 v[164:165], v21 offset:49152
    ds_read_b64_tr_b16 v[166:167], v21 offset:51200
    v_sub_f32 v92, v92, v97
    v_mfma_f32_16x16x32_bf16 v[68:71], v[172:175], v[228:231], v[68:71]
    v_sub_f32 v94, v94, v97
    s_waitcnt lgkmcnt(10)
    v_mfma_f32_16x16x32_bf16 v[72:75], v[176:179], v[224:227], v[72:75]
    ds_read_b64_tr_b16 v[168:169], v18 offset:57344
    ds_read_b64_tr_b16 v[170:171], v18 offset:59392
    v_mul_f32 v92, v92, v92
    s_add_u32 s49, s51, 0x7c00
    buffer_load_dwordx4 v[212:215], v6, s[20:23], s49 offen sc1
    v_mfma_f32_16x16x32_bf16 v[76:79], v[176:179], v[228:231], v[76:79]
    s_waitcnt lgkmcnt(10)
    v_mfma_f32_16x16x32_bf16 v[80:83], v[180:183], v[224:227], v[80:83]
    ds_read_b64_tr_b16 v[172:173], v19 offset:57344
    ds_read_b64_tr_b16 v[174:175], v19 offset:59392
    v_fmac_f32 v92, v94, v94
    v_mfma_f32_16x16x32_bf16 v[84:87], v[180:183], v[228:231], v[84:87]
    v_add_f32 v11, v93, v95
    s_waitcnt vmcnt(13) lgkmcnt(10)
    v_mfma_f32_16x16x32_bf16 v[24:27], v[152:155], v[232:235], v[24:27]
    ds_read_b64_tr_b16 v[176:177], v20 offset:57344
    ds_read_b64_tr_b16 v[178:179], v20 offset:59392
    v_fmac_f32 v11, 0x42a00000, v92
    s_waitcnt vmcnt(12)
    v_mfma_f32_16x16x32_bf16 v[28:31], v[152:155], v[236:239], v[28:31]
    v_mov_b32 v100, v10
    s_waitcnt lgkmcnt(10)
    v_mfma_f32_16x16x32_bf16 v[32:35], v[156:159], v[232:235], v[32:35]
    ds_read_b64_tr_b16 v[180:181], v21 offset:57344
    ds_read_b64_tr_b16 v[182:183], v21 offset:59392
    v_mov_b32 v101, v11
    s_add_u32 s43, s48, 0x1b0000
    s_add_u32 m0, s39, 0x10000
    s_nop 0
    buffer_load_dwordx4 v5, s[12:15], s43 offen lds
    v_mfma_f32_16x16x32_bf16 v[36:39], v[156:159], v[236:239], v[36:39]
    s_waitcnt lgkmcnt(10)
    v_mfma_f32_16x16x32_bf16 v[40:43], v[160:163], v[232:235], v[40:43]
    ds_read_b64_tr_b16 v[152:153], v18 offset:53248
    ds_read_b64_tr_b16 v[154:155], v18 offset:55296
    v_permlane16_swap_b32 v10, v100
    v_mfma_f32_16x16x32_bf16 v[44:47], v[160:163], v[236:239], v[44:47]
    v_permlane16_swap_b32 v11, v101
    s_waitcnt lgkmcnt(10)
    v_mfma_f32_16x16x32_bf16 v[48:51], v[164:167], v[232:235], v[48:51]
    ds_read_b64_tr_b16 v[156:157], v19 offset:53248
    ds_read_b64_tr_b16 v[158:159], v19 offset:55296
    v_add_f32 v10, v10, v100
    s_add_u32 s49, s51, 0x3000
    buffer_load_dwordx4 v[216:219], v6, s[20:23], s49 offen sc1
    v_mfma_f32_16x16x32_bf16 v[52:55], v[164:167], v[236:239], v[52:55]
    v_add_f32 v11, v11, v101
    s_waitcnt lgkmcnt(10)
    v_mfma_f32_16x16x32_bf16 v[56:59], v[168:171], v[232:235], v[56:59]
    ds_read_b64_tr_b16 v[160:161], v20 offset:53248
    ds_read_b64_tr_b16 v[162:163], v20 offset:55296
    v_mov_b32 v100, v10
    v_mfma_f32_16x16x32_bf16 v[60:63], v[168:171], v[236:239], v[60:63]
    s_waitcnt lgkmcnt(10)
    v_mfma_f32_16x16x32_bf16 v[64:67], v[172:175], v[232:235], v[64:67]
    ds_read_b64_tr_b16 v[164:165], v21 offset:53248
    ds_read_b64_tr_b16 v[166:167], v21 offset:55296
    v_mov_b32 v101, v11
    v_mfma_f32_16x16x32_bf16 v[68:71], v[172:175], v[236:239], v[68:71]
    v_permlane32_swap_b32 v10, v100
    s_waitcnt lgkmcnt(10)
    v_mfma_f32_16x16x32_bf16 v[72:75], v[176:179], v[232:235], v[72:75]
    ds_read_b64_tr_b16 v[168:169], v18 offset:61440
    ds_read_b64_tr_b16 v[170:171], v18 offset:63488
    v_permlane32_swap_b32 v11, v101
    s_add_u32 s49, s51, 0x8000
    buffer_load_dwordx4 v[220:223], v6, s[20:23], s49 offen sc1
    v_mfma_f32_16x16x32_bf16 v[76:79], v[176:179], v[236:239], v[76:79]
    v_add_f32 v10, v10, v100
    s_waitcnt lgkmcnt(10)
    v_mfma_f32_16x16x32_bf16 v[80:83], v[180:183], v[232:235], v[80:83]
    ds_read_b64_tr_b16 v[172:173], v19 offset:61440
    ds_read_b64_tr_b16 v[174:175], v19 offset:63488
    v_add_f32 v11, v11, v101
    v_mfma_f32_16x16x32_bf16 v[84:87], v[180:183], v[236:239], v[84:87]
    s_waitcnt vmcnt(14) lgkmcnt(10)
    v_mfma_f32_16x16x32_bf16 v[24:27], v[152:155], v[240:243], v[24:27]
    ds_read_b64_tr_b16 v[176:177], v20 offset:61440
    ds_read_b64_tr_b16 v[178:179], v20 offset:63488
    v_mov_b32 v100, 0x3727c5ac
    s_waitcnt vmcnt(13)
    v_mfma_f32_16x16x32_bf16 v[28:31], v[152:155], v[244:247], v[28:31]
    v_fmac_f32 v100, 0x3acccccd, v10
    s_waitcnt lgkmcnt(10)
    v_mfma_f32_16x16x32_bf16 v[32:35], v[156:159], v[240:243], v[32:35]
    ds_read_b64_tr_b16 v[180:181], v21 offset:61440
    ds_read_b64_tr_b16 v[182:183], v21 offset:63488
    v_rsq_f32 v10, v100
    s_add_u32 s43, s48, 0x1b0000
    s_add_u32 m0, s39, 0x12000
    s_nop 0
    buffer_load_dwordx4 v5, s[16:19], s43 offen lds
    v_mfma_f32_16x16x32_bf16 v[36:39], v[156:159], v[244:247], v[36:39]
    v_mul_f32 v14, v96, v10
    s_waitcnt lgkmcnt(10)
    v_mfma_f32_16x16x32_bf16 v[40:43], v[160:163], v[240:243], v[40:43]
    s_barrier
    v_subrev_u32 v18, 0x10000, v18
    v_subrev_u32 v19, 0x10000, v19
    v_subrev_u32 v20, 0x10000, v20
    v_subrev_u32 v21, 0x10000, v21
    ds_read_b64_tr_b16 v[152:153], v18 offset:0
    ds_read_b64_tr_b16 v[154:155], v18 offset:2048
    v_sub_f32 v14, 0, v14
    v_mfma_f32_16x16x32_bf16 v[44:47], v[160:163], v[244:247], v[44:47]
    s_waitcnt lgkmcnt(10)
    v_mfma_f32_16x16x32_bf16 v[48:51], v[164:167], v[240:243], v[48:51]
    ds_read_b64_tr_b16 v[156:157], v19 offset:0
    ds_read_b64_tr_b16 v[158:159], v19 offset:2048
    v_mov_b32 v101, 0x3727c5ac
    s_add_u32 s49, s51, 0x3400
    buffer_load_dwordx4 v[224:227], v6, s[20:23], s49 offen sc1
    v_mfma_f32_16x16x32_bf16 v[52:55], v[164:167], v[244:247], v[52:55]
    v_fmac_f32 v101, 0x3acccccd, v11
    s_waitcnt lgkmcnt(10)
    v_mfma_f32_16x16x32_bf16 v[56:59], v[168:171], v[240:243], v[56:59]
    ds_read_b64_tr_b16 v[160:161], v20 offset:0
    ds_read_b64_tr_b16 v[162:163], v20 offset:2048
    v_rsq_f32 v11, v101
    v_mfma_f32_16x16x32_bf16 v[60:63], v[168:171], v[244:247], v[60:63]
    v_mul_f32 v15, v97, v11
    s_waitcnt lgkmcnt(10)
    v_mfma_f32_16x16x32_bf16 v[64:67], v[172:175], v[240:243], v[64:67]
    ds_read_b64_tr_b16 v[164:165], v21 offset:0
    ds_read_b64_tr_b16 v[166:167], v21 offset:2048
    v_sub_f32 v15, 0, v15
    v_mfma_f32_16x16x32_bf16 v[68:71], v[172:175], v[244:247], v[68:71]
    s_waitcnt lgkmcnt(10)
    v_mfma_f32_16x16x32_bf16 v[72:75], v[176:179], v[240:243], v[72:75]
    ds_read_b64_tr_b16 v[168:169], v18 offset:8192
    ds_read_b64_tr_b16 v[170:171], v18 offset:10240
    s_add_u32 s49, s51, 0x8400
    buffer_load_dwordx4 v[228:231], v6, s[20:23], s49 offen sc1
    v_mfma_f32_16x16x32_bf16 v[76:79], v[176:179], v[244:247], v[76:79]
    s_waitcnt lgkmcnt(10)
    v_mfma_f32_16x16x32_bf16 v[80:83], v[180:183], v[240:243], v[80:83]
    ds_read_b64_tr_b16 v[172:173], v19 offset:8192
    ds_read_b64_tr_b16 v[174:175], v19 offset:10240
    v_mfma_f32_16x16x32_bf16 v[84:87], v[180:183], v[244:247], v[84:87]
    s_waitcnt vmcnt(15) lgkmcnt(10)
    v_mfma_f32_16x16x32_bf16 v[24:27], v[152:155], v[184:187], v[24:27]
    ds_read_b64_tr_b16 v[176:177], v20 offset:8192
    ds_read_b64_tr_b16 v[178:179], v20 offset:10240
    s_waitcnt vmcnt(14)
    v_mfma_f32_16x16x32_bf16 v[28:31], v[152:155], v[188:191], v[28:31]
    s_waitcnt lgkmcnt(10)
    v_mfma_f32_16x16x32_bf16 v[32:35], v[156:159], v[184:187], v[32:35]
    ds_read_b64_tr_b16 v[180:181], v21 offset:8192
    ds_read_b64_tr_b16 v[182:183], v21 offset:10240
    ds_read_b128 v[88:91], v7 offset:0
    s_add_u32 s43, s48, 0x1e6000
    s_add_u32 m0, s39, 0x14000
    s_nop 0
    buffer_load_dwordx4 v5, s[12:15], s43 offen lds
    v_mfma_f32_16x16x32_bf16 v[36:39], v[156:159], v[188:191], v[36:39]
    s_waitcnt lgkmcnt(11)
    v_mfma_f32_16x16x32_bf16 v[40:43], v[160:163], v[184:187], v[40:43]
    ds_read_b64_tr_b16 v[152:153], v18 offset:4096
    ds_read_b64_tr_b16 v[154:155], v18 offset:6144
    ds_read_b128 v[92:95], v7 offset:64
    v_mfma_f32_16x16x32_bf16 v[44:47], v[160:163], v[188:191], v[44:47]
    s_waitcnt lgkmcnt(12)
    v_mfma_f32_16x16x32_bf16 v[48:51], v[164:167], v[184:187], v[48:51]
    ds_read_b64_tr_b16 v[156:157], v19 offset:4096
    ds_read_b64_tr_b16 v[158:159], v19 offset:6144
    ds_read_b128 v[96:99], v7 offset:128
    s_add_u32 s49, s51, 0x3800
    buffer_load_dwordx4 v[232:235], v6, s[20:23], s49 offen sc1
    v_mfma_f32_16x16x32_bf16 v[52:55], v[164:167], v[188:191], v[52:55]
    s_waitcnt lgkmcnt(13)
    v_mfma_f32_16x16x32_bf16 v[56:59], v[168:171], v[184:187], v[56:59]
    ds_read_b64_tr_b16 v[160:161], v20 offset:4096
    ds_read_b64_tr_b16 v[162:163], v20 offset:6144
    ds_read_b128 v[100:103], v7 offset:192
    v_mfma_f32_16x16x32_bf16 v[60:63], v[168:171], v[188:191], v[60:63]
    s_waitcnt lgkmcnt(14)
    v_mfma_f32_16x16x32_bf16 v[64:67], v[172:175], v[184:187], v[64:67]
    ds_read_b64_tr_b16 v[164:165], v21 offset:4096
    ds_read_b64_tr_b16 v[166:167], v21 offset:6144
    ds_read_b128 v[104:107], v7 offset:256
    v_mfma_f32_16x16x32_bf16 v[68:71], v[172:175], v[188:191], v[68:71]
    s_waitcnt lgkmcnt(15)
    v_mfma_f32_16x16x32_bf16 v[72:75], v[176:179], v[184:187], v[72:75]
    ds_read_b64_tr_b16 v[168:169], v18 offset:12288
    ds_read_b64_tr_b16 v[170:171], v18 offset:14336
    ds_read_b128 v[108:111], v7 offset:320
    s_add_u32 s49, s51, 0x8800
    buffer_load_dwordx4 v[236:239], v6, s[20:23], s49 offen sc1
    v_mfma_f32_16x16x32_bf16 v[76:79], v[176:179], v[188:191], v[76:79]
    s_waitcnt lgkmcnt(15)
    v_mfma_f32_16x16x32_bf16 v[80:83], v[180:183], v[184:187], v[80:83]
    ds_read_b64_tr_b16 v[172:173], v19 offset:12288
    ds_read_b64_tr_b16 v[174:175], v19 offset:14336
    ds_read_b128 v[112:115], v7 offset:384
    v_mfma_f32_16x16x32_bf16 v[84:87], v[180:183], v[188:191], v[84:87]
    s_waitcnt vmcnt(16) lgkmcnt(15)
    v_mfma_f32_16x16x32_bf16 v[24:27], v[152:155], v[192:195], v[24:27]
    ds_read_b64_tr_b16 v[176:177], v20 offset:12288
    ds_read_b64_tr_b16 v[178:179], v20 offset:14336
    ds_read_b128 v[116:119], v7 offset:448
    s_waitcnt vmcnt(15)
    v_mfma_f32_16x16x32_bf16 v[28:31], v[152:155], v[196:199], v[28:31]
    s_waitcnt lgkmcnt(15)
    v_mfma_f32_16x16x32_bf16 v[32:35], v[156:159], v[192:195], v[32:35]
    ds_read_b64_tr_b16 v[180:181], v21 offset:12288
    ds_read_b64_tr_b16 v[182:183], v21 offset:14336
    ds_read_b128 v[120:123], v7 offset:512
    s_add_u32 s43, s48, 0x1e6000
    s_add_u32 m0, s39, 0x16000
    s_nop 0
    buffer_load_dwordx4 v5, s[16:19], s43 offen lds
    v_mfma_f32_16x16x32_bf16 v[36:39], v[156:159], v[196:199], v[36:39]
    s_waitcnt lgkmcnt(15)
    v_mfma_f32_16x16x32_bf16 v[40:43], v[160:163], v[192:195], v[40:43]
    ds_read_b64_tr_b16 v[152:153], v18 offset:16384
    ds_read_b64_tr_b16 v[154:155], v18 offset:18432
    ds_read_b128 v[124:127], v7 offset:576
    v_mfma_f32_16x16x32_bf16 v[44:47], v[160:163], v[196:199], v[44:47]
    s_waitcnt lgkmcnt(15)
    v_mfma_f32_16x16x32_bf16 v[48:51], v[164:167], v[192:195], v[48:51]
    ds_read_b64_tr_b16 v[156:157], v19 offset:16384
    ds_read_b64_tr_b16 v[158:159], v19 offset:18432
    ds_read_b128 v[128:131], v7 offset:640
    s_add_u32 s49, s51, 0x3c00
    buffer_load_dwordx4 v[240:243], v6, s[20:23], s49 offen sc1
    v_mfma_f32_16x16x32_bf16 v[52:55], v[164:167], v[196:199], v[52:55]
    s_waitcnt lgkmcnt(15)
    v_mfma_f32_16x16x32_bf16 v[56:59], v[168:171], v[192:195], v[56:59]
    ds_read_b64_tr_b16 v[160:161], v20 offset:16384
    ds_read_b64_tr_b16 v[162:163], v20 offset:18432
    ds_read_b128 v[132:135], v7 offset:704
    v_mfma_f32_16x16x32_bf16 v[60:63], v[168:171], v[196:199], v[60:63]
    s_waitcnt lgkmcnt(15)
    v_mfma_f32_16x16x32_bf16 v[64:67], v[172:175], v[192:195], v[64:67]
    ds_read_b64_tr_b16 v[164:165], v21 offset:16384
    ds_read_b64_tr_b16 v[166:167], v21 offset:18432
    ds_read_b128 v[136:139], v7 offset:768
    v_mfma_f32_16x16x32_bf16 v[68:71], v[172:175], v[196:199], v[68:71]
    s_waitcnt lgkmcnt(15)
    v_mfma_f32_16x16x32_bf16 v[72:75], v[176:179], v[192:195], v[72:75]
    ds_read_b64_tr_b16 v[168:169], v18 offset:24576
    ds_read_b64_tr_b16 v[170:171], v18 offset:26624
    ds_read_b128 v[140:143], v7 offset:832
    s_add_u32 s49, s51, 0x8c00
    buffer_load_dwordx4 v[244:247], v6, s[20:23], s49 offen sc1
    v_mfma_f32_16x16x32_bf16 v[76:79], v[176:179], v[196:199], v[76:79]
    s_waitcnt lgkmcnt(15)
    v_mfma_f32_16x16x32_bf16 v[80:83], v[180:183], v[192:195], v[80:83]
    ds_read_b64_tr_b16 v[172:173], v19 offset:24576
    ds_read_b64_tr_b16 v[174:175], v19 offset:26624
    ds_read_b128 v[144:147], v7 offset:896
    v_mfma_f32_16x16x32_bf16 v[84:87], v[180:183], v[196:199], v[84:87]
    s_waitcnt vmcnt(16) lgkmcnt(15)
    v_mfma_f32_16x16x32_bf16 v[24:27], v[152:155], v[200:203], v[24:27]
    ds_read_b64_tr_b16 v[176:177], v20 offset:24576
    ds_read_b64_tr_b16 v[178:179], v20 offset:26624
    ds_read_b128 v[148:151], v7 offset:960
    s_waitcnt vmcnt(15)
    v_mfma_f32_16x16x32_bf16 v[28:31], v[152:155], v[204:207], v[28:31]
    s_waitcnt lgkmcnt(15)
    v_mfma_f32_16x16x32_bf16 v[32:35], v[156:159], v[200:203], v[32:35]
    ds_read_b64_tr_b16 v[180:181], v21 offset:24576
    ds_read_b64_tr_b16 v[182:183], v21 offset:26624
    v_mfma_f32_16x16x32_bf16 v[36:39], v[156:159], v[204:207], v[36:39]
    s_waitcnt lgkmcnt(15)
    v_mfma_f32_16x16x32_bf16 v[40:43], v[160:163], v[200:203], v[40:43]
    ds_read_b64_tr_b16 v[152:153], v18 offset:20480
    ds_read_b64_tr_b16 v[154:155], v18 offset:22528
    v_sub_f32 v22, v14, v15
    v_fma_f32 v92, v15, v88, v92
    v_mfma_f32_16x16x32_bf16 v[44:47], v[160:163], v[204:207], v[44:47]
    v_fma_f32 v88, v22, v88, v92
    s_waitcnt lgkmcnt(14)
    v_mfma_f32_16x16x32_bf16 v[48:51], v[164:167], v[200:203], v[48:51]
    ds_read_b64_tr_b16 v[156:157], v19 offset:20480
    ds_read_b64_tr_b16 v[158:159], v19 offset:22528
    v_mul_f32 v88, s50, v88
    v_mul_f32 v92, s50, v92
    s_add_u32 s49, s51, 0x4000
    buffer_load_dwordx4 v[184:187], v6, s[20:23], s49 offen sc1
    v_mfma_f32_16x16x32_bf16 v[52:55], v[164:167], v[204:207], v[52:55]
    v_fma_f32 v93, v15, v89, v93
    s_waitcnt lgkmcnt(13)
    v_mfma_f32_16x16x32_bf16 v[56:59], v[168:171], v[200:203], v[56:59]
    ds_read_b64_tr_b16 v[160:161], v20 offset:20480
    ds_read_b64_tr_b16 v[162:163], v20 offset:22528
    v_fma_f32 v89, v22, v89, v93
    v_mul_f32 v89, s50, v89
    v_mfma_f32_16x16x32_bf16 v[60:63], v[168:171], v[204:207], v[60:63]
    v_mul_f32 v93, s50, v93
    s_waitcnt lgkmcnt(12)
    v_mfma_f32_16x16x32_bf16 v[64:67], v[172:175], v[200:203], v[64:67]
    ds_read_b64_tr_b16 v[164:165], v21 offset:20480
    ds_read_b64_tr_b16 v[166:167], v21 offset:22528
    v_fma_f32 v94, v15, v90, v94
    v_fma_f32 v90, v22, v90, v94
    v_mfma_f32_16x16x32_bf16 v[68:71], v[172:175], v[204:207], v[68:71]
    v_mul_f32 v90, s50, v90
    s_waitcnt lgkmcnt(11)
    v_mfma_f32_16x16x32_bf16 v[72:75], v[176:179], v[200:203], v[72:75]
    ds_read_b64_tr_b16 v[168:169], v18 offset:28672
    ds_read_b64_tr_b16 v[170:171], v18 offset:30720
    v_mul_f32 v94, s50, v94
    v_fma_f32 v95, v15, v91, v95
    s_add_u32 s49, s51, 0x9000
    buffer_load_dwordx4 v[188:191], v6, s[20:23], s49 offen sc1
    v_mfma_f32_16x16x32_bf16 v[76:79], v[176:179], v[204:207], v[76:79]
    v_fma_f32 v91, v22, v91, v95
    s_waitcnt lgkmcnt(10)
    v_mfma_f32_16x16x32_bf16 v[80:83], v[180:183], v[200:203], v[80:83]
    ds_read_b64_tr_b16 v[172:173], v19 offset:28672
    ds_read_b64_tr_b16 v[174:175], v19 offset:30720
    v_mul_f32 v91, s50, v91
    v_mfma_f32_16x16x32_bf16 v[84:87], v[180:183], v[204:207], v[84:87]
    v_mul_f32 v95, s50, v95
    v_fma_f32 v100, v15, v96, v100
    s_waitcnt vmcnt(15) lgkmcnt(10)
    v_mfma_f32_16x16x32_bf16 v[24:27], v[152:155], v[208:211], v[24:27]
    ds_read_b64_tr_b16 v[176:177], v20 offset:28672
    ds_read_b64_tr_b16 v[178:179], v20 offset:30720
    v_fma_f32 v96, v22, v96, v100
    s_waitcnt vmcnt(14)
    v_mfma_f32_16x16x32_bf16 v[28:31], v[152:155], v[212:215], v[28:31]
    v_mul_f32 v96, s53, v96
    v_mul_f32 v100, s53, v100
    s_waitcnt lgkmcnt(10)
    v_mfma_f32_16x16x32_bf16 v[32:35], v[156:159], v[208:211], v[32:35]
    ds_read_b64_tr_b16 v[180:181], v21 offset:28672
    ds_read_b64_tr_b16 v[182:183], v21 offset:30720
    v_fma_f32 v101, v15, v97, v101
    v_mfma_f32_16x16x32_bf16 v[36:39], v[156:159], v[212:215], v[36:39]
    v_fma_f32 v97, v22, v97, v101
    v_mul_f32 v97, s53, v97
    s_waitcnt lgkmcnt(10)
    v_mfma_f32_16x16x32_bf16 v[40:43], v[160:163], v[208:211], v[40:43]
    s_barrier
    ds_read_b64_tr_b16 v[152:153], v18 offset:32768
    ds_read_b64_tr_b16 v[154:155], v18 offset:34816
    v_mul_f32 v101, s53, v101
    v_mfma_f32_16x16x32_bf16 v[44:47], v[160:163], v[212:215], v[44:47]
    v_fma_f32 v102, v15, v98, v102
    v_fma_f32 v98, v22, v98, v102
    s_waitcnt lgkmcnt(10)
    v_mfma_f32_16x16x32_bf16 v[48:51], v[164:167], v[208:211], v[48:51]
    ds_read_b64_tr_b16 v[156:157], v19 offset:32768
    ds_read_b64_tr_b16 v[158:159], v19 offset:34816
    v_mul_f32 v98, s53, v98
    s_add_u32 s49, s51, 0x4400
    buffer_load_dwordx4 v[192:195], v6, s[20:23], s49 offen sc1
    v_mfma_f32_16x16x32_bf16 v[52:55], v[164:167], v[212:215], v[52:55]
    v_mul_f32 v102, s53, v102
    s_waitcnt lgkmcnt(10)
    v_mfma_f32_16x16x32_bf16 v[56:59], v[168:171], v[208:211], v[56:59]
    ds_read_b64_tr_b16 v[160:161], v20 offset:32768
    ds_read_b64_tr_b16 v[162:163], v20 offset:34816
    v_fma_f32 v103, v15, v99, v103
    v_fma_f32 v99, v22, v99, v103
    v_mfma_f32_16x16x32_bf16 v[60:63], v[168:171], v[212:215], v[60:63]
    v_mul_f32 v99, s53, v99
    s_waitcnt lgkmcnt(10)
    v_mfma_f32_16x16x32_bf16 v[64:67], v[172:175], v[208:211], v[64:67]
    ds_read_b64_tr_b16 v[164:165], v21 offset:32768
    ds_read_b64_tr_b16 v[166:167], v21 offset:34816
    v_mul_f32 v103, s53, v103
    v_fma_f32 v108, v15, v104, v108
    v_mfma_f32_16x16x32_bf16 v[68:71], v[172:175], v[212:215], v[68:71]
    v_fma_f32 v104, v22, v104, v108
    s_waitcnt lgkmcnt(10)
    v_mfma_f32_16x16x32_bf16 v[72:75], v[176:179], v[208:211], v[72:75]
    ds_read_b64_tr_b16 v[168:169], v18 offset:40960
    ds_read_b64_tr_b16 v[170:171], v18 offset:43008
    v_mul_f32 v104, s50, v104
    v_mul_f32 v108, s50, v108
    s_add_u32 s49, s51, 0x9400
    buffer_load_dwordx4 v[196:199], v6, s[20:23], s49 offen sc1
    v_mfma_f32_16x16x32_bf16 v[76:79], v[176:179], v[212:215], v[76:79]
    v_fma_f32 v109, v15, v105, v109
    s_waitcnt lgkmcnt(10)
    v_mfma_f32_16x16x32_bf16 v[80:83], v[180:183], v[208:211], v[80:83]
    ds_read_b64_tr_b16 v[172:173], v19 offset:40960
    ds_read_b64_tr_b16 v[174:175], v19 offset:43008
    v_fma_f32 v105, v22, v105, v109
    v_mul_f32 v105, s50, v105
    v_mfma_f32_16x16x32_bf16 v[84:87], v[180:183], v[212:215], v[84:87]
    v_mul_f32 v109, s50, v109
    s_waitcnt vmcnt(14) lgkmcnt(10)
    v_mfma_f32_16x16x32_bf16 v[24:27], v[152:155], v[216:219], v[24:27]
    ds_read_b64_tr_b16 v[176:177], v20 offset:40960
    ds_read_b64_tr_b16 v[178:179], v20 offset:43008
    v_fma_f32 v110, v15, v106, v110
    s_waitcnt vmcnt(13)
    v_mfma_f32_16x16x32_bf16 v[28:31], v[152:155], v[220:223], v[28:31]
    v_fma_f32 v106, v22, v106, v110
    v_mul_f32 v106, s50, v106
    s_waitcnt lgkmcnt(10)
    v_mfma_f32_16x16x32_bf16 v[32:35], v[156:159], v[216:219], v[32:35]
    ds_read_b64_tr_b16 v[180:181], v21 offset:40960
    ds_read_b64_tr_b16 v[182:183], v21 offset:43008
    v_mul_f32 v110, s50, v110
    v_mfma_f32_16x16x32_bf16 v[36:39], v[156:159], v[220:223], v[36:39]
    v_fma_f32 v111, v15, v107, v111
    v_fma_f32 v107, v22, v107, v111
    s_waitcnt lgkmcnt(10)
    v_mfma_f32_16x16x32_bf16 v[40:43], v[160:163], v[216:219], v[40:43]
    ds_read_b64_tr_b16 v[152:153], v18 offset:36864
    ds_read_b64_tr_b16 v[154:155], v18 offset:38912
    v_mul_f32 v107, s50, v107
    v_mfma_f32_16x16x32_bf16 v[44:47], v[160:163], v[220:223], v[44:47]
    v_mul_f32 v111, s50, v111
    v_fma_f32 v116, v15, v112, v116
    s_waitcnt lgkmcnt(10)
    v_mfma_f32_16x16x32_bf16 v[48:51], v[164:167], v[216:219], v[48:51]
    ds_read_b64_tr_b16 v[156:157], v19 offset:36864
    ds_read_b64_tr_b16 v[158:159], v19 offset:38912
    v_fma_f32 v112, v22, v112, v116
    s_add_u32 s49, s51, 0x4800
    buffer_load_dwordx4 v[200:203], v6, s[20:23], s49 offen sc1
    v_mfma_f32_16x16x32_bf16 v[52:55], v[164:167], v[220:223], v[52:55]
    v_mul_f32 v112, s53, v112
    v_mul_f32 v116, s53, v116
    s_waitcnt lgkmcnt(10)
    v_mfma_f32_16x16x32_bf16 v[56:59], v[168:171], v[216:219], v[56:59]
    ds_read_b64_tr_b16 v[160:161], v20 offset:36864
    ds_read_b64_tr_b16 v[162:163], v20 offset:38912
    v_fma_f32 v117, v15, v113, v117
    v_mfma_f32_16x16x32_bf16 v[60:63], v[168:171], v[220:223], v[60:63]
    v_fma_f32 v113, v22, v113, v117
    s_waitcnt lgkmcnt(10)
    v_mfma_f32_16x16x32_bf16 v[64:67], v[172:175], v[216:219], v[64:67]
    ds_read_b64_tr_b16 v[164:165], v21 offset:36864
    ds_read_b64_tr_b16 v[166:167], v21 offset:38912
    v_mul_f32 v113, s53, v113
    v_mul_f32 v117, s53, v117
    v_mfma_f32_16x16x32_bf16 v[68:71], v[172:175], v[220:223], v[68:71]
    v_fma_f32 v118, v15, v114, v118
    s_waitcnt lgkmcnt(10)
    v_mfma_f32_16x16x32_bf16 v[72:75], v[176:179], v[216:219], v[72:75]
    ds_read_b64_tr_b16 v[168:169], v18 offset:45056
    ds_read_b64_tr_b16 v[170:171], v18 offset:47104
    v_fma_f32 v114, v22, v114, v118
    v_mul_f32 v114, s53, v114
    s_add_u32 s49, s51, 0x9800
    buffer_load_dwordx4 v[204:207], v6, s[20:23], s49 offen sc1
    v_mfma_f32_16x16x32_bf16 v[76:79], v[176:179], v[220:223], v[76:79]
    v_mul_f32 v118, s53, v118
    s_waitcnt lgkmcnt(10)
    v_mfma_f32_16x16x32_bf16 v[80:83], v[180:183], v[216:219], v[80:83]
    ds_read_b64_tr_b16 v[172:173], v19 offset:45056
    ds_read_b64_tr_b16 v[174:175], v19 offset:47104
    v_fma_f32 v119, v15, v115, v119
    v_fma_f32 v115, v22, v115, v119
    v_mfma_f32_16x16x32_bf16 v[84:87], v[180:183], v[220:223], v[84:87]
    v_mul_f32 v115, s53, v115
    s_waitcnt vmcnt(13) lgkmcnt(10)
    v_mfma_f32_16x16x32_bf16 v[24:27], v[152:155], v[224:227], v[24:27]
    ds_read_b64_tr_b16 v[176:177], v20 offset:45056
    ds_read_b64_tr_b16 v[178:179], v20 offset:47104
    v_mul_f32 v119, s53, v119
    v_fma_f32 v124, v15, v120, v124
    s_waitcnt vmcnt(12)
    v_mfma_f32_16x16x32_bf16 v[28:31], v[152:155], v[228:231], v[28:31]
    v_fma_f32 v120, v22, v120, v124
    s_waitcnt lgkmcnt(10)
    v_mfma_f32_16x16x32_bf16 v[32:35], v[156:159], v[224:227], v[32:35]
    ds_read_b64_tr_b16 v[180:181], v21 offset:45056
    ds_read_b64_tr_b16 v[182:183], v21 offset:47104
    v_mul_f32 v120, s50, v120
    v_mfma_f32_16x16x32_bf16 v[36:39], v[156:159], v[228:231], v[36:39]
    v_mul_f32 v124, s50, v124
    v_fma_f32 v125, v15, v121, v125
    s_waitcnt lgkmcnt(10)
    v_mfma_f32_16x16x32_bf16 v[40:43], v[160:163], v[224:227], v[40:43]
    ds_read_b64_tr_b16 v[152:153], v18 offset:49152
    ds_read_b64_tr_b16 v[154:155], v18 offset:51200
    v_fma_f32 v121, v22, v121, v125
    s_cmp_lg_u32 s93, 4
    s_cbranch_scc1 L_adaLN_cond__sliding_block_cached__swiglu_ffn__prompt_kernel_51
    v_min_u32 v2, 39, v1
    v_lshlrev_b32 v2, 7, v2
    v_add_u32 v2, 0x70000, v2
    s_add_u32 s4, s94, 0x380000
    s_addc_u32 s5, s95, 0
    s_mov_b32 s6, 0x80000
    s_mov_b32 s7, 0x20000
    buffer_load_dword v3, v2, s[4:7], 0 offen sc1
L_adaLN_cond__sliding_block_cached__swiglu_ffn__prompt_kernel_51:
    v_mfma_f32_16x16x32_bf16 v[44:47], v[160:163], v[228:231], v[44:47]
    v_mul_f32 v121, s50, v121
    v_mul_f32 v125, s50, v125
    s_waitcnt lgkmcnt(10)
    v_mfma_f32_16x16x32_bf16 v[48:51], v[164:167], v[224:227], v[48:51]
    ds_read_b64_tr_b16 v[156:157], v19 offset:49152
    ds_read_b64_tr_b16 v[158:159], v19 offset:51200
    v_fma_f32 v126, v15, v122, v126
    s_add_u32 s49, s51, 0x4c00
    buffer_load_dwordx4 v[208:211], v6, s[20:23], s49 offen sc1
    v_mfma_f32_16x16x32_bf16 v[52:55], v[164:167], v[228:231], v[52:55]
    v_fma_f32 v122, v22, v122, v126
    v_mul_f32 v122, s50, v122
    s_waitcnt lgkmcnt(10)
    v_mfma_f32_16x16x32_bf16 v[56:59], v[168:171], v[224:227], v[56:59]
    ds_read_b64_tr_b16 v[160:161], v20 offset:49152
    ds_read_b64_tr_b16 v[162:163], v20 offset:51200
    v_mul_f32 v126, s50, v126
    v_mfma_f32_16x16x32_bf16 v[60:63], v[168:171], v[228:231], v[60:63]
    v_fma_f32 v127, v15, v123, v127
    v_fma_f32 v123, v22, v123, v127
    s_waitcnt lgkmcnt(10)
    v_mfma_f32_16x16x32_bf16 v[64:67], v[172:175], v[224:227], v[64:67]
    ds_read_b64_tr_b16 v[164:165], v21 offset:49152
    ds_read_b64_tr_b16 v[166:167], v21 offset:51200
    v_mul_f32 v123, s50, v123
    v_mfma_f32_16x16x32_bf16 v[68:71], v[172:175], v[228:231], v[68:71]
    v_mul_f32 v127, s50, v127
    s_waitcnt lgkmcnt(10)
    v_mfma_f32_16x16x32_bf16 v[72:75], v[176:179], v[224:227], v[72:75]
    ds_read_b64_tr_b16 v[168:169], v18 offset:57344
    ds_read_b64_tr_b16 v[170:171], v18 offset:59392
    v_fma_f32 v132, v15, v128, v132
    v_fma_f32 v128, v22, v128, v132
    s_add_u32 s49, s51, 0x9c00
    buffer_load_dwordx4 v[212:215], v6, s[20:23], s49 offen sc1
    v_mfma_f32_16x16x32_bf16 v[76:79], v[176:179], v[228:231], v[76:79]
    v_mul_f32 v128, s53, v128
    s_waitcnt lgkmcnt(10)
    v_mfma_f32_16x16x32_bf16 v[80:83], v[180:183], v[224:227], v[80:83]
    ds_read_b64_tr_b16 v[172:173], v19 offset:57344
    ds_read_b64_tr_b16 v[174:175], v19 offset:59392
    v_mul_f32 v132, s53, v132
    v_fma_f32 v133, v15, v129, v133
    v_mfma_f32_16x16x32_bf16 v[84:87], v[180:183], v[228:231], v[84:87]
    v_fma_f32 v129, v22, v129, v133
    s_waitcnt vmcnt(12) lgkmcnt(10)
    v_mfma_f32_16x16x32_bf16 v[24:27], v[152:155], v[232:235], v[24:27]
    ds_read_b64_tr_b16 v[176:177], v20 offset:57344
    ds_read_b64_tr_b16 v[178:179], v20 offset:59392
    v_mul_f32 v129, s53, v129
    v_mul_f32 v133, s53, v133
    s_waitcnt vmcnt(11)
    v_mfma_f32_16x16x32_bf16 v[28:31], v[152:155], v[236:239], v[28:31]
    v_fma_f32 v134, v15, v130, v134
    s_waitcnt lgkmcnt(10)
    v_mfma_f32_16x16x32_bf16 v[32:35], v[156:159], v[232:235], v[32:35]
    ds_read_b64_tr_b16 v[180:181], v21 offset:57344
    ds_read_b64_tr_b16 v[182:183], v21 offset:59392
    v_fma_f32 v130, v22, v130, v134
    v_mul_f32 v130, s53, v130
    v_mfma_f32_16x16x32_bf16 v[36:39], v[156:159], v[236:239], v[36:39]
    v_mul_f32 v134, s53, v134
    s_waitcnt lgkmcnt(10)
    v_mfma_f32_16x16x32_bf16 v[40:43], v[160:163], v[232:235], v[40:43]
    ds_read_b64_tr_b16 v[152:153], v18 offset:53248
    ds_read_b64_tr_b16 v[154:155], v18 offset:55296
    v_fma_f32 v135, v15, v131, v135
    v_mfma_f32_16x16x32_bf16 v[44:47], v[160:163], v[236:239], v[44:47]
    v_fma_f32 v131, v22, v131, v135
    v_mul_f32 v131, s53, v131
    s_waitcnt lgkmcnt(10)
    v_mfma_f32_16x16x32_bf16 v[48:51], v[164:167], v[232:235], v[48:51]
    ds_read_b64_tr_b16 v[156:157], v19 offset:53248
    ds_read_b64_tr_b16 v[158:159], v19 offset:55296
    v_mul_f32 v135, s53, v135
    v_mfma_f32_16x16x32_bf16 v[52:55], v[164:167], v[236:239], v[52:55]
    v_fma_f32 v140, v15, v136, v140
    v_fma_f32 v136, v22, v136, v140
    s_waitcnt lgkmcnt(10)
    v_mfma_f32_16x16x32_bf16 v[56:59], v[168:171], v[232:235], v[56:59]
    ds_read_b64_tr_b16 v[160:161], v20 offset:53248
    ds_read_b64_tr_b16 v[162:163], v20 offset:55296
    v_mul_f32 v136, s50, v136
    v_mfma_f32_16x16x32_bf16 v[60:63], v[168:171], v[236:239], v[60:63]
    v_mul_f32 v140, s50, v140
    v_fma_f32 v141, v15, v137, v141
    s_waitcnt lgkmcnt(10)
    v_mfma_f32_16x16x32_bf16 v[64:67], v[172:175], v[232:235], v[64:67]
    ds_read_b64_tr_b16 v[164:165], v21 offset:53248
    ds_read_b64_tr_b16 v[166:167], v21 offset:55296
    v_fma_f32 v137, v22, v137, v141
    v_mfma_f32_16x16x32_bf16 v[68:71], v[172:175], v[236:239], v[68:71]
    v_mul_f32 v137, s50, v137
    v_mul_f32 v141, s50, v141
    s_waitcnt lgkmcnt(10)
    v_mfma_f32_16x16x32_bf16 v[72:75], v[176:179], v[232:235], v[72:75]
    ds_read_b64_tr_b16 v[168:169], v18 offset:61440
    ds_read_b64_tr_b16 v[170:171], v18 offset:63488
    v_fma_f32 v142, v15, v138, v142
    v_mfma_f32_16x16x32_bf16 v[76:79], v[176:179], v[236:239], v[76:79]
    v_fma_f32 v138, v22, v138, v142
    s_waitcnt lgkmcnt(10)
    v_mfma_f32_16x16x32_bf16 v[80:83], v[180:183], v[232:235], v[80:83]
    ds_read_b64_tr_b16 v[172:173], v19 offset:61440
    ds_read_b64_tr_b16 v[174:175], v19 offset:63488
    v_mul_f32 v138, s50, v138
    v_mul_f32 v142, s50, v142
    v_mfma_f32_16x16x32_bf16 v[84:87], v[180:183], v[236:239], v[84:87]
    v_fma_f32 v143, v15, v139, v143
    s_waitcnt vmcnt(9) lgkmcnt(10)
    v_mfma_f32_16x16x32_bf16 v[24:27], v[152:155], v[240:243], v[24:27]
    ds_read_b64_tr_b16 v[176:177], v20 offset:61440
    ds_read_b64_tr_b16 v[178:179], v20 offset:63488
    v_fma_f32 v139, v22, v139, v143
    v_mul_f32 v139, s50, v139
    s_waitcnt vmcnt(8)
    v_mfma_f32_16x16x32_bf16 v[28:31], v[152:155], v[244:247], v[28:31]
    v_mul_f32 v143, s50, v143
    s_waitcnt lgkmcnt(10)
    v_mfma_f32_16x16x32_bf16 v[32:35], v[156:159], v[240:243], v[32:35]
    ds_read_b64_tr_b16 v[180:181], v21 offset:61440
    ds_read_b64_tr_b16 v[182:183], v21 offset:63488
    v_fma_f32 v148, v15, v144, v148
    v_fma_f32 v144, v22, v144, v148
    v_mfma_f32_16x16x32_bf16 v[36:39], v[156:159], v[244:247], v[36:39]
    v_mul_f32 v144, s53, v144
    s_cmp_lg_u32 s93, 4
    s_cbranch_scc1 L_adaLN_cond__sliding_block_cached__swiglu_ffn__prompt_kernel_52
    s_waitcnt vmcnt(2)
    v_xor_b32 v3, s98, v3
    v_cmp_ne_u32 vcc, 0, v3
    s_cbranch_vccnz L_adaLN_cond__sliding_block_cached__swiglu_ffn__prompt_kernel_53
L_adaLN_cond__sliding_block_cached__swiglu_ffn__prompt_kernel_52:
    s_waitcnt lgkmcnt(10)
    v_mfma_f32_16x16x32_bf16 v[40:43], v[160:163], v[240:243], v[40:43]
    s_barrier
    v_add_u32 v18, 0x10000, v18
    v_add_u32 v19, 0x10000, v19
    v_add_u32 v20, 0x10000, v20
    v_add_u32 v21, 0x10000, v21
    ds_read_b64_tr_b16 v[152:153], v18 offset:0
    ds_read_b64_tr_b16 v[154:155], v18 offset:2048
    v_mul_f32 v148, s53, v148
    v_fma_f32 v149, v15, v145, v149
    v_mfma_f32_16x16x32_bf16 v[44:47], v[160:163], v[244:247], v[44:47]
    v_fma_f32 v145, v22, v145, v149
    s_waitcnt lgkmcnt(10)
    v_mfma_f32_16x16x32_bf16 v[48:51], v[164:167], v[240:243], v[48:51]
    ds_read_b64_tr_b16 v[156:157], v18 offset:8192
    ds_read_b64_tr_b16 v[158:159], v18 offset:10240
    v_mul_f32 v145, s53, v145
    v_mfma_f32_16x16x32_bf16 v[52:55], v[164:167], v[244:247], v[52:55]
    v_mul_f32 v149, s53, v149
    v_fma_f32 v150, v15, v146, v150
    s_waitcnt lgkmcnt(10)
    v_mfma_f32_16x16x32_bf16 v[56:59], v[168:171], v[240:243], v[56:59]
    ds_read_b64_tr_b16 v[160:161], v18 offset:4096
    ds_read_b64_tr_b16 v[162:163], v18 offset:6144
    v_fma_f32 v146, v22, v146, v150
    v_mfma_f32_16x16x32_bf16 v[60:63], v[168:171], v[244:247], v[60:63]
    v_mul_f32 v146, s53, v146
    v_mul_f32 v150, s53, v150
    s_waitcnt lgkmcnt(10)
    v_mfma_f32_16x16x32_bf16 v[64:67], v[172:175], v[240:243], v[64:67]
    ds_read_b64_tr_b16 v[164:165], v18 offset:12288
    ds_read_b64_tr_b16 v[166:167], v18 offset:14336
    v_fma_f32 v151, v15, v147, v151
    v_mfma_f32_16x16x32_bf16 v[68:71], v[172:175], v[244:247], v[68:71]
    v_fma_f32 v147, v22, v147, v151
    v_mul_f32 v147, s53, v147
    s_waitcnt lgkmcnt(10)
    v_mfma_f32_16x16x32_bf16 v[72:75], v[176:179], v[240:243], v[72:75]
    ds_read_b64_tr_b16 v[168:169], v18 offset:16384
    ds_read_b64_tr_b16 v[170:171], v18 offset:18432
    v_mul_f32 v151, s53, v151
    v_mfma_f32_16x16x32_bf16 v[76:79], v[176:179], v[244:247], v[76:79]
    v_mul_f32 v12, s53, v10
    v_mul_f32 v10, s50, v10
    s_waitcnt lgkmcnt(10)
    v_mfma_f32_16x16x32_bf16 v[80:83], v[180:183], v[240:243], v[80:83]
    ds_read_b64_tr_b16 v[172:173], v18 offset:24576
    ds_read_b64_tr_b16 v[174:175], v18 offset:26624
    v_mul_f32 v13, s53, v11
    v_mfma_f32_16x16x32_bf16 v[84:87], v[180:183], v[244:247], v[84:87]
    v_mul_f32 v11, s50, v11
    s_waitcnt vmcnt(7) lgkmcnt(10)
    v_mfma_f32_16x16x32_bf16 v[24:27], v[152:155], v[184:187], v[24:27]
    ds_read_b64_tr_b16 v[176:177], v18 offset:20480
    ds_read_b64_tr_b16 v[178:179], v18 offset:22528
    s_waitcnt vmcnt(6)
    v_mfma_f32_16x16x32_bf16 v[28:31], v[152:155], v[188:191], v[28:31]
    s_waitcnt lgkmcnt(10)
    v_mfma_f32_16x16x32_bf16 v[56:59], v[156:159], v[184:187], v[56:59]
    ds_read_b64_tr_b16 v[180:181], v18 offset:28672
    ds_read_b64_tr_b16 v[182:183], v18 offset:30720
    v_mfma_f32_16x16x32_bf16 v[60:63], v[156:159], v[188:191], v[60:63]
    s_waitcnt vmcnt(5) lgkmcnt(10)
    v_mfma_f32_16x16x32_bf16 v[24:27], v[160:163], v[192:195], v[24:27]
    ds_read_b64_tr_b16 v[152:153], v19 offset:0
    ds_read_b64_tr_b16 v[154:155], v19 offset:2048
    s_waitcnt vmcnt(4)
    v_mfma_f32_16x16x32_bf16 v[28:31], v[160:163], v[196:199], v[28:31]
    s_waitcnt lgkmcnt(10)
    v_mfma_f32_16x16x32_bf16 v[56:59], v[164:167], v[192:195], v[56:59]
    ds_read_b64_tr_b16 v[156:157], v19 offset:8192
    ds_read_b64_tr_b16 v[158:159], v19 offset:10240
    v_mfma_f32_16x16x32_bf16 v[60:63], v[164:167], v[196:199], v[60:63]
    s_waitcnt vmcnt(3) lgkmcnt(10)
    v_mfma_f32_16x16x32_bf16 v[24:27], v[168:171], v[200:203], v[24:27]
    ds_read_b64_tr_b16 v[160:161], v19 offset:4096
    ds_read_b64_tr_b16 v[162:163], v19 offset:6144
    s_waitcnt vmcnt(2)
    v_mfma_f32_16x16x32_bf16 v[28:31], v[168:171], v[204:207], v[28:31]
    s_waitcnt lgkmcnt(10)
    v_mfma_f32_16x16x32_bf16 v[56:59], v[172:175], v[200:203], v[56:59]
    ds_read_b64_tr_b16 v[164:165], v19 offset:12288
    ds_read_b64_tr_b16 v[166:167], v19 offset:14336
    v_mfma_f32_16x16x32_bf16 v[60:63], v[172:175], v[204:207], v[60:63]
    s_waitcnt vmcnt(1) lgkmcnt(10)
    v_mfma_f32_16x16x32_bf16 v[24:27], v[176:179], v[208:211], v[24:27]
    ds_read_b64_tr_b16 v[168:169], v19 offset:16384
    ds_read_b64_tr_b16 v[170:171], v19 offset:18432
    s_waitcnt vmcnt(0)
    v_mfma_f32_16x16x32_bf16 v[28:31], v[176:179], v[212:215], v[28:31]
    s_waitcnt lgkmcnt(10)
    v_mfma_f32_16x16x32_bf16 v[56:59], v[180:183], v[208:211], v[56:59]
    ds_read_b64_tr_b16 v[172:173], v19 offset:24576
    ds_read_b64_tr_b16 v[174:175], v19 offset:26624
    v_mfma_f32_16x16x32_bf16 v[60:63], v[180:183], v[212:215], v[60:63]
    s_waitcnt lgkmcnt(10)
    v_mfma_f32_16x16x32_bf16 v[32:35], v[152:155], v[184:187], v[32:35]
    ds_read_b64_tr_b16 v[176:177], v19 offset:20480
    ds_read_b64_tr_b16 v[178:179], v19 offset:22528
    v_mfma_f32_16x16x32_bf16 v[36:39], v[152:155], v[188:191], v[36:39]
    s_waitcnt lgkmcnt(10)
    v_mfma_f32_16x16x32_bf16 v[64:67], v[156:159], v[184:187], v[64:67]
    ds_read_b64_tr_b16 v[180:181], v19 offset:28672
    ds_read_b64_tr_b16 v[182:183], v19 offset:30720
    v_fma_f32 v24, v24, v10, v88
    v_fma_f32 v25, v25, v10, v89
    v_fma_f32 v26, v26, v10, v90
    v_fma_f32 v27, v27, v10, v91
    v_exp_f32 v216, v24
    v_mfma_f32_16x16x32_bf16 v[68:71], v[156:159], v[188:191], v[68:71]
    v_exp_f32 v217, v25
    v_exp_f32 v218, v26
    v_exp_f32 v219, v27
    v_fma_f32 v56, v56, v12, v96
    s_waitcnt lgkmcnt(10)
    v_mfma_f32_16x16x32_bf16 v[32:35], v[160:163], v[192:195], v[32:35]
    ds_read_b64_tr_b16 v[152:153], v20 offset:0
    ds_read_b64_tr_b16 v[154:155], v20 offset:2048
    v_fma_f32 v57, v57, v12, v97
    v_fma_f32 v58, v58, v12, v98
    v_fma_f32 v59, v59, v12, v99
    v_add_f32 v216, 1.0, v216
    v_mfma_f32_16x16x32_bf16 v[36:39], v[160:163], v[196:199], v[36:39]
    v_add_f32 v217, 1.0, v217
    v_add_f32 v218, 1.0, v218
    v_add_f32 v219, 1.0, v219
    v_rcp_f32 v216, v216
    v_rcp_f32 v217, v217
    s_waitcnt lgkmcnt(10)
    v_mfma_f32_16x16x32_bf16 v[64:67], v[164:167], v[192:195], v[64:67]
    ds_read_b64_tr_b16 v[156:157], v20 offset:8192
    ds_read_b64_tr_b16 v[158:159], v20 offset:10240
    v_rcp_f32 v218, v218
    v_rcp_f32 v219, v219
    v_mul_f32 v24, v24, v56
    v_mul_f32 v25, v25, v57
    v_mfma_f32_16x16x32_bf16 v[68:71], v[164:167], v[196:199], v[68:71]
    v_mul_f32 v26, v26, v58
    v_mul_f32 v27, v27, v59
    v_mul_f32 v24, v24, v216
    v_mul_f32 v25, v25, v217
    s_waitcnt lgkmcnt(10)
    v_mfma_f32_16x16x32_bf16 v[32:35], v[168:171], v[200:203], v[32:35]
    ds_read_b64_tr_b16 v[160:161], v20 offset:4096
    ds_read_b64_tr_b16 v[162:163], v20 offset:6144
    v_mul_f32 v26, v26, v218
    v_mul_f32 v27, v27, v219
    v_cvt_pk_bf16_f32 v248, v24, v25
    v_cvt_pk_bf16_f32 v249, v26, v27
    v_mfma_f32_16x16x32_bf16 v[36:39], v[168:171], v[204:207], v[36:39]
    v_fma_f32 v28, v28, v11, v92
    v_fma_f32 v29, v29, v11, v93
    v_fma_f32 v30, v30, v11, v94
    v_fma_f32 v31, v31, v11, v95
    v_exp_f32 v224, v28
    s_waitcnt lgkmcnt(10)
    v_mfma_f32_16x16x32_bf16 v[64:67], v[172:175], v[200:203], v[64:67]
    ds_read_b64_tr_b16 v[164:165], v20 offset:12288
    ds_read_b64_tr_b16 v[166:167], v20 offset:14336
    v_exp_f32 v225, v29
    v_exp_f32 v226, v30
    v_exp_f32 v227, v31
    v_fma_f32 v60, v60, v13, v100
    v_mfma_f32_16x16x32_bf16 v[68:71], v[172:175], v[204:207], v[68:71]
    v_fma_f32 v61, v61, v13, v101
    v_fma_f32 v62, v62, v13, v102
    v_fma_f32 v63, v63, v13, v103
    v_add_f32 v224, 1.0, v224
    s_waitcnt lgkmcnt(10)
    v_mfma_f32_16x16x32_bf16 v[32:35], v[176:179], v[208:211], v[32:35]
    ds_read_b64_tr_b16 v[168:169], v20 offset:16384
    ds_read_b64_tr_b16 v[170:171], v20 offset:18432
    v_add_f32 v225, 1.0, v225
    v_add_f32 v226, 1.0, v226
    v_add_f32 v227, 1.0, v227
    v_rcp_f32 v224, v224
    v_rcp_f32 v225, v225
    v_mfma_f32_16x16x32_bf16 v[36:39], v[176:179], v[212:215], v[36:39]
    v_rcp_f32 v226, v226
    v_rcp_f32 v227, v227
    v_mul_f32 v28, v28, v60
    v_mul_f32 v29, v29, v61
    s_waitcnt lgkmcnt(10)
    v_mfma_f32_16x16x32_bf16 v[64:67], v[180:183], v[208:211], v[64:67]
    ds_read_b64_tr_b16 v[172:173], v20 offset:24576
    ds_read_b64_tr_b16 v[174:175], v20 offset:26624
    v_mul_f32 v30, v30, v62
    v_mul_f32 v31, v31, v63
    v_mul_f32 v28, v28, v224
    v_mul_f32 v29, v29, v225
    v_mfma_f32_16x16x32_bf16 v[68:71], v[180:183], v[212:215], v[68:71]
    v_mul_f32 v30, v30, v226
    v_mul_f32 v31, v31, v227
    v_cvt_pk_bf16_f32 v252, v28, v29
    v_cvt_pk_bf16_f32 v253, v30, v31
    s_waitcnt lgkmcnt(10)
    v_mfma_f32_16x16x32_bf16 v[40:43], v[152:155], v[184:187], v[40:43]
    ds_read_b64_tr_b16 v[176:177], v20 offset:20480
    ds_read_b64_tr_b16 v[178:179], v20 offset:22528
    v_mfma_f32_16x16x32_bf16 v[44:47], v[152:155], v[188:191], v[44:47]
    s_waitcnt lgkmcnt(10)
    v_mfma_f32_16x16x32_bf16 v[72:75], v[156:159], v[184:187], v[72:75]
    ds_read_b64_tr_b16 v[180:181], v20 offset:28672
    ds_read_b64_tr_b16 v[182:183], v20 offset:30720
    v_fma_f32 v32, v32, v10, v104
    v_fma_f32 v33, v33, v10, v105
    v_fma_f32 v34, v34, v10, v106
    v_fma_f32 v35, v35, v10, v107
    v_exp_f32 v220, v32
    v_mfma_f32_16x16x32_bf16 v[76:79], v[156:159], v[188:191], v[76:79]
    v_exp_f32 v221, v33
    v_exp_f32 v222, v34
    v_exp_f32 v223, v35
    v_fma_f32 v64, v64, v12, v112
    s_waitcnt lgkmcnt(10)
    v_mfma_f32_16x16x32_bf16 v[40:43], v[160:163], v[192:195], v[40:43]
    ds_read_b64_tr_b16 v[152:153], v21 offset:0
    ds_read_b64_tr_b16 v[154:155], v21 offset:2048
    v_fma_f32 v65, v65, v12, v113
    v_fma_f32 v66, v66, v12, v114
    v_fma_f32 v67, v67, v12, v115
    v_add_f32 v220, 1.0, v220
    v_add_f32 v221, 1.0, v221
    v_mfma_f32_16x16x32_bf16 v[44:47], v[160:163], v[196:199], v[44:47]
    v_add_f32 v222, 1.0, v222
    v_add_f32 v223, 1.0, v223
    v_rcp_f32 v220, v220
    v_rcp_f32 v221, v221
    s_waitcnt lgkmcnt(10)
    v_mfma_f32_16x16x32_bf16 v[72:75], v[164:167], v[192:195], v[72:75]
    ds_read_b64_tr_b16 v[156:157], v21 offset:8192
    ds_read_b64_tr_b16 v[158:159], v21 offset:10240
    v_rcp_f32 v222, v222
    v_rcp_f32 v223, v223
    v_mul_f32 v32, v32, v64
    v_mul_f32 v33, v33, v65
    v_mul_f32 v34, v34, v66
    v_mfma_f32_16x16x32_bf16 v[76:79], v[164:167], v[196:199], v[76:79]
    v_mul_f32 v35, v35, v67
    v_mul_f32 v32, v32, v220
    v_mul_f32 v33, v33, v221
    v_mul_f32 v34, v34, v222
    s_waitcnt lgkmcnt(10)
    v_mfma_f32_16x16x32_bf16 v[40:43], v[168:171], v[200:203], v[40:43]
    ds_read_b64_tr_b16 v[160:161], v21 offset:4096
    ds_read_b64_tr_b16 v[162:163], v21 offset:6144
    v_mul_f32 v35, v35, v223
    v_cvt_pk_bf16_f32 v250, v32, v33
    v_cvt_pk_bf16_f32 v251, v34, v35
    s_add_u32 s44, s52, 0
    buffer_store_dwordx4 v[248:251], v6, s[32:35], s44 offen offset:0 sc1
    v_mfma_f32_16x16x32_bf16 v[44:47], v[168:171], v[204:207], v[44:47]
    v_fma_f32 v36, v36, v11, v108
    v_fma_f32 v37, v37, v11, v109
    v_fma_f32 v38, v38, v11, v110
    v_fma_f32 v39, v39, v11, v111
    v_exp_f32 v228, v36
    s_waitcnt lgkmcnt(10)
    v_mfma_f32_16x16x32_bf16 v[72:75], v[172:175], v[200:203], v[72:75]
    ds_read_b64_tr_b16 v[164:165], v21 offset:12288
    ds_read_b64_tr_b16 v[166:167], v21 offset:14336
    v_exp_f32 v229, v37
    v_exp_f32 v230, v38
    v_exp_f32 v231, v39
    v_fma_f32 v68, v68, v13, v116
    v_mfma_f32_16x16x32_bf16 v[76:79], v[172:175], v[204:207], v[76:79]
    v_fma_f32 v69, v69, v13, v117
    v_fma_f32 v70, v70, v13, v118
    v_fma_f32 v71, v71, v13, v119
    v_add_f32 v228, 1.0, v228
    v_add_f32 v229, 1.0, v229
    s_waitcnt lgkmcnt(10)
    v_mfma_f32_16x16x32_bf16 v[40:43], v[176:179], v[208:211], v[40:43]
    ds_read_b64_tr_b16 v[168:169], v21 offset:16384
    ds_read_b64_tr_b16 v[170:171], v21 offset:18432
    v_add_f32 v230, 1.0, v230
    v_add_f32 v231, 1.0, v231
    v_rcp_f32 v228, v228
    v_rcp_f32 v229, v229
    v_mfma_f32_16x16x32_bf16 v[44:47], v[176:179], v[212:215], v[44:47]
    v_rcp_f32 v230, v230
    v_rcp_f32 v231, v231
    v_mul_f32 v36, v36, v68
    v_mul_f32 v37, v37, v69
    v_mul_f32 v38, v38, v70
    s_waitcnt lgkmcnt(10)
    v_mfma_f32_16x16x32_bf16 v[72:75], v[180:183], v[208:211], v[72:75]
    ds_read_b64_tr_b16 v[172:173], v21 offset:24576
    ds_read_b64_tr_b16 v[174:175], v21 offset:26624
    v_mul_f32 v39, v39, v71
    v_mul_f32 v36, v36, v228
    v_mul_f32 v37, v37, v229
    v_mul_f32 v38, v38, v230
    v_mfma_f32_16x16x32_bf16 v[76:79], v[180:183], v[212:215], v[76:79]
    v_mul_f32 v39, v39, v231
    v_cvt_pk_bf16_f32 v254, v36, v37
    v_cvt_pk_bf16_f32 v255, v38, v39
    s_add_u32 s44, s52, 0
    buffer_store_dwordx4 v[252:255], v6, s[32:35], s44 offen offset:1024 sc1
    s_waitcnt lgkmcnt(10)
    v_mfma_f32_16x16x32_bf16 v[48:51], v[152:155], v[184:187], v[48:51]
    ds_read_b64_tr_b16 v[176:177], v21 offset:20480
    ds_read_b64_tr_b16 v[178:179], v21 offset:22528
    v_mfma_f32_16x16x32_bf16 v[52:55], v[152:155], v[188:191], v[52:55]
    s_waitcnt lgkmcnt(10)
    v_mfma_f32_16x16x32_bf16 v[80:83], v[156:159], v[184:187], v[80:83]
    ds_read_b64_tr_b16 v[180:181], v21 offset:28672
    ds_read_b64_tr_b16 v[182:183], v21 offset:30720
    v_fma_f32 v40, v40, v10, v120
    v_fma_f32 v41, v41, v10, v121
    v_fma_f32 v42, v42, v10, v122
    v_fma_f32 v43, v43, v10, v123
    v_exp_f32 v216, v40
    v_mfma_f32_16x16x32_bf16 v[84:87], v[156:159], v[188:191], v[84:87]
    v_exp_f32 v217, v41
    v_exp_f32 v218, v42
    v_exp_f32 v219, v43
    v_fma_f32 v72, v72, v12, v128
    s_waitcnt lgkmcnt(10)
    v_mfma_f32_16x16x32_bf16 v[48:51], v[160:163], v[192:195], v[48:51]
    v_fma_f32 v73, v73, v12, v129
    v_fma_f32 v74, v74, v12, v130
    v_fma_f32 v75, v75, v12, v131
    v_add_f32 v216, 1.0, v216
    v_mfma_f32_16x16x32_bf16 v[52:55], v[160:163], v[196:199], v[52:55]
    v_add_f32 v217, 1.0, v217
    v_add_f32 v218, 1.0, v218
    v_add_f32 v219, 1.0, v219
    v_rcp_f32 v216, v216
    v_rcp_f32 v217, v217
    s_waitcnt lgkmcnt(8)
    v_mfma_f32_16x16x32_bf16 v[80:83], v[164:167], v[192:195], v[80:83]
    v_rcp_f32 v218, v218
    v_rcp_f32 v219, v219
    v_mul_f32 v40, v40, v72
    v_mul_f32 v41, v41, v73
    v_mfma_f32_16x16x32_bf16 v[84:87], v[164:167], v[196:199], v[84:87]
    v_mul_f32 v42, v42, v74
    v_mul_f32 v43, v43, v75
    v_mul_f32 v40, v40, v216
    v_mul_f32 v41, v41, v217
    s_waitcnt lgkmcnt(6)
    v_mfma_f32_16x16x32_bf16 v[48:51], v[168:171], v[200:203], v[48:51]
    v_mul_f32 v42, v42, v218
    v_mul_f32 v43, v43, v219
    v_cvt_pk_bf16_f32 v248, v40, v41
    v_cvt_pk_bf16_f32 v249, v42, v43
    v_mfma_f32_16x16x32_bf16 v[52:55], v[168:171], v[204:207], v[52:55]
    v_fma_f32 v44, v44, v11, v124
    v_fma_f32 v45, v45, v11, v125
    v_fma_f32 v46, v46, v11, v126
    v_fma_f32 v47, v47, v11, v127
    v_exp_f32 v224, v44
    s_waitcnt lgkmcnt(4)
    v_mfma_f32_16x16x32_bf16 v[80:83], v[172:175], v[200:203], v[80:83]
    v_exp_f32 v225, v45
    v_exp_f32 v226, v46
    v_exp_f32 v227, v47
    v_fma_f32 v76, v76, v13, v132
    v_mfma_f32_16x16x32_bf16 v[84:87], v[172:175], v[204:207], v[84:87]
    v_fma_f32 v77, v77, v13, v133
    v_fma_f32 v78, v78, v13, v134
    v_fma_f32 v79, v79, v13, v135
    v_add_f32 v224, 1.0, v224
    s_waitcnt lgkmcnt(2)
    v_mfma_f32_16x16x32_bf16 v[48:51], v[176:179], v[208:211], v[48:51]
    v_add_f32 v225, 1.0, v225
    v_add_f32 v226, 1.0, v226
    v_add_f32 v227, 1.0, v227
    v_rcp_f32 v224, v224
    v_rcp_f32 v225, v225
    v_mfma_f32_16x16x32_bf16 v[52:55], v[176:179], v[212:215], v[52:55]
    v_rcp_f32 v226, v226
    v_rcp_f32 v227, v227
    v_mul_f32 v44, v44, v76
    v_mul_f32 v45, v45, v77
    s_waitcnt lgkmcnt(0)
    v_mfma_f32_16x16x32_bf16 v[80:83], v[180:183], v[208:211], v[80:83]
    v_mul_f32 v46, v46, v78
    v_mul_f32 v47, v47, v79
    v_mul_f32 v44, v44, v224
    v_mul_f32 v45, v45, v225
    v_mfma_f32_16x16x32_bf16 v[84:87], v[180:183], v[212:215], v[84:87]
    v_mul_f32 v46, v46, v226
    v_mul_f32 v47, v47, v227
    v_cvt_pk_bf16_f32 v252, v44, v45
    v_cvt_pk_bf16_f32 v253, v46, v47
    v_fma_f32 v48, v48, v10, v136
    v_fma_f32 v49, v49, v10, v137
    v_fma_f32 v50, v50, v10, v138
    v_fma_f32 v51, v51, v10, v139
    v_exp_f32 v220, v48
    v_exp_f32 v221, v49
    v_exp_f32 v222, v50
    v_exp_f32 v223, v51
    v_fma_f32 v80, v80, v12, v144
    v_fma_f32 v81, v81, v12, v145
    v_fma_f32 v82, v82, v12, v146
    v_fma_f32 v83, v83, v12, v147
    v_add_f32 v220, 1.0, v220
    v_add_f32 v221, 1.0, v221
    v_add_f32 v222, 1.0, v222
    v_add_f32 v223, 1.0, v223
    v_rcp_f32 v220, v220
    v_rcp_f32 v221, v221
    v_rcp_f32 v222, v222
    v_rcp_f32 v223, v223
    v_mul_f32 v48, v48, v80
    v_mul_f32 v49, v49, v81
    v_mul_f32 v50, v50, v82
    v_mul_f32 v51, v51, v83
    v_mul_f32 v48, v48, v220
    v_mul_f32 v49, v49, v221
    v_mul_f32 v50, v50, v222
    v_mul_f32 v51, v51, v223
    v_cvt_pk_bf16_f32 v250, v48, v49
    v_cvt_pk_bf16_f32 v251, v50, v51
    s_add_u32 s44, s52, 4096
    buffer_store_dwordx4 v[248:251], v6, s[32:35], s44 offen offset:0 sc1
    v_fma_f32 v52, v52, v11, v140
    v_fma_f32 v53, v53, v11, v141
    v_fma_f32 v54, v54, v11, v142
    v_fma_f32 v55, v55, v11, v143
    v_exp_f32 v228, v52
    v_exp_f32 v229, v53
    v_exp_f32 v230, v54
    v_exp_f32 v231, v55
    v_fma_f32 v84, v84, v13, v148
    v_fma_f32 v85, v85, v13, v149
    v_fma_f32 v86, v86, v13, v150
    v_fma_f32 v87, v87, v13, v151
    v_add_f32 v228, 1.0, v228
    v_add_f32 v229, 1.0, v229
    v_add_f32 v230, 1.0, v230
    v_add_f32 v231, 1.0, v231
    v_rcp_f32 v228, v228
    v_rcp_f32 v229, v229
    v_rcp_f32 v230, v230
    v_rcp_f32 v231, v231
    v_mul_f32 v52, v52, v84
    v_mul_f32 v53, v53, v85
    v_mul_f32 v54, v54, v86
    v_mul_f32 v55, v55, v87
    v_mul_f32 v52, v52, v228
    v_mul_f32 v53, v53, v229
    v_mul_f32 v54, v54, v230
    v_mul_f32 v55, v55, v231
    v_cvt_pk_bf16_f32 v254, v52, v53
    v_cvt_pk_bf16_f32 v255, v54, v55
    s_add_u32 s44, s52, 4096
    buffer_store_dwordx4 v[252:255], v6, s[32:35], s44 offen offset:1024 sc1
    s_lshl_b32 s92, s38, 6
    s_add_u32 s92, s92, s37
    s_lshl_b32 s92, s92, 7
    s_add_u32 s92, s92, 0x40000
    s_branch L_adaLN_cond__sliding_block_cached__swiglu_ffn__prompt_kernel_45
L_adaLN_cond__sliding_block_cached__swiglu_ffn__prompt_kernel_44:
    s_load_dwordx2 s[84:85], s[0:1], 32
    s_load_dwordx2 s[86:87], s[0:1], 64
    v_and_b32 v1, 63, v0
    s_sub_u32 s40, s2, 216
    s_waitcnt lgkmcnt(0)
    s_mul_i32 s72, s40, 8
    s_add_u32 s72, s72, s93
    s_mul_i32 s72, s72, 2
    s_add_u32 s72, s72, 0
    s_add_u32 s72, s72, 1280
    s_sub_u32 s73, s72, 1280
    s_cmp_lt_u32 s72, 1280
    s_cselect_b32 s73, s72, s73
    s_cselect_b32 s78, 128, 54
    s_mov_b32 s74, 0x21c000
    s_cselect_b32 s74, 0x500000, s74
    s_mov_b32 s75, 0x2a00000
    s_cselect_b32 s75, 0x2400000, s75
    s_cselect_b32 s60, s84, s86
    s_cselect_b32 s61, s85, s87
    s_cmp_lt_u32 s72, 1820
    s_cselect_b32 s62, s74, 0
    s_mov_b32 s63, 0x20000
    s_add_u32 s64, s94, s75
    s_addc_u32 s65, s95, 0
    s_mov_b32 s66, s62
    s_mov_b32 s67, 0x20000
    s_mul_hi_u32 s76, s73, 0x1999999a
    s_mul_i32 s77, s76, 10
    s_sub_u32 s77, s73, s77
    s_mul_i32 s73, s76, 40960
    s_lshl_b32 s74, s77, 7
    s_add_u32 s73, s73, s74
    v_lshrrev_b32 v19, 3, v1
    v_mul_u32_u24 v16, 1280, v19
    v_and_b32 v19, 7, v1
    v_lshl_add_u32 v16, v19, 4, v16
    v_lshrrev_b32 v17, 2, v1
    v_lshlrev_b32 v17, 7, v17
    v_and_b32 v19, 3, v1
    v_lshl_add_u32 v17, v19, 3, v17
    s_lshl_b32 s75, s93, 12
    s_add_u32 s75, s75, 0x0
    v_add_u32 v17, s75, v17
    v_lshlrev_b32 v18, 4, v1
    s_add_u32 m0, s75, 0
    s_add_u32 s80, s73, 0
    buffer_load_dwordx4 v16, s[60:63], s80 offen lds
    s_add_u32 m0, s75, 1024
    s_add_u32 s80, s73, 10240
    buffer_load_dwordx4 v16, s[60:63], s80 offen lds
    s_add_u32 m0, s75, 2048
    s_add_u32 s80, s73, 20480
    buffer_load_dwordx4 v16, s[60:63], s80 offen lds
    s_add_u32 m0, s75, 3072
    s_add_u32 s80, s73, 30720
    buffer_load_dwordx4 v16, s[60:63], s80 offen lds
    s_waitcnt vmcnt(0)
    ds_read_b64_tr_b16 v[20:21], v17 offset:0
    ds_read_b64_tr_b16 v[22:23], v17 offset:2048
    ds_read_b64_tr_b16 v[24:25], v17 offset:32
    ds_read_b64_tr_b16 v[26:27], v17 offset:2080
    ds_read_b64_tr_b16 v[28:29], v17 offset:64
    ds_read_b64_tr_b16 v[30:31], v17 offset:2112
    ds_read_b64_tr_b16 v[32:33], v17 offset:96
    ds_read_b64_tr_b16 v[34:35], v17 offset:2144
    s_lshl_b32 s80, s77, 2
    s_add_u32 s80, s80, 0
    s_mul_i32 s82, s80, 52429
    s_lshr_b32 s82, s82, 18
    s_mul_i32 s81, s82, 5
    s_sub_u32 s80, s80, s81
    s_mul_i32 s81, s82, s78
    s_add_u32 s81, s81, s76
    s_mul_i32 s81, s81, 5
    s_add_u32 s80, s80, s81
    s_lshl_b32 s80, s80, 10
    s_waitcnt lgkmcnt(6)
    buffer_store_dwordx4 v[20:23], v18, s[64:67], s80 offen sc1
    s_lshl_b32 s80, s77, 2
    s_add_u32 s80, s80, 1
    s_mul_i32 s82, s80, 52429
    s_lshr_b32 s82, s82, 18
    s_mul_i32 s81, s82, 5
    s_sub_u32 s80, s80, s81
    s_mul_i32 s81, s82, s78
    s_add_u32 s81, s81, s76
    s_mul_i32 s81, s81, 5
    s_add_u32 s80, s80, s81
    s_lshl_b32 s80, s80, 10
    s_waitcnt lgkmcnt(4)
    buffer_store_dwordx4 v[24:27], v18, s[64:67], s80 offen sc1
    s_lshl_b32 s80, s77, 2
    s_add_u32 s80, s80, 2
    s_mul_i32 s82, s80, 52429
    s_lshr_b32 s82, s82, 18
    s_mul_i32 s81, s82, 5
    s_sub_u32 s80, s80, s81
    s_mul_i32 s81, s82, s78
    s_add_u32 s81, s81, s76
    s_mul_i32 s81, s81, 5
    s_add_u32 s80, s80, s81
    s_lshl_b32 s80, s80, 10
    s_waitcnt lgkmcnt(2)
    buffer_store_dwordx4 v[28:31], v18, s[64:67], s80 offen sc1
    s_lshl_b32 s80, s77, 2
    s_add_u32 s80, s80, 3
    s_mul_i32 s82, s80, 52429
    s_lshr_b32 s82, s82, 18
    s_mul_i32 s81, s82, 5
    s_sub_u32 s80, s80, s81
    s_mul_i32 s81, s82, s78
    s_add_u32 s81, s81, s76
    s_mul_i32 s81, s81, 5
    s_add_u32 s80, s80, s81
    s_lshl_b32 s80, s80, 10
    s_waitcnt lgkmcnt(0)
    buffer_store_dwordx4 v[32:35], v18, s[64:67], s80 offen sc1
    s_mul_i32 s72, s40, 8
    s_add_u32 s72, s72, s93
    s_mul_i32 s72, s72, 2
    s_add_u32 s72, s72, 1
    s_add_u32 s72, s72, 1280
    s_sub_u32 s73, s72, 1280
    s_cmp_lt_u32 s72, 1280
    s_cselect_b32 s73, s72, s73
    s_cselect_b32 s78, 128, 54
    s_mov_b32 s74, 0x21c000
    s_cselect_b32 s74, 0x500000, s74
    s_mov_b32 s75, 0x2a00000
    s_cselect_b32 s75, 0x2400000, s75
    s_cselect_b32 s60, s84, s86
    s_cselect_b32 s61, s85, s87
    s_cmp_lt_u32 s72, 1820
    s_cselect_b32 s62, s74, 0
    s_mov_b32 s63, 0x20000
    s_add_u32 s64, s94, s75
    s_addc_u32 s65, s95, 0
    s_mov_b32 s66, s62
    s_mov_b32 s67, 0x20000
    s_mul_hi_u32 s76, s73, 0x1999999a
    s_mul_i32 s77, s76, 10
    s_sub_u32 s77, s73, s77
    s_mul_i32 s73, s76, 40960
    s_lshl_b32 s74, s77, 7
    s_add_u32 s73, s73, s74
    v_lshrrev_b32 v19, 3, v1
    v_mul_u32_u24 v16, 1280, v19
    v_and_b32 v19, 7, v1
    v_lshl_add_u32 v16, v19, 4, v16
    v_lshrrev_b32 v17, 2, v1
    v_lshlrev_b32 v17, 7, v17
    v_and_b32 v19, 3, v1
    v_lshl_add_u32 v17, v19, 3, v17
    s_lshl_b32 s75, s93, 12
    s_add_u32 s75, s75, 0x0
    v_add_u32 v17, s75, v17
    v_lshlrev_b32 v18, 4, v1
    s_add_u32 m0, s75, 0
    s_add_u32 s80, s73, 0
    buffer_load_dwordx4 v16, s[60:63], s80 offen lds
    s_add_u32 m0, s75, 1024
    s_add_u32 s80, s73, 10240
    buffer_load_dwordx4 v16, s[60:63], s80 offen lds
    s_add_u32 m0, s75, 2048
    s_add_u32 s80, s73, 20480
    buffer_load_dwordx4 v16, s[60:63], s80 offen lds
    s_add_u32 m0, s75, 3072
    s_add_u32 s80, s73, 30720
    buffer_load_dwordx4 v16, s[60:63], s80 offen lds
    s_waitcnt vmcnt(0)
    ds_read_b64_tr_b16 v[20:21], v17 offset:0
    ds_read_b64_tr_b16 v[22:23], v17 offset:2048
    ds_read_b64_tr_b16 v[24:25], v17 offset:32
    ds_read_b64_tr_b16 v[26:27], v17 offset:2080
    ds_read_b64_tr_b16 v[28:29], v17 offset:64
    ds_read_b64_tr_b16 v[30:31], v17 offset:2112
    ds_read_b64_tr_b16 v[32:33], v17 offset:96
    ds_read_b64_tr_b16 v[34:35], v17 offset:2144
    s_lshl_b32 s80, s77, 2
    s_add_u32 s80, s80, 0
    s_mul_i32 s82, s80, 52429
    s_lshr_b32 s82, s82, 18
    s_mul_i32 s81, s82, 5
    s_sub_u32 s80, s80, s81
    s_mul_i32 s81, s82, s78
    s_add_u32 s81, s81, s76
    s_mul_i32 s81, s81, 5
    s_add_u32 s80, s80, s81
    s_lshl_b32 s80, s80, 10
    s_waitcnt lgkmcnt(6)
    buffer_store_dwordx4 v[20:23], v18, s[64:67], s80 offen sc1
    s_lshl_b32 s80, s77, 2
    s_add_u32 s80, s80, 1
    s_mul_i32 s82, s80, 52429
    s_lshr_b32 s82, s82, 18
    s_mul_i32 s81, s82, 5
    s_sub_u32 s80, s80, s81
    s_mul_i32 s81, s82, s78
    s_add_u32 s81, s81, s76
    s_mul_i32 s81, s81, 5
    s_add_u32 s80, s80, s81
    s_lshl_b32 s80, s80, 10
    s_waitcnt lgkmcnt(4)
    buffer_store_dwordx4 v[24:27], v18, s[64:67], s80 offen sc1
    s_lshl_b32 s80, s77, 2
    s_add_u32 s80, s80, 2
    s_mul_i32 s82, s80, 52429
    s_lshr_b32 s82, s82, 18
    s_mul_i32 s81, s82, 5
    s_sub_u32 s80, s80, s81
    s_mul_i32 s81, s82, s78
    s_add_u32 s81, s81, s76
    s_mul_i32 s81, s81, 5
    s_add_u32 s80, s80, s81
    s_lshl_b32 s80, s80, 10
    s_waitcnt lgkmcnt(2)
    buffer_store_dwordx4 v[28:31], v18, s[64:67], s80 offen sc1
    s_lshl_b32 s80, s77, 2
    s_add_u32 s80, s80, 3
    s_mul_i32 s82, s80, 52429
    s_lshr_b32 s82, s82, 18
    s_mul_i32 s81, s82, 5
    s_sub_u32 s80, s80, s81
    s_mul_i32 s81, s82, s78
    s_add_u32 s81, s81, s76
    s_mul_i32 s81, s81, 5
    s_add_u32 s80, s80, s81
    s_lshl_b32 s80, s80, 10
    s_waitcnt lgkmcnt(0)
    buffer_store_dwordx4 v[32:35], v18, s[64:67], s80 offen sc1
    s_mov_b32 s41, 0
    s_lshl_b32 s92, s41, 6
    s_add_u32 s92, s92, s40
    s_lshl_b32 s92, s92, 7
    s_add_u32 s92, s92, 0x70000
L_adaLN_cond__sliding_block_cached__swiglu_ffn__prompt_kernel_45:
    s_load_dwordx2 s[8:9], s[0:1], 88
    s_and_b32 s46, s2, 7
    s_lshr_b32 s47, s2, 3
    s_and_b32 s48, s47, 3
    s_lshl_b32 s41, s46, 2
    s_add_u32 s41, s41, s48
    s_lshr_b32 s42, s47, 2
    v_and_b32 v1, 63, v0
    v_lshlrev_b32 v2, 4, v1
    s_waitcnt vmcnt(0)
    s_barrier
    s_cmp_lg_u32 s93, 0
    s_cbranch_scc1 L_adaLN_cond__sliding_block_cached__swiglu_ffn__prompt_kernel_58
    s_add_u32 s4, s94, 0x380000
    s_addc_u32 s5, s95, 0
    s_mov_b32 s6, 0x80000
    s_mov_b32 s7, 0x20000
    s_mov_b64 exec, 1
    v_mov_b32 v252, s98
    v_mov_b32 v253, 0
    buffer_store_dword v252, v253, s[4:7], s92 offen sc1
    s_mov_b64 exec, -1
L_adaLN_cond__sliding_block_cached__swiglu_ffn__prompt_kernel_58:
    s_add_u32 s49, s93, 0
    s_and_b32 s49, s49, 3
    s_lshl_b32 s49, s49, 10
    v_add_u32 v10, s49, v2
    s_add_u32 s49, s93, 1
    s_and_b32 s49, s49, 3
    s_lshl_b32 s49, s49, 10
    v_add_u32 v11, s49, v2
    s_add_u32 s49, s93, 2
    s_and_b32 s49, s49, 3
    s_lshl_b32 s49, s49, 10
    v_add_u32 v12, s49, v2
    s_add_u32 s49, s93, 3
    s_and_b32 s49, s49, 3
    s_lshl_b32 s49, s49, 10
    v_add_u32 v13, s49, v2
    s_and_b32 s50, s93, 3
    s_mul_i32 s49, s50, 14
    s_cmp_eq_u32 s50, 3
    s_cselect_b32 s50, 1, 0
    s_sub_u32 s49, s49, s50
    s_mul_i32 s43, s42, 54
    s_add_u32 s43, s43, s49
    s_mul_i32 s43, s43, 5120
    s_mul_i32 s44, s41, 54
    s_add_u32 s44, s44, s49
    s_lshl_b32 s44, s44, 12
    s_mov_b32 s20, s94
    s_mov_b32 s21, s95
    s_mov_b32 s22, 0x3c00
    s_mov_b32 s23, 0x20000
    s_add_u32 s16, s94, 0xc00000
    s_addc_u32 s17, s95, 0
    s_mov_b32 s18, 0x6c0000
    s_mov_b32 s19, 0x20000
    s_add_u32 s12, s94, 0x2a00000
    s_addc_u32 s13, s95, 0
    s_mov_b32 s14, 0x21c000
    s_mov_b32 s15, 0x20000
    s_cmp_lt_u32 s2, 216
    s_cbranch_scc1 L_adaLN_cond__sliding_block_cached__swiglu_ffn__prompt_kernel_59
    s_cmp_lg_u32 s93, 4
    s_cbranch_scc1 L_adaLN_cond__sliding_block_cached__swiglu_ffn__prompt_kernel_60
    v_min_u32 v248, 39, v1
    v_lshlrev_b32 v248, 7, v248
    v_add_u32 v248, 0x70000, v248
    s_add_u32 s4, s94, 0x380000
    s_addc_u32 s5, s95, 0
    s_mov_b32 s6, 0x80000
    s_mov_b32 s7, 0x20000
    s_mov_b32 s3, 60000
L_adaLN_cond__sliding_block_cached__swiglu_ffn__prompt_kernel_62:
    buffer_load_dword v252, v248, s[4:7], 0 offen sc1
    s_waitcnt vmcnt(0)
    v_cmp_ne_u32 vcc, s98, v252
    s_cbranch_vccz L_adaLN_cond__sliding_block_cached__swiglu_ffn__prompt_kernel_61
    s_sleep 1
    s_sub_u32 s3, s3, 1
    s_cmp_lg_u32 s3, 0
    s_cbranch_scc1 L_adaLN_cond__sliding_block_cached__swiglu_ffn__prompt_kernel_62
L_adaLN_cond__sliding_block_cached__swiglu_ffn__prompt_kernel_61:
L_adaLN_cond__sliding_block_cached__swiglu_ffn__prompt_kernel_60:
    s_barrier
L_adaLN_cond__sliding_block_cached__swiglu_ffn__prompt_kernel_59:
    s_cmp_ge_u32 s93, 4
    s_cbranch_scc1 L_adaLN_cond__sliding_block_cached__swiglu_ffn__prompt_kernel_63
    buffer_load_dwordx4 v[112:115], v2, s[12:15], s43 offen offset:0 sc1
    buffer_load_dwordx4 v[116:119], v2, s[12:15], s43 offen offset:1024 sc1
    buffer_load_dwordx4 v[120:123], v2, s[12:15], s43 offen offset:2048 sc1
    buffer_load_dwordx4 v[124:127], v2, s[12:15], s43 offen offset:3072 sc1
    s_add_u32 s51, s43, 4096
    buffer_load_dwordx4 v[128:131], v2, s[12:15], s51 offen sc1
    s_add_u32 s43, s43, 5120
    buffer_load_dwordx4 v[148:151], v2, s[12:15], s43 offen offset:0 sc1
    buffer_load_dwordx4 v[152:155], v2, s[12:15], s43 offen offset:1024 sc1
    buffer_load_dwordx4 v[156:159], v2, s[12:15], s43 offen offset:2048 sc1
    buffer_load_dwordx4 v[160:163], v2, s[12:15], s43 offen offset:3072 sc1
    s_add_u32 s51, s43, 4096
    buffer_load_dwordx4 v[164:167], v2, s[12:15], s51 offen sc1
    s_add_u32 s43, s43, 5120
L_adaLN_cond__sliding_block_cached__swiglu_ffn__prompt_kernel_63:
    s_cmp_lg_u32 s93, 4
    s_cbranch_scc1 L_adaLN_cond__sliding_block_cached__swiglu_ffn__prompt_kernel_64
    s_lshr_b32 s50, s41, 2
    s_lshl_b32 s51, s50, 6
    s_add_u32 s51, s51, 0
    s_lshl_b32 s51, s51, 7
    s_add_u32 s51, s51, 0x40000
    v_and_b32 v252, 31, v1
    v_min_u32 v252, 26, v252
    v_lshlrev_b32 v252, 7, v252
    v_add_u32 v252, s51, v252
    s_add_u32 s4, s94, 0x380000
    s_addc_u32 s5, s95, 0
    s_mov_b32 s6, 0x80000
    s_mov_b32 s7, 0x20000
    s_mov_b32 s3, 60000
L_adaLN_cond__sliding_block_cached__swiglu_ffn__prompt_kernel_66:
    buffer_load_dword v254, v252, s[4:7], 0 offen sc1
    s_waitcnt vmcnt(0)
    v_cmp_ne_u32 vcc, s98, v254
    s_cbranch_vccz L_adaLN_cond__sliding_block_cached__swiglu_ffn__prompt_kernel_65
    s_sleep 1
    s_sub_u32 s3, s3, 1
    s_cmp_lg_u32 s3, 0
    s_cbranch_scc1 L_adaLN_cond__sliding_block_cached__swiglu_ffn__prompt_kernel_66
L_adaLN_cond__sliding_block_cached__swiglu_ffn__prompt_kernel_65:
L_adaLN_cond__sliding_block_cached__swiglu_ffn__prompt_kernel_64:
    s_barrier
    s_cmp_ge_u32 s93, 4
    s_cbranch_scc1 L_adaLN_cond__sliding_block_cached__swiglu_ffn__prompt_kernel_56
    buffer_load_dwordx4 v[96:99], v10, s[16:19], s44 offen sc1
    buffer_load_dwordx4 v[100:103], v11, s[16:19], s44 offen sc1
    buffer_load_dwordx4 v[104:107], v12, s[16:19], s44 offen sc1
    buffer_load_dwordx4 v[108:111], v13, s[16:19], s44 offen sc1
    s_add_u32 s44, s44, 4096
    buffer_load_dwordx4 v[132:135], v10, s[16:19], s44 offen sc1
    buffer_load_dwordx4 v[136:139], v11, s[16:19], s44 offen sc1
    buffer_load_dwordx4 v[140:143], v12, s[16:19], s44 offen sc1
    buffer_load_dwordx4 v[144:147], v13, s[16:19], s44 offen sc1
    s_add_u32 s44, s44, 4096
    s_waitcnt lgkmcnt(0)
    s_mov_b32 s24, s8
    s_mov_b32 s25, s9
    s_mov_b32 s26, 0x280000
    s_mov_b32 s27, 0x20000
    v_and_b32 v4, 15, v1
    v_lshrrev_b32 v5, 4, v1
    s_mul_i32 s46, s42, 320
    v_lshlrev_b32 v9, 4, v5
    s_add_u32 s66, s46, 12800
    s_lshl_b32 s48, s41, 6
    s_lshl_b32 s49, s93, 4
    s_add_u32 s48, s48, s49
    v_add_u32 v7, s48, v4
    v_mul_u32_u24 v8, 1280, v7
    v_lshl_add_u32 v8, v5, 3, v8
    s_mul_i32 s60, s42, 160
    s_mul_i32 s61, s93, 5120
    s_add_u32 s61, s61, 0x21000
    v_add_u32 v254, s61, v2
    v_mul_u32_u24 v7, 1280, v7
    v_and_b32 v3, 1, v5
    v_lshl_add_u32 v7, v3, 5, v7
    v_lshrrev_b32 v3, 1, v5
    v_lshl_add_u32 v7, v3, 4, v7
    s_mul_i32 s53, s93, 15360
    v_add_u32 v6, s53, v2
    s_add_u32 s53, s93, 1
    s_and_b32 s53, s53, 3
    s_mul_i32 s53, s53, 15360
    v_add_u32 v14, s53, v2
    s_add_u32 s53, s93, 2
    s_and_b32 s53, s53, 3
    s_mul_i32 s53, s53, 15360
    v_add_u32 v15, s53, v2
    s_add_u32 s53, s93, 3
    s_and_b32 s53, s53, 3
    s_mul_i32 s53, s53, 15360
    v_add_u32 v3, s53, v2
    buffer_load_dwordx4 v[168:171], v10, s[16:19], s44 offen sc1
    buffer_load_dwordx4 v[172:175], v11, s[16:19], s44 offen sc1
    buffer_load_dwordx4 v[176:179], v12, s[16:19], s44 offen sc1
    buffer_load_dwordx4 v[180:183], v13, s[16:19], s44 offen sc1
    s_add_u32 s44, s44, 4096
    buffer_load_dwordx4 v[184:187], v2, s[12:15], s43 offen offset:0 sc1
    buffer_load_dwordx4 v[188:191], v2, s[12:15], s43 offen offset:1024 sc1
    buffer_load_dwordx4 v[192:195], v2, s[12:15], s43 offen offset:2048 sc1
    buffer_load_dwordx4 v[196:199], v2, s[12:15], s43 offen offset:3072 sc1
    s_add_u32 s51, s43, 4096
    buffer_load_dwordx4 v[200:203], v2, s[12:15], s51 offen sc1
    s_add_u32 s43, s43, 5120
    s_waitcnt vmcnt(16)
    v_mfma_f32_16x16x32_bf16 v[16:19], v[112:115], v[96:99], 0
    s_waitcnt vmcnt(15)
    v_mfma_f32_16x16x32_bf16 v[36:39], v[112:115], v[100:103], 0
    s_waitcnt vmcnt(14)
    v_mfma_f32_16x16x32_bf16 v[56:59], v[112:115], v[104:107], 0
    s_waitcnt vmcnt(13)
    v_mfma_f32_16x16x32_bf16 v[76:79], v[112:115], v[108:111], 0
    v_mfma_f32_16x16x32_bf16 v[20:23], v[116:119], v[96:99], 0
    v_mfma_f32_16x16x32_bf16 v[40:43], v[116:119], v[100:103], 0
    v_mfma_f32_16x16x32_bf16 v[60:63], v[116:119], v[104:107], 0
    v_mfma_f32_16x16x32_bf16 v[80:83], v[116:119], v[108:111], 0
    v_mfma_f32_16x16x32_bf16 v[24:27], v[120:123], v[96:99], 0
    v_mfma_f32_16x16x32_bf16 v[44:47], v[120:123], v[100:103], 0
    v_mfma_f32_16x16x32_bf16 v[64:67], v[120:123], v[104:107], 0
    v_mfma_f32_16x16x32_bf16 v[84:87], v[120:123], v[108:111], 0
    v_mfma_f32_16x16x32_bf16 v[28:31], v[124:127], v[96:99], 0
    v_mfma_f32_16x16x32_bf16 v[48:51], v[124:127], v[100:103], 0
    v_mfma_f32_16x16x32_bf16 v[68:71], v[124:127], v[104:107], 0
    v_mfma_f32_16x16x32_bf16 v[88:91], v[124:127], v[108:111], 0
    v_mfma_f32_16x16x32_bf16 v[32:35], v[128:131], v[96:99], 0
    v_mfma_f32_16x16x32_bf16 v[52:55], v[128:131], v[100:103], 0
    v_mfma_f32_16x16x32_bf16 v[72:75], v[128:131], v[104:107], 0
    v_mfma_f32_16x16x32_bf16 v[92:95], v[128:131], v[108:111], 0
    buffer_load_dwordx4 v[96:99], v10, s[16:19], s44 offen sc1
    buffer_load_dwordx4 v[100:103], v11, s[16:19], s44 offen sc1
    buffer_load_dwordx4 v[104:107], v12, s[16:19], s44 offen sc1
    buffer_load_dwordx4 v[108:111], v13, s[16:19], s44 offen sc1
    s_add_u32 s44, s44, 4096
    buffer_load_dwordx4 v[112:115], v2, s[12:15], s43 offen offset:0 sc1
    buffer_load_dwordx4 v[116:119], v2, s[12:15], s43 offen offset:1024 sc1
    buffer_load_dwordx4 v[120:123], v2, s[12:15], s43 offen offset:2048 sc1
    buffer_load_dwordx4 v[124:127], v2, s[12:15], s43 offen offset:3072 sc1
    s_add_u32 s51, s43, 4096
    buffer_load_dwordx4 v[128:131], v2, s[12:15], s51 offen sc1
    s_add_u32 s43, s43, 5120
    s_waitcnt vmcnt(21)
    v_mfma_f32_16x16x32_bf16 v[16:19], v[148:151], v[132:135], v[16:19]
    s_waitcnt vmcnt(20)
    v_mfma_f32_16x16x32_bf16 v[36:39], v[148:151], v[136:139], v[36:39]
    s_waitcnt vmcnt(19)
    v_mfma_f32_16x16x32_bf16 v[56:59], v[148:151], v[140:143], v[56:59]
    s_waitcnt vmcnt(18)
    v_mfma_f32_16x16x32_bf16 v[76:79], v[148:151], v[144:147], v[76:79]
    v_mfma_f32_16x16x32_bf16 v[20:23], v[152:155], v[132:135], v[20:23]
    v_mfma_f32_16x16x32_bf16 v[40:43], v[152:155], v[136:139], v[40:43]
    v_mfma_f32_16x16x32_bf16 v[60:63], v[152:155], v[140:143], v[60:63]
    v_mfma_f32_16x16x32_bf16 v[80:83], v[152:155], v[144:147], v[80:83]
    v_mfma_f32_16x16x32_bf16 v[24:27], v[156:159], v[132:135], v[24:27]
    v_mfma_f32_16x16x32_bf16 v[44:47], v[156:159], v[136:139], v[44:47]
    v_mfma_f32_16x16x32_bf16 v[64:67], v[156:159], v[140:143], v[64:67]
    v_mfma_f32_16x16x32_bf16 v[84:87], v[156:159], v[144:147], v[84:87]
    v_mfma_f32_16x16x32_bf16 v[28:31], v[160:163], v[132:135], v[28:31]
    v_mfma_f32_16x16x32_bf16 v[48:51], v[160:163], v[136:139], v[48:51]
    v_mfma_f32_16x16x32_bf16 v[68:71], v[160:163], v[140:143], v[68:71]
    v_mfma_f32_16x16x32_bf16 v[88:91], v[160:163], v[144:147], v[88:91]
    v_mfma_f32_16x16x32_bf16 v[32:35], v[164:167], v[132:135], v[32:35]
    v_mfma_f32_16x16x32_bf16 v[52:55], v[164:167], v[136:139], v[52:55]
    v_mfma_f32_16x16x32_bf16 v[72:75], v[164:167], v[140:143], v[72:75]
    v_mfma_f32_16x16x32_bf16 v[92:95], v[164:167], v[144:147], v[92:95]
    buffer_load_dwordx4 v[132:135], v10, s[16:19], s44 offen sc1
    buffer_load_dwordx4 v[136:139], v11, s[16:19], s44 offen sc1
    buffer_load_dwordx4 v[140:143], v12, s[16:19], s44 offen sc1
    buffer_load_dwordx4 v[144:147], v13, s[16:19], s44 offen sc1
    s_add_u32 s44, s44, 4096
    buffer_load_dwordx4 v[148:151], v2, s[12:15], s43 offen offset:0 sc1
    buffer_load_dwordx4 v[152:155], v2, s[12:15], s43 offen offset:1024 sc1
    buffer_load_dwordx4 v[156:159], v2, s[12:15], s43 offen offset:2048 sc1
    buffer_load_dwordx4 v[160:163], v2, s[12:15], s43 offen offset:3072 sc1
    s_add_u32 s51, s43, 4096
    buffer_load_dwordx4 v[164:167], v2, s[12:15], s51 offen sc1
    s_add_u32 s43, s43, 5120
    s_waitcnt vmcnt(22)
    v_mfma_f32_16x16x32_bf16 v[16:19], v[184:187], v[168:171], v[16:19]
    v_mfma_f32_16x16x32_bf16 v[36:39], v[184:187], v[172:175], v[36:39]
    v_mfma_f32_16x16x32_bf16 v[56:59], v[184:187], v[176:179], v[56:59]
    v_mfma_f32_16x16x32_bf16 v[76:79], v[184:187], v[180:183], v[76:79]
    s_waitcnt vmcnt(21)
    v_mfma_f32_16x16x32_bf16 v[20:23], v[188:191], v[168:171], v[20:23]
    v_mfma_f32_16x16x32_bf16 v[40:43], v[188:191], v[172:175], v[40:43]
    v_mfma_f32_16x16x32_bf16 v[60:63], v[188:191], v[176:179], v[60:63]
    v_mfma_f32_16x16x32_bf16 v[80:83], v[188:191], v[180:183], v[80:83]
    s_waitcnt vmcnt(20)
    v_mfma_f32_16x16x32_bf16 v[24:27], v[192:195], v[168:171], v[24:27]
    v_mfma_f32_16x16x32_bf16 v[44:47], v[192:195], v[172:175], v[44:47]
    v_mfma_f32_16x16x32_bf16 v[64:67], v[192:195], v[176:179], v[64:67]
    v_mfma_f32_16x16x32_bf16 v[84:87], v[192:195], v[180:183], v[84:87]
    s_waitcnt vmcnt(19)
    v_mfma_f32_16x16x32_bf16 v[28:31], v[196:199], v[168:171], v[28:31]
    v_mfma_f32_16x16x32_bf16 v[48:51], v[196:199], v[172:175], v[48:51]
    v_mfma_f32_16x16x32_bf16 v[68:71], v[196:199], v[176:179], v[68:71]
    v_mfma_f32_16x16x32_bf16 v[88:91], v[196:199], v[180:183], v[88:91]
    s_waitcnt vmcnt(18)
    v_mfma_f32_16x16x32_bf16 v[32:35], v[200:203], v[168:171], v[32:35]
    v_mfma_f32_16x16x32_bf16 v[52:55], v[200:203], v[172:175], v[52:55]
    v_mfma_f32_16x16x32_bf16 v[72:75], v[200:203], v[176:179], v[72:75]
    v_mfma_f32_16x16x32_bf16 v[92:95], v[200:203], v[180:183], v[92:95]
    buffer_load_dwordx4 v[168:171], v10, s[16:19], s44 offen sc1
    buffer_load_dwordx4 v[172:175], v11, s[16:19], s44 offen sc1
    buffer_load_dwordx4 v[176:179], v12, s[16:19], s44 offen sc1
    buffer_load_dwordx4 v[180:183], v13, s[16:19], s44 offen sc1
    s_add_u32 s44, s44, 4096
    buffer_load_dwordx4 v[184:187], v2, s[12:15], s43 offen offset:0 sc1
    buffer_load_dwordx4 v[188:191], v2, s[12:15], s43 offen offset:1024 sc1
    buffer_load_dwordx4 v[192:195], v2, s[12:15], s43 offen offset:2048 sc1
    buffer_load_dwordx4 v[196:199], v2, s[12:15], s43 offen offset:3072 sc1
    s_add_u32 s51, s43, 4096
    buffer_load_dwordx4 v[200:203], v2, s[12:15], s51 offen sc1
    s_add_u32 s43, s43, 5120
    s_waitcnt vmcnt(22)
    v_mfma_f32_16x16x32_bf16 v[16:19], v[112:115], v[96:99], v[16:19]
    v_mfma_f32_16x16x32_bf16 v[36:39], v[112:115], v[100:103], v[36:39]
    v_mfma_f32_16x16x32_bf16 v[56:59], v[112:115], v[104:107], v[56:59]
    v_mfma_f32_16x16x32_bf16 v[76:79], v[112:115], v[108:111], v[76:79]
    s_waitcnt vmcnt(21)
    v_mfma_f32_16x16x32_bf16 v[20:23], v[116:119], v[96:99], v[20:23]
    v_mfma_f32_16x16x32_bf16 v[40:43], v[116:119], v[100:103], v[40:43]
    v_mfma_f32_16x16x32_bf16 v[60:63], v[116:119], v[104:107], v[60:63]
    v_mfma_f32_16x16x32_bf16 v[80:83], v[116:119], v[108:111], v[80:83]
    s_waitcnt vmcnt(20)
    v_mfma_f32_16x16x32_bf16 v[24:27], v[120:123], v[96:99], v[24:27]
    v_mfma_f32_16x16x32_bf16 v[44:47], v[120:123], v[100:103], v[44:47]
    v_mfma_f32_16x16x32_bf16 v[64:67], v[120:123], v[104:107], v[64:67]
    v_mfma_f32_16x16x32_bf16 v[84:87], v[120:123], v[108:111], v[84:87]
    s_waitcnt vmcnt(19)
    v_mfma_f32_16x16x32_bf16 v[28:31], v[124:127], v[96:99], v[28:31]
    v_mfma_f32_16x16x32_bf16 v[48:51], v[124:127], v[100:103], v[48:51]
    v_mfma_f32_16x16x32_bf16 v[68:71], v[124:127], v[104:107], v[68:71]
    v_mfma_f32_16x16x32_bf16 v[88:91], v[124:127], v[108:111], v[88:91]
    s_waitcnt vmcnt(18)
    v_mfma_f32_16x16x32_bf16 v[32:35], v[128:131], v[96:99], v[32:35]
    v_mfma_f32_16x16x32_bf16 v[52:55], v[128:131], v[100:103], v[52:55]
    v_mfma_f32_16x16x32_bf16 v[72:75], v[128:131], v[104:107], v[72:75]
    v_mfma_f32_16x16x32_bf16 v[92:95], v[128:131], v[108:111], v[92:95]
    buffer_load_dwordx4 v[96:99], v10, s[16:19], s44 offen sc1
    buffer_load_dwordx4 v[100:103], v11, s[16:19], s44 offen sc1
    buffer_load_dwordx4 v[104:107], v12, s[16:19], s44 offen sc1
    buffer_load_dwordx4 v[108:111], v13, s[16:19], s44 offen sc1
    s_add_u32 s44, s44, 4096
    buffer_load_dwordx4 v[112:115], v2, s[12:15], s43 offen offset:0 sc1
    buffer_load_dwordx4 v[116:119], v2, s[12:15], s43 offen offset:1024 sc1
    buffer_load_dwordx4 v[120:123], v2, s[12:15], s43 offen offset:2048 sc1
    buffer_load_dwordx4 v[124:127], v2, s[12:15], s43 offen offset:3072 sc1
    s_add_u32 s51, s43, 4096
    buffer_load_dwordx4 v[128:131], v2, s[12:15], s51 offen sc1
    s_add_u32 s43, s43, 5120
    s_waitcnt vmcnt(22)
    v_mfma_f32_16x16x32_bf16 v[16:19], v[148:151], v[132:135], v[16:19]
    v_mfma_f32_16x16x32_bf16 v[36:39], v[148:151], v[136:139], v[36:39]
    v_mfma_f32_16x16x32_bf16 v[56:59], v[148:151], v[140:143], v[56:59]
    v_mfma_f32_16x16x32_bf16 v[76:79], v[148:151], v[144:147], v[76:79]
    s_waitcnt vmcnt(21)
    v_mfma_f32_16x16x32_bf16 v[20:23], v[152:155], v[132:135], v[20:23]
    v_mfma_f32_16x16x32_bf16 v[40:43], v[152:155], v[136:139], v[40:43]
    v_mfma_f32_16x16x32_bf16 v[60:63], v[152:155], v[140:143], v[60:63]
    v_mfma_f32_16x16x32_bf16 v[80:83], v[152:155], v[144:147], v[80:83]
    s_waitcnt vmcnt(20)
    v_mfma_f32_16x16x32_bf16 v[24:27], v[156:159], v[132:135], v[24:27]
    v_mfma_f32_16x16x32_bf16 v[44:47], v[156:159], v[136:139], v[44:47]
    v_mfma_f32_16x16x32_bf16 v[64:67], v[156:159], v[140:143], v[64:67]
    v_mfma_f32_16x16x32_bf16 v[84:87], v[156:159], v[144:147], v[84:87]
    s_waitcnt vmcnt(19)
    v_mfma_f32_16x16x32_bf16 v[28:31], v[160:163], v[132:135], v[28:31]
    v_mfma_f32_16x16x32_bf16 v[48:51], v[160:163], v[136:139], v[48:51]
    v_mfma_f32_16x16x32_bf16 v[68:71], v[160:163], v[140:143], v[68:71]
    v_mfma_f32_16x16x32_bf16 v[88:91], v[160:163], v[144:147], v[88:91]
    s_waitcnt vmcnt(18)
    v_mfma_f32_16x16x32_bf16 v[32:35], v[164:167], v[132:135], v[32:35]
    v_mfma_f32_16x16x32_bf16 v[52:55], v[164:167], v[136:139], v[52:55]
    v_mfma_f32_16x16x32_bf16 v[72:75], v[164:167], v[140:143], v[72:75]
    v_mfma_f32_16x16x32_bf16 v[92:95], v[164:167], v[144:147], v[92:95]
    buffer_load_dwordx4 v[132:135], v10, s[16:19], s44 offen sc1
    buffer_load_dwordx4 v[136:139], v11, s[16:19], s44 offen sc1
    buffer_load_dwordx4 v[140:143], v12, s[16:19], s44 offen sc1
    buffer_load_dwordx4 v[144:147], v13, s[16:19], s44 offen sc1
    s_add_u32 s44, s44, 4096
    buffer_load_dwordx4 v[148:151], v2, s[12:15], s43 offen offset:0 sc1
    buffer_load_dwordx4 v[152:155], v2, s[12:15], s43 offen offset:1024 sc1
    buffer_load_dwordx4 v[156:159], v2, s[12:15], s43 offen offset:2048 sc1
    buffer_load_dwordx4 v[160:163], v2, s[12:15], s43 offen offset:3072 sc1
    s_add_u32 s51, s43, 4096
    buffer_load_dwordx4 v[164:167], v2, s[12:15], s51 offen sc1
    s_add_u32 s43, s43, 5120
    s_waitcnt vmcnt(22)
    v_mfma_f32_16x16x32_bf16 v[16:19], v[184:187], v[168:171], v[16:19]
    v_mfma_f32_16x16x32_bf16 v[36:39], v[184:187], v[172:175], v[36:39]
    v_mfma_f32_16x16x32_bf16 v[56:59], v[184:187], v[176:179], v[56:59]
    v_mfma_f32_16x16x32_bf16 v[76:79], v[184:187], v[180:183], v[76:79]
    s_waitcnt vmcnt(21)
    v_mfma_f32_16x16x32_bf16 v[20:23], v[188:191], v[168:171], v[20:23]
    v_mfma_f32_16x16x32_bf16 v[40:43], v[188:191], v[172:175], v[40:43]
    v_mfma_f32_16x16x32_bf16 v[60:63], v[188:191], v[176:179], v[60:63]
    v_mfma_f32_16x16x32_bf16 v[80:83], v[188:191], v[180:183], v[80:83]
    s_waitcnt vmcnt(20)
    v_mfma_f32_16x16x32_bf16 v[24:27], v[192:195], v[168:171], v[24:27]
    v_mfma_f32_16x16x32_bf16 v[44:47], v[192:195], v[172:175], v[44:47]
    v_mfma_f32_16x16x32_bf16 v[64:67], v[192:195], v[176:179], v[64:67]
    v_mfma_f32_16x16x32_bf16 v[84:87], v[192:195], v[180:183], v[84:87]
    s_waitcnt vmcnt(19)
    v_mfma_f32_16x16x32_bf16 v[28:31], v[196:199], v[168:171], v[28:31]
    v_mfma_f32_16x16x32_bf16 v[48:51], v[196:199], v[172:175], v[48:51]
    v_mfma_f32_16x16x32_bf16 v[68:71], v[196:199], v[176:179], v[68:71]
    v_mfma_f32_16x16x32_bf16 v[88:91], v[196:199], v[180:183], v[88:91]
    s_waitcnt vmcnt(18)
    v_mfma_f32_16x16x32_bf16 v[32:35], v[200:203], v[168:171], v[32:35]
    v_mfma_f32_16x16x32_bf16 v[52:55], v[200:203], v[172:175], v[52:55]
    v_mfma_f32_16x16x32_bf16 v[72:75], v[200:203], v[176:179], v[72:75]
    v_mfma_f32_16x16x32_bf16 v[92:95], v[200:203], v[180:183], v[92:95]
    buffer_load_dwordx4 v[168:171], v10, s[16:19], s44 offen sc1
    buffer_load_dwordx4 v[172:175], v11, s[16:19], s44 offen sc1
    buffer_load_dwordx4 v[176:179], v12, s[16:19], s44 offen sc1
    buffer_load_dwordx4 v[180:183], v13, s[16:19], s44 offen sc1
    s_add_u32 s44, s44, 4096
    buffer_load_dwordx4 v[184:187], v2, s[12:15], s43 offen offset:0 sc1
    buffer_load_dwordx4 v[188:191], v2, s[12:15], s43 offen offset:1024 sc1
    buffer_load_dwordx4 v[192:195], v2, s[12:15], s43 offen offset:2048 sc1
    buffer_load_dwordx4 v[196:199], v2, s[12:15], s43 offen offset:3072 sc1
    s_add_u32 s51, s43, 4096
    buffer_load_dwordx4 v[200:203], v2, s[12:15], s51 offen sc1
    s_add_u32 s43, s43, 5120
    s_waitcnt vmcnt(22)
    v_mfma_f32_16x16x32_bf16 v[16:19], v[112:115], v[96:99], v[16:19]
    v_mfma_f32_16x16x32_bf16 v[36:39], v[112:115], v[100:103], v[36:39]
    v_mfma_f32_16x16x32_bf16 v[56:59], v[112:115], v[104:107], v[56:59]
    v_mfma_f32_16x16x32_bf16 v[76:79], v[112:115], v[108:111], v[76:79]
    s_waitcnt vmcnt(21)
    v_mfma_f32_16x16x32_bf16 v[20:23], v[116:119], v[96:99], v[20:23]
    v_mfma_f32_16x16x32_bf16 v[40:43], v[116:119], v[100:103], v[40:43]
    v_mfma_f32_16x16x32_bf16 v[60:63], v[116:119], v[104:107], v[60:63]
    v_mfma_f32_16x16x32_bf16 v[80:83], v[116:119], v[108:111], v[80:83]
    s_waitcnt vmcnt(20)
    v_mfma_f32_16x16x32_bf16 v[24:27], v[120:123], v[96:99], v[24:27]
    v_mfma_f32_16x16x32_bf16 v[44:47], v[120:123], v[100:103], v[44:47]
    v_mfma_f32_16x16x32_bf16 v[64:67], v[120:123], v[104:107], v[64:67]
    v_mfma_f32_16x16x32_bf16 v[84:87], v[120:123], v[108:111], v[84:87]
    s_waitcnt vmcnt(19)
    v_mfma_f32_16x16x32_bf16 v[28:31], v[124:127], v[96:99], v[28:31]
    v_mfma_f32_16x16x32_bf16 v[48:51], v[124:127], v[100:103], v[48:51]
    v_mfma_f32_16x16x32_bf16 v[68:71], v[124:127], v[104:107], v[68:71]
    v_mfma_f32_16x16x32_bf16 v[88:91], v[124:127], v[108:111], v[88:91]
    s_waitcnt vmcnt(18)
    v_mfma_f32_16x16x32_bf16 v[32:35], v[128:131], v[96:99], v[32:35]
    v_mfma_f32_16x16x32_bf16 v[52:55], v[128:131], v[100:103], v[52:55]
    v_mfma_f32_16x16x32_bf16 v[72:75], v[128:131], v[104:107], v[72:75]
    v_mfma_f32_16x16x32_bf16 v[92:95], v[128:131], v[108:111], v[92:95]
    buffer_load_dwordx4 v[96:99], v10, s[16:19], s44 offen sc1
    buffer_load_dwordx4 v[100:103], v11, s[16:19], s44 offen sc1
    buffer_load_dwordx4 v[104:107], v12, s[16:19], s44 offen sc1
    buffer_load_dwordx4 v[108:111], v13, s[16:19], s44 offen sc1
    s_add_u32 s44, s44, 4096
    buffer_load_dwordx4 v[112:115], v2, s[12:15], s43 offen offset:0 sc1
    buffer_load_dwordx4 v[116:119], v2, s[12:15], s43 offen offset:1024 sc1
    buffer_load_dwordx4 v[120:123], v2, s[12:15], s43 offen offset:2048 sc1
    buffer_load_dwordx4 v[124:127], v2, s[12:15], s43 offen offset:3072 sc1
    s_add_u32 s51, s43, 4096
    buffer_load_dwordx4 v[128:131], v2, s[12:15], s51 offen sc1
    s_add_u32 s43, s43, 5120
    s_waitcnt vmcnt(22)
    v_mfma_f32_16x16x32_bf16 v[16:19], v[148:151], v[132:135], v[16:19]
    v_mfma_f32_16x16x32_bf16 v[36:39], v[148:151], v[136:139], v[36:39]
    v_mfma_f32_16x16x32_bf16 v[56:59], v[148:151], v[140:143], v[56:59]
    v_mfma_f32_16x16x32_bf16 v[76:79], v[148:151], v[144:147], v[76:79]
    s_waitcnt vmcnt(21)
    v_mfma_f32_16x16x32_bf16 v[20:23], v[152:155], v[132:135], v[20:23]
    v_mfma_f32_16x16x32_bf16 v[40:43], v[152:155], v[136:139], v[40:43]
    v_mfma_f32_16x16x32_bf16 v[60:63], v[152:155], v[140:143], v[60:63]
    v_mfma_f32_16x16x32_bf16 v[80:83], v[152:155], v[144:147], v[80:83]
    s_waitcnt vmcnt(20)
    v_mfma_f32_16x16x32_bf16 v[24:27], v[156:159], v[132:135], v[24:27]
    v_mfma_f32_16x16x32_bf16 v[44:47], v[156:159], v[136:139], v[44:47]
    v_mfma_f32_16x16x32_bf16 v[64:67], v[156:159], v[140:143], v[64:67]
    v_mfma_f32_16x16x32_bf16 v[84:87], v[156:159], v[144:147], v[84:87]
    s_waitcnt vmcnt(19)
    v_mfma_f32_16x16x32_bf16 v[28:31], v[160:163], v[132:135], v[28:31]
    v_mfma_f32_16x16x32_bf16 v[48:51], v[160:163], v[136:139], v[48:51]
    v_mfma_f32_16x16x32_bf16 v[68:71], v[160:163], v[140:143], v[68:71]
    v_mfma_f32_16x16x32_bf16 v[88:91], v[160:163], v[144:147], v[88:91]
    s_waitcnt vmcnt(18)
    v_mfma_f32_16x16x32_bf16 v[32:35], v[164:167], v[132:135], v[32:35]
    v_mfma_f32_16x16x32_bf16 v[52:55], v[164:167], v[136:139], v[52:55]
    v_mfma_f32_16x16x32_bf16 v[72:75], v[164:167], v[140:143], v[72:75]
    v_mfma_f32_16x16x32_bf16 v[92:95], v[164:167], v[144:147], v[92:95]
    buffer_load_dwordx4 v[132:135], v10, s[16:19], s44 offen sc1
    buffer_load_dwordx4 v[136:139], v11, s[16:19], s44 offen sc1
    buffer_load_dwordx4 v[140:143], v12, s[16:19], s44 offen sc1
    buffer_load_dwordx4 v[144:147], v13, s[16:19], s44 offen sc1
    s_add_u32 s44, s44, 4096
    buffer_load_dwordx4 v[148:151], v2, s[12:15], s43 offen offset:0 sc1
    buffer_load_dwordx4 v[152:155], v2, s[12:15], s43 offen offset:1024 sc1
    buffer_load_dwordx4 v[156:159], v2, s[12:15], s43 offen offset:2048 sc1
    buffer_load_dwordx4 v[160:163], v2, s[12:15], s43 offen offset:3072 sc1
    s_add_u32 s51, s43, 4096
    buffer_load_dwordx4 v[164:167], v2, s[12:15], s51 offen sc1
    s_add_u32 s43, s43, 5120
    s_waitcnt vmcnt(22)
    v_mfma_f32_16x16x32_bf16 v[16:19], v[184:187], v[168:171], v[16:19]
    v_mfma_f32_16x16x32_bf16 v[36:39], v[184:187], v[172:175], v[36:39]
    v_mfma_f32_16x16x32_bf16 v[56:59], v[184:187], v[176:179], v[56:59]
    v_mfma_f32_16x16x32_bf16 v[76:79], v[184:187], v[180:183], v[76:79]
    s_waitcnt vmcnt(21)
    v_mfma_f32_16x16x32_bf16 v[20:23], v[188:191], v[168:171], v[20:23]
    v_mfma_f32_16x16x32_bf16 v[40:43], v[188:191], v[172:175], v[40:43]
    v_mfma_f32_16x16x32_bf16 v[60:63], v[188:191], v[176:179], v[60:63]
    v_mfma_f32_16x16x32_bf16 v[80:83], v[188:191], v[180:183], v[80:83]
    s_waitcnt vmcnt(20)
    v_mfma_f32_16x16x32_bf16 v[24:27], v[192:195], v[168:171], v[24:27]
    v_mfma_f32_16x16x32_bf16 v[44:47], v[192:195], v[172:175], v[44:47]
    v_mfma_f32_16x16x32_bf16 v[64:67], v[192:195], v[176:179], v[64:67]
    v_mfma_f32_16x16x32_bf16 v[84:87], v[192:195], v[180:183], v[84:87]
    s_waitcnt vmcnt(19)
    v_mfma_f32_16x16x32_bf16 v[28:31], v[196:199], v[168:171], v[28:31]
    v_mfma_f32_16x16x32_bf16 v[48:51], v[196:199], v[172:175], v[48:51]
    v_mfma_f32_16x16x32_bf16 v[68:71], v[196:199], v[176:179], v[68:71]
    v_mfma_f32_16x16x32_bf16 v[88:91], v[196:199], v[180:183], v[88:91]
    s_waitcnt vmcnt(18)
    v_mfma_f32_16x16x32_bf16 v[32:35], v[200:203], v[168:171], v[32:35]
    v_mfma_f32_16x16x32_bf16 v[52:55], v[200:203], v[172:175], v[52:55]
    v_mfma_f32_16x16x32_bf16 v[72:75], v[200:203], v[176:179], v[72:75]
    v_mfma_f32_16x16x32_bf16 v[92:95], v[200:203], v[180:183], v[92:95]
    buffer_load_dwordx4 v[168:171], v10, s[16:19], s44 offen sc1
    buffer_load_dwordx4 v[172:175], v11, s[16:19], s44 offen sc1
    buffer_load_dwordx4 v[176:179], v12, s[16:19], s44 offen sc1
    buffer_load_dwordx4 v[180:183], v13, s[16:19], s44 offen sc1
    s_add_u32 s44, s44, 4096
    buffer_load_dwordx4 v[184:187], v2, s[12:15], s43 offen offset:0 sc1
    buffer_load_dwordx4 v[188:191], v2, s[12:15], s43 offen offset:1024 sc1
    buffer_load_dwordx4 v[192:195], v2, s[12:15], s43 offen offset:2048 sc1
    buffer_load_dwordx4 v[196:199], v2, s[12:15], s43 offen offset:3072 sc1
    s_add_u32 s51, s43, 4096
    buffer_load_dwordx4 v[200:203], v2, s[12:15], s51 offen sc1
    s_add_u32 s43, s43, 5120
    s_waitcnt vmcnt(22)
    v_mfma_f32_16x16x32_bf16 v[16:19], v[112:115], v[96:99], v[16:19]
    v_mfma_f32_16x16x32_bf16 v[36:39], v[112:115], v[100:103], v[36:39]
    v_mfma_f32_16x16x32_bf16 v[56:59], v[112:115], v[104:107], v[56:59]
    v_mfma_f32_16x16x32_bf16 v[76:79], v[112:115], v[108:111], v[76:79]
    s_waitcnt vmcnt(21)
    v_mfma_f32_16x16x32_bf16 v[20:23], v[116:119], v[96:99], v[20:23]
    v_mfma_f32_16x16x32_bf16 v[40:43], v[116:119], v[100:103], v[40:43]
    v_mfma_f32_16x16x32_bf16 v[60:63], v[116:119], v[104:107], v[60:63]
    v_mfma_f32_16x16x32_bf16 v[80:83], v[116:119], v[108:111], v[80:83]
    s_waitcnt vmcnt(20)
    v_mfma_f32_16x16x32_bf16 v[24:27], v[120:123], v[96:99], v[24:27]
    v_mfma_f32_16x16x32_bf16 v[44:47], v[120:123], v[100:103], v[44:47]
    v_mfma_f32_16x16x32_bf16 v[64:67], v[120:123], v[104:107], v[64:67]
    v_mfma_f32_16x16x32_bf16 v[84:87], v[120:123], v[108:111], v[84:87]
    s_waitcnt vmcnt(19)
    v_mfma_f32_16x16x32_bf16 v[28:31], v[124:127], v[96:99], v[28:31]
    v_mfma_f32_16x16x32_bf16 v[48:51], v[124:127], v[100:103], v[48:51]
    v_mfma_f32_16x16x32_bf16 v[68:71], v[124:127], v[104:107], v[68:71]
    v_mfma_f32_16x16x32_bf16 v[88:91], v[124:127], v[108:111], v[88:91]
    s_waitcnt vmcnt(18)
    v_mfma_f32_16x16x32_bf16 v[32:35], v[128:131], v[96:99], v[32:35]
    v_mfma_f32_16x16x32_bf16 v[52:55], v[128:131], v[100:103], v[52:55]
    v_mfma_f32_16x16x32_bf16 v[72:75], v[128:131], v[104:107], v[72:75]
    v_mfma_f32_16x16x32_bf16 v[92:95], v[128:131], v[108:111], v[92:95]
    buffer_load_dwordx4 v[96:99], v10, s[16:19], s44 offen sc1
    buffer_load_dwordx4 v[100:103], v11, s[16:19], s44 offen sc1
    buffer_load_dwordx4 v[104:107], v12, s[16:19], s44 offen sc1
    buffer_load_dwordx4 v[108:111], v13, s[16:19], s44 offen sc1
    s_add_u32 s44, s44, 4096
    buffer_load_dwordx4 v[112:115], v2, s[12:15], s43 offen offset:0 sc1
    buffer_load_dwordx4 v[116:119], v2, s[12:15], s43 offen offset:1024 sc1
    buffer_load_dwordx4 v[120:123], v2, s[12:15], s43 offen offset:2048 sc1
    buffer_load_dwordx4 v[124:127], v2, s[12:15], s43 offen offset:3072 sc1
    s_add_u32 s51, s43, 4096
    buffer_load_dwordx4 v[128:131], v2, s[12:15], s51 offen sc1
    s_add_u32 s43, s43, 5120
    s_waitcnt vmcnt(22)
    v_mfma_f32_16x16x32_bf16 v[16:19], v[148:151], v[132:135], v[16:19]
    v_mfma_f32_16x16x32_bf16 v[36:39], v[148:151], v[136:139], v[36:39]
    v_mfma_f32_16x16x32_bf16 v[56:59], v[148:151], v[140:143], v[56:59]
    v_mfma_f32_16x16x32_bf16 v[76:79], v[148:151], v[144:147], v[76:79]
    s_waitcnt vmcnt(21)
    v_mfma_f32_16x16x32_bf16 v[20:23], v[152:155], v[132:135], v[20:23]
    v_mfma_f32_16x16x32_bf16 v[40:43], v[152:155], v[136:139], v[40:43]
    v_mfma_f32_16x16x32_bf16 v[60:63], v[152:155], v[140:143], v[60:63]
    v_mfma_f32_16x16x32_bf16 v[80:83], v[152:155], v[144:147], v[80:83]
    s_waitcnt vmcnt(20)
    v_mfma_f32_16x16x32_bf16 v[24:27], v[156:159], v[132:135], v[24:27]
    v_mfma_f32_16x16x32_bf16 v[44:47], v[156:159], v[136:139], v[44:47]
    v_mfma_f32_16x16x32_bf16 v[64:67], v[156:159], v[140:143], v[64:67]
    v_mfma_f32_16x16x32_bf16 v[84:87], v[156:159], v[144:147], v[84:87]
    s_waitcnt vmcnt(19)
    v_mfma_f32_16x16x32_bf16 v[28:31], v[160:163], v[132:135], v[28:31]
    v_mfma_f32_16x16x32_bf16 v[48:51], v[160:163], v[136:139], v[48:51]
    v_mfma_f32_16x16x32_bf16 v[68:71], v[160:163], v[140:143], v[68:71]
    v_mfma_f32_16x16x32_bf16 v[88:91], v[160:163], v[144:147], v[88:91]
    s_waitcnt vmcnt(18)
    v_mfma_f32_16x16x32_bf16 v[32:35], v[164:167], v[132:135], v[32:35]
    v_mfma_f32_16x16x32_bf16 v[52:55], v[164:167], v[136:139], v[52:55]
    v_mfma_f32_16x16x32_bf16 v[72:75], v[164:167], v[140:143], v[72:75]
    v_mfma_f32_16x16x32_bf16 v[92:95], v[164:167], v[144:147], v[92:95]
    buffer_load_dwordx4 v[132:135], v10, s[16:19], s44 offen sc1
    buffer_load_dwordx4 v[136:139], v11, s[16:19], s44 offen sc1
    buffer_load_dwordx4 v[140:143], v12, s[16:19], s44 offen sc1
    buffer_load_dwordx4 v[144:147], v13, s[16:19], s44 offen sc1
    s_add_u32 s44, s44, 4096
    buffer_load_dwordx4 v[148:151], v2, s[12:15], s43 offen offset:0 sc1
    buffer_load_dwordx4 v[152:155], v2, s[12:15], s43 offen offset:1024 sc1
    buffer_load_dwordx4 v[156:159], v2, s[12:15], s43 offen offset:2048 sc1
    buffer_load_dwordx4 v[160:163], v2, s[12:15], s43 offen offset:3072 sc1
    s_add_u32 s51, s43, 4096
    buffer_load_dwordx4 v[164:167], v2, s[12:15], s51 offen sc1
    s_add_u32 s43, s43, 5120
    buffer_load_dwordx4 v[204:207], v9, s[20:23], s66 offen offset:0 sc1
    buffer_load_dwordx4 v[208:211], v9, s[20:23], s66 offen offset:64 sc1
    buffer_load_dwordx4 v[212:215], v9, s[20:23], s66 offen offset:128 sc1
    buffer_load_dwordx4 v[216:219], v9, s[20:23], s66 offen offset:192 sc1
    buffer_load_dwordx4 v[220:223], v9, s[20:23], s66 offen offset:256 sc1
    ds_read_b128 v[224:227], v254 offset:0
    ds_read_b128 v[228:231], v254 offset:1024
    ds_read_b128 v[232:235], v254 offset:2048
    ds_read_b128 v[236:239], v254 offset:3072
    ds_read_b128 v[240:243], v254 offset:4096
    s_waitcnt vmcnt(27)
    v_mfma_f32_16x16x32_bf16 v[16:19], v[184:187], v[168:171], v[16:19]
    v_mfma_f32_16x16x32_bf16 v[36:39], v[184:187], v[172:175], v[36:39]
    v_mfma_f32_16x16x32_bf16 v[56:59], v[184:187], v[176:179], v[56:59]
    v_mfma_f32_16x16x32_bf16 v[76:79], v[184:187], v[180:183], v[76:79]
    s_waitcnt vmcnt(26)
    v_mfma_f32_16x16x32_bf16 v[20:23], v[188:191], v[168:171], v[20:23]
    v_mfma_f32_16x16x32_bf16 v[40:43], v[188:191], v[172:175], v[40:43]
    v_mfma_f32_16x16x32_bf16 v[60:63], v[188:191], v[176:179], v[60:63]
    v_mfma_f32_16x16x32_bf16 v[80:83], v[188:191], v[180:183], v[80:83]
    s_waitcnt vmcnt(25)
    v_mfma_f32_16x16x32_bf16 v[24:27], v[192:195], v[168:171], v[24:27]
    v_mfma_f32_16x16x32_bf16 v[44:47], v[192:195], v[172:175], v[44:47]
    v_mfma_f32_16x16x32_bf16 v[64:67], v[192:195], v[176:179], v[64:67]
    v_mfma_f32_16x16x32_bf16 v[84:87], v[192:195], v[180:183], v[84:87]
    s_waitcnt vmcnt(24)
    v_mfma_f32_16x16x32_bf16 v[28:31], v[196:199], v[168:171], v[28:31]
    v_mfma_f32_16x16x32_bf16 v[48:51], v[196:199], v[172:175], v[48:51]
    v_mfma_f32_16x16x32_bf16 v[68:71], v[196:199], v[176:179], v[68:71]
    v_mfma_f32_16x16x32_bf16 v[88:91], v[196:199], v[180:183], v[88:91]
    s_waitcnt vmcnt(23)
    v_mfma_f32_16x16x32_bf16 v[32:35], v[200:203], v[168:171], v[32:35]
    v_mfma_f32_16x16x32_bf16 v[52:55], v[200:203], v[172:175], v[52:55]
    v_mfma_f32_16x16x32_bf16 v[72:75], v[200:203], v[176:179], v[72:75]
    v_mfma_f32_16x16x32_bf16 v[92:95], v[200:203], v[180:183], v[92:95]
    s_cmp_ge_u32 s93, 2
    s_cbranch_scc1 L_adaLN_cond__sliding_block_cached__swiglu_ffn__prompt_kernel_67
    s_waitcnt vmcnt(18)
    v_mfma_f32_16x16x32_bf16 v[16:19], v[112:115], v[96:99], v[16:19]
    v_mfma_f32_16x16x32_bf16 v[36:39], v[112:115], v[100:103], v[36:39]
    v_mfma_f32_16x16x32_bf16 v[56:59], v[112:115], v[104:107], v[56:59]
    v_mfma_f32_16x16x32_bf16 v[76:79], v[112:115], v[108:111], v[76:79]
    s_waitcnt vmcnt(17)
    v_mfma_f32_16x16x32_bf16 v[20:23], v[116:119], v[96:99], v[20:23]
    v_mfma_f32_16x16x32_bf16 v[40:43], v[116:119], v[100:103], v[40:43]
    v_mfma_f32_16x16x32_bf16 v[60:63], v[116:119], v[104:107], v[60:63]
    v_mfma_f32_16x16x32_bf16 v[80:83], v[116:119], v[108:111], v[80:83]
    s_waitcnt vmcnt(16)
    v_mfma_f32_16x16x32_bf16 v[24:27], v[120:123], v[96:99], v[24:27]
    v_mfma_f32_16x16x32_bf16 v[44:47], v[120:123], v[100:103], v[44:47]
    v_mfma_f32_16x16x32_bf16 v[64:67], v[120:123], v[104:107], v[64:67]
    v_mfma_f32_16x16x32_bf16 v[84:87], v[120:123], v[108:111], v[84:87]
    s_waitcnt vmcnt(15)
    v_mfma_f32_16x16x32_bf16 v[28:31], v[124:127], v[96:99], v[28:31]
    v_mfma_f32_16x16x32_bf16 v[48:51], v[124:127], v[100:103], v[48:51]
    v_mfma_f32_16x16x32_bf16 v[68:71], v[124:127], v[104:107], v[68:71]
    v_mfma_f32_16x16x32_bf16 v[88:91], v[124:127], v[108:111], v[88:91]
    s_waitcnt vmcnt(14)
    v_mfma_f32_16x16x32_bf16 v[32:35], v[128:131], v[96:99], v[32:35]
    v_mfma_f32_16x16x32_bf16 v[52:55], v[128:131], v[100:103], v[52:55]
    v_mfma_f32_16x16x32_bf16 v[72:75], v[128:131], v[104:107], v[72:75]
    v_mfma_f32_16x16x32_bf16 v[92:95], v[128:131], v[108:111], v[92:95]
    s_waitcnt vmcnt(9)
    v_mfma_f32_16x16x32_bf16 v[36:39], v[148:151], v[136:139], v[36:39]
    s_waitcnt vmcnt(8)
    v_mfma_f32_16x16x32_bf16 v[40:43], v[152:155], v[136:139], v[40:43]
    s_waitcnt vmcnt(7)
    v_mfma_f32_16x16x32_bf16 v[44:47], v[156:159], v[136:139], v[44:47]
    s_waitcnt vmcnt(6)
    v_mfma_f32_16x16x32_bf16 v[48:51], v[160:163], v[136:139], v[48:51]
    s_waitcnt vmcnt(5)
    v_mfma_f32_16x16x32_bf16 v[52:55], v[164:167], v[136:139], v[52:55]
    v_mfma_f32_16x16x32_bf16 v[56:59], v[148:151], v[140:143], v[56:59]
    v_mfma_f32_16x16x32_bf16 v[60:63], v[152:155], v[140:143], v[60:63]
    v_mfma_f32_16x16x32_bf16 v[64:67], v[156:159], v[140:143], v[64:67]
    ds_write_b128 v14, v[36:39] offset:10240
    v_mfma_f32_16x16x32_bf16 v[68:71], v[160:163], v[140:143], v[68:71]
    ds_write_b128 v14, v[40:43] offset:11264
    v_mfma_f32_16x16x32_bf16 v[72:75], v[164:167], v[140:143], v[72:75]
    ds_write_b128 v14, v[44:47] offset:12288
    v_mfma_f32_16x16x32_bf16 v[76:79], v[148:151], v[144:147], v[76:79]
    ds_write_b128 v14, v[48:51] offset:13312
    v_mfma_f32_16x16x32_bf16 v[80:83], v[152:155], v[144:147], v[80:83]
    ds_write_b128 v14, v[52:55] offset:14336
    v_mfma_f32_16x16x32_bf16 v[84:87], v[156:159], v[144:147], v[84:87]
    ds_write_b128 v15, v[56:59] offset:5120
    v_mfma_f32_16x16x32_bf16 v[88:91], v[160:163], v[144:147], v[88:91]
    ds_write_b128 v15, v[60:63] offset:6144
    v_mfma_f32_16x16x32_bf16 v[92:95], v[164:167], v[144:147], v[92:95]
    ds_write_b128 v15, v[64:67] offset:7168
    v_mfma_f32_16x16x32_bf16 v[16:19], v[148:151], v[132:135], v[16:19]
    ds_write_b128 v15, v[68:71] offset:8192
    v_mfma_f32_16x16x32_bf16 v[20:23], v[152:155], v[132:135], v[20:23]
    ds_write_b128 v15, v[72:75] offset:9216
    v_mfma_f32_16x16x32_bf16 v[24:27], v[156:159], v[132:135], v[24:27]
    ds_write_b128 v3, v[76:79] offset:0
    v_mfma_f32_16x16x32_bf16 v[28:31], v[160:163], v[132:135], v[28:31]
    ds_write_b128 v3, v[80:83] offset:1024
    v_mfma_f32_16x16x32_bf16 v[32:35], v[164:167], v[132:135], v[32:35]
    ds_write_b128 v3, v[84:87] offset:2048
    ds_write_b128 v3, v[88:91] offset:3072
    ds_write_b128 v3, v[92:95] offset:4096
    s_branch L_adaLN_cond__sliding_block_cached__swiglu_ffn__prompt_kernel_68
L_adaLN_cond__sliding_block_cached__swiglu_ffn__prompt_kernel_67:
    s_waitcnt vmcnt(18)
    v_mfma_f32_16x16x32_bf16 v[36:39], v[112:115], v[100:103], v[36:39]
    s_waitcnt vmcnt(17)
    v_mfma_f32_16x16x32_bf16 v[40:43], v[116:119], v[100:103], v[40:43]
    s_waitcnt vmcnt(16)
    v_mfma_f32_16x16x32_bf16 v[44:47], v[120:123], v[100:103], v[44:47]
    s_waitcnt vmcnt(15)
    v_mfma_f32_16x16x32_bf16 v[48:51], v[124:127], v[100:103], v[48:51]
    s_waitcnt vmcnt(14)
    v_mfma_f32_16x16x32_bf16 v[52:55], v[128:131], v[100:103], v[52:55]
    v_mfma_f32_16x16x32_bf16 v[56:59], v[112:115], v[104:107], v[56:59]
    v_mfma_f32_16x16x32_bf16 v[60:63], v[116:119], v[104:107], v[60:63]
    v_mfma_f32_16x16x32_bf16 v[64:67], v[120:123], v[104:107], v[64:67]
    ds_write_b128 v14, v[36:39] offset:10240
    v_mfma_f32_16x16x32_bf16 v[68:71], v[124:127], v[104:107], v[68:71]
    ds_write_b128 v14, v[40:43] offset:11264
    v_mfma_f32_16x16x32_bf16 v[72:75], v[128:131], v[104:107], v[72:75]
    ds_write_b128 v14, v[44:47] offset:12288
    v_mfma_f32_16x16x32_bf16 v[76:79], v[112:115], v[108:111], v[76:79]
    ds_write_b128 v14, v[48:51] offset:13312
    v_mfma_f32_16x16x32_bf16 v[80:83], v[116:119], v[108:111], v[80:83]
    ds_write_b128 v14, v[52:55] offset:14336
    v_mfma_f32_16x16x32_bf16 v[84:87], v[120:123], v[108:111], v[84:87]
    ds_write_b128 v15, v[56:59] offset:5120
    v_mfma_f32_16x16x32_bf16 v[88:91], v[124:127], v[108:111], v[88:91]
    ds_write_b128 v15, v[60:63] offset:6144
    v_mfma_f32_16x16x32_bf16 v[92:95], v[128:131], v[108:111], v[92:95]
    ds_write_b128 v15, v[64:67] offset:7168
    v_mfma_f32_16x16x32_bf16 v[16:19], v[112:115], v[96:99], v[16:19]
    ds_write_b128 v15, v[68:71] offset:8192
    v_mfma_f32_16x16x32_bf16 v[20:23], v[116:119], v[96:99], v[20:23]
    ds_write_b128 v15, v[72:75] offset:9216
    v_mfma_f32_16x16x32_bf16 v[24:27], v[120:123], v[96:99], v[24:27]
    ds_write_b128 v3, v[76:79] offset:0
    v_mfma_f32_16x16x32_bf16 v[28:31], v[124:127], v[96:99], v[28:31]
    ds_write_b128 v3, v[80:83] offset:1024
    v_mfma_f32_16x16x32_bf16 v[32:35], v[128:131], v[96:99], v[32:35]
    ds_write_b128 v3, v[84:87] offset:2048
    ds_write_b128 v3, v[88:91] offset:3072
    ds_write_b128 v3, v[92:95] offset:4096
L_adaLN_cond__sliding_block_cached__swiglu_ffn__prompt_kernel_68:
    s_waitcnt vmcnt(0) lgkmcnt(0)
    s_barrier
    ds_read_b128 v[96:99], v6 offset:0
    ds_read_b128 v[100:103], v6 offset:1024
    ds_read_b128 v[104:107], v6 offset:2048
    ds_read_b128 v[108:111], v6 offset:3072
    ds_read_b128 v[112:115], v6 offset:4096
    ds_read_b128 v[116:119], v6 offset:5120
    ds_read_b128 v[120:123], v6 offset:6144
    ds_read_b128 v[124:127], v6 offset:7168
    ds_read_b128 v[128:131], v6 offset:8192
    ds_read_b128 v[132:135], v6 offset:9216
    ds_read_b128 v[136:139], v6 offset:10240
    ds_read_b128 v[140:143], v6 offset:11264
    ds_read_b128 v[144:147], v6 offset:12288
    ds_read_b128 v[148:151], v6 offset:13312
    ds_read_b128 v[152:155], v6 offset:14336
    s_waitcnt lgkmcnt(14)
    v_pk_add_f32 v[16:17], v[16:17], v[96:97]
    v_pk_add_f32 v[18:19], v[18:19], v[98:99]
    s_waitcnt lgkmcnt(13)
    v_pk_add_f32 v[20:21], v[20:21], v[100:101]
    v_pk_add_f32 v[22:23], v[22:23], v[102:103]
    s_waitcnt lgkmcnt(12)
    v_pk_add_f32 v[24:25], v[24:25], v[104:105]
    v_pk_add_f32 v[26:27], v[26:27], v[106:107]
    s_waitcnt lgkmcnt(11)
    v_pk_add_f32 v[28:29], v[28:29], v[108:109]
    v_pk_add_f32 v[30:31], v[30:31], v[110:111]
    s_waitcnt lgkmcnt(10)
    v_pk_add_f32 v[32:33], v[32:33], v[112:113]
    v_pk_add_f32 v[34:35], v[34:35], v[114:115]
    s_waitcnt lgkmcnt(4)
    v_pk_add_f32 v[116:117], v[116:117], v[136:137]
    v_pk_add_f32 v[118:119], v[118:119], v[138:139]
    s_waitcnt lgkmcnt(3)
    v_pk_add_f32 v[120:121], v[120:121], v[140:141]
    v_pk_add_f32 v[122:123], v[122:123], v[142:143]
    s_waitcnt lgkmcnt(2)
    v_pk_add_f32 v[124:125], v[124:125], v[144:145]
    v_pk_add_f32 v[126:127], v[126:127], v[146:147]
    s_waitcnt lgkmcnt(1)
    v_pk_add_f32 v[128:129], v[128:129], v[148:149]
    v_pk_add_f32 v[130:131], v[130:131], v[150:151]
    s_waitcnt lgkmcnt(0)
    v_pk_add_f32 v[132:133], v[132:133], v[152:153]
    v_pk_add_f32 v[134:135], v[134:135], v[154:155]
    v_pk_add_f32 v[16:17], v[16:17], v[116:117]
    v_pk_add_f32 v[18:19], v[18:19], v[118:119]
    v_pk_add_f32 v[20:21], v[20:21], v[120:121]
    v_pk_add_f32 v[22:23], v[22:23], v[122:123]
    v_pk_add_f32 v[24:25], v[24:25], v[124:125]
    v_pk_add_f32 v[26:27], v[26:27], v[126:127]
    v_pk_add_f32 v[28:29], v[28:29], v[128:129]
    v_pk_add_f32 v[30:31], v[30:31], v[130:131]
    v_pk_add_f32 v[32:33], v[32:33], v[132:133]
    v_pk_add_f32 v[34:35], v[34:35], v[134:135]
    v_pk_fma_f32 v[16:17], v[16:17], v[204:205], v[224:225]
    v_pk_fma_f32 v[18:19], v[18:19], v[206:207], v[226:227]
    v_cvt_pk_bf16_f32 v136, v16, v17
    v_cvt_pk_bf16_f32 v137, v18, v19
    v_pk_fma_f32 v[20:21], v[20:21], v[208:209], v[228:229]
    v_pk_fma_f32 v[22:23], v[22:23], v[210:211], v[230:231]
    v_cvt_pk_bf16_f32 v138, v20, v21
    v_cvt_pk_bf16_f32 v139, v22, v23
    s_nop 0
    v_permlane16_swap_b32 v136, v138
    v_permlane16_swap_b32 v137, v139
    buffer_store_dwordx4 v[136:139], v7, s[24:27], s60 offen offset:0
    v_pk_fma_f32 v[24:25], v[24:25], v[212:213], v[232:233]
    v_pk_fma_f32 v[26:27], v[26:27], v[214:215], v[234:235]
    v_cvt_pk_bf16_f32 v140, v24, v25
    v_cvt_pk_bf16_f32 v141, v26, v27
    v_pk_fma_f32 v[28:29], v[28:29], v[216:217], v[236:237]
    v_pk_fma_f32 v[30:31], v[30:31], v[218:219], v[238:239]
    v_cvt_pk_bf16_f32 v142, v28, v29
    v_cvt_pk_bf16_f32 v143, v30, v31
    s_nop 0
    v_permlane16_swap_b32 v140, v142
    v_permlane16_swap_b32 v141, v143
    buffer_store_dwordx4 v[140:143], v7, s[24:27], s60 offen offset:64
    v_pk_fma_f32 v[32:33], v[32:33], v[220:221], v[240:241]
    v_pk_fma_f32 v[34:35], v[34:35], v[222:223], v[242:243]
    v_cvt_pk_bf16_f32 v144, v32, v33
    v_cvt_pk_bf16_f32 v145, v34, v35
    buffer_store_dwordx2 v[144:145], v8, s[24:27], s60 offen offset:128
    s_endpgm
L_adaLN_cond__sliding_block_cached__swiglu_ffn__prompt_kernel_56:
    s_endpgm
L_done:
    s_endpgm
L_adaLN_cond__sliding_block_cached__swiglu_ffn__prompt_kernel_11:
    v_mov_b32 v198, 0
    s_mov_b32 s3, 60000
L_adaLN_cond__sliding_block_cached__swiglu_ffn__prompt_kernel_13:
    buffer_load_dword v33, v198, s[56:59], 0 offen sc1
    s_waitcnt vmcnt(0)
    v_cmp_eq_u32 vcc, 0, v33
    s_cbranch_vccz L_adaLN_cond__sliding_block_cached__swiglu_ffn__prompt_kernel_12
    s_sleep 1
    s_sub_u32 s3, s3, 1
    s_cmp_lg_u32 s3, 0
    s_cbranch_scc1 L_adaLN_cond__sliding_block_cached__swiglu_ffn__prompt_kernel_13
L_adaLN_cond__sliding_block_cached__swiglu_ffn__prompt_kernel_12:
    s_branch L_adaLN_cond__sliding_block_cached__swiglu_ffn__prompt_kernel_10
L_adaLN_cond__sliding_block_cached__swiglu_ffn__prompt_kernel_15:
    v_mov_b32 v198, 0
    s_mov_b32 s3, 60000
L_adaLN_cond__sliding_block_cached__swiglu_ffn__prompt_kernel_17:
    buffer_load_dword v33, v198, s[56:59], 0 offen sc1
    s_waitcnt vmcnt(0)
    v_cmp_eq_u32 vcc, 0, v33
    s_cbranch_vccz L_adaLN_cond__sliding_block_cached__swiglu_ffn__prompt_kernel_16
    s_sleep 1
    s_sub_u32 s3, s3, 1
    s_cmp_lg_u32 s3, 0
    s_cbranch_scc1 L_adaLN_cond__sliding_block_cached__swiglu_ffn__prompt_kernel_17
L_adaLN_cond__sliding_block_cached__swiglu_ffn__prompt_kernel_16:
    s_branch L_adaLN_cond__sliding_block_cached__swiglu_ffn__prompt_kernel_14
L_attn_cold1:
    s_nop 15
    v_max3_f32 v124, v100, v101, v102
    v_max3_f32 v44, v103, v108, v109
    v_max3_f32 v124, v124, v110, v111
    v_max_f32 v124, v124, v44
    v_max3_f32 v125, v104, v105, v106
    v_max3_f32 v45, v107, v112, v113
    v_max3_f32 v125, v125, v114, v115
    v_max_f32 v125, v125, v45
    v_mov_b32 v44, v124
    v_mov_b32 v45, v125
    s_nop 0
    v_permlane16_swap_b32 v124, v44
    v_permlane16_swap_b32 v125, v45
    v_max_f32 v124, v124, v44
    v_max_f32 v125, v125, v45
    v_mov_b32 v44, v124
    v_mov_b32 v45, v125
    s_nop 0
    v_permlane32_swap_b32 v124, v44
    v_permlane32_swap_b32 v125, v45
    v_max_f32 v124, v124, v44
    v_max_f32 v125, v125, v45
    v_add_f32 v124, v124, v36
    v_max_f32 v14, 0, v124
    v_add_f32 v125, v125, v40
    v_max_f32 v15, 0, v125
    v_sub_f32 v44, 0, v14
    v_exp_f32 v44, v44
    v_sub_f32 v45, 0, v15
    v_exp_f32 v45, v45
    v_sub_f32 v36, v36, v14
    v_sub_f32 v37, v37, v14
    v_sub_f32 v38, v38, v14
    v_sub_f32 v39, v39, v14
    v_mul_f32 v12, v12, v44
    v_mul_f32 v132, v132, v44
    v_mul_f32 v133, v133, v44
    v_mul_f32 v134, v134, v44
    v_mul_f32 v135, v135, v44
    v_mul_f32 v140, v140, v44
    v_mul_f32 v141, v141, v44
    v_mul_f32 v142, v142, v44
    v_mul_f32 v143, v143, v44
    v_mul_f32 v148, v148, v44
    v_mul_f32 v149, v149, v44
    v_mul_f32 v150, v150, v44
    v_mul_f32 v151, v151, v44
    v_mul_f32 v156, v156, v44
    v_mul_f32 v157, v157, v44
    v_mul_f32 v158, v158, v44
    v_mul_f32 v159, v159, v44
    v_mul_f32 v164, v164, v44
    v_mul_f32 v165, v165, v44
    v_mul_f32 v166, v166, v44
    v_mul_f32 v167, v167, v44
    v_mul_f32 v172, v172, v44
    v_mul_f32 v173, v173, v44
    v_mul_f32 v174, v174, v44
    v_mul_f32 v175, v175, v44
    v_mul_f32 v180, v180, v44
    v_mul_f32 v181, v181, v44
    v_mul_f32 v182, v182, v44
    v_mul_f32 v183, v183, v44
    v_mul_f32 v188, v188, v44
    v_mul_f32 v189, v189, v44
    v_mul_f32 v190, v190, v44
    v_mul_f32 v191, v191, v44
    v_sub_f32 v84, v84, v14
    v_sub_f32 v85, v85, v14
    v_sub_f32 v86, v86, v14
    v_sub_f32 v87, v87, v14
    v_sub_f32 v92, v92, v14
    v_sub_f32 v93, v93, v14
    v_sub_f32 v94, v94, v14
    v_sub_f32 v95, v95, v14
    v_sub_f32 v40, v40, v15
    v_sub_f32 v41, v41, v15
    v_sub_f32 v42, v42, v15
    v_sub_f32 v43, v43, v15
    v_mul_f32 v13, v13, v45
    v_mul_f32 v136, v136, v45
    v_mul_f32 v137, v137, v45
    v_mul_f32 v138, v138, v45
    v_mul_f32 v139, v139, v45
    v_mul_f32 v144, v144, v45
    v_mul_f32 v145, v145, v45
    v_mul_f32 v146, v146, v45
    v_mul_f32 v147, v147, v45
    v_mul_f32 v152, v152, v45
    v_mul_f32 v153, v153, v45
    v_mul_f32 v154, v154, v45
    v_mul_f32 v155, v155, v45
    v_mul_f32 v160, v160, v45
    v_mul_f32 v161, v161, v45
    v_mul_f32 v162, v162, v45
    v_mul_f32 v163, v163, v45
    v_mul_f32 v168, v168, v45
    v_mul_f32 v169, v169, v45
    v_mul_f32 v170, v170, v45
    v_mul_f32 v171, v171, v45
    v_mul_f32 v176, v176, v45
    v_mul_f32 v177, v177, v45
    v_mul_f32 v178, v178, v45
    v_mul_f32 v179, v179, v45
    v_mul_f32 v184, v184, v45
    v_mul_f32 v185, v185, v45
    v_mul_f32 v186, v186, v45
    v_mul_f32 v187, v187, v45
    v_mul_f32 v192, v192, v45
    v_mul_f32 v193, v193, v45
    v_mul_f32 v194, v194, v45
    v_mul_f32 v195, v195, v45
    v_sub_f32 v88, v88, v15
    v_sub_f32 v89, v89, v15
    v_sub_f32 v90, v90, v15
    v_sub_f32 v91, v91, v15
    v_sub_f32 v96, v96, v15
    v_sub_f32 v97, v97, v15
    v_sub_f32 v98, v98, v15
    v_sub_f32 v99, v99, v15
    v_add_f32 v44, v100, v36
    v_add_f32 v45, v101, v36
    v_add_f32 v46, v102, v36
    v_add_f32 v47, v103, v36
    v_exp_f32 v44, v44
    v_exp_f32 v45, v45
    v_add_f32 v48, v108, v36
    v_add_f32 v49, v109, v36
    v_exp_f32 v46, v46
    v_exp_f32 v47, v47
    v_add_f32 v14, v44, v45
    v_cvt_pk_bf16_f32 v124, v44, v45
    v_add_f32 v50, v110, v36
    v_add_f32 v51, v111, v36
    v_exp_f32 v48, v48
    v_exp_f32 v49, v49
    v_add_f32 v32, v46, v47
    v_add_f32 v14, v14, v32
    v_cvt_pk_bf16_f32 v125, v46, v47
    v_add_f32 v44, v104, v40
    v_add_f32 v45, v105, v40
    v_exp_f32 v50, v50
    v_exp_f32 v51, v51
    v_add_f32 v32, v48, v49
    v_add_f32 v14, v14, v32
    v_cvt_pk_bf16_f32 v126, v48, v49
    v_add_f32 v46, v106, v40
    v_add_f32 v47, v107, v40
    v_exp_f32 v44, v44
    v_exp_f32 v45, v45
    v_add_f32 v32, v50, v51
    v_add_f32 v14, v14, v32
    v_cvt_pk_bf16_f32 v127, v50, v51
    v_add_f32 v48, v112, v40
    v_add_f32 v49, v113, v40
    v_exp_f32 v46, v46
    v_exp_f32 v47, v47
    v_add_f32 v15, v44, v45
    v_cvt_pk_bf16_f32 v128, v44, v45
    v_add_f32 v50, v114, v40
    v_add_f32 v51, v115, v40
    v_exp_f32 v48, v48
    v_exp_f32 v49, v49
    v_add_f32 v32, v46, v47
    v_add_f32 v15, v15, v32
    v_cvt_pk_bf16_f32 v129, v46, v47
    v_exp_f32 v50, v50
    v_exp_f32 v51, v51
    v_add_f32 v32, v48, v49
    v_add_f32 v15, v15, v32
    v_cvt_pk_bf16_f32 v130, v48, v49
    v_add_f32 v32, v50, v51
    v_add_f32 v15, v15, v32
    v_cvt_pk_bf16_f32 v131, v50, v51
    s_nop 3
    s_branch L_attn_back1
L_attn_cold2:
    s_nop 15
    v_max3_f32 v116, v84, v85, v86
    v_max3_f32 v44, v87, v92, v93
    v_max3_f32 v116, v116, v94, v95
    v_max_f32 v116, v116, v44
    v_max3_f32 v117, v88, v89, v90
    v_max3_f32 v45, v91, v96, v97
    v_max3_f32 v117, v117, v98, v99
    v_max_f32 v117, v117, v45
    v_mov_b32 v44, v116
    v_mov_b32 v45, v117
    s_nop 0
    v_permlane16_swap_b32 v116, v44
    v_permlane16_swap_b32 v117, v45
    v_max_f32 v116, v116, v44
    v_max_f32 v117, v117, v45
    v_mov_b32 v44, v116
    v_mov_b32 v45, v117
    s_nop 0
    v_permlane32_swap_b32 v116, v44
    v_permlane32_swap_b32 v117, v45
    v_max_f32 v116, v116, v44
    v_max_f32 v117, v117, v45
    v_max_f32 v14, 0, v116
    v_max_f32 v15, 0, v117
    v_sub_f32 v44, 0, v14
    v_exp_f32 v44, v44
    v_sub_f32 v45, 0, v15
    v_exp_f32 v45, v45
    v_sub_f32 v36, v36, v14
    v_sub_f32 v37, v37, v14
    v_sub_f32 v38, v38, v14
    v_sub_f32 v39, v39, v14
    v_mul_f32 v12, v12, v44
    v_mul_f32 v132, v132, v44
    v_mul_f32 v133, v133, v44
    v_mul_f32 v134, v134, v44
    v_mul_f32 v135, v135, v44
    v_mul_f32 v140, v140, v44
    v_mul_f32 v141, v141, v44
    v_mul_f32 v142, v142, v44
    v_mul_f32 v143, v143, v44
    v_mul_f32 v148, v148, v44
    v_mul_f32 v149, v149, v44
    v_mul_f32 v150, v150, v44
    v_mul_f32 v151, v151, v44
    v_mul_f32 v156, v156, v44
    v_mul_f32 v157, v157, v44
    v_mul_f32 v158, v158, v44
    v_mul_f32 v159, v159, v44
    v_mul_f32 v164, v164, v44
    v_mul_f32 v165, v165, v44
    v_mul_f32 v166, v166, v44
    v_mul_f32 v167, v167, v44
    v_mul_f32 v172, v172, v44
    v_mul_f32 v173, v173, v44
    v_mul_f32 v174, v174, v44
    v_mul_f32 v175, v175, v44
    v_mul_f32 v180, v180, v44
    v_mul_f32 v181, v181, v44
    v_mul_f32 v182, v182, v44
    v_mul_f32 v183, v183, v44
    v_mul_f32 v188, v188, v44
    v_mul_f32 v189, v189, v44
    v_mul_f32 v190, v190, v44
    v_mul_f32 v191, v191, v44
    v_sub_f32 v100, v100, v14
    v_sub_f32 v101, v101, v14
    v_sub_f32 v102, v102, v14
    v_sub_f32 v103, v103, v14
    v_sub_f32 v108, v108, v14
    v_sub_f32 v109, v109, v14
    v_sub_f32 v110, v110, v14
    v_sub_f32 v111, v111, v14
    v_sub_f32 v84, v84, v14
    v_sub_f32 v85, v85, v14
    v_sub_f32 v86, v86, v14
    v_sub_f32 v87, v87, v14
    v_sub_f32 v92, v92, v14
    v_sub_f32 v93, v93, v14
    v_sub_f32 v94, v94, v14
    v_sub_f32 v95, v95, v14
    v_sub_f32 v40, v40, v15
    v_sub_f32 v41, v41, v15
    v_sub_f32 v42, v42, v15
    v_sub_f32 v43, v43, v15
    v_mul_f32 v13, v13, v45
    v_mul_f32 v136, v136, v45
    v_mul_f32 v137, v137, v45
    v_mul_f32 v138, v138, v45
    v_mul_f32 v139, v139, v45
    v_mul_f32 v144, v144, v45
    v_mul_f32 v145, v145, v45
    v_mul_f32 v146, v146, v45
    v_mul_f32 v147, v147, v45
    v_mul_f32 v152, v152, v45
    v_mul_f32 v153, v153, v45
    v_mul_f32 v154, v154, v45
    v_mul_f32 v155, v155, v45
    v_mul_f32 v160, v160, v45
    v_mul_f32 v161, v161, v45
    v_mul_f32 v162, v162, v45
    v_mul_f32 v163, v163, v45
    v_mul_f32 v168, v168, v45
    v_mul_f32 v169, v169, v45
    v_mul_f32 v170, v170, v45
    v_mul_f32 v171, v171, v45
    v_mul_f32 v176, v176, v45
    v_mul_f32 v177, v177, v45
    v_mul_f32 v178, v178, v45
    v_mul_f32 v179, v179, v45
    v_mul_f32 v184, v184, v45
    v_mul_f32 v185, v185, v45
    v_mul_f32 v186, v186, v45
    v_mul_f32 v187, v187, v45
    v_mul_f32 v192, v192, v45
    v_mul_f32 v193, v193, v45
    v_mul_f32 v194, v194, v45
    v_mul_f32 v195, v195, v45
    v_sub_f32 v104, v104, v15
    v_sub_f32 v105, v105, v15
    v_sub_f32 v106, v106, v15
    v_sub_f32 v107, v107, v15
    v_sub_f32 v112, v112, v15
    v_sub_f32 v113, v113, v15
    v_sub_f32 v114, v114, v15
    v_sub_f32 v115, v115, v15
    v_sub_f32 v88, v88, v15
    v_sub_f32 v89, v89, v15
    v_sub_f32 v90, v90, v15
    v_sub_f32 v91, v91, v15
    v_sub_f32 v96, v96, v15
    v_sub_f32 v97, v97, v15
    v_sub_f32 v98, v98, v15
    v_sub_f32 v99, v99, v15
    v_exp_f32 v44, v84
    v_exp_f32 v45, v85
    v_exp_f32 v46, v86
    v_exp_f32 v47, v87
    v_add_f32 v14, v44, v45
    v_cvt_pk_bf16_f32 v116, v44, v45
    v_exp_f32 v48, v92
    v_exp_f32 v49, v93
    v_add_f32 v32, v46, v47
    v_add_f32 v14, v14, v32
    v_cvt_pk_bf16_f32 v117, v46, v47
    v_exp_f32 v50, v94
    v_exp_f32 v51, v95
    v_add_f32 v32, v48, v49
    v_add_f32 v14, v14, v32
    v_cvt_pk_bf16_f32 v118, v48, v49
    v_exp_f32 v44, v88
    v_exp_f32 v45, v89
    v_add_f32 v32, v50, v51
    v_add_f32 v14, v14, v32
    v_cvt_pk_bf16_f32 v119, v50, v51
    v_exp_f32 v46, v90
    v_exp_f32 v47, v91
    v_add_f32 v15, v44, v45
    v_cvt_pk_bf16_f32 v120, v44, v45
    v_exp_f32 v48, v96
    v_exp_f32 v49, v97
    v_add_f32 v32, v46, v47
    v_add_f32 v15, v15, v32
    v_cvt_pk_bf16_f32 v121, v46, v47
    v_exp_f32 v50, v98
    v_exp_f32 v51, v99
    v_add_f32 v32, v48, v49
    v_add_f32 v15, v15, v32
    v_cvt_pk_bf16_f32 v122, v48, v49
    v_add_f32 v32, v50, v51
    v_add_f32 v15, v15, v32
    v_cvt_pk_bf16_f32 v123, v50, v51
    s_nop 3
    s_branch L_attn_back2
L_attn_cold3:
    s_nop 15
    v_max3_f32 v124, v100, v101, v102
    v_max3_f32 v44, v103, v108, v109
    v_max3_f32 v124, v124, v110, v111
    v_max_f32 v124, v124, v44
    v_max3_f32 v125, v104, v105, v106
    v_max3_f32 v45, v107, v112, v113
    v_max3_f32 v125, v125, v114, v115
    v_max_f32 v125, v125, v45
    v_mov_b32 v44, v124
    v_mov_b32 v45, v125
    s_nop 0
    v_permlane16_swap_b32 v124, v44
    v_permlane16_swap_b32 v125, v45
    v_max_f32 v124, v124, v44
    v_max_f32 v125, v125, v45
    v_mov_b32 v44, v124
    v_mov_b32 v45, v125
    s_nop 0
    v_permlane32_swap_b32 v124, v44
    v_permlane32_swap_b32 v125, v45
    v_max_f32 v124, v124, v44
    v_max_f32 v125, v125, v45
    v_max_f32 v14, 0, v124
    v_max_f32 v15, 0, v125
    v_sub_f32 v44, 0, v14
    v_exp_f32 v44, v44
    v_sub_f32 v45, 0, v15
    v_exp_f32 v45, v45
    v_sub_f32 v36, v36, v14
    v_sub_f32 v37, v37, v14
    v_sub_f32 v38, v38, v14
    v_sub_f32 v39, v39, v14
    v_mul_f32 v12, v12, v44
    v_mul_f32 v132, v132, v44
    v_mul_f32 v133, v133, v44
    v_mul_f32 v134, v134, v44
    v_mul_f32 v135, v135, v44
    v_mul_f32 v140, v140, v44
    v_mul_f32 v141, v141, v44
    v_mul_f32 v142, v142, v44
    v_mul_f32 v143, v143, v44
    v_mul_f32 v148, v148, v44
    v_mul_f32 v149, v149, v44
    v_mul_f32 v150, v150, v44
    v_mul_f32 v151, v151, v44
    v_mul_f32 v156, v156, v44
    v_mul_f32 v157, v157, v44
    v_mul_f32 v158, v158, v44
    v_mul_f32 v159, v159, v44
    v_mul_f32 v164, v164, v44
    v_mul_f32 v165, v165, v44
    v_mul_f32 v166, v166, v44
    v_mul_f32 v167, v167, v44
    v_mul_f32 v172, v172, v44
    v_mul_f32 v173, v173, v44
    v_mul_f32 v174, v174, v44
    v_mul_f32 v175, v175, v44
    v_mul_f32 v180, v180, v44
    v_mul_f32 v181, v181, v44
    v_mul_f32 v182, v182, v44
    v_mul_f32 v183, v183, v44
    v_mul_f32 v188, v188, v44
    v_mul_f32 v189, v189, v44
    v_mul_f32 v190, v190, v44
    v_mul_f32 v191, v191, v44
    v_sub_f32 v84, v84, v14
    v_sub_f32 v85, v85, v14
    v_sub_f32 v86, v86, v14
    v_sub_f32 v87, v87, v14
    v_sub_f32 v92, v92, v14
    v_sub_f32 v93, v93, v14
    v_sub_f32 v94, v94, v14
    v_sub_f32 v95, v95, v14
    v_sub_f32 v100, v100, v14
    v_sub_f32 v101, v101, v14
    v_sub_f32 v102, v102, v14
    v_sub_f32 v103, v103, v14
    v_sub_f32 v108, v108, v14
    v_sub_f32 v109, v109, v14
    v_sub_f32 v110, v110, v14
    v_sub_f32 v111, v111, v14
    v_sub_f32 v40, v40, v15
    v_sub_f32 v41, v41, v15
    v_sub_f32 v42, v42, v15
    v_sub_f32 v43, v43, v15
    v_mul_f32 v13, v13, v45
    v_mul_f32 v136, v136, v45
    v_mul_f32 v137, v137, v45
    v_mul_f32 v138, v138, v45
    v_mul_f32 v139, v139, v45
    v_mul_f32 v144, v144, v45
    v_mul_f32 v145, v145, v45
    v_mul_f32 v146, v146, v45
    v_mul_f32 v147, v147, v45
    v_mul_f32 v152, v152, v45
    v_mul_f32 v153, v153, v45
    v_mul_f32 v154, v154, v45
    v_mul_f32 v155, v155, v45
    v_mul_f32 v160, v160, v45
    v_mul_f32 v161, v161, v45
    v_mul_f32 v162, v162, v45
    v_mul_f32 v163, v163, v45
    v_mul_f32 v168, v168, v45
    v_mul_f32 v169, v169, v45
    v_mul_f32 v170, v170, v45
    v_mul_f32 v171, v171, v45
    v_mul_f32 v176, v176, v45
    v_mul_f32 v177, v177, v45
    v_mul_f32 v178, v178, v45
    v_mul_f32 v179, v179, v45
    v_mul_f32 v184, v184, v45
    v_mul_f32 v185, v185, v45
    v_mul_f32 v186, v186, v45
    v_mul_f32 v187, v187, v45
    v_mul_f32 v192, v192, v45
    v_mul_f32 v193, v193, v45
    v_mul_f32 v194, v194, v45
    v_mul_f32 v195, v195, v45
    v_sub_f32 v88, v88, v15
    v_sub_f32 v89, v89, v15
    v_sub_f32 v90, v90, v15
    v_sub_f32 v91, v91, v15
    v_sub_f32 v96, v96, v15
    v_sub_f32 v97, v97, v15
    v_sub_f32 v98, v98, v15
    v_sub_f32 v99, v99, v15
    v_sub_f32 v104, v104, v15
    v_sub_f32 v105, v105, v15
    v_sub_f32 v106, v106, v15
    v_sub_f32 v107, v107, v15
    v_sub_f32 v112, v112, v15
    v_sub_f32 v113, v113, v15
    v_sub_f32 v114, v114, v15
    v_sub_f32 v115, v115, v15
    v_exp_f32 v44, v100
    v_exp_f32 v45, v101
    v_exp_f32 v46, v102
    v_exp_f32 v47, v103
    v_add_f32 v14, v44, v45
    v_cvt_pk_bf16_f32 v124, v44, v45
    v_exp_f32 v48, v108
    v_exp_f32 v49, v109
    v_add_f32 v32, v46, v47
    v_add_f32 v14, v14, v32
    v_cvt_pk_bf16_f32 v125, v46, v47
    v_exp_f32 v50, v110
    v_exp_f32 v51, v111
    v_add_f32 v32, v48, v49
    v_add_f32 v14, v14, v32
    v_cvt_pk_bf16_f32 v126, v48, v49
    v_exp_f32 v44, v104
    v_exp_f32 v45, v105
    v_add_f32 v32, v50, v51
    v_add_f32 v14, v14, v32
    v_cvt_pk_bf16_f32 v127, v50, v51
    v_exp_f32 v46, v106
    v_exp_f32 v47, v107
    v_add_f32 v15, v44, v45
    v_cvt_pk_bf16_f32 v128, v44, v45
    v_exp_f32 v48, v112
    v_exp_f32 v49, v113
    v_add_f32 v32, v46, v47
    v_add_f32 v15, v15, v32
    v_cvt_pk_bf16_f32 v129, v46, v47
    v_exp_f32 v50, v114
    v_exp_f32 v51, v115
    v_add_f32 v32, v48, v49
    v_add_f32 v15, v15, v32
    v_cvt_pk_bf16_f32 v130, v48, v49
    v_add_f32 v32, v50, v51
    v_add_f32 v15, v15, v32
    v_cvt_pk_bf16_f32 v131, v50, v51
    s_nop 3
    s_branch L_attn_back3
L_attn_cold4:
    s_nop 15
    v_max3_f32 v116, v84, v85, v86
    v_max3_f32 v44, v87, v92, v93
    v_max3_f32 v116, v116, v94, v95
    v_max_f32 v116, v116, v44
    v_max3_f32 v117, v88, v89, v90
    v_max3_f32 v45, v91, v96, v97
    v_max3_f32 v117, v117, v98, v99
    v_max_f32 v117, v117, v45
    v_mov_b32 v44, v116
    v_mov_b32 v45, v117
    s_nop 0
    v_permlane16_swap_b32 v116, v44
    v_permlane16_swap_b32 v117, v45
    v_max_f32 v116, v116, v44
    v_max_f32 v117, v117, v45
    v_mov_b32 v44, v116
    v_mov_b32 v45, v117
    s_nop 0
    v_permlane32_swap_b32 v116, v44
    v_permlane32_swap_b32 v117, v45
    v_max_f32 v116, v116, v44
    v_max_f32 v117, v117, v45
    v_max_f32 v14, 0, v116
    v_max_f32 v15, 0, v117
    v_sub_f32 v44, 0, v14
    v_exp_f32 v44, v44
    v_sub_f32 v45, 0, v15
    v_exp_f32 v45, v45
    v_sub_f32 v36, v36, v14
    v_sub_f32 v37, v37, v14
    v_sub_f32 v38, v38, v14
    v_sub_f32 v39, v39, v14
    v_mul_f32 v12, v12, v44
    v_mul_f32 v132, v132, v44
    v_mul_f32 v133, v133, v44
    v_mul_f32 v134, v134, v44
    v_mul_f32 v135, v135, v44
    v_mul_f32 v140, v140, v44
    v_mul_f32 v141, v141, v44
    v_mul_f32 v142, v142, v44
    v_mul_f32 v143, v143, v44
    v_mul_f32 v148, v148, v44
    v_mul_f32 v149, v149, v44
    v_mul_f32 v150, v150, v44
    v_mul_f32 v151, v151, v44
    v_mul_f32 v156, v156, v44
    v_mul_f32 v157, v157, v44
    v_mul_f32 v158, v158, v44
    v_mul_f32 v159, v159, v44
    v_mul_f32 v164, v164, v44
    v_mul_f32 v165, v165, v44
    v_mul_f32 v166, v166, v44
    v_mul_f32 v167, v167, v44
    v_mul_f32 v172, v172, v44
    v_mul_f32 v173, v173, v44
    v_mul_f32 v174, v174, v44
    v_mul_f32 v175, v175, v44
    v_mul_f32 v180, v180, v44
    v_mul_f32 v181, v181, v44
    v_mul_f32 v182, v182, v44
    v_mul_f32 v183, v183, v44
    v_mul_f32 v188, v188, v44
    v_mul_f32 v189, v189, v44
    v_mul_f32 v190, v190, v44
    v_mul_f32 v191, v191, v44
    v_sub_f32 v100, v100, v14
    v_sub_f32 v101, v101, v14
    v_sub_f32 v102, v102, v14
    v_sub_f32 v103, v103, v14
    v_sub_f32 v108, v108, v14
    v_sub_f32 v109, v109, v14
    v_sub_f32 v110, v110, v14
    v_sub_f32 v111, v111, v14
    v_sub_f32 v84, v84, v14
    v_sub_f32 v85, v85, v14
    v_sub_f32 v86, v86, v14
    v_sub_f32 v87, v87, v14
    v_sub_f32 v92, v92, v14
    v_sub_f32 v93, v93, v14
    v_sub_f32 v94, v94, v14
    v_sub_f32 v95, v95, v14
    v_sub_f32 v40, v40, v15
    v_sub_f32 v41, v41, v15
    v_sub_f32 v42, v42, v15
    v_sub_f32 v43, v43, v15
    v_mul_f32 v13, v13, v45
    v_mul_f32 v136, v136, v45
    v_mul_f32 v137, v137, v45
    v_mul_f32 v138, v138, v45
    v_mul_f32 v139, v139, v45
    v_mul_f32 v144, v144, v45
    v_mul_f32 v145, v145, v45
    v_mul_f32 v146, v146, v45
    v_mul_f32 v147, v147, v45
    v_mul_f32 v152, v152, v45
    v_mul_f32 v153, v153, v45
    v_mul_f32 v154, v154, v45
    v_mul_f32 v155, v155, v45
    v_mul_f32 v160, v160, v45
    v_mul_f32 v161, v161, v45
    v_mul_f32 v162, v162, v45
    v_mul_f32 v163, v163, v45
    v_mul_f32 v168, v168, v45
    v_mul_f32 v169, v169, v45
    v_mul_f32 v170, v170, v45
    v_mul_f32 v171, v171, v45
    v_mul_f32 v176, v176, v45
    v_mul_f32 v177, v177, v45
    v_mul_f32 v178, v178, v45
    v_mul_f32 v179, v179, v45
    v_mul_f32 v184, v184, v45
    v_mul_f32 v185, v185, v45
    v_mul_f32 v186, v186, v45
    v_mul_f32 v187, v187, v45
    v_mul_f32 v192, v192, v45
    v_mul_f32 v193, v193, v45
    v_mul_f32 v194, v194, v45
    v_mul_f32 v195, v195, v45
    v_sub_f32 v104, v104, v15
    v_sub_f32 v105, v105, v15
    v_sub_f32 v106, v106, v15
    v_sub_f32 v107, v107, v15
    v_sub_f32 v112, v112, v15
    v_sub_f32 v113, v113, v15
    v_sub_f32 v114, v114, v15
    v_sub_f32 v115, v115, v15
    v_sub_f32 v88, v88, v15
    v_sub_f32 v89, v89, v15
    v_sub_f32 v90, v90, v15
    v_sub_f32 v91, v91, v15
    v_sub_f32 v96, v96, v15
    v_sub_f32 v97, v97, v15
    v_sub_f32 v98, v98, v15
    v_sub_f32 v99, v99, v15
    v_exp_f32 v44, v84
    v_exp_f32 v45, v85
    v_exp_f32 v46, v86
    v_exp_f32 v47, v87
    v_add_f32 v14, v44, v45
    v_cvt_pk_bf16_f32 v116, v44, v45
    v_exp_f32 v48, v92
    v_exp_f32 v49, v93
    v_add_f32 v32, v46, v47
    v_add_f32 v14, v14, v32
    v_cvt_pk_bf16_f32 v117, v46, v47
    v_exp_f32 v50, v94
    v_exp_f32 v51, v95
    v_add_f32 v32, v48, v49
    v_add_f32 v14, v14, v32
    v_cvt_pk_bf16_f32 v118, v48, v49
    v_exp_f32 v44, v88
    v_exp_f32 v45, v89
    v_add_f32 v32, v50, v51
    v_add_f32 v14, v14, v32
    v_cvt_pk_bf16_f32 v119, v50, v51
    v_exp_f32 v46, v90
    v_exp_f32 v47, v91
    v_add_f32 v15, v44, v45
    v_cvt_pk_bf16_f32 v120, v44, v45
    v_exp_f32 v48, v96
    v_exp_f32 v49, v97
    v_add_f32 v32, v46, v47
    v_add_f32 v15, v15, v32
    v_cvt_pk_bf16_f32 v121, v46, v47
    v_exp_f32 v50, v98
    v_exp_f32 v51, v99
    v_add_f32 v32, v48, v49
    v_add_f32 v15, v15, v32
    v_cvt_pk_bf16_f32 v122, v48, v49
    v_add_f32 v32, v50, v51
    v_add_f32 v15, v15, v32
    v_cvt_pk_bf16_f32 v123, v50, v51
    s_nop 3
    s_branch L_attn_back4
L_attn_cold5:
    s_nop 15
    v_max3_f32 v124, v100, v101, v102
    v_max3_f32 v44, v103, v108, v109
    v_max3_f32 v124, v124, v110, v111
    v_max_f32 v124, v124, v44
    v_max3_f32 v125, v104, v105, v106
    v_max3_f32 v45, v107, v112, v113
    v_max3_f32 v125, v125, v114, v115
    v_max_f32 v125, v125, v45
    v_mov_b32 v44, v124
    v_mov_b32 v45, v125
    s_nop 0
    v_permlane16_swap_b32 v124, v44
    v_permlane16_swap_b32 v125, v45
    v_max_f32 v124, v124, v44
    v_max_f32 v125, v125, v45
    v_mov_b32 v44, v124
    v_mov_b32 v45, v125
    s_nop 0
    v_permlane32_swap_b32 v124, v44
    v_permlane32_swap_b32 v125, v45
    v_max_f32 v124, v124, v44
    v_max_f32 v125, v125, v45
    v_max_f32 v14, 0, v124
    v_max_f32 v15, 0, v125
    v_sub_f32 v44, 0, v14
    v_exp_f32 v44, v44
    v_sub_f32 v45, 0, v15
    v_exp_f32 v45, v45
    v_sub_f32 v36, v36, v14
    v_sub_f32 v37, v37, v14
    v_sub_f32 v38, v38, v14
    v_sub_f32 v39, v39, v14
    v_mul_f32 v12, v12, v44
    v_mul_f32 v132, v132, v44
    v_mul_f32 v133, v133, v44
    v_mul_f32 v134, v134, v44
    v_mul_f32 v135, v135, v44
    v_mul_f32 v140, v140, v44
    v_mul_f32 v141, v141, v44
    v_mul_f32 v142, v142, v44
    v_mul_f32 v143, v143, v44
    v_mul_f32 v148, v148, v44
    v_mul_f32 v149, v149, v44
    v_mul_f32 v150, v150, v44
    v_mul_f32 v151, v151, v44
    v_mul_f32 v156, v156, v44
    v_mul_f32 v157, v157, v44
    v_mul_f32 v158, v158, v44
    v_mul_f32 v159, v159, v44
    v_mul_f32 v164, v164, v44
    v_mul_f32 v165, v165, v44
    v_mul_f32 v166, v166, v44
    v_mul_f32 v167, v167, v44
    v_mul_f32 v172, v172, v44
    v_mul_f32 v173, v173, v44
    v_mul_f32 v174, v174, v44
    v_mul_f32 v175, v175, v44
    v_mul_f32 v180, v180, v44
    v_mul_f32 v181, v181, v44
    v_mul_f32 v182, v182, v44
    v_mul_f32 v183, v183, v44
    v_mul_f32 v188, v188, v44
    v_mul_f32 v189, v189, v44
    v_mul_f32 v190, v190, v44
    v_mul_f32 v191, v191, v44
    v_sub_f32 v84, v84, v14
    v_sub_f32 v85, v85, v14
    v_sub_f32 v86, v86, v14
    v_sub_f32 v87, v87, v14
    v_sub_f32 v92, v92, v14
    v_sub_f32 v93, v93, v14
    v_sub_f32 v94, v94, v14
    v_sub_f32 v95, v95, v14
    v_sub_f32 v100, v100, v14
    v_sub_f32 v101, v101, v14
    v_sub_f32 v102, v102, v14
    v_sub_f32 v103, v103, v14
    v_sub_f32 v108, v108, v14
    v_sub_f32 v109, v109, v14
    v_sub_f32 v110, v110, v14
    v_sub_f32 v111, v111, v14
    v_sub_f32 v40, v40, v15
    v_sub_f32 v41, v41, v15
    v_sub_f32 v42, v42, v15
    v_sub_f32 v43, v43, v15
    v_mul_f32 v13, v13, v45
    v_mul_f32 v136, v136, v45
    v_mul_f32 v137, v137, v45
    v_mul_f32 v138, v138, v45
    v_mul_f32 v139, v139, v45
    v_mul_f32 v144, v144, v45
    v_mul_f32 v145, v145, v45
    v_mul_f32 v146, v146, v45
    v_mul_f32 v147, v147, v45
    v_mul_f32 v152, v152, v45
    v_mul_f32 v153, v153, v45
    v_mul_f32 v154, v154, v45
    v_mul_f32 v155, v155, v45
    v_mul_f32 v160, v160, v45
    v_mul_f32 v161, v161, v45
    v_mul_f32 v162, v162, v45
    v_mul_f32 v163, v163, v45
    v_mul_f32 v168, v168, v45
    v_mul_f32 v169, v169, v45
    v_mul_f32 v170, v170, v45
    v_mul_f32 v171, v171, v45
    v_mul_f32 v176, v176, v45
    v_mul_f32 v177, v177, v45
    v_mul_f32 v178, v178, v45
    v_mul_f32 v179, v179, v45
    v_mul_f32 v184, v184, v45
    v_mul_f32 v185, v185, v45
    v_mul_f32 v186, v186, v45
    v_mul_f32 v187, v187, v45
    v_mul_f32 v192, v192, v45
    v_mul_f32 v193, v193, v45
    v_mul_f32 v194, v194, v45
    v_mul_f32 v195, v195, v45
    v_sub_f32 v88, v88, v15
    v_sub_f32 v89, v89, v15
    v_sub_f32 v90, v90, v15
    v_sub_f32 v91, v91, v15
    v_sub_f32 v96, v96, v15
    v_sub_f32 v97, v97, v15
    v_sub_f32 v98, v98, v15
    v_sub_f32 v99, v99, v15
    v_sub_f32 v104, v104, v15
    v_sub_f32 v105, v105, v15
    v_sub_f32 v106, v106, v15
    v_sub_f32 v107, v107, v15
    v_sub_f32 v112, v112, v15
    v_sub_f32 v113, v113, v15
    v_sub_f32 v114, v114, v15
    v_sub_f32 v115, v115, v15
    v_exp_f32 v44, v100
    v_exp_f32 v45, v101
    v_exp_f32 v46, v102
    v_exp_f32 v47, v103
    v_add_f32 v14, v44, v45
    v_cvt_pk_bf16_f32 v124, v44, v45
    v_exp_f32 v48, v108
    v_exp_f32 v49, v109
    v_add_f32 v32, v46, v47
    v_add_f32 v14, v14, v32
    v_cvt_pk_bf16_f32 v125, v46, v47
    v_exp_f32 v50, v110
    v_exp_f32 v51, v111
    v_add_f32 v32, v48, v49
    v_add_f32 v14, v14, v32
    v_cvt_pk_bf16_f32 v126, v48, v49
    v_exp_f32 v44, v104
    v_exp_f32 v45, v105
    v_add_f32 v32, v50, v51
    v_add_f32 v14, v14, v32
    v_cvt_pk_bf16_f32 v127, v50, v51
    v_exp_f32 v46, v106
    v_exp_f32 v47, v107
    v_add_f32 v15, v44, v45
    v_cvt_pk_bf16_f32 v128, v44, v45
    v_exp_f32 v48, v112
    v_exp_f32 v49, v113
    v_add_f32 v32, v46, v47
    v_add_f32 v15, v15, v32
    v_cvt_pk_bf16_f32 v129, v46, v47
    v_exp_f32 v50, v114
    v_exp_f32 v51, v115
    v_add_f32 v32, v48, v49
    v_add_f32 v15, v15, v32
    v_cvt_pk_bf16_f32 v130, v48, v49
    v_add_f32 v32, v50, v51
    v_add_f32 v15, v15, v32
    v_cvt_pk_bf16_f32 v131, v50, v51
    s_nop 3
    s_branch L_attn_back5
L_adaLN_cond__sliding_block_cached__swiglu_ffn__prompt_kernel_24:
    v_mov_b32 v34, 0
    s_mov_b32 s3, 60000
L_adaLN_cond__sliding_block_cached__swiglu_ffn__prompt_kernel_26:
    buffer_load_dword v33, v34, s[56:59], 0 offen sc1
    s_waitcnt vmcnt(0)
    v_cmp_eq_u32 vcc, 0, v33
    s_cbranch_vccz L_adaLN_cond__sliding_block_cached__swiglu_ffn__prompt_kernel_25
    s_sleep 1
    s_sub_u32 s3, s3, 1
    s_cmp_lg_u32 s3, 0
    s_cbranch_scc1 L_adaLN_cond__sliding_block_cached__swiglu_ffn__prompt_kernel_26
L_adaLN_cond__sliding_block_cached__swiglu_ffn__prompt_kernel_25:
    s_branch L_adaLN_cond__sliding_block_cached__swiglu_ffn__prompt_kernel_23
L_attn_cold6:
    s_nop 15
    v_max3_f32 v116, v84, v85, v86
    v_max3_f32 v44, v87, v92, v93
    v_max3_f32 v116, v116, v94, v95
    v_max_f32 v116, v116, v44
    v_max3_f32 v117, v88, v89, v90
    v_max3_f32 v45, v91, v96, v97
    v_max3_f32 v117, v117, v98, v99
    v_max_f32 v117, v117, v45
    v_mov_b32 v44, v116
    v_mov_b32 v45, v117
    s_nop 0
    v_permlane16_swap_b32 v116, v44
    v_permlane16_swap_b32 v117, v45
    v_max_f32 v116, v116, v44
    v_max_f32 v117, v117, v45
    v_mov_b32 v44, v116
    v_mov_b32 v45, v117
    s_nop 0
    v_permlane32_swap_b32 v116, v44
    v_permlane32_swap_b32 v117, v45
    v_max_f32 v116, v116, v44
    v_max_f32 v117, v117, v45
    v_max_f32 v14, 0, v116
    v_max_f32 v15, 0, v117
    v_sub_f32 v44, 0, v14
    v_exp_f32 v44, v44
    v_sub_f32 v45, 0, v15
    v_exp_f32 v45, v45
    v_sub_f32 v36, v36, v14
    v_sub_f32 v37, v37, v14
    v_sub_f32 v38, v38, v14
    v_sub_f32 v39, v39, v14
    v_mul_f32 v12, v12, v44
    v_mul_f32 v132, v132, v44
    v_mul_f32 v133, v133, v44
    v_mul_f32 v134, v134, v44
    v_mul_f32 v135, v135, v44
    v_mul_f32 v140, v140, v44
    v_mul_f32 v141, v141, v44
    v_mul_f32 v142, v142, v44
    v_mul_f32 v143, v143, v44
    v_mul_f32 v148, v148, v44
    v_mul_f32 v149, v149, v44
    v_mul_f32 v150, v150, v44
    v_mul_f32 v151, v151, v44
    v_mul_f32 v156, v156, v44
    v_mul_f32 v157, v157, v44
    v_mul_f32 v158, v158, v44
    v_mul_f32 v159, v159, v44
    v_mul_f32 v164, v164, v44
    v_mul_f32 v165, v165, v44
    v_mul_f32 v166, v166, v44
    v_mul_f32 v167, v167, v44
    v_mul_f32 v172, v172, v44
    v_mul_f32 v173, v173, v44
    v_mul_f32 v174, v174, v44
    v_mul_f32 v175, v175, v44
    v_mul_f32 v180, v180, v44
    v_mul_f32 v181, v181, v44
    v_mul_f32 v182, v182, v44
    v_mul_f32 v183, v183, v44
    v_mul_f32 v188, v188, v44
    v_mul_f32 v189, v189, v44
    v_mul_f32 v190, v190, v44
    v_mul_f32 v191, v191, v44
    v_sub_f32 v100, v100, v14
    v_sub_f32 v101, v101, v14
    v_sub_f32 v102, v102, v14
    v_sub_f32 v103, v103, v14
    v_sub_f32 v108, v108, v14
    v_sub_f32 v109, v109, v14
    v_sub_f32 v110, v110, v14
    v_sub_f32 v111, v111, v14
    v_sub_f32 v84, v84, v14
    v_sub_f32 v85, v85, v14
    v_sub_f32 v86, v86, v14
    v_sub_f32 v87, v87, v14
    v_sub_f32 v92, v92, v14
    v_sub_f32 v93, v93, v14
    v_sub_f32 v94, v94, v14
    v_sub_f32 v95, v95, v14
    v_sub_f32 v40, v40, v15
    v_sub_f32 v41, v41, v15
    v_sub_f32 v42, v42, v15
    v_sub_f32 v43, v43, v15
    v_mul_f32 v13, v13, v45
    v_mul_f32 v136, v136, v45
    v_mul_f32 v137, v137, v45
    v_mul_f32 v138, v138, v45
    v_mul_f32 v139, v139, v45
    v_mul_f32 v144, v144, v45
    v_mul_f32 v145, v145, v45
    v_mul_f32 v146, v146, v45
    v_mul_f32 v147, v147, v45
    v_mul_f32 v152, v152, v45
    v_mul_f32 v153, v153, v45
    v_mul_f32 v154, v154, v45
    v_mul_f32 v155, v155, v45
    v_mul_f32 v160, v160, v45
    v_mul_f32 v161, v161, v45
    v_mul_f32 v162, v162, v45
    v_mul_f32 v163, v163, v45
    v_mul_f32 v168, v168, v45
    v_mul_f32 v169, v169, v45
    v_mul_f32 v170, v170, v45
    v_mul_f32 v171, v171, v45
    v_mul_f32 v176, v176, v45
    v_mul_f32 v177, v177, v45
    v_mul_f32 v178, v178, v45
    v_mul_f32 v179, v179, v45
    v_mul_f32 v184, v184, v45
    v_mul_f32 v185, v185, v45
    v_mul_f32 v186, v186, v45
    v_mul_f32 v187, v187, v45
    v_mul_f32 v192, v192, v45
    v_mul_f32 v193, v193, v45
    v_mul_f32 v194, v194, v45
    v_mul_f32 v195, v195, v45
    v_sub_f32 v104, v104, v15
    v_sub_f32 v105, v105, v15
    v_sub_f32 v106, v106, v15
    v_sub_f32 v107, v107, v15
    v_sub_f32 v112, v112, v15
    v_sub_f32 v113, v113, v15
    v_sub_f32 v114, v114, v15
    v_sub_f32 v115, v115, v15
    v_sub_f32 v88, v88, v15
    v_sub_f32 v89, v89, v15
    v_sub_f32 v90, v90, v15
    v_sub_f32 v91, v91, v15
    v_sub_f32 v96, v96, v15
    v_sub_f32 v97, v97, v15
    v_sub_f32 v98, v98, v15
    v_sub_f32 v99, v99, v15
    v_exp_f32 v44, v84
    v_exp_f32 v45, v85
    v_exp_f32 v46, v86
    v_exp_f32 v47, v87
    v_add_f32 v14, v44, v45
    v_cvt_pk_bf16_f32 v116, v44, v45
    v_exp_f32 v48, v92
    v_exp_f32 v49, v93
    v_add_f32 v32, v46, v47
    v_add_f32 v14, v14, v32
    v_cvt_pk_bf16_f32 v117, v46, v47
    v_exp_f32 v50, v94
    v_exp_f32 v51, v95
    v_add_f32 v32, v48, v49
    v_add_f32 v14, v14, v32
    v_cvt_pk_bf16_f32 v118, v48, v49
    v_exp_f32 v44, v88
    v_exp_f32 v45, v89
    v_add_f32 v32, v50, v51
    v_add_f32 v14, v14, v32
    v_cvt_pk_bf16_f32 v119, v50, v51
    v_exp_f32 v46, v90
    v_exp_f32 v47, v91
    v_add_f32 v15, v44, v45
    v_cvt_pk_bf16_f32 v120, v44, v45
    v_exp_f32 v48, v96
    v_exp_f32 v49, v97
    v_add_f32 v32, v46, v47
    v_add_f32 v15, v15, v32
    v_cvt_pk_bf16_f32 v121, v46, v47
    v_exp_f32 v50, v98
    v_exp_f32 v51, v99
    v_add_f32 v32, v48, v49
    v_add_f32 v15, v15, v32
    v_cvt_pk_bf16_f32 v122, v48, v49
    v_add_f32 v32, v50, v51
    v_add_f32 v15, v15, v32
    v_cvt_pk_bf16_f32 v123, v50, v51
    s_nop 3
    s_branch L_attn_back6
L_attn_cold7:
    s_nop 15
    v_max3_f32 v124, v100, v101, v102
    v_max3_f32 v44, v103, v108, v109
    v_max3_f32 v124, v124, v110, v111
    v_max_f32 v124, v124, v44
    v_max3_f32 v125, v104, v105, v106
    v_max3_f32 v45, v107, v112, v113
    v_max3_f32 v125, v125, v114, v115
    v_max_f32 v125, v125, v45
    v_mov_b32 v44, v124
    v_mov_b32 v45, v125
    s_nop 0
    v_permlane16_swap_b32 v124, v44
    v_permlane16_swap_b32 v125, v45
    v_max_f32 v124, v124, v44
    v_max_f32 v125, v125, v45
    v_mov_b32 v44, v124
    v_mov_b32 v45, v125
    s_nop 0
    v_permlane32_swap_b32 v124, v44
    v_permlane32_swap_b32 v125, v45
    v_max_f32 v124, v124, v44
    v_max_f32 v125, v125, v45
    v_max_f32 v14, 0, v124
    v_max_f32 v15, 0, v125
    v_sub_f32 v44, 0, v14
    v_exp_f32 v44, v44
    v_sub_f32 v45, 0, v15
    v_exp_f32 v45, v45
    v_sub_f32 v36, v36, v14
    v_sub_f32 v37, v37, v14
    v_sub_f32 v38, v38, v14
    v_sub_f32 v39, v39, v14
    v_mul_f32 v12, v12, v44
    v_mul_f32 v132, v132, v44
    v_mul_f32 v133, v133, v44
    v_mul_f32 v134, v134, v44
    v_mul_f32 v135, v135, v44
    v_mul_f32 v140, v140, v44
    v_mul_f32 v141, v141, v44
    v_mul_f32 v142, v142, v44
    v_mul_f32 v143, v143, v44
    v_mul_f32 v148, v148, v44
    v_mul_f32 v149, v149, v44
    v_mul_f32 v150, v150, v44
    v_mul_f32 v151, v151, v44
    v_mul_f32 v156, v156, v44
    v_mul_f32 v157, v157, v44
    v_mul_f32 v158, v158, v44
    v_mul_f32 v159, v159, v44
    v_mul_f32 v164, v164, v44
    v_mul_f32 v165, v165, v44
    v_mul_f32 v166, v166, v44
    v_mul_f32 v167, v167, v44
    v_mul_f32 v172, v172, v44
    v_mul_f32 v173, v173, v44
    v_mul_f32 v174, v174, v44
    v_mul_f32 v175, v175, v44
    v_mul_f32 v180, v180, v44
    v_mul_f32 v181, v181, v44
    v_mul_f32 v182, v182, v44
    v_mul_f32 v183, v183, v44
    v_mul_f32 v188, v188, v44
    v_mul_f32 v189, v189, v44
    v_mul_f32 v190, v190, v44
    v_mul_f32 v191, v191, v44
    v_sub_f32 v84, v84, v14
    v_sub_f32 v85, v85, v14
    v_sub_f32 v86, v86, v14
    v_sub_f32 v87, v87, v14
    v_sub_f32 v92, v92, v14
    v_sub_f32 v93, v93, v14
    v_sub_f32 v94, v94, v14
    v_sub_f32 v95, v95, v14
    v_sub_f32 v100, v100, v14
    v_sub_f32 v101, v101, v14
    v_sub_f32 v102, v102, v14
    v_sub_f32 v103, v103, v14
    v_sub_f32 v108, v108, v14
    v_sub_f32 v109, v109, v14
    v_sub_f32 v110, v110, v14
    v_sub_f32 v111, v111, v14
    v_sub_f32 v40, v40, v15
    v_sub_f32 v41, v41, v15
    v_sub_f32 v42, v42, v15
    v_sub_f32 v43, v43, v15
    v_mul_f32 v13, v13, v45
    v_mul_f32 v136, v136, v45
    v_mul_f32 v137, v137, v45
    v_mul_f32 v138, v138, v45
    v_mul_f32 v139, v139, v45
    v_mul_f32 v144, v144, v45
    v_mul_f32 v145, v145, v45
    v_mul_f32 v146, v146, v45
    v_mul_f32 v147, v147, v45
    v_mul_f32 v152, v152, v45
    v_mul_f32 v153, v153, v45
    v_mul_f32 v154, v154, v45
    v_mul_f32 v155, v155, v45
    v_mul_f32 v160, v160, v45
    v_mul_f32 v161, v161, v45
    v_mul_f32 v162, v162, v45
    v_mul_f32 v163, v163, v45
    v_mul_f32 v168, v168, v45
    v_mul_f32 v169, v169, v45
    v_mul_f32 v170, v170, v45
    v_mul_f32 v171, v171, v45
    v_mul_f32 v176, v176, v45
    v_mul_f32 v177, v177, v45
    v_mul_f32 v178, v178, v45
    v_mul_f32 v179, v179, v45
    v_mul_f32 v184, v184, v45
    v_mul_f32 v185, v185, v45
    v_mul_f32 v186, v186, v45
    v_mul_f32 v187, v187, v45
    v_mul_f32 v192, v192, v45
    v_mul_f32 v193, v193, v45
    v_mul_f32 v194, v194, v45
    v_mul_f32 v195, v195, v45
    v_sub_f32 v88, v88, v15
    v_sub_f32 v89, v89, v15
    v_sub_f32 v90, v90, v15
    v_sub_f32 v91, v91, v15
    v_sub_f32 v96, v96, v15
    v_sub_f32 v97, v97, v15
    v_sub_f32 v98, v98, v15
    v_sub_f32 v99, v99, v15
    v_sub_f32 v104, v104, v15
    v_sub_f32 v105, v105, v15
    v_sub_f32 v106, v106, v15
    v_sub_f32 v107, v107, v15
    v_sub_f32 v112, v112, v15
    v_sub_f32 v113, v113, v15
    v_sub_f32 v114, v114, v15
    v_sub_f32 v115, v115, v15
    v_exp_f32 v44, v100
    v_exp_f32 v45, v101
    v_exp_f32 v46, v102
    v_exp_f32 v47, v103
    v_add_f32 v14, v44, v45
    v_cvt_pk_bf16_f32 v124, v44, v45
    v_exp_f32 v48, v108
    v_exp_f32 v49, v109
    v_add_f32 v32, v46, v47
    v_add_f32 v14, v14, v32
    v_cvt_pk_bf16_f32 v125, v46, v47
    v_exp_f32 v50, v110
    v_exp_f32 v51, v111
    v_add_f32 v32, v48, v49
    v_add_f32 v14, v14, v32
    v_cvt_pk_bf16_f32 v126, v48, v49
    v_exp_f32 v44, v104
    v_exp_f32 v45, v105
    v_add_f32 v32, v50, v51
    v_add_f32 v14, v14, v32
    v_cvt_pk_bf16_f32 v127, v50, v51
    v_exp_f32 v46, v106
    v_exp_f32 v47, v107
    v_add_f32 v15, v44, v45
    v_cvt_pk_bf16_f32 v128, v44, v45
    v_exp_f32 v48, v112
    v_exp_f32 v49, v113
    v_add_f32 v32, v46, v47
    v_add_f32 v15, v15, v32
    v_cvt_pk_bf16_f32 v129, v46, v47
    v_exp_f32 v50, v114
    v_exp_f32 v51, v115
    v_add_f32 v32, v48, v49
    v_add_f32 v15, v15, v32
    v_cvt_pk_bf16_f32 v130, v48, v49
    v_add_f32 v32, v50, v51
    v_add_f32 v15, v15, v32
    v_cvt_pk_bf16_f32 v131, v50, v51
    s_nop 3
    s_branch L_attn_back7
L_attn_cold8:
    s_nop 15
    v_max3_f32 v116, v84, v85, v86
    v_max3_f32 v44, v87, v92, v93
    v_max3_f32 v116, v116, v94, v95
    v_max_f32 v116, v116, v44
    v_max3_f32 v117, v88, v89, v90
    v_max3_f32 v45, v91, v96, v97
    v_max3_f32 v117, v117, v98, v99
    v_max_f32 v117, v117, v45
    v_mov_b32 v44, v116
    v_mov_b32 v45, v117
    s_nop 0
    v_permlane16_swap_b32 v116, v44
    v_permlane16_swap_b32 v117, v45
    v_max_f32 v116, v116, v44
    v_max_f32 v117, v117, v45
    v_mov_b32 v44, v116
    v_mov_b32 v45, v117
    s_nop 0
    v_permlane32_swap_b32 v116, v44
    v_permlane32_swap_b32 v117, v45
    v_max_f32 v116, v116, v44
    v_max_f32 v117, v117, v45
    v_max_f32 v14, 0, v116
    v_max_f32 v15, 0, v117
    v_sub_f32 v44, 0, v14
    v_exp_f32 v44, v44
    v_sub_f32 v45, 0, v15
    v_exp_f32 v45, v45
    v_sub_f32 v36, v36, v14
    v_sub_f32 v37, v37, v14
    v_sub_f32 v38, v38, v14
    v_sub_f32 v39, v39, v14
    v_mul_f32 v12, v12, v44
    v_mul_f32 v132, v132, v44
    v_mul_f32 v133, v133, v44
    v_mul_f32 v134, v134, v44
    v_mul_f32 v135, v135, v44
    v_mul_f32 v140, v140, v44
    v_mul_f32 v141, v141, v44
    v_mul_f32 v142, v142, v44
    v_mul_f32 v143, v143, v44
    v_mul_f32 v148, v148, v44
    v_mul_f32 v149, v149, v44
    v_mul_f32 v150, v150, v44
    v_mul_f32 v151, v151, v44
    v_mul_f32 v156, v156, v44
    v_mul_f32 v157, v157, v44
    v_mul_f32 v158, v158, v44
    v_mul_f32 v159, v159, v44
    v_mul_f32 v164, v164, v44
    v_mul_f32 v165, v165, v44
    v_mul_f32 v166, v166, v44
    v_mul_f32 v167, v167, v44
    v_mul_f32 v172, v172, v44
    v_mul_f32 v173, v173, v44
    v_mul_f32 v174, v174, v44
    v_mul_f32 v175, v175, v44
    v_mul_f32 v180, v180, v44
    v_mul_f32 v181, v181, v44
    v_mul_f32 v182, v182, v44
    v_mul_f32 v183, v183, v44
    v_mul_f32 v188, v188, v44
    v_mul_f32 v189, v189, v44
    v_mul_f32 v190, v190, v44
    v_mul_f32 v191, v191, v44
    v_sub_f32 v100, v100, v14
    v_sub_f32 v101, v101, v14
    v_sub_f32 v102, v102, v14
    v_sub_f32 v103, v103, v14
    v_sub_f32 v108, v108, v14
    v_sub_f32 v109, v109, v14
    v_sub_f32 v110, v110, v14
    v_sub_f32 v111, v111, v14
    v_sub_f32 v84, v84, v14
    v_sub_f32 v85, v85, v14
    v_sub_f32 v86, v86, v14
    v_sub_f32 v87, v87, v14
    v_sub_f32 v92, v92, v14
    v_sub_f32 v93, v93, v14
    v_sub_f32 v94, v94, v14
    v_sub_f32 v95, v95, v14
    v_sub_f32 v40, v40, v15
    v_sub_f32 v41, v41, v15
    v_sub_f32 v42, v42, v15
    v_sub_f32 v43, v43, v15
    v_mul_f32 v13, v13, v45
    v_mul_f32 v136, v136, v45
    v_mul_f32 v137, v137, v45
    v_mul_f32 v138, v138, v45
    v_mul_f32 v139, v139, v45
    v_mul_f32 v144, v144, v45
    v_mul_f32 v145, v145, v45
    v_mul_f32 v146, v146, v45
    v_mul_f32 v147, v147, v45
    v_mul_f32 v152, v152, v45
    v_mul_f32 v153, v153, v45
    v_mul_f32 v154, v154, v45
    v_mul_f32 v155, v155, v45
    v_mul_f32 v160, v160, v45
    v_mul_f32 v161, v161, v45
    v_mul_f32 v162, v162, v45
    v_mul_f32 v163, v163, v45
    v_mul_f32 v168, v168, v45
    v_mul_f32 v169, v169, v45
    v_mul_f32 v170, v170, v45
    v_mul_f32 v171, v171, v45
    v_mul_f32 v176, v176, v45
    v_mul_f32 v177, v177, v45
    v_mul_f32 v178, v178, v45
    v_mul_f32 v179, v179, v45
    v_mul_f32 v184, v184, v45
    v_mul_f32 v185, v185, v45
    v_mul_f32 v186, v186, v45
    v_mul_f32 v187, v187, v45
    v_mul_f32 v192, v192, v45
    v_mul_f32 v193, v193, v45
    v_mul_f32 v194, v194, v45
    v_mul_f32 v195, v195, v45
    v_sub_f32 v104, v104, v15
    v_sub_f32 v105, v105, v15
    v_sub_f32 v106, v106, v15
    v_sub_f32 v107, v107, v15
    v_sub_f32 v112, v112, v15
    v_sub_f32 v113, v113, v15
    v_sub_f32 v114, v114, v15
    v_sub_f32 v115, v115, v15
    v_sub_f32 v88, v88, v15
    v_sub_f32 v89, v89, v15
    v_sub_f32 v90, v90, v15
    v_sub_f32 v91, v91, v15
    v_sub_f32 v96, v96, v15
    v_sub_f32 v97, v97, v15
    v_sub_f32 v98, v98, v15
    v_sub_f32 v99, v99, v15
    v_exp_f32 v44, v84
    v_exp_f32 v45, v85
    v_exp_f32 v46, v86
    v_exp_f32 v47, v87
    v_add_f32 v14, v44, v45
    v_cvt_pk_bf16_f32 v116, v44, v45
    v_exp_f32 v48, v92
    v_exp_f32 v49, v93
    v_add_f32 v32, v46, v47
    v_add_f32 v14, v14, v32
    v_cvt_pk_bf16_f32 v117, v46, v47
    v_exp_f32 v50, v94
    v_exp_f32 v51, v95
    v_add_f32 v32, v48, v49
    v_add_f32 v14, v14, v32
    v_cvt_pk_bf16_f32 v118, v48, v49
    v_exp_f32 v44, v88
    v_exp_f32 v45, v89
    v_add_f32 v32, v50, v51
    v_add_f32 v14, v14, v32
    v_cvt_pk_bf16_f32 v119, v50, v51
    v_exp_f32 v46, v90
    v_exp_f32 v47, v91
    v_add_f32 v15, v44, v45
    v_cvt_pk_bf16_f32 v120, v44, v45
    v_exp_f32 v48, v96
    v_exp_f32 v49, v97
    v_add_f32 v32, v46, v47
    v_add_f32 v15, v15, v32
    v_cvt_pk_bf16_f32 v121, v46, v47
    v_exp_f32 v50, v98
    v_exp_f32 v51, v99
    v_add_f32 v32, v48, v49
    v_add_f32 v15, v15, v32
    v_cvt_pk_bf16_f32 v122, v48, v49
    v_add_f32 v32, v50, v51
    v_add_f32 v15, v15, v32
    v_cvt_pk_bf16_f32 v123, v50, v51
    s_nop 3
    s_branch L_attn_back8
L_attn_cold9:
    s_nop 15
    v_max3_f32 v124, v100, v101, v102
    v_max3_f32 v44, v103, v108, v109
    v_max3_f32 v124, v124, v110, v111
    v_max_f32 v124, v124, v44
    v_max3_f32 v125, v104, v105, v106
    v_max3_f32 v45, v107, v112, v113
    v_max3_f32 v125, v125, v114, v115
    v_max_f32 v125, v125, v45
    v_mov_b32 v44, v124
    v_mov_b32 v45, v125
    s_nop 0
    v_permlane16_swap_b32 v124, v44
    v_permlane16_swap_b32 v125, v45
    v_max_f32 v124, v124, v44
    v_max_f32 v125, v125, v45
    v_mov_b32 v44, v124
    v_mov_b32 v45, v125
    s_nop 0
    v_permlane32_swap_b32 v124, v44
    v_permlane32_swap_b32 v125, v45
    v_max_f32 v124, v124, v44
    v_max_f32 v125, v125, v45
    v_max_f32 v14, 0, v124
    v_max_f32 v15, 0, v125
    v_sub_f32 v44, 0, v14
    v_exp_f32 v44, v44
    v_sub_f32 v45, 0, v15
    v_exp_f32 v45, v45
    v_sub_f32 v36, v36, v14
    v_sub_f32 v37, v37, v14
    v_sub_f32 v38, v38, v14
    v_sub_f32 v39, v39, v14
    v_mul_f32 v12, v12, v44
    v_mul_f32 v132, v132, v44
    v_mul_f32 v133, v133, v44
    v_mul_f32 v134, v134, v44
    v_mul_f32 v135, v135, v44
    v_mul_f32 v140, v140, v44
    v_mul_f32 v141, v141, v44
    v_mul_f32 v142, v142, v44
    v_mul_f32 v143, v143, v44
    v_mul_f32 v148, v148, v44
    v_mul_f32 v149, v149, v44
    v_mul_f32 v150, v150, v44
    v_mul_f32 v151, v151, v44
    v_mul_f32 v156, v156, v44
    v_mul_f32 v157, v157, v44
    v_mul_f32 v158, v158, v44
    v_mul_f32 v159, v159, v44
    v_mul_f32 v164, v164, v44
    v_mul_f32 v165, v165, v44
    v_mul_f32 v166, v166, v44
    v_mul_f32 v167, v167, v44
    v_mul_f32 v172, v172, v44
    v_mul_f32 v173, v173, v44
    v_mul_f32 v174, v174, v44
    v_mul_f32 v175, v175, v44
    v_mul_f32 v180, v180, v44
    v_mul_f32 v181, v181, v44
    v_mul_f32 v182, v182, v44
    v_mul_f32 v183, v183, v44
    v_mul_f32 v188, v188, v44
    v_mul_f32 v189, v189, v44
    v_mul_f32 v190, v190, v44
    v_mul_f32 v191, v191, v44
    v_sub_f32 v84, v84, v14
    v_sub_f32 v85, v85, v14
    v_sub_f32 v86, v86, v14
    v_sub_f32 v87, v87, v14
    v_sub_f32 v92, v92, v14
    v_sub_f32 v93, v93, v14
    v_sub_f32 v94, v94, v14
    v_sub_f32 v95, v95, v14
    v_sub_f32 v100, v100, v14
    v_sub_f32 v101, v101, v14
    v_sub_f32 v102, v102, v14
    v_sub_f32 v103, v103, v14
    v_sub_f32 v108, v108, v14
    v_sub_f32 v109, v109, v14
    v_sub_f32 v110, v110, v14
    v_sub_f32 v111, v111, v14
    v_sub_f32 v40, v40, v15
    v_sub_f32 v41, v41, v15
    v_sub_f32 v42, v42, v15
    v_sub_f32 v43, v43, v15
    v_mul_f32 v13, v13, v45
    v_mul_f32 v136, v136, v45
    v_mul_f32 v137, v137, v45
    v_mul_f32 v138, v138, v45
    v_mul_f32 v139, v139, v45
    v_mul_f32 v144, v144, v45
    v_mul_f32 v145, v145, v45
    v_mul_f32 v146, v146, v45
    v_mul_f32 v147, v147, v45
    v_mul_f32 v152, v152, v45
    v_mul_f32 v153, v153, v45
    v_mul_f32 v154, v154, v45
    v_mul_f32 v155, v155, v45
    v_mul_f32 v160, v160, v45
    v_mul_f32 v161, v161, v45
    v_mul_f32 v162, v162, v45
    v_mul_f32 v163, v163, v45
    v_mul_f32 v168, v168, v45
    v_mul_f32 v169, v169, v45
    v_mul_f32 v170, v170, v45
    v_mul_f32 v171, v171, v45
    v_mul_f32 v176, v176, v45
    v_mul_f32 v177, v177, v45
    v_mul_f32 v178, v178, v45
    v_mul_f32 v179, v179, v45
    v_mul_f32 v184, v184, v45
    v_mul_f32 v185, v185, v45
    v_mul_f32 v186, v186, v45
    v_mul_f32 v187, v187, v45
    v_mul_f32 v192, v192, v45
    v_mul_f32 v193, v193, v45
    v_mul_f32 v194, v194, v45
    v_mul_f32 v195, v195, v45
    v_sub_f32 v88, v88, v15
    v_sub_f32 v89, v89, v15
    v_sub_f32 v90, v90, v15
    v_sub_f32 v91, v91, v15
    v_sub_f32 v96, v96, v15
    v_sub_f32 v97, v97, v15
    v_sub_f32 v98, v98, v15
    v_sub_f32 v99, v99, v15
    v_sub_f32 v104, v104, v15
    v_sub_f32 v105, v105, v15
    v_sub_f32 v106, v106, v15
    v_sub_f32 v107, v107, v15
    v_sub_f32 v112, v112, v15
    v_sub_f32 v113, v113, v15
    v_sub_f32 v114, v114, v15
    v_sub_f32 v115, v115, v15
    v_exp_f32 v44, v100
    v_exp_f32 v45, v101
    v_exp_f32 v46, v102
    v_exp_f32 v47, v103
    v_add_f32 v14, v44, v45
    v_cvt_pk_bf16_f32 v124, v44, v45
    v_exp_f32 v48, v108
    v_exp_f32 v49, v109
    v_add_f32 v32, v46, v47
    v_add_f32 v14, v14, v32
    v_cvt_pk_bf16_f32 v125, v46, v47
    v_exp_f32 v50, v110
    v_exp_f32 v51, v111
    v_add_f32 v32, v48, v49
    v_add_f32 v14, v14, v32
    v_cvt_pk_bf16_f32 v126, v48, v49
    v_exp_f32 v44, v104
    v_exp_f32 v45, v105
    v_add_f32 v32, v50, v51
    v_add_f32 v14, v14, v32
    v_cvt_pk_bf16_f32 v127, v50, v51
    v_exp_f32 v46, v106
    v_exp_f32 v47, v107
    v_add_f32 v15, v44, v45
    v_cvt_pk_bf16_f32 v128, v44, v45
    v_exp_f32 v48, v112
    v_exp_f32 v49, v113
    v_add_f32 v32, v46, v47
    v_add_f32 v15, v15, v32
    v_cvt_pk_bf16_f32 v129, v46, v47
    v_exp_f32 v50, v114
    v_exp_f32 v51, v115
    v_add_f32 v32, v48, v49
    v_add_f32 v15, v15, v32
    v_cvt_pk_bf16_f32 v130, v48, v49
    v_add_f32 v32, v50, v51
    v_add_f32 v15, v15, v32
    v_cvt_pk_bf16_f32 v131, v50, v51
    s_nop 3
    s_branch L_attn_back9
L_attn_cold10:
    s_nop 15
    v_max3_f32 v116, v84, v85, v86
    v_max3_f32 v44, v87, v92, v93
    v_max3_f32 v116, v116, v94, v95
    v_max_f32 v116, v116, v44
    v_max3_f32 v117, v88, v89, v90
    v_max3_f32 v45, v91, v96, v97
    v_max3_f32 v117, v117, v98, v99
    v_max_f32 v117, v117, v45
    v_mov_b32 v44, v116
    v_mov_b32 v45, v117
    s_nop 0
    v_permlane16_swap_b32 v116, v44
    v_permlane16_swap_b32 v117, v45
    v_max_f32 v116, v116, v44
    v_max_f32 v117, v117, v45
    v_mov_b32 v44, v116
    v_mov_b32 v45, v117
    s_nop 0
    v_permlane32_swap_b32 v116, v44
    v_permlane32_swap_b32 v117, v45
    v_max_f32 v116, v116, v44
    v_max_f32 v117, v117, v45
    v_max_f32 v14, 0, v116
    v_max_f32 v15, 0, v117
    v_sub_f32 v44, 0, v14
    v_exp_f32 v44, v44
    v_sub_f32 v45, 0, v15
    v_exp_f32 v45, v45
    v_sub_f32 v36, v36, v14
    v_sub_f32 v37, v37, v14
    v_sub_f32 v38, v38, v14
    v_sub_f32 v39, v39, v14
    v_mul_f32 v12, v12, v44
    v_mul_f32 v132, v132, v44
    v_mul_f32 v133, v133, v44
    v_mul_f32 v134, v134, v44
    v_mul_f32 v135, v135, v44
    v_mul_f32 v140, v140, v44
    v_mul_f32 v141, v141, v44
    v_mul_f32 v142, v142, v44
    v_mul_f32 v143, v143, v44
    v_mul_f32 v148, v148, v44
    v_mul_f32 v149, v149, v44
    v_mul_f32 v150, v150, v44
    v_mul_f32 v151, v151, v44
    v_mul_f32 v156, v156, v44
    v_mul_f32 v157, v157, v44
    v_mul_f32 v158, v158, v44
    v_mul_f32 v159, v159, v44
    v_mul_f32 v164, v164, v44
    v_mul_f32 v165, v165, v44
    v_mul_f32 v166, v166, v44
    v_mul_f32 v167, v167, v44
    v_mul_f32 v172, v172, v44
    v_mul_f32 v173, v173, v44
    v_mul_f32 v174, v174, v44
    v_mul_f32 v175, v175, v44
    v_mul_f32 v180, v180, v44
    v_mul_f32 v181, v181, v44
    v_mul_f32 v182, v182, v44
    v_mul_f32 v183, v183, v44
    v_mul_f32 v188, v188, v44
    v_mul_f32 v189, v189, v44
    v_mul_f32 v190, v190, v44
    v_mul_f32 v191, v191, v44
    v_sub_f32 v100, v100, v14
    v_sub_f32 v101, v101, v14
    v_sub_f32 v102, v102, v14
    v_sub_f32 v103, v103, v14
    v_sub_f32 v108, v108, v14
    v_sub_f32 v109, v109, v14
    v_sub_f32 v110, v110, v14
    v_sub_f32 v111, v111, v14
    v_sub_f32 v84, v84, v14
    v_sub_f32 v85, v85, v14
    v_sub_f32 v86, v86, v14
    v_sub_f32 v87, v87, v14
    v_sub_f32 v92, v92, v14
    v_sub_f32 v93, v93, v14
    v_sub_f32 v94, v94, v14
    v_sub_f32 v95, v95, v14
    v_sub_f32 v40, v40, v15
    v_sub_f32 v41, v41, v15
    v_sub_f32 v42, v42, v15
    v_sub_f32 v43, v43, v15
    v_mul_f32 v13, v13, v45
    v_mul_f32 v136, v136, v45
    v_mul_f32 v137, v137, v45
    v_mul_f32 v138, v138, v45
    v_mul_f32 v139, v139, v45
    v_mul_f32 v144, v144, v45
    v_mul_f32 v145, v145, v45
    v_mul_f32 v146, v146, v45
    v_mul_f32 v147, v147, v45
    v_mul_f32 v152, v152, v45
    v_mul_f32 v153, v153, v45
    v_mul_f32 v154, v154, v45
    v_mul_f32 v155, v155, v45
    v_mul_f32 v160, v160, v45
    v_mul_f32 v161, v161, v45
    v_mul_f32 v162, v162, v45
    v_mul_f32 v163, v163, v45
    v_mul_f32 v168, v168, v45
    v_mul_f32 v169, v169, v45
    v_mul_f32 v170, v170, v45
    v_mul_f32 v171, v171, v45
    v_mul_f32 v176, v176, v45
    v_mul_f32 v177, v177, v45
    v_mul_f32 v178, v178, v45
    v_mul_f32 v179, v179, v45
    v_mul_f32 v184, v184, v45
    v_mul_f32 v185, v185, v45
    v_mul_f32 v186, v186, v45
    v_mul_f32 v187, v187, v45
    v_mul_f32 v192, v192, v45
    v_mul_f32 v193, v193, v45
    v_mul_f32 v194, v194, v45
    v_mul_f32 v195, v195, v45
    v_sub_f32 v104, v104, v15
    v_sub_f32 v105, v105, v15
    v_sub_f32 v106, v106, v15
    v_sub_f32 v107, v107, v15
    v_sub_f32 v112, v112, v15
    v_sub_f32 v113, v113, v15
    v_sub_f32 v114, v114, v15
    v_sub_f32 v115, v115, v15
    v_sub_f32 v88, v88, v15
    v_sub_f32 v89, v89, v15
    v_sub_f32 v90, v90, v15
    v_sub_f32 v91, v91, v15
    v_sub_f32 v96, v96, v15
    v_sub_f32 v97, v97, v15
    v_sub_f32 v98, v98, v15
    v_sub_f32 v99, v99, v15
    v_exp_f32 v44, v84
    v_exp_f32 v45, v85
    v_exp_f32 v46, v86
    v_exp_f32 v47, v87
    v_add_f32 v14, v44, v45
    v_cvt_pk_bf16_f32 v116, v44, v45
    v_exp_f32 v48, v92
    v_exp_f32 v49, v93
    v_add_f32 v32, v46, v47
    v_add_f32 v14, v14, v32
    v_cvt_pk_bf16_f32 v117, v46, v47
    v_exp_f32 v50, v94
    v_exp_f32 v51, v95
    v_add_f32 v32, v48, v49
    v_add_f32 v14, v14, v32
    v_cvt_pk_bf16_f32 v118, v48, v49
    v_exp_f32 v44, v88
    v_exp_f32 v45, v89
    v_add_f32 v32, v50, v51
    v_add_f32 v14, v14, v32
    v_cvt_pk_bf16_f32 v119, v50, v51
    v_exp_f32 v46, v90
    v_exp_f32 v47, v91
    v_add_f32 v15, v44, v45
    v_cvt_pk_bf16_f32 v120, v44, v45
    v_exp_f32 v48, v96
    v_exp_f32 v49, v97
    v_add_f32 v32, v46, v47
    v_add_f32 v15, v15, v32
    v_cvt_pk_bf16_f32 v121, v46, v47
    v_exp_f32 v50, v98
    v_exp_f32 v51, v99
    v_add_f32 v32, v48, v49
    v_add_f32 v15, v15, v32
    v_cvt_pk_bf16_f32 v122, v48, v49
    v_add_f32 v32, v50, v51
    v_add_f32 v15, v15, v32
    v_cvt_pk_bf16_f32 v123, v50, v51
    s_nop 3
    s_branch L_attn_back10
L_attn_cold11:
    s_nop 15
    v_max3_f32 v124, v100, v101, v102
    v_max3_f32 v44, v103, v108, v109
    v_max3_f32 v124, v124, v110, v111
    v_max_f32 v124, v124, v44
    v_max3_f32 v125, v104, v105, v106
    v_max3_f32 v45, v107, v112, v113
    v_max3_f32 v125, v125, v114, v115
    v_max_f32 v125, v125, v45
    v_mov_b32 v44, v124
    v_mov_b32 v45, v125
    s_nop 0
    v_permlane16_swap_b32 v124, v44
    v_permlane16_swap_b32 v125, v45
    v_max_f32 v124, v124, v44
    v_max_f32 v125, v125, v45
    v_mov_b32 v44, v124
    v_mov_b32 v45, v125
    s_nop 0
    v_permlane32_swap_b32 v124, v44
    v_permlane32_swap_b32 v125, v45
    v_max_f32 v124, v124, v44
    v_max_f32 v125, v125, v45
    v_max_f32 v14, 0, v124
    v_max_f32 v15, 0, v125
    v_sub_f32 v44, 0, v14
    v_exp_f32 v44, v44
    v_sub_f32 v45, 0, v15
    v_exp_f32 v45, v45
    v_sub_f32 v36, v36, v14
    v_sub_f32 v37, v37, v14
    v_sub_f32 v38, v38, v14
    v_sub_f32 v39, v39, v14
    v_mul_f32 v12, v12, v44
    v_mul_f32 v132, v132, v44
    v_mul_f32 v133, v133, v44
    v_mul_f32 v134, v134, v44
    v_mul_f32 v135, v135, v44
    v_mul_f32 v140, v140, v44
    v_mul_f32 v141, v141, v44
    v_mul_f32 v142, v142, v44
    v_mul_f32 v143, v143, v44
    v_mul_f32 v148, v148, v44
    v_mul_f32 v149, v149, v44
    v_mul_f32 v150, v150, v44
    v_mul_f32 v151, v151, v44
    v_mul_f32 v156, v156, v44
    v_mul_f32 v157, v157, v44
    v_mul_f32 v158, v158, v44
    v_mul_f32 v159, v159, v44
    v_mul_f32 v164, v164, v44
    v_mul_f32 v165, v165, v44
    v_mul_f32 v166, v166, v44
    v_mul_f32 v167, v167, v44
    v_mul_f32 v172, v172, v44
    v_mul_f32 v173, v173, v44
    v_mul_f32 v174, v174, v44
    v_mul_f32 v175, v175, v44
    v_mul_f32 v180, v180, v44
    v_mul_f32 v181, v181, v44
    v_mul_f32 v182, v182, v44
    v_mul_f32 v183, v183, v44
    v_mul_f32 v188, v188, v44
    v_mul_f32 v189, v189, v44
    v_mul_f32 v190, v190, v44
    v_mul_f32 v191, v191, v44
    v_sub_f32 v84, v84, v14
    v_sub_f32 v85, v85, v14
    v_sub_f32 v86, v86, v14
    v_sub_f32 v87, v87, v14
    v_sub_f32 v92, v92, v14
    v_sub_f32 v93, v93, v14
    v_sub_f32 v94, v94, v14
    v_sub_f32 v95, v95, v14
    v_sub_f32 v100, v100, v14
    v_sub_f32 v101, v101, v14
    v_sub_f32 v102, v102, v14
    v_sub_f32 v103, v103, v14
    v_sub_f32 v108, v108, v14
    v_sub_f32 v109, v109, v14
    v_sub_f32 v110, v110, v14
    v_sub_f32 v111, v111, v14
    v_sub_f32 v40, v40, v15
    v_sub_f32 v41, v41, v15
    v_sub_f32 v42, v42, v15
    v_sub_f32 v43, v43, v15
    v_mul_f32 v13, v13, v45
    v_mul_f32 v136, v136, v45
    v_mul_f32 v137, v137, v45
    v_mul_f32 v138, v138, v45
    v_mul_f32 v139, v139, v45
    v_mul_f32 v144, v144, v45
    v_mul_f32 v145, v145, v45
    v_mul_f32 v146, v146, v45
    v_mul_f32 v147, v147, v45
    v_mul_f32 v152, v152, v45
    v_mul_f32 v153, v153, v45
    v_mul_f32 v154, v154, v45
    v_mul_f32 v155, v155, v45
    v_mul_f32 v160, v160, v45
    v_mul_f32 v161, v161, v45
    v_mul_f32 v162, v162, v45
    v_mul_f32 v163, v163, v45
    v_mul_f32 v168, v168, v45
    v_mul_f32 v169, v169, v45
    v_mul_f32 v170, v170, v45
    v_mul_f32 v171, v171, v45
    v_mul_f32 v176, v176, v45
    v_mul_f32 v177, v177, v45
    v_mul_f32 v178, v178, v45
    v_mul_f32 v179, v179, v45
    v_mul_f32 v184, v184, v45
    v_mul_f32 v185, v185, v45
    v_mul_f32 v186, v186, v45
    v_mul_f32 v187, v187, v45
    v_mul_f32 v192, v192, v45
    v_mul_f32 v193, v193, v45
    v_mul_f32 v194, v194, v45
    v_mul_f32 v195, v195, v45
    v_sub_f32 v88, v88, v15
    v_sub_f32 v89, v89, v15
    v_sub_f32 v90, v90, v15
    v_sub_f32 v91, v91, v15
    v_sub_f32 v96, v96, v15
    v_sub_f32 v97, v97, v15
    v_sub_f32 v98, v98, v15
    v_sub_f32 v99, v99, v15
    v_sub_f32 v104, v104, v15
    v_sub_f32 v105, v105, v15
    v_sub_f32 v106, v106, v15
    v_sub_f32 v107, v107, v15
    v_sub_f32 v112, v112, v15
    v_sub_f32 v113, v113, v15
    v_sub_f32 v114, v114, v15
    v_sub_f32 v115, v115, v15
    v_exp_f32 v44, v100
    v_exp_f32 v45, v101
    v_exp_f32 v46, v102
    v_exp_f32 v47, v103
    v_add_f32 v14, v44, v45
    v_cvt_pk_bf16_f32 v124, v44, v45
    v_exp_f32 v48, v108
    v_exp_f32 v49, v109
    v_add_f32 v32, v46, v47
    v_add_f32 v14, v14, v32
    v_cvt_pk_bf16_f32 v125, v46, v47
    v_exp_f32 v50, v110
    v_exp_f32 v51, v111
    v_add_f32 v32, v48, v49
    v_add_f32 v14, v14, v32
    v_cvt_pk_bf16_f32 v126, v48, v49
    v_exp_f32 v44, v104
    v_exp_f32 v45, v105
    v_add_f32 v32, v50, v51
    v_add_f32 v14, v14, v32
    v_cvt_pk_bf16_f32 v127, v50, v51
    v_exp_f32 v46, v106
    v_exp_f32 v47, v107
    v_add_f32 v15, v44, v45
    v_cvt_pk_bf16_f32 v128, v44, v45
    v_exp_f32 v48, v112
    v_exp_f32 v49, v113
    v_add_f32 v32, v46, v47
    v_add_f32 v15, v15, v32
    v_cvt_pk_bf16_f32 v129, v46, v47
    v_exp_f32 v50, v114
    v_exp_f32 v51, v115
    v_add_f32 v32, v48, v49
    v_add_f32 v15, v15, v32
    v_cvt_pk_bf16_f32 v130, v48, v49
    v_add_f32 v32, v50, v51
    v_add_f32 v15, v15, v32
    v_cvt_pk_bf16_f32 v131, v50, v51
    s_nop 3
    s_branch L_attn_back11
L_adaLN_cond__sliding_block_cached__swiglu_ffn__prompt_kernel_30:
    s_add_u32 s4, s94, 0x380000
    s_addc_u32 s5, s95, 0
    s_mov_b32 s6, 0x80000
    s_mov_b32 s7, 0x20000
    s_mov_b32 s3, 60000
L_adaLN_cond__sliding_block_cached__swiglu_ffn__prompt_kernel_32:
    buffer_load_dword v232, v2, s[4:7], 0 offen sc1
    buffer_load_dword v233, v3, s[4:7], 0 offen sc1
    buffer_load_dword v234, v4, s[4:7], 0 offen sc1
    buffer_load_dword v235, v5, s[4:7], 0 offen sc1
    s_waitcnt vmcnt(3)
    v_cmp_ne_u32 vcc, s98, v232
    s_nop 0
    s_mov_b64 s[100:101], vcc
    s_waitcnt vmcnt(2)
    v_cmp_ne_u32 vcc, s98, v233
    s_nop 0
    s_or_b64 s[100:101], s[100:101], vcc
    s_waitcnt vmcnt(1)
    v_cmp_ne_u32 vcc, s98, v234
    s_nop 0
    s_or_b64 s[100:101], s[100:101], vcc
    s_waitcnt vmcnt(0)
    v_cmp_ne_u32 vcc, s98, v235
    s_nop 0
    s_or_b64 s[100:101], s[100:101], vcc
    s_mov_b64 vcc, s[100:101]
    s_cbranch_vccz L_adaLN_cond__sliding_block_cached__swiglu_ffn__prompt_kernel_31
    s_sleep 1
    s_sub_u32 s3, s3, 1
    s_cmp_lg_u32 s3, 0
    s_cbranch_scc1 L_adaLN_cond__sliding_block_cached__swiglu_ffn__prompt_kernel_32
L_adaLN_cond__sliding_block_cached__swiglu_ffn__prompt_kernel_31:
    s_branch L_adaLN_cond__sliding_block_cached__swiglu_ffn__prompt_kernel_29
L_attn_cold12:
    s_nop 15
    v_max3_f32 v116, v84, v85, v86
    v_max3_f32 v44, v87, v92, v93
    v_max3_f32 v116, v116, v94, v95
    v_max_f32 v116, v116, v44
    v_max3_f32 v117, v88, v89, v90
    v_max3_f32 v45, v91, v96, v97
    v_max3_f32 v117, v117, v98, v99
    v_max_f32 v117, v117, v45
    v_mov_b32 v44, v116
    v_mov_b32 v45, v117
    s_nop 0
    v_permlane16_swap_b32 v116, v44
    v_permlane16_swap_b32 v117, v45
    v_max_f32 v116, v116, v44
    v_max_f32 v117, v117, v45
    v_mov_b32 v44, v116
    v_mov_b32 v45, v117
    s_nop 0
    v_permlane32_swap_b32 v116, v44
    v_permlane32_swap_b32 v117, v45
    v_max_f32 v116, v116, v44
    v_max_f32 v117, v117, v45
    v_max_f32 v14, 0, v116
    v_max_f32 v15, 0, v117
    v_sub_f32 v44, 0, v14
    v_exp_f32 v44, v44
    v_sub_f32 v45, 0, v15
    v_exp_f32 v45, v45
    v_sub_f32 v36, v36, v14
    v_sub_f32 v37, v37, v14
    v_sub_f32 v38, v38, v14
    v_sub_f32 v39, v39, v14
    v_mul_f32 v12, v12, v44
    v_mul_f32 v132, v132, v44
    v_mul_f32 v133, v133, v44
    v_mul_f32 v134, v134, v44
    v_mul_f32 v135, v135, v44
    v_mul_f32 v140, v140, v44
    v_mul_f32 v141, v141, v44
    v_mul_f32 v142, v142, v44
    v_mul_f32 v143, v143, v44
    v_mul_f32 v148, v148, v44
    v_mul_f32 v149, v149, v44
    v_mul_f32 v150, v150, v44
    v_mul_f32 v151, v151, v44
    v_mul_f32 v156, v156, v44
    v_mul_f32 v157, v157, v44
    v_mul_f32 v158, v158, v44
    v_mul_f32 v159, v159, v44
    v_mul_f32 v164, v164, v44
    v_mul_f32 v165, v165, v44
    v_mul_f32 v166, v166, v44
    v_mul_f32 v167, v167, v44
    v_mul_f32 v172, v172, v44
    v_mul_f32 v173, v173, v44
    v_mul_f32 v174, v174, v44
    v_mul_f32 v175, v175, v44
    v_mul_f32 v180, v180, v44
    v_mul_f32 v181, v181, v44
    v_mul_f32 v182, v182, v44
    v_mul_f32 v183, v183, v44
    v_mul_f32 v188, v188, v44
    v_mul_f32 v189, v189, v44
    v_mul_f32 v190, v190, v44
    v_mul_f32 v191, v191, v44
    v_sub_f32 v100, v100, v14
    v_sub_f32 v101, v101, v14
    v_sub_f32 v102, v102, v14
    v_sub_f32 v103, v103, v14
    v_sub_f32 v108, v108, v14
    v_sub_f32 v109, v109, v14
    v_sub_f32 v110, v110, v14
    v_sub_f32 v111, v111, v14
    v_sub_f32 v84, v84, v14
    v_sub_f32 v85, v85, v14
    v_sub_f32 v86, v86, v14
    v_sub_f32 v87, v87, v14
    v_sub_f32 v92, v92, v14
    v_sub_f32 v93, v93, v14
    v_sub_f32 v94, v94, v14
    v_sub_f32 v95, v95, v14
    v_sub_f32 v40, v40, v15
    v_sub_f32 v41, v41, v15
    v_sub_f32 v42, v42, v15
    v_sub_f32 v43, v43, v15
    v_mul_f32 v13, v13, v45
    v_mul_f32 v136, v136, v45
    v_mul_f32 v137, v137, v45
    v_mul_f32 v138, v138, v45
    v_mul_f32 v139, v139, v45
    v_mul_f32 v144, v144, v45
    v_mul_f32 v145, v145, v45
    v_mul_f32 v146, v146, v45
    v_mul_f32 v147, v147, v45
    v_mul_f32 v152, v152, v45
    v_mul_f32 v153, v153, v45
    v_mul_f32 v154, v154, v45
    v_mul_f32 v155, v155, v45
    v_mul_f32 v160, v160, v45
    v_mul_f32 v161, v161, v45
    v_mul_f32 v162, v162, v45
    v_mul_f32 v163, v163, v45
    v_mul_f32 v168, v168, v45
    v_mul_f32 v169, v169, v45
    v_mul_f32 v170, v170, v45
    v_mul_f32 v171, v171, v45
    v_mul_f32 v176, v176, v45
    v_mul_f32 v177, v177, v45
    v_mul_f32 v178, v178, v45
    v_mul_f32 v179, v179, v45
    v_mul_f32 v184, v184, v45
    v_mul_f32 v185, v185, v45
    v_mul_f32 v186, v186, v45
    v_mul_f32 v187, v187, v45
    v_mul_f32 v192, v192, v45
    v_mul_f32 v193, v193, v45
    v_mul_f32 v194, v194, v45
    v_mul_f32 v195, v195, v45
    v_sub_f32 v104, v104, v15
    v_sub_f32 v105, v105, v15
    v_sub_f32 v106, v106, v15
    v_sub_f32 v107, v107, v15
    v_sub_f32 v112, v112, v15
    v_sub_f32 v113, v113, v15
    v_sub_f32 v114, v114, v15
    v_sub_f32 v115, v115, v15
    v_sub_f32 v88, v88, v15
    v_sub_f32 v89, v89, v15
    v_sub_f32 v90, v90, v15
    v_sub_f32 v91, v91, v15
    v_sub_f32 v96, v96, v15
    v_sub_f32 v97, v97, v15
    v_sub_f32 v98, v98, v15
    v_sub_f32 v99, v99, v15
    v_exp_f32 v44, v84
    v_exp_f32 v45, v85
    v_exp_f32 v46, v86
    v_exp_f32 v47, v87
    v_add_f32 v14, v44, v45
    v_cvt_pk_bf16_f32 v116, v44, v45
    v_exp_f32 v48, v92
    v_exp_f32 v49, v93
    v_add_f32 v32, v46, v47
    v_add_f32 v14, v14, v32
    v_cvt_pk_bf16_f32 v117, v46, v47
    v_exp_f32 v50, v94
    v_exp_f32 v51, v95
    v_add_f32 v32, v48, v49
    v_add_f32 v14, v14, v32
    v_cvt_pk_bf16_f32 v118, v48, v49
    v_exp_f32 v44, v88
    v_exp_f32 v45, v89
    v_add_f32 v32, v50, v51
    v_add_f32 v14, v14, v32
    v_cvt_pk_bf16_f32 v119, v50, v51
    v_exp_f32 v46, v90
    v_exp_f32 v47, v91
    v_add_f32 v15, v44, v45
    v_cvt_pk_bf16_f32 v120, v44, v45
    v_exp_f32 v48, v96
    v_exp_f32 v49, v97
    v_add_f32 v32, v46, v47
    v_add_f32 v15, v15, v32
    v_cvt_pk_bf16_f32 v121, v46, v47
    v_exp_f32 v50, v98
    v_exp_f32 v51, v99
    v_add_f32 v32, v48, v49
    v_add_f32 v15, v15, v32
    v_cvt_pk_bf16_f32 v122, v48, v49
    v_add_f32 v32, v50, v51
    v_add_f32 v15, v15, v32
    v_cvt_pk_bf16_f32 v123, v50, v51
    s_nop 3
    s_branch L_attn_back12
L_attn_cold13:
    s_nop 15
    v_max3_f32 v124, v100, v101, v102
    v_max3_f32 v44, v103, v108, v109
    v_max3_f32 v124, v124, v110, v111
    v_max_f32 v124, v124, v44
    v_max3_f32 v125, v104, v105, v106
    v_max3_f32 v45, v107, v112, v113
    v_max3_f32 v125, v125, v114, v115
    v_max_f32 v125, v125, v45
    v_mov_b32 v44, v124
    v_mov_b32 v45, v125
    s_nop 0
    v_permlane16_swap_b32 v124, v44
    v_permlane16_swap_b32 v125, v45
    v_max_f32 v124, v124, v44
    v_max_f32 v125, v125, v45
    v_mov_b32 v44, v124
    v_mov_b32 v45, v125
    s_nop 0
    v_permlane32_swap_b32 v124, v44
    v_permlane32_swap_b32 v125, v45
    v_max_f32 v124, v124, v44
    v_max_f32 v125, v125, v45
    v_max_f32 v14, 0, v124
    v_max_f32 v15, 0, v125
    v_sub_f32 v44, 0, v14
    v_exp_f32 v44, v44
    v_sub_f32 v45, 0, v15
    v_exp_f32 v45, v45
    v_sub_f32 v36, v36, v14
    v_sub_f32 v37, v37, v14
    v_sub_f32 v38, v38, v14
    v_sub_f32 v39, v39, v14
    v_mul_f32 v12, v12, v44
    v_mul_f32 v132, v132, v44
    v_mul_f32 v133, v133, v44
    v_mul_f32 v134, v134, v44
    v_mul_f32 v135, v135, v44
    v_mul_f32 v140, v140, v44
    v_mul_f32 v141, v141, v44
    v_mul_f32 v142, v142, v44
    v_mul_f32 v143, v143, v44
    v_mul_f32 v148, v148, v44
    v_mul_f32 v149, v149, v44
    v_mul_f32 v150, v150, v44
    v_mul_f32 v151, v151, v44
    v_mul_f32 v156, v156, v44
    v_mul_f32 v157, v157, v44
    v_mul_f32 v158, v158, v44
    v_mul_f32 v159, v159, v44
    v_mul_f32 v164, v164, v44
    v_mul_f32 v165, v165, v44
    v_mul_f32 v166, v166, v44
    v_mul_f32 v167, v167, v44
    v_mul_f32 v172, v172, v44
    v_mul_f32 v173, v173, v44
    v_mul_f32 v174, v174, v44
    v_mul_f32 v175, v175, v44
    v_mul_f32 v180, v180, v44
    v_mul_f32 v181, v181, v44
    v_mul_f32 v182, v182, v44
    v_mul_f32 v183, v183, v44
    v_mul_f32 v188, v188, v44
    v_mul_f32 v189, v189, v44
    v_mul_f32 v190, v190, v44
    v_mul_f32 v191, v191, v44
    v_sub_f32 v84, v84, v14
    v_sub_f32 v85, v85, v14
    v_sub_f32 v86, v86, v14
    v_sub_f32 v87, v87, v14
    v_sub_f32 v92, v92, v14
    v_sub_f32 v93, v93, v14
    v_sub_f32 v94, v94, v14
    v_sub_f32 v95, v95, v14
    v_sub_f32 v100, v100, v14
    v_sub_f32 v101, v101, v14
    v_sub_f32 v102, v102, v14
    v_sub_f32 v103, v103, v14
    v_sub_f32 v108, v108, v14
    v_sub_f32 v109, v109, v14
    v_sub_f32 v110, v110, v14
    v_sub_f32 v111, v111, v14
    v_sub_f32 v40, v40, v15
    v_sub_f32 v41, v41, v15
    v_sub_f32 v42, v42, v15
    v_sub_f32 v43, v43, v15
    v_mul_f32 v13, v13, v45
    v_mul_f32 v136, v136, v45
    v_mul_f32 v137, v137, v45
    v_mul_f32 v138, v138, v45
    v_mul_f32 v139, v139, v45
    v_mul_f32 v144, v144, v45
    v_mul_f32 v145, v145, v45
    v_mul_f32 v146, v146, v45
    v_mul_f32 v147, v147, v45
    v_mul_f32 v152, v152, v45
    v_mul_f32 v153, v153, v45
    v_mul_f32 v154, v154, v45
    v_mul_f32 v155, v155, v45
    v_mul_f32 v160, v160, v45
    v_mul_f32 v161, v161, v45
    v_mul_f32 v162, v162, v45
    v_mul_f32 v163, v163, v45
    v_mul_f32 v168, v168, v45
    v_mul_f32 v169, v169, v45
    v_mul_f32 v170, v170, v45
    v_mul_f32 v171, v171, v45
    v_mul_f32 v176, v176, v45
    v_mul_f32 v177, v177, v45
    v_mul_f32 v178, v178, v45
    v_mul_f32 v179, v179, v45
    v_mul_f32 v184, v184, v45
    v_mul_f32 v185, v185, v45
    v_mul_f32 v186, v186, v45
    v_mul_f32 v187, v187, v45
    v_mul_f32 v192, v192, v45
    v_mul_f32 v193, v193, v45
    v_mul_f32 v194, v194, v45
    v_mul_f32 v195, v195, v45
    v_sub_f32 v88, v88, v15
    v_sub_f32 v89, v89, v15
    v_sub_f32 v90, v90, v15
    v_sub_f32 v91, v91, v15
    v_sub_f32 v96, v96, v15
    v_sub_f32 v97, v97, v15
    v_sub_f32 v98, v98, v15
    v_sub_f32 v99, v99, v15
    v_sub_f32 v104, v104, v15
    v_sub_f32 v105, v105, v15
    v_sub_f32 v106, v106, v15
    v_sub_f32 v107, v107, v15
    v_sub_f32 v112, v112, v15
    v_sub_f32 v113, v113, v15
    v_sub_f32 v114, v114, v15
    v_sub_f32 v115, v115, v15
    v_exp_f32 v44, v100
    v_exp_f32 v45, v101
    v_exp_f32 v46, v102
    v_exp_f32 v47, v103
    v_add_f32 v14, v44, v45
    v_cvt_pk_bf16_f32 v124, v44, v45
    v_exp_f32 v48, v108
    v_exp_f32 v49, v109
    v_add_f32 v32, v46, v47
    v_add_f32 v14, v14, v32
    v_cvt_pk_bf16_f32 v125, v46, v47
    v_exp_f32 v50, v110
    v_exp_f32 v51, v111
    v_add_f32 v32, v48, v49
    v_add_f32 v14, v14, v32
    v_cvt_pk_bf16_f32 v126, v48, v49
    v_exp_f32 v44, v104
    v_exp_f32 v45, v105
    v_add_f32 v32, v50, v51
    v_add_f32 v14, v14, v32
    v_cvt_pk_bf16_f32 v127, v50, v51
    v_exp_f32 v46, v106
    v_exp_f32 v47, v107
    v_add_f32 v15, v44, v45
    v_cvt_pk_bf16_f32 v128, v44, v45
    v_exp_f32 v48, v112
    v_exp_f32 v49, v113
    v_add_f32 v32, v46, v47
    v_add_f32 v15, v15, v32
    v_cvt_pk_bf16_f32 v129, v46, v47
    v_exp_f32 v50, v114
    v_exp_f32 v51, v115
    v_add_f32 v32, v48, v49
    v_add_f32 v15, v15, v32
    v_cvt_pk_bf16_f32 v130, v48, v49
    v_add_f32 v32, v50, v51
    v_add_f32 v15, v15, v32
    v_cvt_pk_bf16_f32 v131, v50, v51
    s_nop 3
    s_branch L_attn_back13
L_attn_cold14:
    s_nop 15
    v_max3_f32 v116, v84, v85, v86
    v_max3_f32 v44, v87, v92, v93
    v_max3_f32 v116, v116, v94, v95
    v_max_f32 v116, v116, v44
    v_max3_f32 v117, v88, v89, v90
    v_max3_f32 v45, v91, v96, v97
    v_max3_f32 v117, v117, v98, v99
    v_max_f32 v117, v117, v45
    v_mov_b32 v44, v116
    v_mov_b32 v45, v117
    s_nop 0
    v_permlane16_swap_b32 v116, v44
    v_permlane16_swap_b32 v117, v45
    v_max_f32 v116, v116, v44
    v_max_f32 v117, v117, v45
    v_mov_b32 v44, v116
    v_mov_b32 v45, v117
    s_nop 0
    v_permlane32_swap_b32 v116, v44
    v_permlane32_swap_b32 v117, v45
    v_max_f32 v116, v116, v44
    v_max_f32 v117, v117, v45
    v_max_f32 v14, 0, v116
    v_max_f32 v15, 0, v117
    v_sub_f32 v44, 0, v14
    v_exp_f32 v44, v44
    v_sub_f32 v45, 0, v15
    v_exp_f32 v45, v45
    v_sub_f32 v36, v36, v14
    v_sub_f32 v37, v37, v14
    v_sub_f32 v38, v38, v14
    v_sub_f32 v39, v39, v14
    v_mul_f32 v12, v12, v44
    v_mul_f32 v132, v132, v44
    v_mul_f32 v133, v133, v44
    v_mul_f32 v134, v134, v44
    v_mul_f32 v135, v135, v44
    v_mul_f32 v140, v140, v44
    v_mul_f32 v141, v141, v44
    v_mul_f32 v142, v142, v44
    v_mul_f32 v143, v143, v44
    v_mul_f32 v148, v148, v44
    v_mul_f32 v149, v149, v44
    v_mul_f32 v150, v150, v44
    v_mul_f32 v151, v151, v44
    v_mul_f32 v156, v156, v44
    v_mul_f32 v157, v157, v44
    v_mul_f32 v158, v158, v44
    v_mul_f32 v159, v159, v44
    v_mul_f32 v164, v164, v44
    v_mul_f32 v165, v165, v44
    v_mul_f32 v166, v166, v44
    v_mul_f32 v167, v167, v44
    v_mul_f32 v172, v172, v44
    v_mul_f32 v173, v173, v44
    v_mul_f32 v174, v174, v44
    v_mul_f32 v175, v175, v44
    v_mul_f32 v180, v180, v44
    v_mul_f32 v181, v181, v44
    v_mul_f32 v182, v182, v44
    v_mul_f32 v183, v183, v44
    v_mul_f32 v188, v188, v44
    v_mul_f32 v189, v189, v44
    v_mul_f32 v190, v190, v44
    v_mul_f32 v191, v191, v44
    v_sub_f32 v100, v100, v14
    v_sub_f32 v101, v101, v14
    v_sub_f32 v102, v102, v14
    v_sub_f32 v103, v103, v14
    v_sub_f32 v108, v108, v14
    v_sub_f32 v109, v109, v14
    v_sub_f32 v110, v110, v14
    v_sub_f32 v111, v111, v14
    v_sub_f32 v84, v84, v14
    v_sub_f32 v85, v85, v14
    v_sub_f32 v86, v86, v14
    v_sub_f32 v87, v87, v14
    v_sub_f32 v92, v92, v14
    v_sub_f32 v93, v93, v14
    v_sub_f32 v94, v94, v14
    v_sub_f32 v95, v95, v14
    v_sub_f32 v40, v40, v15
    v_sub_f32 v41, v41, v15
    v_sub_f32 v42, v42, v15
    v_sub_f32 v43, v43, v15
    v_mul_f32 v13, v13, v45
    v_mul_f32 v136, v136, v45
    v_mul_f32 v137, v137, v45
    v_mul_f32 v138, v138, v45
    v_mul_f32 v139, v139, v45
    v_mul_f32 v144, v144, v45
    v_mul_f32 v145, v145, v45
    v_mul_f32 v146, v146, v45
    v_mul_f32 v147, v147, v45
    v_mul_f32 v152, v152, v45
    v_mul_f32 v153, v153, v45
    v_mul_f32 v154, v154, v45
    v_mul_f32 v155, v155, v45
    v_mul_f32 v160, v160, v45
    v_mul_f32 v161, v161, v45
    v_mul_f32 v162, v162, v45
    v_mul_f32 v163, v163, v45
    v_mul_f32 v168, v168, v45
    v_mul_f32 v169, v169, v45
    v_mul_f32 v170, v170, v45
    v_mul_f32 v171, v171, v45
    v_mul_f32 v176, v176, v45
    v_mul_f32 v177, v177, v45
    v_mul_f32 v178, v178, v45
    v_mul_f32 v179, v179, v45
    v_mul_f32 v184, v184, v45
    v_mul_f32 v185, v185, v45
    v_mul_f32 v186, v186, v45
    v_mul_f32 v187, v187, v45
    v_mul_f32 v192, v192, v45
    v_mul_f32 v193, v193, v45
    v_mul_f32 v194, v194, v45
    v_mul_f32 v195, v195, v45
    v_sub_f32 v104, v104, v15
    v_sub_f32 v105, v105, v15
    v_sub_f32 v106, v106, v15
    v_sub_f32 v107, v107, v15
    v_sub_f32 v112, v112, v15
    v_sub_f32 v113, v113, v15
    v_sub_f32 v114, v114, v15
    v_sub_f32 v115, v115, v15
    v_sub_f32 v88, v88, v15
    v_sub_f32 v89, v89, v15
    v_sub_f32 v90, v90, v15
    v_sub_f32 v91, v91, v15
    v_sub_f32 v96, v96, v15
    v_sub_f32 v97, v97, v15
    v_sub_f32 v98, v98, v15
    v_sub_f32 v99, v99, v15
    v_exp_f32 v44, v84
    v_exp_f32 v45, v85
    v_exp_f32 v46, v86
    v_exp_f32 v47, v87
    v_add_f32 v14, v44, v45
    v_cvt_pk_bf16_f32 v116, v44, v45
    v_exp_f32 v48, v92
    v_exp_f32 v49, v93
    v_add_f32 v32, v46, v47
    v_add_f32 v14, v14, v32
    v_cvt_pk_bf16_f32 v117, v46, v47
    v_exp_f32 v50, v94
    v_exp_f32 v51, v95
    v_add_f32 v32, v48, v49
    v_add_f32 v14, v14, v32
    v_cvt_pk_bf16_f32 v118, v48, v49
    v_exp_f32 v44, v88
    v_exp_f32 v45, v89
    v_add_f32 v32, v50, v51
    v_add_f32 v14, v14, v32
    v_cvt_pk_bf16_f32 v119, v50, v51
    v_exp_f32 v46, v90
    v_exp_f32 v47, v91
    v_add_f32 v15, v44, v45
    v_cvt_pk_bf16_f32 v120, v44, v45
    v_exp_f32 v48, v96
    v_exp_f32 v49, v97
    v_add_f32 v32, v46, v47
    v_add_f32 v15, v15, v32
    v_cvt_pk_bf16_f32 v121, v46, v47
    v_exp_f32 v50, v98
    v_exp_f32 v51, v99
    v_add_f32 v32, v48, v49
    v_add_f32 v15, v15, v32
    v_cvt_pk_bf16_f32 v122, v48, v49
    v_add_f32 v32, v50, v51
    v_add_f32 v15, v15, v32
    v_cvt_pk_bf16_f32 v123, v50, v51
    s_nop 3
    s_branch L_attn_back14
L_attn_cold15:
    s_nop 15
    v_max3_f32 v124, v100, v101, v102
    v_max3_f32 v44, v103, v108, v109
    v_max3_f32 v124, v124, v110, v111
    v_max_f32 v124, v124, v44
    v_max3_f32 v125, v104, v105, v106
    v_max3_f32 v45, v107, v112, v113
    v_max3_f32 v125, v125, v114, v115
    v_max_f32 v125, v125, v45
    v_mov_b32 v44, v124
    v_mov_b32 v45, v125
    s_nop 0
    v_permlane16_swap_b32 v124, v44
    v_permlane16_swap_b32 v125, v45
    v_max_f32 v124, v124, v44
    v_max_f32 v125, v125, v45
    v_mov_b32 v44, v124
    v_mov_b32 v45, v125
    s_nop 0
    v_permlane32_swap_b32 v124, v44
    v_permlane32_swap_b32 v125, v45
    v_max_f32 v124, v124, v44
    v_max_f32 v125, v125, v45
    v_max_f32 v14, 0, v124
    v_max_f32 v15, 0, v125
    v_sub_f32 v44, 0, v14
    v_exp_f32 v44, v44
    v_sub_f32 v45, 0, v15
    v_exp_f32 v45, v45
    v_sub_f32 v36, v36, v14
    v_sub_f32 v37, v37, v14
    v_sub_f32 v38, v38, v14
    v_sub_f32 v39, v39, v14
    v_mul_f32 v12, v12, v44
    v_mul_f32 v132, v132, v44
    v_mul_f32 v133, v133, v44
    v_mul_f32 v134, v134, v44
    v_mul_f32 v135, v135, v44
    v_mul_f32 v140, v140, v44
    v_mul_f32 v141, v141, v44
    v_mul_f32 v142, v142, v44
    v_mul_f32 v143, v143, v44
    v_mul_f32 v148, v148, v44
    v_mul_f32 v149, v149, v44
    v_mul_f32 v150, v150, v44
    v_mul_f32 v151, v151, v44
    v_mul_f32 v156, v156, v44
    v_mul_f32 v157, v157, v44
    v_mul_f32 v158, v158, v44
    v_mul_f32 v159, v159, v44
    v_mul_f32 v164, v164, v44
    v_mul_f32 v165, v165, v44
    v_mul_f32 v166, v166, v44
    v_mul_f32 v167, v167, v44
    v_mul_f32 v172, v172, v44
    v_mul_f32 v173, v173, v44
    v_mul_f32 v174, v174, v44
    v_mul_f32 v175, v175, v44
    v_mul_f32 v180, v180, v44
    v_mul_f32 v181, v181, v44
    v_mul_f32 v182, v182, v44
    v_mul_f32 v183, v183, v44
    v_mul_f32 v188, v188, v44
    v_mul_f32 v189, v189, v44
    v_mul_f32 v190, v190, v44
    v_mul_f32 v191, v191, v44
    v_sub_f32 v100, v100, v14
    v_sub_f32 v101, v101, v14
    v_sub_f32 v102, v102, v14
    v_sub_f32 v103, v103, v14
    v_sub_f32 v108, v108, v14
    v_sub_f32 v109, v109, v14
    v_sub_f32 v110, v110, v14
    v_sub_f32 v111, v111, v14
    v_sub_f32 v40, v40, v15
    v_sub_f32 v41, v41, v15
    v_sub_f32 v42, v42, v15
    v_sub_f32 v43, v43, v15
    v_mul_f32 v13, v13, v45
    v_mul_f32 v136, v136, v45
    v_mul_f32 v137, v137, v45
    v_mul_f32 v138, v138, v45
    v_mul_f32 v139, v139, v45
    v_mul_f32 v144, v144, v45
    v_mul_f32 v145, v145, v45
    v_mul_f32 v146, v146, v45
    v_mul_f32 v147, v147, v45
    v_mul_f32 v152, v152, v45
    v_mul_f32 v153, v153, v45
    v_mul_f32 v154, v154, v45
    v_mul_f32 v155, v155, v45
    v_mul_f32 v160, v160, v45
    v_mul_f32 v161, v161, v45
    v_mul_f32 v162, v162, v45
    v_mul_f32 v163, v163, v45
    v_mul_f32 v168, v168, v45
    v_mul_f32 v169, v169, v45
    v_mul_f32 v170, v170, v45
    v_mul_f32 v171, v171, v45
    v_mul_f32 v176, v176, v45
    v_mul_f32 v177, v177, v45
    v_mul_f32 v178, v178, v45
    v_mul_f32 v179, v179, v45
    v_mul_f32 v184, v184, v45
    v_mul_f32 v185, v185, v45
    v_mul_f32 v186, v186, v45
    v_mul_f32 v187, v187, v45
    v_mul_f32 v192, v192, v45
    v_mul_f32 v193, v193, v45
    v_mul_f32 v194, v194, v45
    v_mul_f32 v195, v195, v45
    v_sub_f32 v104, v104, v15
    v_sub_f32 v105, v105, v15
    v_sub_f32 v106, v106, v15
    v_sub_f32 v107, v107, v15
    v_sub_f32 v112, v112, v15
    v_sub_f32 v113, v113, v15
    v_sub_f32 v114, v114, v15
    v_sub_f32 v115, v115, v15
    v_exp_f32 v44, v100
    v_exp_f32 v45, v101
    v_exp_f32 v46, v102
    v_exp_f32 v47, v103
    v_add_f32 v14, v44, v45
    v_cvt_pk_bf16_f32 v124, v44, v45
    v_exp_f32 v48, v108
    v_exp_f32 v49, v109
    v_add_f32 v32, v46, v47
    v_add_f32 v14, v14, v32
    v_cvt_pk_bf16_f32 v125, v46, v47
    v_exp_f32 v50, v110
    v_exp_f32 v51, v111
    v_add_f32 v32, v48, v49
    v_add_f32 v14, v14, v32
    v_cvt_pk_bf16_f32 v126, v48, v49
    v_exp_f32 v44, v104
    v_exp_f32 v45, v105
    v_add_f32 v32, v50, v51
    v_add_f32 v14, v14, v32
    v_cvt_pk_bf16_f32 v127, v50, v51
    v_exp_f32 v46, v106
    v_exp_f32 v47, v107
    v_add_f32 v15, v44, v45
    v_cvt_pk_bf16_f32 v128, v44, v45
    v_exp_f32 v48, v112
    v_exp_f32 v49, v113
    v_add_f32 v32, v46, v47
    v_add_f32 v15, v15, v32
    v_cvt_pk_bf16_f32 v129, v46, v47
    v_exp_f32 v50, v114
    v_exp_f32 v51, v115
    v_add_f32 v32, v48, v49
    v_add_f32 v15, v15, v32
    v_cvt_pk_bf16_f32 v130, v48, v49
    v_add_f32 v32, v50, v51
    v_add_f32 v15, v15, v32
    v_cvt_pk_bf16_f32 v131, v50, v51
    s_nop 3
    s_branch L_attn_back15
L_adaLN_cond__sliding_block_cached__swiglu_ffn__prompt_kernel_53:
    s_add_u32 s4, s94, 0x380000
    s_addc_u32 s5, s95, 0
    s_mov_b32 s6, 0x80000
    s_mov_b32 s7, 0x20000
    s_mov_b32 s3, 60000
L_adaLN_cond__sliding_block_cached__swiglu_ffn__prompt_kernel_55:
    buffer_load_dword v3, v2, s[4:7], 0 offen sc1
    s_waitcnt vmcnt(0)
    v_cmp_ne_u32 vcc, s98, v3
    s_cbranch_vccz L_adaLN_cond__sliding_block_cached__swiglu_ffn__prompt_kernel_54
    s_sleep 1
    s_sub_u32 s3, s3, 1
    s_cmp_lg_u32 s3, 0
    s_cbranch_scc1 L_adaLN_cond__sliding_block_cached__swiglu_ffn__prompt_kernel_55
L_adaLN_cond__sliding_block_cached__swiglu_ffn__prompt_kernel_54:
    s_branch L_adaLN_cond__sliding_block_cached__swiglu_ffn__prompt_kernel_52

.section .rodata,"a"
.p2align 6
.amdhsa_kernel adaLN_cond__sliding_block_cached__swiglu_ffn__prompt_kernel
  .amdhsa_next_free_vgpr 256
  .amdhsa_next_free_sgpr 102
  .amdhsa_accum_offset 256
  .amdhsa_group_segment_fixed_size 0
  .amdhsa_kernarg_size 112
  .amdhsa_user_sgpr_count 2
  .amdhsa_user_sgpr_kernarg_segment_ptr 1
  .amdhsa_system_sgpr_workgroup_id_x 1
  .amdhsa_float_denorm_mode_32 3
.end_amdhsa_kernel
```
